```python
import torch

def _softmax(x, axis=-1):
    return torch.softmax(x, dim=axis)

def _gelu(x):
    return torch.nn.functional.gelu(x, approximate='tanh')

def _silu(x):
    return torch.nn.functional.silu(x)

def _sigmoid(x):
    return torch.sigmoid(x)

def _layernorm(x, axis=-1, eps=1e-05):
    m = x.mean(dim=axis, keepdim=True)
    v = x.var(dim=axis, keepdim=True, unbiased=False)
    return (x - m) / torch.sqrt(v + eps)

def _scatter_add(tgt, idx, src, axis=0):
    return tgt.clone().index_add_(axis, idx, src)

def _segment_sum(src, seg, n):
    out = torch.zeros((n,) + src.shape[1:], dtype=src.dtype)
    return out.index_add_(0, seg, src)

def _pad(x, pw):
    flat = tuple((v for pair in reversed(pw) for v in pair))
    return torch.nn.functional.pad(x, flat)
kernel_name = 'adaLN_cond__mha_block_cached__swiglu_ffn__prompt'

def setup_inputs():

    _w = lambda a: (lambda t: t.to(torch.bfloat16) if t.is_floating_point() else t)(torch.as_tensor(a))

    def _A_setup():
        B, Sq, D = (1, 2048, 512)
        H, Sk, Dh = (32, 2048, 128)
        return {'x': _w((lambda *s: torch.randn(*s, dtype=torch.bfloat16) * 0.1)(B, Sq, D)), 'k_cache': _w((lambda *s: torch.randn(*s, dtype=torch.bfloat16) * 0.8)(B, H, Sk, Dh)), 'v_cache': _w((lambda *s: torch.randn(*s, dtype=torch.bfloat16) * 1.6)(B, H, Sk, Dh)), 'wq': _w((lambda *s: torch.randn(*s, dtype=torch.bfloat16) * 0.8)(D, H * Dh) * D ** (-0.5)), 'wo': _w((lambda *s: torch.randn(*s, dtype=torch.bfloat16) * 1.6)(H * Dh, D) * (H * Dh) ** (-0.5))}
    _A_in = _A_setup()

    def _B_setup():
        B, S, D, F = (1, 2048, 512, 1792)
        return {'x': _w((lambda *s: torch.randn(*s, dtype=torch.bfloat16) * 0.1)(B, S, D)), 'w_gate': _w((lambda *s: torch.randn(*s, dtype=torch.bfloat16) * 0.1)(D, F)), 'w_up': _w((lambda *s: torch.randn(*s, dtype=torch.bfloat16) * 0.1)(D, F)), 'w_down': _w((lambda *s: torch.randn(*s, dtype=torch.bfloat16) * 0.1)(F, D))}
    _B_in = _B_setup()
    return {'A_x': _A_in['x'], 'A_k_cache': _A_in['k_cache'], 'A_v_cache': _A_in['v_cache'], 'A_wq': _A_in['wq'], 'A_wo': _A_in['wo'], 'B_x': _B_in['x'], 'B_w_gate': _B_in['w_gate'], 'B_w_up': _B_in['w_up'], 'B_w_down': _B_in['w_down'], 'c': _w((lambda *s: torch.randn(*s, dtype=torch.bfloat16) * 0.8)(1, 512) * 8.0), 'w_mod': _w((lambda *s: torch.randn(*s, dtype=torch.bfloat16) * 0.8)(512, 6 * 512) * 512 ** (-0.5) * 8.0)}

def reference(A_x, A_k_cache, A_v_cache, A_wq, A_wo, B_x, B_w_gate, B_w_up, B_w_down, c, w_mod):

    def _A_ref(x, k_cache, v_cache, wq, wo):
        B, Sq, D = x.shape
        H, Dh = (32, 128)
        q = (lambda x, *d: x.permute(*d))((x @ wq).reshape(B, Sq, H, Dh), 0, 2, 1, 3)
        scores = torch.einsum('bhqd,bhkd->bhqk', q, k_cache) * Dh ** (-0.5)
        p = _softmax(scores, axis=-1)
        o = torch.einsum('bhqk,bhkd->bhqd', p, v_cache)
        return (lambda x, *d: x.permute(*d))(o, 0, 2, 1, 3).reshape(B, Sq, H * Dh) @ wo

    def _B_ref(x, w_gate, w_up, w_down):
        g = _silu(x @ w_gate)
        u = x @ w_up
        return g * u @ w_down
    x = A_x
    mod = (_silu(c) @ w_mod).reshape(c.shape[0], 6, 1, -1)
    sa, ca, ga, sb, cb, gb = (mod[:, 0].clone(), mod[:, 1].clone(), mod[:, 2].clone(), mod[:, 3].clone(), mod[:, 4].clone(), mod[:, 5].clone())
    h = _layernorm(x, axis=-1) * (1 + ca) + sa
    x = x + ga * _A_ref(h, A_k_cache, A_v_cache, A_wq, A_wo)
    h = _layernorm(x, axis=-1) * (1 + cb) + sb
    x = x + gb * _B_ref(h, B_w_gate, B_w_up, B_w_down)
    return x
```

```asm
; @launch grid=(256,1,1) block=(256,1,1) lds=147456
.amdgcn_target "amdgcn-amd-amdhsa--gfx950"
.text
.globl adaLN_cond__mha_block_cached__swiglu_ffn__prompt_kernel
.p2align 8
.type adaLN_cond__mha_block_cached__swiglu_ffn__prompt_kernel,@function
adaLN_cond__mha_block_cached__swiglu_ffn__prompt_kernel:

  s_cmp_ge_u32 s2, 256
  s_cbranch_scc1 K_END
  v_mov_b32 v255, v0
  v_lshrrev_b32 v1, 6, v0
  v_and_b32 v245, 63, v0
  s_nop 0
  v_readfirstlane_b32 s3, v1
  v_lshlrev_b32 v3, 4, v245
  s_getpc_b64 s[92:93]
PC_REF:
  s_lshr_b32 s94, s2, 3
  s_lshl_b32 s94, s94, 2
  s_add_u32 s94, s94, s3
  s_lshl_b32 s94, s94, 10
  s_cmp_ge_u32 s94, 12288
  s_cbranch_scc1 NO_CPF
  v_add_u32 v164, s94, v3
  global_load_dwordx4 v[168:171], v164, s[92:93]
NO_CPF:
  s_load_dwordx2 s[4:5], s[0:1], 104
  s_load_dwordx2 s[6:7], s[0:1], 72
  s_load_dwordx2 s[8:9], s[0:1], 80
  s_load_dwordx2 s[10:11], s[0:1], 0
  s_load_dwordx2 s[74:75], s[0:1], 24
  s_load_dwordx2 s[76:77], s[0:1], 96
  s_load_dwordx2 s[78:79], s[0:1], 8
  s_load_dwordx2 s[90:91], s[0:1], 16
  s_and_b32 s36, s2, 31
  s_lshr_b32 s37, s2, 5
  v_and_b32 v4, 3, v255
  v_lshlrev_b32 v4, 4, v4
  v_lshrrev_b32 v5, 2, v255
  v_mul_u32_u24 v6, 49152, v5
  v_add_u32 v6, v6, v4
  v_lshlrev_b32 v7, 4, v5
  s_and_b32 s82, s36, 7
  s_lshl_b32 s82, s82, 2
  s_lshr_b32 s83, s36, 3
  s_add_u32 s82, s82, s83
  s_and_b32 s83, s2, 7
  s_lshl_b32 s83, s83, 5
  s_lshr_b32 s85, s2, 3
  s_add_u32 s83, s83, s85
  s_lshl_b32 s84, s82, 6
  v_mul_u32_u24 v67, 6144, v255
  s_lshl_b32 s87, s83, 4
  s_add_u32 s87, s87, 2048
  v_lshlrev_b32 v68, 1, v255
  s_lshl_b32 s80, s2, 3
  s_lshl_b32 s81, s3, 1
  s_add_u32 s80, s80, s81
  s_lshl_b32 s80, s80, 10
  s_waitcnt lgkmcnt(0)
  s_add_u32 s60, s4, 3145728
  s_addc_u32 s61, s5, 0
  s_mov_b32 s62, 28672
  s_mov_b32 s63, 0x00020000
  s_mov_b32 s64, s76
  s_mov_b32 s65, s77
  s_mov_b32 s66, 256
  s_mov_b32 s67, 0x00020000
  s_cmp_lg_u32 s2, 0
  s_cbranch_scc1 F_NOZ
  v_mov_b32 v72, 0
  v_mov_b32 v73, 0
  v_mov_b32 v74, 0
  v_mov_b32 v75, 0
  v_lshlrev_b32 v76, 4, v255
  s_mov_b32 s43, 0
  buffer_store_dwordx4 v[72:75], v76, s[60:63], s43 offen sc1
  s_mov_b32 s43, 4096
  buffer_store_dwordx4 v[72:75], v76, s[60:63], s43 offen sc1
  s_mov_b32 s43, 8192
  buffer_store_dwordx4 v[72:75], v76, s[60:63], s43 offen sc1
  s_mov_b32 s43, 12288
  buffer_store_dwordx4 v[72:75], v76, s[60:63], s43 offen sc1
  s_mov_b32 s43, 16384
  buffer_store_dwordx4 v[72:75], v76, s[60:63], s43 offen sc1
  s_mov_b32 s43, 20480
  buffer_store_dwordx4 v[72:75], v76, s[60:63], s43 offen sc1
  s_mov_b32 s43, 24576
  buffer_store_dwordx4 v[72:75], v76, s[60:63], s43 offen sc1
F_NOZ:
  s_mov_b32 s12, s6
  s_mov_b32 s13, s7
  s_mov_b32 s14, 1024
  s_mov_b32 s15, 0x00020000
  s_mov_b32 s16, s8
  s_mov_b32 s17, s9
  s_mov_b32 s18, 3145728
  s_mov_b32 s19, 0x00020000
  s_mov_b32 s28, s10
  s_mov_b32 s29, s11
  s_mov_b32 s30, 2097152
  s_mov_b32 s31, 0x00020000
  buffer_load_dwordx4 v[16:19], v7, s[12:15], 0 offen
  s_add_u32 s86, s84, 0
  buffer_load_dwordx4 v[20:23], v6, s[16:19], s86 offen
  s_add_u32 s86, s84, 6144
  buffer_load_dwordx4 v[24:27], v6, s[16:19], s86 offen
  s_add_u32 s86, s84, 12288
  buffer_load_dwordx4 v[28:31], v6, s[16:19], s86 offen
  s_add_u32 s86, s84, 18432
  buffer_load_dwordx4 v[32:35], v6, s[16:19], s86 offen
  s_add_u32 s86, s84, 24576
  buffer_load_dwordx4 v[36:39], v6, s[16:19], s86 offen
  s_add_u32 s86, s84, 30720
  buffer_load_dwordx4 v[40:43], v6, s[16:19], s86 offen
  s_add_u32 s86, s84, 36864
  buffer_load_dwordx4 v[44:47], v6, s[16:19], s86 offen
  s_add_u32 s86, s84, 43008
  buffer_load_dwordx4 v[48:51], v6, s[16:19], s86 offen
  s_cmp_lg_u32 s2, 0
  s_cbranch_scc1 F_NOZ2
  s_waitcnt vmcnt(9)
  s_barrier
  s_cmp_lg_u32 s3, 0
  s_cbranch_scc1 F_NOZ2
  s_mov_b64 exec, 1
  v_mov_b32 v72, 1
  v_mov_b32 v73, 0
  buffer_store_dword v72, v73, s[64:67], 0 offen sc1
  s_mov_b64 exec, -1
F_NOZ2:
  s_add_u32 s24, s4, 65536
  s_addc_u32 s25, s5, 0
  s_mov_b32 s26, 2097152
  s_mov_b32 s27, 0x00020000
  s_mov_b32 s20, s74
  s_mov_b32 s21, s75
  s_mov_b32 s22, 4194304
  s_mov_b32 s23, 0x00020000
  s_mov_b32 s32, s4
  s_mov_b32 s33, s5
  s_mov_b32 s34, 2236416
  s_mov_b32 s35, 0x00020000
  s_waitcnt vmcnt(8)
  v_lshlrev_b32 v100, 16, v16
  v_and_b32 v101, 0xffff0000, v16
  v_lshlrev_b32 v102, 16, v17
  v_and_b32 v103, 0xffff0000, v17
  v_lshlrev_b32 v104, 16, v18
  v_and_b32 v105, 0xffff0000, v18
  v_lshlrev_b32 v106, 16, v19
  v_and_b32 v107, 0xffff0000, v19
  v_mul_f32 v124, 3216550459, v100
  v_mul_f32 v125, 3216550459, v101
  v_mul_f32 v126, 3216550459, v102
  v_mul_f32 v127, 3216550459, v103
  v_mul_f32 v128, 3216550459, v104
  v_mul_f32 v129, 3216550459, v105
  v_mul_f32 v130, 3216550459, v106
  v_mul_f32 v131, 3216550459, v107
  v_exp_f32 v124, v124
  v_exp_f32 v125, v125
  v_exp_f32 v126, v126
  v_exp_f32 v127, v127
  v_exp_f32 v128, v128
  v_exp_f32 v129, v129
  v_exp_f32 v130, v130
  v_exp_f32 v131, v131
  s_nop 0
  v_add_f32 v124, 1.0, v124
  v_add_f32 v125, 1.0, v125
  v_add_f32 v126, 1.0, v126
  v_add_f32 v127, 1.0, v127
  v_add_f32 v128, 1.0, v128
  v_add_f32 v129, 1.0, v129
  v_add_f32 v130, 1.0, v130
  v_add_f32 v131, 1.0, v131
  v_rcp_f32 v124, v124
  v_rcp_f32 v125, v125
  v_rcp_f32 v126, v126
  v_rcp_f32 v127, v127
  v_rcp_f32 v128, v128
  v_rcp_f32 v129, v129
  v_rcp_f32 v130, v130
  v_rcp_f32 v131, v131
  s_nop 0
  v_mul_f32 v100, v100, v124
  v_mul_f32 v101, v101, v125
  v_mul_f32 v102, v102, v126
  v_mul_f32 v103, v103, v127
  v_mul_f32 v104, v104, v128
  v_mul_f32 v105, v105, v129
  v_mul_f32 v106, v106, v130
  v_mul_f32 v107, v107, v131
  v_cvt_pk_bf16_f32 v132, v100, v100
  v_and_b32 v100, 0xffff0000, v132
  v_cvt_pk_bf16_f32 v132, v101, v101
  v_and_b32 v101, 0xffff0000, v132
  v_cvt_pk_bf16_f32 v132, v102, v102
  v_and_b32 v102, 0xffff0000, v132
  v_cvt_pk_bf16_f32 v132, v103, v103
  v_and_b32 v103, 0xffff0000, v132
  v_cvt_pk_bf16_f32 v132, v104, v104
  v_and_b32 v104, 0xffff0000, v132
  v_cvt_pk_bf16_f32 v132, v105, v105
  v_and_b32 v105, 0xffff0000, v132
  v_cvt_pk_bf16_f32 v132, v106, v106
  v_and_b32 v106, 0xffff0000, v132
  v_cvt_pk_bf16_f32 v132, v107, v107
  v_and_b32 v107, 0xffff0000, v132
  s_waitcnt vmcnt(0)
  v_lshlrev_b32 v108, 16, v20
  v_and_b32 v109, 0xffff0000, v20
  v_pk_mul_f32 v[110:111], v[108:109], v[100:101] op_sel_hi:[1,0]
  v_lshlrev_b32 v118, 16, v21
  v_and_b32 v119, 0xffff0000, v21
  v_pk_mul_f32 v[112:113], v[118:119], v[100:101] op_sel_hi:[1,0]
  v_lshlrev_b32 v108, 16, v22
  v_and_b32 v109, 0xffff0000, v22
  v_pk_mul_f32 v[114:115], v[108:109], v[100:101] op_sel_hi:[1,0]
  v_lshlrev_b32 v118, 16, v23
  v_and_b32 v119, 0xffff0000, v23
  v_pk_mul_f32 v[116:117], v[118:119], v[100:101] op_sel_hi:[1,0]
  v_lshlrev_b32 v108, 16, v24
  v_and_b32 v109, 0xffff0000, v24
  v_pk_fma_f32 v[110:111], v[108:109], v[100:101], v[110:111] op_sel:[0,1,0] op_sel_hi:[1,1,1]
  v_lshlrev_b32 v118, 16, v25
  v_and_b32 v119, 0xffff0000, v25
  v_pk_fma_f32 v[112:113], v[118:119], v[100:101], v[112:113] op_sel:[0,1,0] op_sel_hi:[1,1,1]
  v_lshlrev_b32 v108, 16, v26
  v_and_b32 v109, 0xffff0000, v26
  v_pk_fma_f32 v[114:115], v[108:109], v[100:101], v[114:115] op_sel:[0,1,0] op_sel_hi:[1,1,1]
  v_lshlrev_b32 v118, 16, v27
  v_and_b32 v119, 0xffff0000, v27
  v_pk_fma_f32 v[116:117], v[118:119], v[100:101], v[116:117] op_sel:[0,1,0] op_sel_hi:[1,1,1]
  v_lshlrev_b32 v108, 16, v28
  v_and_b32 v109, 0xffff0000, v28
  v_pk_fma_f32 v[110:111], v[108:109], v[102:103], v[110:111] op_sel_hi:[1,0,1]
  v_lshlrev_b32 v118, 16, v29
  v_and_b32 v119, 0xffff0000, v29
  v_pk_fma_f32 v[112:113], v[118:119], v[102:103], v[112:113] op_sel_hi:[1,0,1]
  v_lshlrev_b32 v108, 16, v30
  v_and_b32 v109, 0xffff0000, v30
  v_pk_fma_f32 v[114:115], v[108:109], v[102:103], v[114:115] op_sel_hi:[1,0,1]
  v_lshlrev_b32 v118, 16, v31
  v_and_b32 v119, 0xffff0000, v31
  v_pk_fma_f32 v[116:117], v[118:119], v[102:103], v[116:117] op_sel_hi:[1,0,1]
  v_lshlrev_b32 v108, 16, v32
  v_and_b32 v109, 0xffff0000, v32
  v_pk_fma_f32 v[110:111], v[108:109], v[102:103], v[110:111] op_sel:[0,1,0] op_sel_hi:[1,1,1]
  v_lshlrev_b32 v118, 16, v33
  v_and_b32 v119, 0xffff0000, v33
  v_pk_fma_f32 v[112:113], v[118:119], v[102:103], v[112:113] op_sel:[0,1,0] op_sel_hi:[1,1,1]
  v_lshlrev_b32 v108, 16, v34
  v_and_b32 v109, 0xffff0000, v34
  v_pk_fma_f32 v[114:115], v[108:109], v[102:103], v[114:115] op_sel:[0,1,0] op_sel_hi:[1,1,1]
  v_lshlrev_b32 v118, 16, v35
  v_and_b32 v119, 0xffff0000, v35
  v_pk_fma_f32 v[116:117], v[118:119], v[102:103], v[116:117] op_sel:[0,1,0] op_sel_hi:[1,1,1]
  v_lshlrev_b32 v108, 16, v36
  v_and_b32 v109, 0xffff0000, v36
  v_pk_fma_f32 v[110:111], v[108:109], v[104:105], v[110:111] op_sel_hi:[1,0,1]
  v_lshlrev_b32 v118, 16, v37
  v_and_b32 v119, 0xffff0000, v37
  v_pk_fma_f32 v[112:113], v[118:119], v[104:105], v[112:113] op_sel_hi:[1,0,1]
  v_lshlrev_b32 v108, 16, v38
  v_and_b32 v109, 0xffff0000, v38
  v_pk_fma_f32 v[114:115], v[108:109], v[104:105], v[114:115] op_sel_hi:[1,0,1]
  v_lshlrev_b32 v118, 16, v39
  v_and_b32 v119, 0xffff0000, v39
  v_pk_fma_f32 v[116:117], v[118:119], v[104:105], v[116:117] op_sel_hi:[1,0,1]
  v_lshlrev_b32 v108, 16, v40
  v_and_b32 v109, 0xffff0000, v40
  v_pk_fma_f32 v[110:111], v[108:109], v[104:105], v[110:111] op_sel:[0,1,0] op_sel_hi:[1,1,1]
  v_lshlrev_b32 v118, 16, v41
  v_and_b32 v119, 0xffff0000, v41
  v_pk_fma_f32 v[112:113], v[118:119], v[104:105], v[112:113] op_sel:[0,1,0] op_sel_hi:[1,1,1]
  v_lshlrev_b32 v108, 16, v42
  v_and_b32 v109, 0xffff0000, v42
  v_pk_fma_f32 v[114:115], v[108:109], v[104:105], v[114:115] op_sel:[0,1,0] op_sel_hi:[1,1,1]
  v_lshlrev_b32 v118, 16, v43
  v_and_b32 v119, 0xffff0000, v43
  v_pk_fma_f32 v[116:117], v[118:119], v[104:105], v[116:117] op_sel:[0,1,0] op_sel_hi:[1,1,1]
  v_lshlrev_b32 v108, 16, v44
  v_and_b32 v109, 0xffff0000, v44
  v_pk_fma_f32 v[110:111], v[108:109], v[106:107], v[110:111] op_sel_hi:[1,0,1]
  v_lshlrev_b32 v118, 16, v45
  v_and_b32 v119, 0xffff0000, v45
  v_pk_fma_f32 v[112:113], v[118:119], v[106:107], v[112:113] op_sel_hi:[1,0,1]
  v_lshlrev_b32 v108, 16, v46
  v_and_b32 v109, 0xffff0000, v46
  v_pk_fma_f32 v[114:115], v[108:109], v[106:107], v[114:115] op_sel_hi:[1,0,1]
  v_lshlrev_b32 v118, 16, v47
  v_and_b32 v119, 0xffff0000, v47
  v_pk_fma_f32 v[116:117], v[118:119], v[106:107], v[116:117] op_sel_hi:[1,0,1]
  v_lshlrev_b32 v108, 16, v48
  v_and_b32 v109, 0xffff0000, v48
  v_pk_fma_f32 v[110:111], v[108:109], v[106:107], v[110:111] op_sel:[0,1,0] op_sel_hi:[1,1,1]
  v_lshlrev_b32 v118, 16, v49
  v_and_b32 v119, 0xffff0000, v49
  v_pk_fma_f32 v[112:113], v[118:119], v[106:107], v[112:113] op_sel:[0,1,0] op_sel_hi:[1,1,1]
  v_lshlrev_b32 v108, 16, v50
  v_and_b32 v109, 0xffff0000, v50
  v_pk_fma_f32 v[114:115], v[108:109], v[106:107], v[114:115] op_sel:[0,1,0] op_sel_hi:[1,1,1]
  v_lshlrev_b32 v118, 16, v51
  v_and_b32 v119, 0xffff0000, v51
  v_pk_fma_f32 v[116:117], v[118:119], v[106:107], v[116:117] op_sel:[0,1,0] op_sel_hi:[1,1,1]
  v_lshlrev_b32 v108, 7, v5
  v_lshlrev_b32 v109, 1, v4
  v_add_u32 v108, v108, v109
  v_add_u32 v108, 131072, v108
  ds_write_b64 v108, v[110:111] offset:0
  ds_write_b64 v108, v[112:113] offset:8
  ds_write_b64 v108, v[114:115] offset:16
  ds_write_b64 v108, v[116:117] offset:24
  s_waitcnt lgkmcnt(0)
  s_barrier
  s_cmp_lg_u32 s3, 0
  s_cbranch_scc1 F_NOT0
  v_and_b32 v70, 31, v245
  v_lshlrev_b32 v70, 2, v70
  v_lshrrev_b32 v71, 5, v245
  v_lshlrev_b32 v71, 12, v71
  v_add_u32 v71, v71, v70
  v_add_u32 v71, 131072, v71
  ds_read_b32 v20, v71 offset:0
  ds_read_b32 v21, v71 offset:128
  ds_read_b32 v22, v71 offset:256
  ds_read_b32 v23, v71 offset:384
  ds_read_b32 v24, v71 offset:512
  ds_read_b32 v25, v71 offset:640
  ds_read_b32 v26, v71 offset:768
  ds_read_b32 v27, v71 offset:896
  ds_read_b32 v28, v71 offset:1024
  ds_read_b32 v29, v71 offset:1152
  ds_read_b32 v30, v71 offset:1280
  ds_read_b32 v31, v71 offset:1408
  ds_read_b32 v32, v71 offset:1536
  ds_read_b32 v33, v71 offset:1664
  ds_read_b32 v34, v71 offset:1792
  ds_read_b32 v35, v71 offset:1920
  ds_read_b32 v36, v71 offset:2048
  ds_read_b32 v37, v71 offset:2176
  ds_read_b32 v38, v71 offset:2304
  ds_read_b32 v39, v71 offset:2432
  ds_read_b32 v40, v71 offset:2560
  ds_read_b32 v41, v71 offset:2688
  ds_read_b32 v42, v71 offset:2816
  ds_read_b32 v43, v71 offset:2944
  ds_read_b32 v44, v71 offset:3072
  ds_read_b32 v45, v71 offset:3200
  ds_read_b32 v46, v71 offset:3328
  ds_read_b32 v47, v71 offset:3456
  ds_read_b32 v48, v71 offset:3584
  ds_read_b32 v49, v71 offset:3712
  ds_read_b32 v50, v71 offset:3840
  ds_read_b32 v51, v71 offset:3968
  s_waitcnt lgkmcnt(0)
  v_add_f32 v20, v20, v36
  v_add_f32 v21, v21, v37
  v_add_f32 v22, v22, v38
  v_add_f32 v23, v23, v39
  v_add_f32 v24, v24, v40
  v_add_f32 v25, v25, v41
  v_add_f32 v26, v26, v42
  v_add_f32 v27, v27, v43
  v_add_f32 v28, v28, v44
  v_add_f32 v29, v29, v45
  v_add_f32 v30, v30, v46
  v_add_f32 v31, v31, v47
  v_add_f32 v32, v32, v48
  v_add_f32 v33, v33, v49
  v_add_f32 v34, v34, v50
  v_add_f32 v35, v35, v51
  v_add_f32 v20, v20, v28
  v_add_f32 v21, v21, v29
  v_add_f32 v22, v22, v30
  v_add_f32 v23, v23, v31
  v_add_f32 v24, v24, v32
  v_add_f32 v25, v25, v33
  v_add_f32 v26, v26, v34
  v_add_f32 v27, v27, v35
  v_add_f32 v20, v20, v24
  v_add_f32 v21, v21, v25
  v_add_f32 v22, v22, v26
  v_add_f32 v23, v23, v27
  v_add_f32 v20, v20, v22
  v_add_f32 v21, v21, v23
  v_add_f32 v20, v20, v21
  v_mov_b32 v21, v20
  s_nop 1
  v_permlane32_swap_b32 v21, v20
  s_nop 1
  v_add_f32 v20, v20, v21
  v_cvt_pk_bf16_f32 v21, v20, v20
  v_and_b32 v20, 0xffff0000, v21
  s_cmp_lt_u32 s82, 16
  s_cbranch_scc1 F_ISSA
  v_add_f32 v20, 1.0, v20
  v_cvt_pk_bf16_f32 v21, v20, v20
  v_and_b32 v20, 0xffff0000, v21
F_ISSA:
  s_lshl_b32 s44, s37, 12
  s_lshl_b32 s45, s82, 7
  s_add_u32 s44, s44, s45
  s_mov_b64 exec, 0xffffffff
  buffer_store_dword v20, v70, s[32:35], s44 offen sc1
  s_mov_b64 exec, 1
  v_mov_b32 v252, 0
  s_mov_b32 s68, 0
F_ZP:
  buffer_load_dword v251, v252, s[64:67], 0 offen sc1
  s_waitcnt vmcnt(0)
  v_readfirstlane_b32 s69, v251
  s_add_u32 s68, s68, 1
  s_cmp_lg_u32 s69, 0
  s_cbranch_scc1 F_ZD
  s_cmp_gt_u32 s68, 200000
  s_cbranch_scc1 F_ZD
  s_sleep 1
  s_branch F_ZP
F_ZD:
  s_lshl_b32 s70, s37, 8
  v_mov_b32 v251, 1
  v_mov_b32 v252, s70
  buffer_atomic_add v251, v252, s[60:63], 0 offen sc1
  s_mov_b64 exec, -1
F_NOT0:
  buffer_load_dwordx4 v[8:11], v3, s[28:31], s80 offen
  buffer_load_dwordx4 v[12:15], v3, s[28:31], s80 offen offset:1024
  buffer_load_ushort v52, v68, s[12:15], 0 offen
  buffer_load_ushort v53, v68, s[12:15], 0 offen offset:512
  s_add_u32 s86, s87, 0
  buffer_load_dwordx4 v[56:59], v67, s[16:19], s86 offen
  s_add_u32 s86, s87, 1572864
  buffer_load_dwordx4 v[60:63], v67, s[16:19], s86 offen
  s_add_u32 s94, s94, 12288
  s_cmp_ge_u32 s94, CODE_END-PC_REF-1024
  s_cbranch_scc1 NO_CPFB
  v_add_u32 v164, s94, v3
  global_load_dwordx4 v[168:171], v164, s[92:93]
NO_CPFB:
  s_waitcnt vmcnt(4)
  v_lshlrev_b32 v100, 16, v8
  v_and_b32 v101, 0xffff0000, v8
  v_lshlrev_b32 v102, 16, v9
  v_and_b32 v103, 0xffff0000, v9
  v_lshlrev_b32 v104, 16, v10
  v_and_b32 v105, 0xffff0000, v10
  v_lshlrev_b32 v106, 16, v11
  v_and_b32 v107, 0xffff0000, v11
  v_add_f32 v116, v100, v101
  v_add_f32 v116, v116, v102
  v_add_f32 v116, v116, v103
  v_add_f32 v116, v116, v104
  v_add_f32 v116, v116, v105
  v_add_f32 v116, v116, v106
  v_add_f32 v116, v116, v107
  v_lshlrev_b32 v108, 16, v12
  v_and_b32 v109, 0xffff0000, v12
  v_lshlrev_b32 v110, 16, v13
  v_and_b32 v111, 0xffff0000, v13
  v_lshlrev_b32 v112, 16, v14
  v_and_b32 v113, 0xffff0000, v14
  v_lshlrev_b32 v114, 16, v15
  v_and_b32 v115, 0xffff0000, v15
  v_add_f32 v117, v108, v109
  v_add_f32 v117, v117, v110
  v_add_f32 v117, v117, v111
  v_add_f32 v117, v117, v112
  v_add_f32 v117, v117, v113
  v_add_f32 v117, v117, v114
  v_add_f32 v117, v117, v115
  s_nop 0
  v_add_f32_dpp v116, v116, v116 row_ror:8 row_mask:0xf bank_mask:0xf
  v_add_f32_dpp v117, v117, v117 row_ror:8 row_mask:0xf bank_mask:0xf
  s_nop 0
  v_add_f32_dpp v116, v116, v116 row_ror:4 row_mask:0xf bank_mask:0xf
  v_add_f32_dpp v117, v117, v117 row_ror:4 row_mask:0xf bank_mask:0xf
  s_nop 0
  v_add_f32_dpp v116, v116, v116 row_ror:2 row_mask:0xf bank_mask:0xf
  v_add_f32_dpp v117, v117, v117 row_ror:2 row_mask:0xf bank_mask:0xf
  s_nop 0
  v_add_f32_dpp v116, v116, v116 row_ror:1 row_mask:0xf bank_mask:0xf
  v_add_f32_dpp v117, v117, v117 row_ror:1 row_mask:0xf bank_mask:0xf
  v_mov_b32 v118, v116
  v_mov_b32 v119, v117
  s_nop 1
  v_permlane16_swap_b32 v118, v116
  v_permlane16_swap_b32 v119, v117
  s_nop 1
  v_add_f32 v116, v116, v118
  v_add_f32 v117, v117, v119
  v_mov_b32 v118, v116
  v_mov_b32 v119, v117
  s_nop 1
  v_permlane32_swap_b32 v118, v116
  v_permlane32_swap_b32 v119, v117
  s_nop 1
  v_add_f32 v116, v116, v118
  v_add_f32 v117, v117, v119
  v_mul_f32 v116, 989855744, v116
  v_sub_f32 v118, v100, v116
  v_mul_f32 v120, v118, v118
  v_sub_f32 v118, v101, v116
  v_fmac_f32 v120, v118, v118
  v_sub_f32 v118, v102, v116
  v_fmac_f32 v120, v118, v118
  v_sub_f32 v118, v103, v116
  v_fmac_f32 v120, v118, v118
  v_sub_f32 v118, v104, v116
  v_fmac_f32 v120, v118, v118
  v_sub_f32 v118, v105, v116
  v_fmac_f32 v120, v118, v118
  v_sub_f32 v118, v106, v116
  v_fmac_f32 v120, v118, v118
  v_sub_f32 v118, v107, v116
  v_fmac_f32 v120, v118, v118
  v_mul_f32 v117, 989855744, v117
  v_sub_f32 v118, v108, v117
  v_mul_f32 v121, v118, v118
  v_sub_f32 v118, v109, v117
  v_fmac_f32 v121, v118, v118
  v_sub_f32 v118, v110, v117
  v_fmac_f32 v121, v118, v118
  v_sub_f32 v118, v111, v117
  v_fmac_f32 v121, v118, v118
  v_sub_f32 v118, v112, v117
  v_fmac_f32 v121, v118, v118
  v_sub_f32 v118, v113, v117
  v_fmac_f32 v121, v118, v118
  v_sub_f32 v118, v114, v117
  v_fmac_f32 v121, v118, v118
  v_sub_f32 v118, v115, v117
  v_fmac_f32 v121, v118, v118
  s_nop 0
  v_add_f32_dpp v120, v120, v120 row_ror:8 row_mask:0xf bank_mask:0xf
  v_add_f32_dpp v121, v121, v121 row_ror:8 row_mask:0xf bank_mask:0xf
  s_nop 0
  v_add_f32_dpp v120, v120, v120 row_ror:4 row_mask:0xf bank_mask:0xf
  v_add_f32_dpp v121, v121, v121 row_ror:4 row_mask:0xf bank_mask:0xf
  s_nop 0
  v_add_f32_dpp v120, v120, v120 row_ror:2 row_mask:0xf bank_mask:0xf
  v_add_f32_dpp v121, v121, v121 row_ror:2 row_mask:0xf bank_mask:0xf
  s_nop 0
  v_add_f32_dpp v120, v120, v120 row_ror:1 row_mask:0xf bank_mask:0xf
  v_add_f32_dpp v121, v121, v121 row_ror:1 row_mask:0xf bank_mask:0xf
  v_mov_b32 v118, v120
  v_mov_b32 v119, v121
  s_nop 1
  v_permlane16_swap_b32 v118, v120
  v_permlane16_swap_b32 v119, v121
  s_nop 1
  v_add_f32 v120, v120, v118
  v_add_f32 v121, v121, v119
  v_mov_b32 v118, v120
  v_mov_b32 v119, v121
  s_nop 1
  v_permlane32_swap_b32 v118, v120
  v_permlane32_swap_b32 v119, v121
  s_nop 1
  v_add_f32 v120, v120, v118
  v_add_f32 v121, v121, v119
  v_mul_f32 v120, 989855744, v120
  v_cvt_pk_bf16_f32 v118, v120, v120
  v_and_b32 v120, 0xffff0000, v118
  v_add_f32 v120, 925353388, v120
  v_cvt_pk_bf16_f32 v118, v120, v120
  v_and_b32 v120, 0xffff0000, v118
  v_sqrt_f32 v120, v120
  s_nop 0
  v_cvt_pk_bf16_f32 v118, v120, v120
  v_and_b32 v120, 0xffff0000, v118
  v_rcp_f32 v120, v120
  v_cvt_pk_bf16_f32 v118, v116, v116
  v_and_b32 v116, 0xffff0000, v118
  v_sub_f32 v118, v100, v116
  v_sub_f32 v119, v101, v116
  v_cvt_pk_bf16_f32 v122, v118, v119
  v_lshlrev_b32 v118, 16, v122
  v_and_b32 v119, 0xffff0000, v122
  v_mul_f32 v118, v118, v120
  v_mul_f32 v119, v119, v120
  v_cvt_pk_bf16_f32 v122, v118, v119
  v_lshlrev_b32 v100, 16, v122
  v_and_b32 v101, 0xffff0000, v122
  v_sub_f32 v118, v102, v116
  v_sub_f32 v119, v103, v116
  v_cvt_pk_bf16_f32 v122, v118, v119
  v_lshlrev_b32 v118, 16, v122
  v_and_b32 v119, 0xffff0000, v122
  v_mul_f32 v118, v118, v120
  v_mul_f32 v119, v119, v120
  v_cvt_pk_bf16_f32 v122, v118, v119
  v_lshlrev_b32 v102, 16, v122
  v_and_b32 v103, 0xffff0000, v122
  v_sub_f32 v118, v104, v116
  v_sub_f32 v119, v105, v116
  v_cvt_pk_bf16_f32 v122, v118, v119
  v_lshlrev_b32 v118, 16, v122
  v_and_b32 v119, 0xffff0000, v122
  v_mul_f32 v118, v118, v120
  v_mul_f32 v119, v119, v120
  v_cvt_pk_bf16_f32 v122, v118, v119
  v_lshlrev_b32 v104, 16, v122
  v_and_b32 v105, 0xffff0000, v122
  v_sub_f32 v118, v106, v116
  v_sub_f32 v119, v107, v116
  v_cvt_pk_bf16_f32 v122, v118, v119
  v_lshlrev_b32 v118, 16, v122
  v_and_b32 v119, 0xffff0000, v122
  v_mul_f32 v118, v118, v120
  v_mul_f32 v119, v119, v120
  v_cvt_pk_bf16_f32 v122, v118, v119
  v_lshlrev_b32 v106, 16, v122
  v_and_b32 v107, 0xffff0000, v122
  v_mul_f32 v121, 989855744, v121
  v_cvt_pk_bf16_f32 v118, v121, v121
  v_and_b32 v121, 0xffff0000, v118
  v_add_f32 v121, 925353388, v121
  v_cvt_pk_bf16_f32 v118, v121, v121
  v_and_b32 v121, 0xffff0000, v118
  v_sqrt_f32 v121, v121
  s_nop 0
  v_cvt_pk_bf16_f32 v118, v121, v121
  v_and_b32 v121, 0xffff0000, v118
  v_rcp_f32 v121, v121
  v_cvt_pk_bf16_f32 v118, v117, v117
  v_and_b32 v117, 0xffff0000, v118
  v_sub_f32 v118, v108, v117
  v_sub_f32 v119, v109, v117
  v_cvt_pk_bf16_f32 v122, v118, v119
  v_lshlrev_b32 v118, 16, v122
  v_and_b32 v119, 0xffff0000, v122
  v_mul_f32 v118, v118, v121
  v_mul_f32 v119, v119, v121
  v_cvt_pk_bf16_f32 v122, v118, v119
  v_lshlrev_b32 v108, 16, v122
  v_and_b32 v109, 0xffff0000, v122
  v_sub_f32 v118, v110, v117
  v_sub_f32 v119, v111, v117
  v_cvt_pk_bf16_f32 v122, v118, v119
  v_lshlrev_b32 v118, 16, v122
  v_and_b32 v119, 0xffff0000, v122
  v_mul_f32 v118, v118, v121
  v_mul_f32 v119, v119, v121
  v_cvt_pk_bf16_f32 v122, v118, v119
  v_lshlrev_b32 v110, 16, v122
  v_and_b32 v111, 0xffff0000, v122
  v_sub_f32 v118, v112, v117
  v_sub_f32 v119, v113, v117
  v_cvt_pk_bf16_f32 v122, v118, v119
  v_lshlrev_b32 v118, 16, v122
  v_and_b32 v119, 0xffff0000, v122
  v_mul_f32 v118, v118, v121
  v_mul_f32 v119, v119, v121
  v_cvt_pk_bf16_f32 v122, v118, v119
  v_lshlrev_b32 v112, 16, v122
  v_and_b32 v113, 0xffff0000, v122
  v_sub_f32 v118, v114, v117
  v_sub_f32 v119, v115, v117
  v_cvt_pk_bf16_f32 v122, v118, v119
  v_lshlrev_b32 v118, 16, v122
  v_and_b32 v119, 0xffff0000, v122
  v_mul_f32 v118, v118, v121
  v_mul_f32 v119, v119, v121
  v_cvt_pk_bf16_f32 v122, v118, v119
  v_lshlrev_b32 v114, 16, v122
  v_and_b32 v115, 0xffff0000, v122
  s_mov_b32 s20, s74
  s_mov_b32 s21, s75
  s_mov_b32 s22, 4194304
  s_mov_b32 s23, 0x00020000
  s_cmp_eq_u32 s3, 0
  s_cbranch_scc1 F_NOW
  v_lshrrev_b32 v70, 4, v245
  v_and_b32 v71, 15, v245
  v_lshlrev_b32 v72, 2, v70
  v_xor_b32 v72, v71, v72
  v_lshlrev_b32 v72, 4, v72
  v_lshlrev_b32 v222, 13, v70
  v_add_u32 v222, v222, v72
  s_sub_u32 s89, s3, 1
  s_lshl_b32 s99, s37, 4
  s_add_u32 s89, s89, s99
  s_lshl_b32 s99, s36, 8
  s_add_u32 s43, s89, 0
  s_and_b32 s43, s43, 127
  s_lshl_b32 m0, s43, 10
  s_lshl_b32 s43, s43, 15
  s_add_u32 s43, s43, s99
  buffer_load_dwordx4 v222, s[20:23], s43 offen lds
  s_add_u32 s43, s89, 3
  s_and_b32 s43, s43, 127
  s_lshl_b32 m0, s43, 10
  s_lshl_b32 s43, s43, 15
  s_add_u32 s43, s43, s99
  buffer_load_dwordx4 v222, s[20:23], s43 offen lds
  s_add_u32 s43, s89, 6
  s_and_b32 s43, s43, 127
  s_lshl_b32 m0, s43, 10
  s_lshl_b32 s43, s43, 15
  s_add_u32 s43, s43, s99
  buffer_load_dwordx4 v222, s[20:23], s43 offen lds
  s_add_u32 s43, s89, 9
  s_and_b32 s43, s43, 127
  s_lshl_b32 m0, s43, 10
  s_lshl_b32 s43, s43, 15
  s_add_u32 s43, s43, s99
  buffer_load_dwordx4 v222, s[20:23], s43 offen lds
  s_add_u32 s43, s89, 12
  s_and_b32 s43, s43, 127
  s_lshl_b32 m0, s43, 10
  s_lshl_b32 s43, s43, 15
  s_add_u32 s43, s43, s99
  buffer_load_dwordx4 v222, s[20:23], s43 offen lds
  s_add_u32 s43, s89, 15
  s_and_b32 s43, s43, 127
  s_lshl_b32 m0, s43, 10
  s_lshl_b32 s43, s43, 15
  s_add_u32 s43, s43, s99
  buffer_load_dwordx4 v222, s[20:23], s43 offen lds
  s_add_u32 s43, s89, 18
  s_and_b32 s43, s43, 127
  s_lshl_b32 m0, s43, 10
  s_lshl_b32 s43, s43, 15
  s_add_u32 s43, s43, s99
  buffer_load_dwordx4 v222, s[20:23], s43 offen lds
  s_add_u32 s43, s89, 21
  s_and_b32 s43, s43, 127
  s_lshl_b32 m0, s43, 10
  s_lshl_b32 s43, s43, 15
  s_add_u32 s43, s43, s99
  buffer_load_dwordx4 v222, s[20:23], s43 offen lds
  s_add_u32 s43, s89, 24
  s_and_b32 s43, s43, 127
  s_lshl_b32 m0, s43, 10
  s_lshl_b32 s43, s43, 15
  s_add_u32 s43, s43, s99
  buffer_load_dwordx4 v222, s[20:23], s43 offen lds
  s_add_u32 s43, s89, 27
  s_and_b32 s43, s43, 127
  s_lshl_b32 m0, s43, 10
  s_lshl_b32 s43, s43, 15
  s_add_u32 s43, s43, s99
  buffer_load_dwordx4 v222, s[20:23], s43 offen lds
  s_add_u32 s43, s89, 30
  s_and_b32 s43, s43, 127
  s_lshl_b32 m0, s43, 10
  s_lshl_b32 s43, s43, 15
  s_add_u32 s43, s43, s99
  buffer_load_dwordx4 v222, s[20:23], s43 offen lds
  s_add_u32 s43, s89, 33
  s_and_b32 s43, s43, 127
  s_lshl_b32 m0, s43, 10
  s_lshl_b32 s43, s43, 15
  s_add_u32 s43, s43, s99
  buffer_load_dwordx4 v222, s[20:23], s43 offen lds
  s_add_u32 s43, s89, 36
  s_and_b32 s43, s43, 127
  s_lshl_b32 m0, s43, 10
  s_lshl_b32 s43, s43, 15
  s_add_u32 s43, s43, s99
  buffer_load_dwordx4 v222, s[20:23], s43 offen lds
  s_add_u32 s43, s89, 39
  s_and_b32 s43, s43, 127
  s_lshl_b32 m0, s43, 10
  s_lshl_b32 s43, s43, 15
  s_add_u32 s43, s43, s99
  buffer_load_dwordx4 v222, s[20:23], s43 offen lds
  s_add_u32 s43, s89, 42
  s_and_b32 s43, s43, 127
  s_lshl_b32 m0, s43, 10
  s_lshl_b32 s43, s43, 15
  s_add_u32 s43, s43, s99
  buffer_load_dwordx4 v222, s[20:23], s43 offen lds
  s_add_u32 s43, s89, 45
  s_and_b32 s43, s43, 127
  s_lshl_b32 m0, s43, 10
  s_lshl_b32 s43, s43, 15
  s_add_u32 s43, s43, s99
  buffer_load_dwordx4 v222, s[20:23], s43 offen lds
  s_add_u32 s43, s89, 48
  s_and_b32 s43, s43, 127
  s_lshl_b32 m0, s43, 10
  s_lshl_b32 s43, s43, 15
  s_add_u32 s43, s43, s99
  buffer_load_dwordx4 v222, s[20:23], s43 offen lds
  s_add_u32 s43, s89, 51
  s_and_b32 s43, s43, 127
  s_lshl_b32 m0, s43, 10
  s_lshl_b32 s43, s43, 15
  s_add_u32 s43, s43, s99
  buffer_load_dwordx4 v222, s[20:23], s43 offen lds
  s_add_u32 s43, s89, 54
  s_and_b32 s43, s43, 127
  s_lshl_b32 m0, s43, 10
  s_lshl_b32 s43, s43, 15
  s_add_u32 s43, s43, s99
  buffer_load_dwordx4 v222, s[20:23], s43 offen lds
  s_add_u32 s43, s89, 57
  s_and_b32 s43, s43, 127
  s_lshl_b32 m0, s43, 10
  s_lshl_b32 s43, s43, 15
  s_add_u32 s43, s43, s99
  buffer_load_dwordx4 v222, s[20:23], s43 offen lds
  s_add_u32 s43, s89, 60
  s_and_b32 s43, s43, 127
  s_lshl_b32 m0, s43, 10
  s_lshl_b32 s43, s43, 15
  s_add_u32 s43, s43, s99
  buffer_load_dwordx4 v222, s[20:23], s43 offen lds
  s_add_u32 s43, s89, 63
  s_and_b32 s43, s43, 127
  s_lshl_b32 m0, s43, 10
  s_lshl_b32 s43, s43, 15
  s_add_u32 s43, s43, s99
  buffer_load_dwordx4 v222, s[20:23], s43 offen lds
  s_add_u32 s43, s89, 66
  s_and_b32 s43, s43, 127
  s_lshl_b32 m0, s43, 10
  s_lshl_b32 s43, s43, 15
  s_add_u32 s43, s43, s99
  buffer_load_dwordx4 v222, s[20:23], s43 offen lds
  s_add_u32 s43, s89, 69
  s_and_b32 s43, s43, 127
  s_lshl_b32 m0, s43, 10
  s_lshl_b32 s43, s43, 15
  s_add_u32 s43, s43, s99
  buffer_load_dwordx4 v222, s[20:23], s43 offen lds
  s_add_u32 s43, s89, 72
  s_and_b32 s43, s43, 127
  s_lshl_b32 m0, s43, 10
  s_lshl_b32 s43, s43, 15
  s_add_u32 s43, s43, s99
  buffer_load_dwordx4 v222, s[20:23], s43 offen lds
  s_add_u32 s43, s89, 75
  s_and_b32 s43, s43, 127
  s_lshl_b32 m0, s43, 10
  s_lshl_b32 s43, s43, 15
  s_add_u32 s43, s43, s99
  buffer_load_dwordx4 v222, s[20:23], s43 offen lds
  s_add_u32 s43, s89, 78
  s_and_b32 s43, s43, 127
  s_lshl_b32 m0, s43, 10
  s_lshl_b32 s43, s43, 15
  s_add_u32 s43, s43, s99
  buffer_load_dwordx4 v222, s[20:23], s43 offen lds
  s_add_u32 s43, s89, 81
  s_and_b32 s43, s43, 127
  s_lshl_b32 m0, s43, 10
  s_lshl_b32 s43, s43, 15
  s_add_u32 s43, s43, s99
  buffer_load_dwordx4 v222, s[20:23], s43 offen lds
  s_add_u32 s43, s89, 84
  s_and_b32 s43, s43, 127
  s_lshl_b32 m0, s43, 10
  s_lshl_b32 s43, s43, 15
  s_add_u32 s43, s43, s99
  buffer_load_dwordx4 v222, s[20:23], s43 offen lds
  s_add_u32 s43, s89, 87
  s_and_b32 s43, s43, 127
  s_lshl_b32 m0, s43, 10
  s_lshl_b32 s43, s43, 15
  s_add_u32 s43, s43, s99
  buffer_load_dwordx4 v222, s[20:23], s43 offen lds
  s_add_u32 s43, s89, 90
  s_and_b32 s43, s43, 127
  s_lshl_b32 m0, s43, 10
  s_lshl_b32 s43, s43, 15
  s_add_u32 s43, s43, s99
  buffer_load_dwordx4 v222, s[20:23], s43 offen lds
  s_add_u32 s43, s89, 93
  s_and_b32 s43, s43, 127
  s_lshl_b32 m0, s43, 10
  s_lshl_b32 s43, s43, 15
  s_add_u32 s43, s43, s99
  buffer_load_dwordx4 v222, s[20:23], s43 offen lds
  s_add_u32 s43, s89, 96
  s_and_b32 s43, s43, 127
  s_lshl_b32 m0, s43, 10
  s_lshl_b32 s43, s43, 15
  s_add_u32 s43, s43, s99
  buffer_load_dwordx4 v222, s[20:23], s43 offen lds
  s_add_u32 s43, s89, 99
  s_and_b32 s43, s43, 127
  s_lshl_b32 m0, s43, 10
  s_lshl_b32 s43, s43, 15
  s_add_u32 s43, s43, s99
  buffer_load_dwordx4 v222, s[20:23], s43 offen lds
  s_add_u32 s43, s89, 102
  s_and_b32 s43, s43, 127
  s_lshl_b32 m0, s43, 10
  s_lshl_b32 s43, s43, 15
  s_add_u32 s43, s43, s99
  buffer_load_dwordx4 v222, s[20:23], s43 offen lds
  s_add_u32 s43, s89, 105
  s_and_b32 s43, s43, 127
  s_lshl_b32 m0, s43, 10
  s_lshl_b32 s43, s43, 15
  s_add_u32 s43, s43, s99
  buffer_load_dwordx4 v222, s[20:23], s43 offen lds
  s_add_u32 s43, s89, 108
  s_and_b32 s43, s43, 127
  s_lshl_b32 m0, s43, 10
  s_lshl_b32 s43, s43, 15
  s_add_u32 s43, s43, s99
  buffer_load_dwordx4 v222, s[20:23], s43 offen lds
  s_add_u32 s43, s89, 111
  s_and_b32 s43, s43, 127
  s_lshl_b32 m0, s43, 10
  s_lshl_b32 s43, s43, 15
  s_add_u32 s43, s43, s99
  buffer_load_dwordx4 v222, s[20:23], s43 offen lds
  s_add_u32 s43, s89, 114
  s_and_b32 s43, s43, 127
  s_lshl_b32 m0, s43, 10
  s_lshl_b32 s43, s43, 15
  s_add_u32 s43, s43, s99
  buffer_load_dwordx4 v222, s[20:23], s43 offen lds
  s_add_u32 s43, s89, 117
  s_and_b32 s43, s43, 127
  s_lshl_b32 m0, s43, 10
  s_lshl_b32 s43, s43, 15
  s_add_u32 s43, s43, s99
  buffer_load_dwordx4 v222, s[20:23], s43 offen lds
  s_add_u32 s43, s89, 120
  s_and_b32 s43, s43, 127
  s_lshl_b32 m0, s43, 10
  s_lshl_b32 s43, s43, 15
  s_add_u32 s43, s43, s99
  buffer_load_dwordx4 v222, s[20:23], s43 offen lds
  s_add_u32 s43, s89, 123
  s_and_b32 s43, s43, 127
  s_lshl_b32 m0, s43, 10
  s_lshl_b32 s43, s43, 15
  s_add_u32 s43, s43, s99
  buffer_load_dwordx4 v222, s[20:23], s43 offen lds
  s_cmp_eq_u32 s3, 3
  s_cbranch_scc1 F_NOW
  s_add_u32 s43, s89, 126
  s_and_b32 s43, s43, 127
  s_lshl_b32 m0, s43, 10
  s_lshl_b32 s43, s43, 15
  s_add_u32 s43, s43, s99
  buffer_load_dwordx4 v222, s[20:23], s43 offen lds
F_NOW:
  s_lshl_b32 s70, s37, 8
  v_lshlrev_b32 v70, 5, v245
  s_lshl_b32 s44, s37, 12
  v_add_u32 v71, 131072, v70
  s_cmp_lg_u32 s3, 0
  s_cbranch_scc1 F_G1
  s_mov_b64 exec, 1
  v_mov_b32 v252, s70
  s_mov_b32 s68, 0
POLL_1:
  buffer_load_dword v251, v252, s[60:63], 0 offen sc1
  s_waitcnt vmcnt(0)
  v_cmp_le_u32 vcc, 32, v251
  s_add_u32 s68, s68, 1
  s_cmp_eq_u64 vcc, exec
  s_cbranch_scc1 POK_2
  s_cmp_gt_u32 s68, 200000
  s_cbranch_scc1 POK_2
  s_sleep 1
  s_branch POLL_1
POK_2:
  s_mov_b64 exec, -1
  buffer_load_dwordx4 v[20:23], v70, s[32:35], s44 offen offset:0 sc1
  buffer_load_dwordx4 v[24:27], v70, s[32:35], s44 offen offset:16 sc1
  buffer_load_dwordx4 v[28:31], v70, s[32:35], s44 offen offset:2048 sc1
  buffer_load_dwordx4 v[32:35], v70, s[32:35], s44 offen offset:2064 sc1
  s_waitcnt vmcnt(0)
  ds_write_b128 v71, v[20:23] offset:0
  ds_write_b128 v71, v[24:27] offset:16
  ds_write_b128 v71, v[28:31] offset:2048
  ds_write_b128 v71, v[32:35] offset:2064
  s_waitcnt lgkmcnt(0)
F_G1:
  s_barrier
  ds_read_b128 v[20:23], v71 offset:0
  ds_read_b128 v[24:27], v71 offset:16
  ds_read_b128 v[28:31], v71 offset:2048
  ds_read_b128 v[32:35], v71 offset:2064
  s_waitcnt lgkmcnt(0)
  v_pk_fma_f32 v[100:101], v[100:101], v[28:29], v[20:21]
  v_pk_fma_f32 v[102:103], v[102:103], v[30:31], v[22:23]
  v_pk_fma_f32 v[104:105], v[104:105], v[32:33], v[24:25]
  v_pk_fma_f32 v[106:107], v[106:107], v[34:35], v[26:27]
  v_cvt_pk_bf16_f32 v8, v100, v101
  v_cvt_pk_bf16_f32 v9, v102, v103
  v_cvt_pk_bf16_f32 v10, v104, v105
  v_cvt_pk_bf16_f32 v11, v106, v107
  v_pk_fma_f32 v[108:109], v[108:109], v[28:29], v[20:21]
  v_pk_fma_f32 v[110:111], v[110:111], v[30:31], v[22:23]
  v_pk_fma_f32 v[112:113], v[112:113], v[32:33], v[24:25]
  v_pk_fma_f32 v[114:115], v[114:115], v[34:35], v[26:27]
  v_cvt_pk_bf16_f32 v12, v108, v109
  v_cvt_pk_bf16_f32 v13, v110, v111
  v_cvt_pk_bf16_f32 v14, v112, v113
  v_cvt_pk_bf16_f32 v15, v114, v115
  v_lshlrev_b32 v118, 7, v245
  s_lshl_b32 s44, s3, 5
  s_add_u32 s44, s44, 139264
  v_add_u32 v118, s44, v118
  ds_write_b128 v118, v[8:11]
  ds_write_b128 v118, v[12:15] offset:16
  s_waitcnt lgkmcnt(0)
  s_barrier
  s_cmp_lg_u32 s3, 0
  s_cbranch_scc1 F_G2
  v_lshlrev_b32 v118, 4, v245
  v_add_u32 v118, 139264, v118
  ds_read_b128 v[20:23], v118 offset:0
  ds_read_b128 v[24:27], v118 offset:1024
  ds_read_b128 v[28:31], v118 offset:2048
  ds_read_b128 v[32:35], v118 offset:3072
  ds_read_b128 v[36:39], v118 offset:4096
  ds_read_b128 v[40:43], v118 offset:5120
  ds_read_b128 v[44:47], v118 offset:6144
  ds_read_b128 v[48:51], v118 offset:7168
  v_lshrrev_b32 v119, 3, v245
  v_lshlrev_b32 v119, 9, v119
  v_and_b32 v120, 7, v245
  v_lshlrev_b32 v120, 4, v120
  v_add_u32 v119, v119, v120
  s_lshr_b32 s44, s2, 2
  s_lshl_b32 s44, s44, 15
  s_and_b32 s45, s2, 3
  s_lshl_b32 s45, s45, 7
  s_add_u32 s44, s44, s45
  s_waitcnt lgkmcnt(0)
  buffer_store_dwordx4 v[20:23], v119, s[24:27], s44 offen sc1
  s_add_u32 s44, s44, 4096
  buffer_store_dwordx4 v[24:27], v119, s[24:27], s44 offen sc1
  s_add_u32 s44, s44, 4096
  buffer_store_dwordx4 v[28:31], v119, s[24:27], s44 offen sc1
  s_add_u32 s44, s44, 4096
  buffer_store_dwordx4 v[32:35], v119, s[24:27], s44 offen sc1
  s_add_u32 s44, s44, 4096
  buffer_store_dwordx4 v[36:39], v119, s[24:27], s44 offen sc1
  s_add_u32 s44, s44, 4096
  buffer_store_dwordx4 v[40:43], v119, s[24:27], s44 offen sc1
  s_add_u32 s44, s44, 4096
  buffer_store_dwordx4 v[44:47], v119, s[24:27], s44 offen sc1
  s_add_u32 s44, s44, 4096
  buffer_store_dwordx4 v[48:51], v119, s[24:27], s44 offen sc1
  s_add_u32 s44, s44, 4096
  s_add_u32 s70, s37, 96
  s_lshl_b32 s70, s70, 8
  s_waitcnt vmcnt(0)
  s_mov_b64 exec, 1
  v_mov_b32 v251, 1
  v_mov_b32 v252, s70
  buffer_atomic_add v251, v252, s[60:63], 0 offen sc1
  s_mov_b64 exec, -1
F_G2:
  s_waitcnt vmcnt(0)
  v_lshlrev_b32 v134, 16, v52
  v_lshlrev_b32 v135, 16, v53
  v_mul_f32 v124, 3216550459, v134
  v_mul_f32 v125, 3216550459, v135
  v_exp_f32 v124, v124
  v_exp_f32 v125, v125
  s_nop 0
  v_add_f32 v124, 1.0, v124
  v_add_f32 v125, 1.0, v125
  v_rcp_f32 v124, v124
  v_rcp_f32 v125, v125
  s_nop 0
  v_mul_f32 v134, v134, v124
  v_mul_f32 v135, v135, v125
  v_cvt_pk_bf16_f32 v132, v134, v134
  v_and_b32 v134, 0xffff0000, v132
  v_cvt_pk_bf16_f32 v132, v135, v135
  v_and_b32 v135, 0xffff0000, v132
  v_lshlrev_b32 v136, 16, v56
  v_and_b32 v137, 0xffff0000, v56
  v_mul_f32 v140, v136, v134
  v_mul_f32 v141, v137, v134
  v_lshlrev_b32 v136, 16, v57
  v_and_b32 v137, 0xffff0000, v57
  v_mul_f32 v142, v136, v134
  v_mul_f32 v143, v137, v134
  v_lshlrev_b32 v136, 16, v58
  v_and_b32 v137, 0xffff0000, v58
  v_mul_f32 v144, v136, v134
  v_mul_f32 v145, v137, v134
  v_lshlrev_b32 v136, 16, v59
  v_and_b32 v137, 0xffff0000, v59
  v_mul_f32 v146, v136, v134
  v_mul_f32 v147, v137, v134
  v_lshlrev_b32 v136, 16, v60
  v_and_b32 v137, 0xffff0000, v60
  v_fmac_f32 v140, v136, v135
  v_fmac_f32 v141, v137, v135
  v_lshlrev_b32 v136, 16, v61
  v_and_b32 v137, 0xffff0000, v61
  v_fmac_f32 v142, v136, v135
  v_fmac_f32 v143, v137, v135
  v_lshlrev_b32 v136, 16, v62
  v_and_b32 v137, 0xffff0000, v62
  v_fmac_f32 v144, v136, v135
  v_fmac_f32 v145, v137, v135
  v_lshlrev_b32 v136, 16, v63
  v_and_b32 v137, 0xffff0000, v63
  v_fmac_f32 v146, v136, v135
  v_fmac_f32 v147, v137, v135
  s_nop 1
  v_add_f32_dpp v140, v140, v140 row_ror:8 row_mask:0xf bank_mask:0xf
  v_add_f32_dpp v141, v141, v141 row_ror:8 row_mask:0xf bank_mask:0xf
  v_add_f32_dpp v142, v142, v142 row_ror:8 row_mask:0xf bank_mask:0xf
  v_add_f32_dpp v143, v143, v143 row_ror:8 row_mask:0xf bank_mask:0xf
  v_add_f32_dpp v144, v144, v144 row_ror:8 row_mask:0xf bank_mask:0xf
  v_add_f32_dpp v145, v145, v145 row_ror:8 row_mask:0xf bank_mask:0xf
  v_add_f32_dpp v146, v146, v146 row_ror:8 row_mask:0xf bank_mask:0xf
  v_add_f32_dpp v147, v147, v147 row_ror:8 row_mask:0xf bank_mask:0xf
  v_add_f32_dpp v140, v140, v140 row_ror:4 row_mask:0xf bank_mask:0xf
  v_add_f32_dpp v141, v141, v141 row_ror:4 row_mask:0xf bank_mask:0xf
  v_add_f32_dpp v142, v142, v142 row_ror:4 row_mask:0xf bank_mask:0xf
  v_add_f32_dpp v143, v143, v143 row_ror:4 row_mask:0xf bank_mask:0xf
  v_add_f32_dpp v144, v144, v144 row_ror:4 row_mask:0xf bank_mask:0xf
  v_add_f32_dpp v145, v145, v145 row_ror:4 row_mask:0xf bank_mask:0xf
  v_add_f32_dpp v146, v146, v146 row_ror:4 row_mask:0xf bank_mask:0xf
  v_add_f32_dpp v147, v147, v147 row_ror:4 row_mask:0xf bank_mask:0xf
  v_add_f32_dpp v140, v140, v140 row_ror:2 row_mask:0xf bank_mask:0xf
  v_add_f32_dpp v141, v141, v141 row_ror:2 row_mask:0xf bank_mask:0xf
  v_add_f32_dpp v142, v142, v142 row_ror:2 row_mask:0xf bank_mask:0xf
  v_add_f32_dpp v143, v143, v143 row_ror:2 row_mask:0xf bank_mask:0xf
  v_add_f32_dpp v144, v144, v144 row_ror:2 row_mask:0xf bank_mask:0xf
  v_add_f32_dpp v145, v145, v145 row_ror:2 row_mask:0xf bank_mask:0xf
  v_add_f32_dpp v146, v146, v146 row_ror:2 row_mask:0xf bank_mask:0xf
  v_add_f32_dpp v147, v147, v147 row_ror:2 row_mask:0xf bank_mask:0xf
  v_add_f32_dpp v140, v140, v140 row_ror:1 row_mask:0xf bank_mask:0xf
  v_add_f32_dpp v141, v141, v141 row_ror:1 row_mask:0xf bank_mask:0xf
  v_add_f32_dpp v142, v142, v142 row_ror:1 row_mask:0xf bank_mask:0xf
  v_add_f32_dpp v143, v143, v143 row_ror:1 row_mask:0xf bank_mask:0xf
  v_add_f32_dpp v144, v144, v144 row_ror:1 row_mask:0xf bank_mask:0xf
  v_add_f32_dpp v145, v145, v145 row_ror:1 row_mask:0xf bank_mask:0xf
  v_add_f32_dpp v146, v146, v146 row_ror:1 row_mask:0xf bank_mask:0xf
  v_add_f32_dpp v147, v147, v147 row_ror:1 row_mask:0xf bank_mask:0xf
  v_mov_b32 v124, v140
  v_mov_b32 v125, v141
  v_mov_b32 v126, v142
  v_mov_b32 v127, v143
  v_mov_b32 v128, v144
  v_mov_b32 v129, v145
  v_mov_b32 v130, v146
  v_mov_b32 v131, v147
  v_permlane16_swap_b32 v124, v140
  v_permlane16_swap_b32 v125, v141
  v_permlane16_swap_b32 v126, v142
  v_permlane16_swap_b32 v127, v143
  v_permlane16_swap_b32 v128, v144
  v_permlane16_swap_b32 v129, v145
  v_permlane16_swap_b32 v130, v146
  v_permlane16_swap_b32 v131, v147
  s_nop 1
  v_add_f32 v140, v140, v124
  v_add_f32 v141, v141, v125
  v_add_f32 v142, v142, v126
  v_add_f32 v143, v143, v127
  v_add_f32 v144, v144, v128
  v_add_f32 v145, v145, v129
  v_add_f32 v146, v146, v130
  v_add_f32 v147, v147, v131
  v_mov_b32 v124, v140
  v_mov_b32 v125, v141
  v_mov_b32 v126, v142
  v_mov_b32 v127, v143
  v_mov_b32 v128, v144
  v_mov_b32 v129, v145
  v_mov_b32 v130, v146
  v_mov_b32 v131, v147
  v_permlane32_swap_b32 v124, v140
  v_permlane32_swap_b32 v125, v141
  v_permlane32_swap_b32 v126, v142
  v_permlane32_swap_b32 v127, v143
  v_permlane32_swap_b32 v128, v144
  v_permlane32_swap_b32 v129, v145
  v_permlane32_swap_b32 v130, v146
  v_permlane32_swap_b32 v131, v147
  s_nop 1
  v_add_f32 v140, v140, v124
  v_add_f32 v141, v141, v125
  v_add_f32 v142, v142, v126
  v_add_f32 v143, v143, v127
  v_add_f32 v144, v144, v128
  v_add_f32 v145, v145, v129
  v_add_f32 v146, v146, v130
  v_add_f32 v147, v147, v131
  s_lshl_b32 s44, s3, 5
  s_add_u32 s44, s44, 135168
  v_mov_b32 v136, s44
  s_mov_b64 exec, 1
  ds_write_b128 v136, v[140:143]
  ds_write_b128 v136, v[144:147] offset:16
  s_mov_b64 exec, -1
  s_waitcnt lgkmcnt(0)
  s_barrier
  s_cmp_lg_u32 s3, 1
  s_cbranch_scc1 F_NOT1
  v_and_b32 v70, 7, v245
  v_lshlrev_b32 v70, 2, v70
  v_add_u32 v71, 135168, v70
  ds_read_b32 v20, v71 offset:0
  ds_read_b32 v21, v71 offset:32
  ds_read_b32 v22, v71 offset:64
  ds_read_b32 v23, v71 offset:96
  s_waitcnt lgkmcnt(0)
  v_add_f32 v20, v20, v21
  v_add_f32 v22, v22, v23
  v_add_f32 v20, v20, v22
  v_cvt_pk_bf16_f32 v21, v20, v20
  v_and_b32 v20, 0xffff0000, v21
  s_sub_u32 s44, s83, 128
  s_cmp_ge_u32 s44, 64
  s_cbranch_scc1 F_NOTCB
  v_add_f32 v20, 1.0, v20
  v_cvt_pk_bf16_f32 v21, v20, v20
  v_and_b32 v20, 0xffff0000, v21
F_NOTCB:
  s_lshl_b32 s44, s83, 5
  s_add_u32 s44, s44, 2228224
  s_mov_b64 exec, 0xff
  buffer_store_dword v20, v70, s[32:35], s44 offen sc1
  s_mov_b64 exec, 1
  v_mov_b32 v252, 0
  s_mov_b32 s68, 0
F_ZP1:
  buffer_load_dword v251, v252, s[64:67], 0 offen sc1
  s_waitcnt vmcnt(0)
  v_readfirstlane_b32 s69, v251
  s_add_u32 s68, s68, 1
  s_cmp_lg_u32 s69, 0
  s_cbranch_scc1 F_ZD1
  s_cmp_gt_u32 s68, 200000
  s_cbranch_scc1 F_ZD1
  s_sleep 1
  s_branch F_ZP1
F_ZD1:
  s_and_b32 s71, s2, 7
  s_add_u32 s71, s71, 8
  s_lshl_b32 s71, s71, 8
  v_mov_b32 v251, 1
  v_mov_b32 v252, s71
  buffer_atomic_add v251, v252, s[60:63], 0 offen sc1
  s_mov_b64 exec, -1
F_NOT1:
  s_load_dwordx2 s[6:7], s[0:1], 8
  s_load_dwordx2 s[8:9], s[0:1], 16
  s_load_dwordx2 s[56:57], s[0:1], 32
  s_load_dwordx2 s[90:91], s[0:1], 48
  s_load_dwordx2 s[92:93], s[0:1], 56
  s_load_dwordx2 s[94:95], s[0:1], 64
  s_lshl_b32 s38, s37, 3
  s_lshl_b32 s43, s3, 1
  s_add_u32 s38, s38, s43
  s_lshl_b32 s41, s3, 12
  s_mov_b32 s44, 1602224128
  s_mov_b32 s58, 4194304
  s_mov_b32 s59, 0x00020000
  s_mov_b32 s96, 1835008
  s_mov_b32 s97, 1835008
  s_mov_b32 s98, 1835008
  s_lshl_b32 s50, s2, 12
  s_lshl_b32 s51, s3, 10
  s_add_u32 s50, s50, s51
  s_add_u32 s51, s51, 131072
  v_lshrrev_b32 v200, 4, v245
  v_lshrrev_b32 v201, 5, v245
  v_and_b32 v202, 1, v200
  v_bfe_u32 v203, v245, 2, 2
  v_and_b32 v204, 3, v245
  v_and_b32 v205, 15, v245
  v_lshlrev_b32 v206, 2, v200
  v_xor_b32 v206, v205, v206
  v_lshlrev_b32 v206, 4, v206
  v_lshlrev_b32 v240, 8, v200
  v_add_u32 v240, v240, v206
  v_add_u32 v206, 0, v200
  v_xor_b32 v206, v205, v206
  v_lshlrev_b32 v206, 4, v206
  v_lshlrev_b32 v236, 8, v200
  v_add_u32 v236, v236, v206
  v_add_u32 v206, 4, v200
  v_xor_b32 v206, v205, v206
  v_lshlrev_b32 v206, 4, v206
  v_lshlrev_b32 v237, 8, v200
  v_add_u32 v237, v237, v206
  v_add_u32 v206, 8, v200
  v_xor_b32 v206, v205, v206
  v_lshlrev_b32 v206, 4, v206
  v_lshlrev_b32 v238, 8, v200
  v_add_u32 v238, v238, v206
  v_add_u32 v206, 12, v200
  v_xor_b32 v206, v205, v206
  v_lshlrev_b32 v206, 4, v206
  v_lshlrev_b32 v239, 8, v200
  v_add_u32 v239, v239, v206
  v_and_b32 v205, 31, v245
  v_add_u32 v206, 0, v201
  v_and_b32 v224, 15, v205
  v_xor_b32 v206, v206, v224
  v_lshlrev_b32 v206, 4, v206
  v_lshlrev_b32 v224, 8, v205
  v_add_u32 v224, v224, v206
  v_add_u32 v206, 2, v201
  v_and_b32 v225, 15, v205
  v_xor_b32 v206, v206, v225
  v_lshlrev_b32 v206, 4, v206
  v_lshlrev_b32 v225, 8, v205
  v_add_u32 v225, v225, v206
  v_add_u32 v206, 4, v201
  v_and_b32 v226, 15, v205
  v_xor_b32 v206, v206, v226
  v_lshlrev_b32 v206, 4, v206
  v_lshlrev_b32 v226, 8, v205
  v_add_u32 v226, v226, v206
  v_add_u32 v206, 6, v201
  v_and_b32 v227, 15, v205
  v_xor_b32 v206, v206, v227
  v_lshlrev_b32 v206, 4, v206
  v_lshlrev_b32 v227, 8, v205
  v_add_u32 v227, v227, v206
  v_add_u32 v206, 8, v201
  v_and_b32 v228, 15, v205
  v_xor_b32 v206, v206, v228
  v_lshlrev_b32 v206, 4, v206
  v_lshlrev_b32 v228, 8, v205
  v_add_u32 v228, v228, v206
  v_add_u32 v206, 10, v201
  v_and_b32 v229, 15, v205
  v_xor_b32 v206, v206, v229
  v_lshlrev_b32 v206, 4, v206
  v_lshlrev_b32 v229, 8, v205
  v_add_u32 v229, v229, v206
  v_add_u32 v206, 12, v201
  v_and_b32 v230, 15, v205
  v_xor_b32 v206, v206, v230
  v_lshlrev_b32 v206, 4, v206
  v_lshlrev_b32 v230, 8, v205
  v_add_u32 v230, v230, v206
  v_add_u32 v206, 14, v201
  v_and_b32 v231, 15, v205
  v_xor_b32 v206, v206, v231
  v_lshlrev_b32 v206, 4, v206
  v_lshlrev_b32 v231, 8, v205
  v_add_u32 v231, v231, v206
  v_xor_b32 v205, 0, v203
  v_lshlrev_b32 v205, 2, v205
  v_lshlrev_b32 v206, 1, v202
  v_add_u32 v205, v205, v206
  v_lshrrev_b32 v206, 1, v204
  v_add_u32 v206, v205, v206
  v_lshlrev_b32 v206, 4, v206
  v_and_b32 v207, 1, v204
  v_lshlrev_b32 v207, 3, v207
  v_add_u32 v206, v206, v207
  v_lshlrev_b32 v207, 2, v201
  v_add_u32 v207, v207, v203
  v_lshlrev_b32 v207, 8, v207
  v_add_u32 v206, v206, v207
  v_add_u32 v232, 65536, v206
  v_and_b32 v206, 1, v204
  v_add_u32 v206, v205, v206
  v_lshlrev_b32 v206, 4, v206
  v_lshrrev_b32 v207, 1, v204
  v_lshlrev_b32 v207, 3, v207
  v_add_u32 v206, v206, v207
  v_lshlrev_b32 v207, 3, v201
  v_add_u32 v207, v207, v203
  v_lshlrev_b32 v207, 8, v207
  v_add_u32 v246, v206, v207
  v_xor_b32 v205, 1, v203
  v_lshlrev_b32 v205, 2, v205
  v_lshlrev_b32 v206, 1, v202
  v_add_u32 v205, v205, v206
  v_lshrrev_b32 v206, 1, v204
  v_add_u32 v206, v205, v206
  v_lshlrev_b32 v206, 4, v206
  v_and_b32 v207, 1, v204
  v_lshlrev_b32 v207, 3, v207
  v_add_u32 v206, v206, v207
  v_lshlrev_b32 v207, 2, v201
  v_add_u32 v207, v207, v203
  v_lshlrev_b32 v207, 8, v207
  v_add_u32 v206, v206, v207
  v_add_u32 v233, 65536, v206
  v_and_b32 v206, 1, v204
  v_add_u32 v206, v205, v206
  v_lshlrev_b32 v206, 4, v206
  v_lshrrev_b32 v207, 1, v204
  v_lshlrev_b32 v207, 3, v207
  v_add_u32 v206, v206, v207
  v_lshlrev_b32 v207, 3, v201
  v_add_u32 v207, v207, v203
  v_lshlrev_b32 v207, 8, v207
  v_add_u32 v247, v206, v207
  v_xor_b32 v205, 2, v203
  v_lshlrev_b32 v205, 2, v205
  v_lshlrev_b32 v206, 1, v202
  v_add_u32 v205, v205, v206
  v_lshrrev_b32 v206, 1, v204
  v_add_u32 v206, v205, v206
  v_lshlrev_b32 v206, 4, v206
  v_and_b32 v207, 1, v204
  v_lshlrev_b32 v207, 3, v207
  v_add_u32 v206, v206, v207
  v_lshlrev_b32 v207, 2, v201
  v_add_u32 v207, v207, v203
  v_lshlrev_b32 v207, 8, v207
  v_add_u32 v206, v206, v207
  v_add_u32 v234, 65536, v206
  v_and_b32 v206, 1, v204
  v_add_u32 v206, v205, v206
  v_lshlrev_b32 v206, 4, v206
  v_lshrrev_b32 v207, 1, v204
  v_lshlrev_b32 v207, 3, v207
  v_add_u32 v206, v206, v207
  v_lshlrev_b32 v207, 3, v201
  v_add_u32 v207, v207, v203
  v_lshlrev_b32 v207, 8, v207
  v_add_u32 v248, v206, v207
  v_xor_b32 v205, 3, v203
  v_lshlrev_b32 v205, 2, v205
  v_lshlrev_b32 v206, 1, v202
  v_add_u32 v205, v205, v206
  v_lshrrev_b32 v206, 1, v204
  v_add_u32 v206, v205, v206
  v_lshlrev_b32 v206, 4, v206
  v_and_b32 v207, 1, v204
  v_lshlrev_b32 v207, 3, v207
  v_add_u32 v206, v206, v207
  v_lshlrev_b32 v207, 2, v201
  v_add_u32 v207, v207, v203
  v_lshlrev_b32 v207, 8, v207
  v_add_u32 v206, v206, v207
  v_add_u32 v235, 65536, v206
  v_and_b32 v206, 1, v204
  v_add_u32 v206, v205, v206
  v_lshlrev_b32 v206, 4, v206
  v_lshrrev_b32 v207, 1, v204
  v_lshlrev_b32 v207, 3, v207
  v_add_u32 v206, v206, v207
  v_lshlrev_b32 v207, 3, v201
  v_add_u32 v207, v207, v203
  v_lshlrev_b32 v207, 8, v207
  v_add_u32 v249, v206, v207
  v_lshlrev_b32 v221, 4, v245
  s_waitcnt lgkmcnt(0)
  s_lshl_b32 s43, s36, 19
  s_add_u32 s12, s6, s43
  s_addc_u32 s13, s7, 0
  s_mov_b32 s14, 524288
  s_mov_b32 s15, 0x00020000
  s_add_u32 s16, s8, s43
  s_addc_u32 s17, s9, 0
  s_mov_b32 s18, 524288
  s_mov_b32 s19, 0x00020000
  s_add_u32 s28, s4, 4194304
  s_addc_u32 s29, s5, 0
  s_mov_b32 s30, 16777216
  s_mov_b32 s31, 0x00020000
  s_add_u32 s70, s37, 96
  s_lshl_b32 s70, s70, 8
  s_cmp_lg_u32 s3, 0
  s_cbranch_scc1 WDONE_3
  s_mov_b64 exec, 1
  v_and_b32 v252, 63, v255
  v_lshlrev_b32 v252, 8, v252
  v_add_u32 v252, s70, v252
  s_mov_b32 s68, 0
POLL_6:
  buffer_load_dword v251, v252, s[60:63], 0 offen sc1
  s_waitcnt vmcnt(0)
  v_cmp_le_u32 vcc, 32, v251
  s_add_u32 s68, s68, 1
  s_cmp_eq_u64 vcc, exec
  s_cbranch_scc1 POK_7
  s_cmp_gt_u32 s68, 200000
  s_cbranch_scc1 POK_7
  s_sleep 1
  s_branch POLL_6
POK_7:
  s_mov_b64 exec, -1
WDONE_3:
  s_barrier
  s_lshl_b32 s48, s38, 15
  s_add_u32 s49, s48, 32768
  s_add_u32 s43, s48, 0
  buffer_load_dwordx4 v[0:3], v221, s[24:27], s43 offen offset:0 sc1
  s_add_u32 s43, s49, 0
  buffer_load_dwordx4 v[4:7], v221, s[24:27], s43 offen offset:0 sc1
  s_add_u32 s43, s48, 0
  buffer_load_dwordx4 v[8:11], v221, s[24:27], s43 offen offset:1024 sc1
  s_add_u32 s43, s49, 0
  buffer_load_dwordx4 v[12:15], v221, s[24:27], s43 offen offset:1024 sc1
  s_add_u32 s43, s48, 0
  buffer_load_dwordx4 v[16:19], v221, s[24:27], s43 offen offset:2048 sc1
  s_add_u32 s43, s49, 0
  buffer_load_dwordx4 v[20:23], v221, s[24:27], s43 offen offset:2048 sc1
  s_add_u32 s43, s48, 0
  buffer_load_dwordx4 v[24:27], v221, s[24:27], s43 offen offset:3072 sc1
  s_add_u32 s43, s49, 0
  buffer_load_dwordx4 v[28:31], v221, s[24:27], s43 offen offset:3072 sc1
  s_add_u32 s43, s48, 4096
  buffer_load_dwordx4 v[32:35], v221, s[24:27], s43 offen offset:0 sc1
  s_add_u32 s43, s49, 4096
  buffer_load_dwordx4 v[36:39], v221, s[24:27], s43 offen offset:0 sc1
  s_add_u32 s43, s48, 4096
  buffer_load_dwordx4 v[40:43], v221, s[24:27], s43 offen offset:1024 sc1
  s_add_u32 s43, s49, 4096
  buffer_load_dwordx4 v[44:47], v221, s[24:27], s43 offen offset:1024 sc1
  s_add_u32 s43, s48, 4096
  buffer_load_dwordx4 v[48:51], v221, s[24:27], s43 offen offset:2048 sc1
  s_add_u32 s43, s49, 4096
  buffer_load_dwordx4 v[52:55], v221, s[24:27], s43 offen offset:2048 sc1
  s_add_u32 s43, s48, 4096
  buffer_load_dwordx4 v[56:59], v221, s[24:27], s43 offen offset:3072 sc1
  s_add_u32 s43, s49, 4096
  buffer_load_dwordx4 v[60:63], v221, s[24:27], s43 offen offset:3072 sc1
  ds_read_b64_tr_b16 a[192:193], v246 offset:0
  ds_read_b64_tr_b16 a[194:195], v246 offset:1024
  ds_read_b64_tr_b16 a[196:197], v247 offset:0
  ds_read_b64_tr_b16 a[198:199], v247 offset:1024
  ds_read_b64_tr_b16 a[200:201], v248 offset:0
  ds_read_b64_tr_b16 a[202:203], v248 offset:1024
  ds_read_b64_tr_b16 a[204:205], v249 offset:0
  ds_read_b64_tr_b16 a[206:207], v249 offset:1024
  ds_read_b64_tr_b16 a[208:209], v246 offset:4096
  ds_read_b64_tr_b16 a[210:211], v246 offset:5120
  ds_read_b64_tr_b16 a[212:213], v247 offset:4096
  ds_read_b64_tr_b16 a[214:215], v247 offset:5120
  ds_read_b64_tr_b16 a[216:217], v248 offset:4096
  ds_read_b64_tr_b16 a[218:219], v248 offset:5120
  ds_read_b64_tr_b16 a[220:221], v249 offset:4096
  ds_read_b64_tr_b16 a[222:223], v249 offset:5120
  s_waitcnt vmcnt(14)
  s_waitcnt lgkmcnt(8)
  s_add_u32 s43, s48, 8192
  v_mfma_f32_32x32x16_bf16 v[64:79], a[192:195], v[0:3], 0
  buffer_load_dwordx4 v[192:195], v221, s[24:27], s43 offen offset:0 sc1
  v_mfma_f32_32x32x16_bf16 v[128:143], a[192:195], v[4:7], 0
  ds_read_b64_tr_b16 a[224:225], v246 offset:8192
  ds_read_b64_tr_b16 a[226:227], v246 offset:9216
  s_add_u32 s43, s49, 8192
  v_mfma_f32_32x32x16_bf16 v[80:95], a[196:199], v[0:3], 0
  buffer_load_dwordx4 v[196:199], v221, s[24:27], s43 offen offset:0 sc1
  v_mfma_f32_32x32x16_bf16 v[144:159], a[196:199], v[4:7], 0
  ds_read_b64_tr_b16 a[228:229], v247 offset:8192
  ds_read_b64_tr_b16 a[230:231], v247 offset:9216
  s_add_u32 s43, s48, 8192
  v_mfma_f32_32x32x16_bf16 v[96:111], a[200:203], v[0:3], 0
  buffer_load_dwordx4 v[200:203], v221, s[24:27], s43 offen offset:1024 sc1
  v_mfma_f32_32x32x16_bf16 v[160:175], a[200:203], v[4:7], 0
  ds_read_b64_tr_b16 a[232:233], v248 offset:8192
  ds_read_b64_tr_b16 a[234:235], v248 offset:9216
  s_add_u32 s43, s49, 8192
  v_mfma_f32_32x32x16_bf16 v[112:127], a[204:207], v[0:3], 0
  buffer_load_dwordx4 v[204:207], v221, s[24:27], s43 offen offset:1024 sc1
  v_mfma_f32_32x32x16_bf16 v[176:191], a[204:207], v[4:7], 0
  ds_read_b64_tr_b16 a[236:237], v249 offset:8192
  ds_read_b64_tr_b16 a[238:239], v249 offset:9216
  s_waitcnt vmcnt(16)
  s_waitcnt lgkmcnt(8)
  s_add_u32 s43, s48, 8192
  v_mfma_f32_32x32x16_bf16 v[64:79], a[208:211], v[8:11], v[64:79]
  buffer_load_dwordx4 v[208:211], v221, s[24:27], s43 offen offset:2048 sc1
  v_mfma_f32_32x32x16_bf16 v[128:143], a[208:211], v[12:15], v[128:143]
  ds_read_b64_tr_b16 a[192:193], v246 offset:12288
  ds_read_b64_tr_b16 a[194:195], v246 offset:13312
  s_add_u32 s43, s49, 8192
  v_mfma_f32_32x32x16_bf16 v[80:95], a[212:215], v[8:11], v[80:95]
  buffer_load_dwordx4 v[212:215], v221, s[24:27], s43 offen offset:2048 sc1
  v_mfma_f32_32x32x16_bf16 v[144:159], a[212:215], v[12:15], v[144:159]
  ds_read_b64_tr_b16 a[196:197], v247 offset:12288
  ds_read_b64_tr_b16 a[198:199], v247 offset:13312
  s_add_u32 s43, s48, 8192
  v_mfma_f32_32x32x16_bf16 v[96:111], a[216:219], v[8:11], v[96:111]
  buffer_load_dwordx4 v[0:3], v221, s[24:27], s43 offen offset:3072 sc1
  v_mfma_f32_32x32x16_bf16 v[160:175], a[216:219], v[12:15], v[160:175]
  ds_read_b64_tr_b16 a[200:201], v248 offset:12288
  ds_read_b64_tr_b16 a[202:203], v248 offset:13312
  s_add_u32 s43, s49, 8192
  v_mfma_f32_32x32x16_bf16 v[112:127], a[220:223], v[8:11], v[112:127]
  buffer_load_dwordx4 v[4:7], v221, s[24:27], s43 offen offset:3072 sc1
  v_mfma_f32_32x32x16_bf16 v[176:191], a[220:223], v[12:15], v[176:191]
  ds_read_b64_tr_b16 a[204:205], v249 offset:12288
  ds_read_b64_tr_b16 a[206:207], v249 offset:13312
  s_waitcnt vmcnt(18)
  s_waitcnt lgkmcnt(8)
  s_add_u32 s43, s48, 12288
  v_mfma_f32_32x32x16_bf16 v[64:79], a[224:227], v[16:19], v[64:79]
  buffer_load_dwordx4 v[8:11], v221, s[24:27], s43 offen offset:0 sc1
  v_mfma_f32_32x32x16_bf16 v[128:143], a[224:227], v[20:23], v[128:143]
  ds_read_b64_tr_b16 a[208:209], v246 offset:16384
  ds_read_b64_tr_b16 a[210:211], v246 offset:17408
  s_add_u32 s43, s49, 12288
  v_mfma_f32_32x32x16_bf16 v[80:95], a[228:231], v[16:19], v[80:95]
  buffer_load_dwordx4 v[12:15], v221, s[24:27], s43 offen offset:0 sc1
  v_mfma_f32_32x32x16_bf16 v[144:159], a[228:231], v[20:23], v[144:159]
  ds_read_b64_tr_b16 a[212:213], v247 offset:16384
  ds_read_b64_tr_b16 a[214:215], v247 offset:17408
  v_mfma_f32_32x32x16_bf16 v[96:111], a[232:235], v[16:19], v[96:111]
  ds_read_b64_tr_b16 a[216:217], v248 offset:16384
  ds_read_b64_tr_b16 a[218:219], v248 offset:17408
  v_mfma_f32_32x32x16_bf16 v[160:175], a[232:235], v[20:23], v[160:175]
  ds_read_b64_tr_b16 a[220:221], v249 offset:16384
  ds_read_b64_tr_b16 a[222:223], v249 offset:17408
  v_mfma_f32_32x32x16_bf16 v[112:127], a[236:239], v[16:19], v[112:127]
  v_mfma_f32_32x32x16_bf16 v[176:191], a[236:239], v[20:23], v[176:191]
  s_waitcnt vmcnt(18)
  s_waitcnt lgkmcnt(8)
  s_add_u32 s43, s48, 12288
  v_mfma_f32_32x32x16_bf16 v[64:79], a[192:195], v[24:27], v[64:79]
  buffer_load_dwordx4 v[16:19], v221, s[24:27], s43 offen offset:1024 sc1
  v_mfma_f32_32x32x16_bf16 v[128:143], a[192:195], v[28:31], v[128:143]
  ds_read_b64_tr_b16 a[224:225], v246 offset:20480
  ds_read_b64_tr_b16 a[226:227], v246 offset:21504
  s_add_u32 s43, s49, 12288
  v_mfma_f32_32x32x16_bf16 v[80:95], a[196:199], v[24:27], v[80:95]
  buffer_load_dwordx4 v[20:23], v221, s[24:27], s43 offen offset:1024 sc1
  v_mfma_f32_32x32x16_bf16 v[144:159], a[196:199], v[28:31], v[144:159]
  ds_read_b64_tr_b16 a[228:229], v247 offset:20480
  ds_read_b64_tr_b16 a[230:231], v247 offset:21504
  v_mfma_f32_32x32x16_bf16 v[96:111], a[200:203], v[24:27], v[96:111]
  ds_read_b64_tr_b16 a[232:233], v248 offset:20480
  ds_read_b64_tr_b16 a[234:235], v248 offset:21504
  v_mfma_f32_32x32x16_bf16 v[160:175], a[200:203], v[28:31], v[160:175]
  ds_read_b64_tr_b16 a[236:237], v249 offset:20480
  ds_read_b64_tr_b16 a[238:239], v249 offset:21504
  v_mfma_f32_32x32x16_bf16 v[112:127], a[204:207], v[24:27], v[112:127]
  v_mfma_f32_32x32x16_bf16 v[176:191], a[204:207], v[28:31], v[176:191]
  s_waitcnt vmcnt(18)
  s_waitcnt lgkmcnt(8)
  s_add_u32 s43, s48, 12288
  v_mfma_f32_32x32x16_bf16 v[64:79], a[208:211], v[32:35], v[64:79]
  buffer_load_dwordx4 v[24:27], v221, s[24:27], s43 offen offset:2048 sc1
  v_mfma_f32_32x32x16_bf16 v[128:143], a[208:211], v[36:39], v[128:143]
  ds_read_b64_tr_b16 a[192:193], v246 offset:24576
  ds_read_b64_tr_b16 a[194:195], v246 offset:25600
  s_add_u32 s43, s49, 12288
  v_mfma_f32_32x32x16_bf16 v[80:95], a[212:215], v[32:35], v[80:95]
  buffer_load_dwordx4 v[28:31], v221, s[24:27], s43 offen offset:2048 sc1
  v_mfma_f32_32x32x16_bf16 v[144:159], a[212:215], v[36:39], v[144:159]
  ds_read_b64_tr_b16 a[196:197], v247 offset:24576
  ds_read_b64_tr_b16 a[198:199], v247 offset:25600
  v_mfma_f32_32x32x16_bf16 v[96:111], a[216:219], v[32:35], v[96:111]
  ds_read_b64_tr_b16 a[200:201], v248 offset:24576
  ds_read_b64_tr_b16 a[202:203], v248 offset:25600
  v_mfma_f32_32x32x16_bf16 v[160:175], a[216:219], v[36:39], v[160:175]
  ds_read_b64_tr_b16 a[204:205], v249 offset:24576
  ds_read_b64_tr_b16 a[206:207], v249 offset:25600
  v_mfma_f32_32x32x16_bf16 v[112:127], a[220:223], v[32:35], v[112:127]
  v_mfma_f32_32x32x16_bf16 v[176:191], a[220:223], v[36:39], v[176:191]
  s_waitcnt vmcnt(18)
  s_waitcnt lgkmcnt(8)
  s_add_u32 s43, s48, 12288
  v_mfma_f32_32x32x16_bf16 v[64:79], a[224:227], v[40:43], v[64:79]
  buffer_load_dwordx4 v[32:35], v221, s[24:27], s43 offen offset:3072 sc1
  v_mfma_f32_32x32x16_bf16 v[128:143], a[224:227], v[44:47], v[128:143]
  ds_read_b64_tr_b16 a[208:209], v246 offset:28672
  ds_read_b64_tr_b16 a[210:211], v246 offset:29696
  s_add_u32 s43, s49, 12288
  v_mfma_f32_32x32x16_bf16 v[80:95], a[228:231], v[40:43], v[80:95]
  buffer_load_dwordx4 v[36:39], v221, s[24:27], s43 offen offset:3072 sc1
  v_mfma_f32_32x32x16_bf16 v[144:159], a[228:231], v[44:47], v[144:159]
  ds_read_b64_tr_b16 a[212:213], v247 offset:28672
  ds_read_b64_tr_b16 a[214:215], v247 offset:29696
  v_mfma_f32_32x32x16_bf16 v[96:111], a[232:235], v[40:43], v[96:111]
  ds_read_b64_tr_b16 a[216:217], v248 offset:28672
  ds_read_b64_tr_b16 a[218:219], v248 offset:29696
  v_mfma_f32_32x32x16_bf16 v[160:175], a[232:235], v[44:47], v[160:175]
  ds_read_b64_tr_b16 a[220:221], v249 offset:28672
  ds_read_b64_tr_b16 a[222:223], v249 offset:29696
  v_mfma_f32_32x32x16_bf16 v[112:127], a[236:239], v[40:43], v[112:127]
  v_mfma_f32_32x32x16_bf16 v[176:191], a[236:239], v[44:47], v[176:191]
  s_waitcnt vmcnt(18)
  s_waitcnt lgkmcnt(8)
  s_add_u32 s43, s48, 16384
  v_mfma_f32_32x32x16_bf16 v[64:79], a[192:195], v[48:51], v[64:79]
  buffer_load_dwordx4 v[40:43], v221, s[24:27], s43 offen offset:0 sc1
  v_mfma_f32_32x32x16_bf16 v[128:143], a[192:195], v[52:55], v[128:143]
  ds_read_b64_tr_b16 a[224:225], v246 offset:32768
  ds_read_b64_tr_b16 a[226:227], v246 offset:33792
  s_add_u32 s43, s49, 16384
  v_mfma_f32_32x32x16_bf16 v[80:95], a[196:199], v[48:51], v[80:95]
  buffer_load_dwordx4 v[44:47], v221, s[24:27], s43 offen offset:0 sc1
  v_mfma_f32_32x32x16_bf16 v[144:159], a[196:199], v[52:55], v[144:159]
  ds_read_b64_tr_b16 a[228:229], v247 offset:32768
  ds_read_b64_tr_b16 a[230:231], v247 offset:33792
  v_mfma_f32_32x32x16_bf16 v[96:111], a[200:203], v[48:51], v[96:111]
  ds_read_b64_tr_b16 a[232:233], v248 offset:32768
  ds_read_b64_tr_b16 a[234:235], v248 offset:33792
  v_mfma_f32_32x32x16_bf16 v[160:175], a[200:203], v[52:55], v[160:175]
  ds_read_b64_tr_b16 a[236:237], v249 offset:32768
  ds_read_b64_tr_b16 a[238:239], v249 offset:33792
  v_mfma_f32_32x32x16_bf16 v[112:127], a[204:207], v[48:51], v[112:127]
  v_mfma_f32_32x32x16_bf16 v[176:191], a[204:207], v[52:55], v[176:191]
  s_waitcnt vmcnt(18)
  s_waitcnt lgkmcnt(0)
  s_barrier
  s_add_u32 s43, s48, 16384
  v_mfma_f32_32x32x16_bf16 v[64:79], a[208:211], v[56:59], v[64:79]
  buffer_load_dwordx4 v[48:51], v221, s[24:27], s43 offen offset:1024 sc1
  v_mfma_f32_32x32x16_bf16 v[128:143], a[208:211], v[60:63], v[128:143]
  ds_read_b64_tr_b16 a[192:193], v246 offset:36864
  ds_read_b64_tr_b16 a[194:195], v246 offset:37888
  s_add_u32 s43, s49, 16384
  v_mfma_f32_32x32x16_bf16 v[80:95], a[212:215], v[56:59], v[80:95]
  buffer_load_dwordx4 v[52:55], v221, s[24:27], s43 offen offset:1024 sc1
  v_mfma_f32_32x32x16_bf16 v[144:159], a[212:215], v[60:63], v[144:159]
  ds_read_b64_tr_b16 a[196:197], v247 offset:36864
  ds_read_b64_tr_b16 a[198:199], v247 offset:37888
  s_add_u32 m0, s41, 0
  s_add_u32 s43, s41, 0
  v_mfma_f32_32x32x16_bf16 v[96:111], a[216:219], v[56:59], v[96:111]
  buffer_load_dwordx4 v236, s[12:15], s43 offen offset:0 lds
  v_mfma_f32_32x32x16_bf16 v[160:175], a[216:219], v[60:63], v[160:175]
  ds_read_b64_tr_b16 a[200:201], v248 offset:36864
  ds_read_b64_tr_b16 a[202:203], v248 offset:37888
  s_add_u32 m0, s41, 0
  s_add_u32 s43, s41, 0
  v_mfma_f32_32x32x16_bf16 v[112:127], a[220:223], v[56:59], v[112:127]
  buffer_load_dwordx4 v237, s[12:15], s43 offen offset:1024 lds
  v_mfma_f32_32x32x16_bf16 v[176:191], a[220:223], v[60:63], v[176:191]
  ds_read_b64_tr_b16 a[204:205], v249 offset:36864
  ds_read_b64_tr_b16 a[206:207], v249 offset:37888
  s_waitcnt vmcnt(20)
  s_add_u32 s43, s48, 16384
  v_mfma_f32_32x32x16_bf16 v[64:79], a[224:227], v[192:195], v[64:79]
  buffer_load_dwordx4 v[56:59], v221, s[24:27], s43 offen offset:2048 sc1
  v_mfma_f32_32x32x16_bf16 v[128:143], a[224:227], v[196:199], v[128:143]
  ds_read_b64_tr_b16 a[208:209], v246 offset:40960
  ds_read_b64_tr_b16 a[210:211], v246 offset:41984
  s_add_u32 s43, s49, 16384
  v_mfma_f32_32x32x16_bf16 v[80:95], a[228:231], v[192:195], v[80:95]
  buffer_load_dwordx4 v[60:63], v221, s[24:27], s43 offen offset:2048 sc1
  v_mfma_f32_32x32x16_bf16 v[144:159], a[228:231], v[196:199], v[144:159]
  ds_read_b64_tr_b16 a[212:213], v247 offset:40960
  ds_read_b64_tr_b16 a[214:215], v247 offset:41984
  s_add_u32 m0, s41, 0
  s_add_u32 s43, s41, 0
  v_mfma_f32_32x32x16_bf16 v[96:111], a[232:235], v[192:195], v[96:111]
  buffer_load_dwordx4 v238, s[12:15], s43 offen offset:2048 lds
  v_mfma_f32_32x32x16_bf16 v[160:175], a[232:235], v[196:199], v[160:175]
  ds_read_b64_tr_b16 a[216:217], v248 offset:40960
  ds_read_b64_tr_b16 a[218:219], v248 offset:41984
  s_add_u32 m0, s41, 0
  s_add_u32 s43, s41, 0
  v_mfma_f32_32x32x16_bf16 v[112:127], a[236:239], v[192:195], v[112:127]
  buffer_load_dwordx4 v239, s[12:15], s43 offen offset:3072 lds
  v_mfma_f32_32x32x16_bf16 v[176:191], a[236:239], v[196:199], v[176:191]
  ds_read_b64_tr_b16 a[220:221], v249 offset:40960
  ds_read_b64_tr_b16 a[222:223], v249 offset:41984
  s_waitcnt vmcnt(22)
  s_waitcnt lgkmcnt(8)
  s_add_u32 s43, s48, 16384
  v_mfma_f32_32x32x16_bf16 v[64:79], a[192:195], v[200:203], v[64:79]
  buffer_load_dwordx4 v[192:195], v221, s[24:27], s43 offen offset:3072 sc1
  v_mfma_f32_32x32x16_bf16 v[128:143], a[192:195], v[204:207], v[128:143]
  ds_read_b64_tr_b16 a[224:225], v246 offset:45056
  ds_read_b64_tr_b16 a[226:227], v246 offset:46080
  s_add_u32 s43, s49, 16384
  v_mfma_f32_32x32x16_bf16 v[80:95], a[196:199], v[200:203], v[80:95]
  buffer_load_dwordx4 v[196:199], v221, s[24:27], s43 offen offset:3072 sc1
  v_mfma_f32_32x32x16_bf16 v[144:159], a[196:199], v[204:207], v[144:159]
  ds_read_b64_tr_b16 a[228:229], v247 offset:45056
  ds_read_b64_tr_b16 a[230:231], v247 offset:46080
  s_add_u32 m0, s41, 16384
  s_add_u32 s43, s41, 16384
  v_mfma_f32_32x32x16_bf16 v[96:111], a[200:203], v[200:203], v[96:111]
  buffer_load_dwordx4 v236, s[12:15], s43 offen offset:0 lds
  v_mfma_f32_32x32x16_bf16 v[160:175], a[200:203], v[204:207], v[160:175]
  ds_read_b64_tr_b16 a[232:233], v248 offset:45056
  ds_read_b64_tr_b16 a[234:235], v248 offset:46080
  s_add_u32 m0, s41, 16384
  s_add_u32 s43, s41, 16384
  v_mfma_f32_32x32x16_bf16 v[112:127], a[204:207], v[200:203], v[112:127]
  buffer_load_dwordx4 v237, s[12:15], s43 offen offset:1024 lds
  v_mfma_f32_32x32x16_bf16 v[176:191], a[204:207], v[204:207], v[176:191]
  ds_read_b64_tr_b16 a[236:237], v249 offset:45056
  ds_read_b64_tr_b16 a[238:239], v249 offset:46080
  s_waitcnt vmcnt(24)
  s_waitcnt lgkmcnt(8)
  s_add_u32 s43, s48, 20480
  v_mfma_f32_32x32x16_bf16 v[64:79], a[208:211], v[208:211], v[64:79]
  buffer_load_dwordx4 v[200:203], v221, s[24:27], s43 offen offset:0 sc1
  v_mfma_f32_32x32x16_bf16 v[128:143], a[208:211], v[212:215], v[128:143]
  ds_read_b64_tr_b16 a[192:193], v246 offset:49152
  ds_read_b64_tr_b16 a[194:195], v246 offset:50176
  s_add_u32 s43, s49, 20480
  v_mfma_f32_32x32x16_bf16 v[80:95], a[212:215], v[208:211], v[80:95]
  buffer_load_dwordx4 v[204:207], v221, s[24:27], s43 offen offset:0 sc1
  v_mfma_f32_32x32x16_bf16 v[144:159], a[212:215], v[212:215], v[144:159]
  ds_read_b64_tr_b16 a[196:197], v247 offset:49152
  ds_read_b64_tr_b16 a[198:199], v247 offset:50176
  s_add_u32 m0, s41, 16384
  s_add_u32 s43, s41, 16384
  v_mfma_f32_32x32x16_bf16 v[96:111], a[216:219], v[208:211], v[96:111]
  buffer_load_dwordx4 v238, s[12:15], s43 offen offset:2048 lds
  v_mfma_f32_32x32x16_bf16 v[160:175], a[216:219], v[212:215], v[160:175]
  ds_read_b64_tr_b16 a[200:201], v248 offset:49152
  ds_read_b64_tr_b16 a[202:203], v248 offset:50176
  s_add_u32 m0, s41, 16384
  s_add_u32 s43, s41, 16384
  v_mfma_f32_32x32x16_bf16 v[112:127], a[220:223], v[208:211], v[112:127]
  buffer_load_dwordx4 v239, s[12:15], s43 offen offset:3072 lds
  v_mfma_f32_32x32x16_bf16 v[176:191], a[220:223], v[212:215], v[176:191]
  ds_read_b64_tr_b16 a[204:205], v249 offset:49152
  ds_read_b64_tr_b16 a[206:207], v249 offset:50176
  s_waitcnt vmcnt(26)
  s_waitcnt lgkmcnt(8)
  s_add_u32 s43, s48, 20480
  v_mfma_f32_32x32x16_bf16 v[64:79], a[224:227], v[0:3], v[64:79]
  buffer_load_dwordx4 v[208:211], v221, s[24:27], s43 offen offset:1024 sc1
  v_mfma_f32_32x32x16_bf16 v[128:143], a[224:227], v[4:7], v[128:143]
  ds_read_b64_tr_b16 a[208:209], v246 offset:53248
  ds_read_b64_tr_b16 a[210:211], v246 offset:54272
  s_add_u32 s43, s49, 20480
  v_mfma_f32_32x32x16_bf16 v[80:95], a[228:231], v[0:3], v[80:95]
  buffer_load_dwordx4 v[212:215], v221, s[24:27], s43 offen offset:1024 sc1
  v_mfma_f32_32x32x16_bf16 v[144:159], a[228:231], v[4:7], v[144:159]
  ds_read_b64_tr_b16 a[212:213], v247 offset:53248
  ds_read_b64_tr_b16 a[214:215], v247 offset:54272
  v_mfma_f32_32x32x16_bf16 v[96:111], a[232:235], v[0:3], v[96:111]
  ds_read_b64_tr_b16 a[216:217], v248 offset:53248
  ds_read_b64_tr_b16 a[218:219], v248 offset:54272
  v_mfma_f32_32x32x16_bf16 v[160:175], a[232:235], v[4:7], v[160:175]
  ds_read_b64_tr_b16 a[220:221], v249 offset:53248
  ds_read_b64_tr_b16 a[222:223], v249 offset:54272
  v_mfma_f32_32x32x16_bf16 v[112:127], a[236:239], v[0:3], v[112:127]
  v_mfma_f32_32x32x16_bf16 v[176:191], a[236:239], v[4:7], v[176:191]
  s_waitcnt vmcnt(26)
  s_waitcnt lgkmcnt(8)
  s_add_u32 s43, s48, 20480
  v_mfma_f32_32x32x16_bf16 v[64:79], a[192:195], v[8:11], v[64:79]
  buffer_load_dwordx4 v[0:3], v221, s[24:27], s43 offen offset:2048 sc1
  v_mfma_f32_32x32x16_bf16 v[128:143], a[192:195], v[12:15], v[128:143]
  ds_read_b64_tr_b16 a[224:225], v246 offset:57344
  ds_read_b64_tr_b16 a[226:227], v246 offset:58368
  s_add_u32 s43, s49, 20480
  v_mfma_f32_32x32x16_bf16 v[80:95], a[196:199], v[8:11], v[80:95]
  buffer_load_dwordx4 v[4:7], v221, s[24:27], s43 offen offset:2048 sc1
  v_mfma_f32_32x32x16_bf16 v[144:159], a[196:199], v[12:15], v[144:159]
  ds_read_b64_tr_b16 a[228:229], v247 offset:57344
  ds_read_b64_tr_b16 a[230:231], v247 offset:58368
  v_mfma_f32_32x32x16_bf16 v[96:111], a[200:203], v[8:11], v[96:111]
  ds_read_b64_tr_b16 a[232:233], v248 offset:57344
  ds_read_b64_tr_b16 a[234:235], v248 offset:58368
  v_mfma_f32_32x32x16_bf16 v[160:175], a[200:203], v[12:15], v[160:175]
  ds_read_b64_tr_b16 a[236:237], v249 offset:57344
  ds_read_b64_tr_b16 a[238:239], v249 offset:58368
  v_mfma_f32_32x32x16_bf16 v[112:127], a[204:207], v[8:11], v[112:127]
  v_mfma_f32_32x32x16_bf16 v[176:191], a[204:207], v[12:15], v[176:191]
  s_waitcnt vmcnt(26)
  s_waitcnt lgkmcnt(8)
  s_add_u32 s43, s48, 20480
  v_mfma_f32_32x32x16_bf16 v[64:79], a[208:211], v[16:19], v[64:79]
  buffer_load_dwordx4 v[8:11], v221, s[24:27], s43 offen offset:3072 sc1
  v_mfma_f32_32x32x16_bf16 v[128:143], a[208:211], v[20:23], v[128:143]
  ds_read_b64_tr_b16 a[192:193], v246 offset:61440
  ds_read_b64_tr_b16 a[194:195], v246 offset:62464
  s_add_u32 s43, s49, 20480
  v_mfma_f32_32x32x16_bf16 v[80:95], a[212:215], v[16:19], v[80:95]
  buffer_load_dwordx4 v[12:15], v221, s[24:27], s43 offen offset:3072 sc1
  v_mfma_f32_32x32x16_bf16 v[144:159], a[212:215], v[20:23], v[144:159]
  ds_read_b64_tr_b16 a[196:197], v247 offset:61440
  ds_read_b64_tr_b16 a[198:199], v247 offset:62464
  v_mfma_f32_32x32x16_bf16 v[96:111], a[216:219], v[16:19], v[96:111]
  ds_read_b64_tr_b16 a[200:201], v248 offset:61440
  ds_read_b64_tr_b16 a[202:203], v248 offset:62464
  v_mfma_f32_32x32x16_bf16 v[160:175], a[216:219], v[20:23], v[160:175]
  ds_read_b64_tr_b16 a[204:205], v249 offset:61440
  ds_read_b64_tr_b16 a[206:207], v249 offset:62464
  v_mfma_f32_32x32x16_bf16 v[112:127], a[220:223], v[16:19], v[112:127]
  v_mfma_f32_32x32x16_bf16 v[176:191], a[220:223], v[20:23], v[176:191]
  s_waitcnt vmcnt(26)
  s_waitcnt lgkmcnt(8)
  v_add_u32 v246, 65536, v246
  v_add_u32 v247, 65536, v247
  v_add_u32 v248, 65536, v248
  v_add_u32 v249, 65536, v249
  s_add_u32 s43, s48, 24576
  v_mfma_f32_32x32x16_bf16 v[64:79], a[224:227], v[24:27], v[64:79]
  buffer_load_dwordx4 v[16:19], v221, s[24:27], s43 offen offset:0 sc1
  v_mfma_f32_32x32x16_bf16 v[128:143], a[224:227], v[28:31], v[128:143]
  ds_read_b64_tr_b16 a[208:209], v246 offset:0
  ds_read_b64_tr_b16 a[210:211], v246 offset:1024
  s_add_u32 s43, s49, 24576
  v_mfma_f32_32x32x16_bf16 v[80:95], a[228:231], v[24:27], v[80:95]
  buffer_load_dwordx4 v[20:23], v221, s[24:27], s43 offen offset:0 sc1
  v_mfma_f32_32x32x16_bf16 v[144:159], a[228:231], v[28:31], v[144:159]
  ds_read_b64_tr_b16 a[212:213], v247 offset:0
  ds_read_b64_tr_b16 a[214:215], v247 offset:1024
  v_mfma_f32_32x32x16_bf16 v[96:111], a[232:235], v[24:27], v[96:111]
  ds_read_b64_tr_b16 a[216:217], v248 offset:0
  ds_read_b64_tr_b16 a[218:219], v248 offset:1024
  v_mfma_f32_32x32x16_bf16 v[160:175], a[232:235], v[28:31], v[160:175]
  ds_read_b64_tr_b16 a[220:221], v249 offset:0
  ds_read_b64_tr_b16 a[222:223], v249 offset:1024
  v_mfma_f32_32x32x16_bf16 v[112:127], a[236:239], v[24:27], v[112:127]
  v_mfma_f32_32x32x16_bf16 v[176:191], a[236:239], v[28:31], v[176:191]
  s_waitcnt vmcnt(26)
  s_waitcnt lgkmcnt(0)
  s_barrier
  s_add_u32 s43, s48, 24576
  v_mfma_f32_32x32x16_bf16 v[64:79], a[192:195], v[32:35], v[64:79]
  buffer_load_dwordx4 v[24:27], v221, s[24:27], s43 offen offset:1024 sc1
  v_mfma_f32_32x32x16_bf16 v[128:143], a[192:195], v[36:39], v[128:143]
  ds_read_b64_tr_b16 a[224:225], v246 offset:4096
  ds_read_b64_tr_b16 a[226:227], v246 offset:5120
  s_add_u32 s43, s49, 24576
  v_mfma_f32_32x32x16_bf16 v[80:95], a[196:199], v[32:35], v[80:95]
  buffer_load_dwordx4 v[28:31], v221, s[24:27], s43 offen offset:1024 sc1
  v_mfma_f32_32x32x16_bf16 v[144:159], a[196:199], v[36:39], v[144:159]
  ds_read_b64_tr_b16 a[228:229], v247 offset:4096
  ds_read_b64_tr_b16 a[230:231], v247 offset:5120
  s_add_u32 m0, s41, 32768
  s_add_u32 s43, s41, 32768
  v_mfma_f32_32x32x16_bf16 v[96:111], a[200:203], v[32:35], v[96:111]
  buffer_load_dwordx4 v236, s[12:15], s43 offen offset:0 lds
  v_mfma_f32_32x32x16_bf16 v[160:175], a[200:203], v[36:39], v[160:175]
  ds_read_b64_tr_b16 a[232:233], v248 offset:4096
  ds_read_b64_tr_b16 a[234:235], v248 offset:5120
  s_add_u32 m0, s41, 32768
  s_add_u32 s43, s41, 32768
  v_mfma_f32_32x32x16_bf16 v[112:127], a[204:207], v[32:35], v[112:127]
  buffer_load_dwordx4 v237, s[12:15], s43 offen offset:1024 lds
  v_mfma_f32_32x32x16_bf16 v[176:191], a[204:207], v[36:39], v[176:191]
  ds_read_b64_tr_b16 a[236:237], v249 offset:4096
  ds_read_b64_tr_b16 a[238:239], v249 offset:5120
  s_waitcnt vmcnt(28)
  s_add_u32 s43, s48, 24576
  v_mfma_f32_32x32x16_bf16 v[64:79], a[208:211], v[40:43], v[64:79]
  buffer_load_dwordx4 v[32:35], v221, s[24:27], s43 offen offset:2048 sc1
  v_mfma_f32_32x32x16_bf16 v[128:143], a[208:211], v[44:47], v[128:143]
  ds_read_b64_tr_b16 a[192:193], v246 offset:8192
  ds_read_b64_tr_b16 a[194:195], v246 offset:9216
  s_add_u32 s43, s49, 24576
  v_mfma_f32_32x32x16_bf16 v[80:95], a[212:215], v[40:43], v[80:95]
  buffer_load_dwordx4 v[36:39], v221, s[24:27], s43 offen offset:2048 sc1
  v_mfma_f32_32x32x16_bf16 v[144:159], a[212:215], v[44:47], v[144:159]
  ds_read_b64_tr_b16 a[196:197], v247 offset:8192
  ds_read_b64_tr_b16 a[198:199], v247 offset:9216
  s_add_u32 m0, s41, 32768
  s_add_u32 s43, s41, 32768
  v_mfma_f32_32x32x16_bf16 v[96:111], a[216:219], v[40:43], v[96:111]
  buffer_load_dwordx4 v238, s[12:15], s43 offen offset:2048 lds
  v_mfma_f32_32x32x16_bf16 v[160:175], a[216:219], v[44:47], v[160:175]
  ds_read_b64_tr_b16 a[200:201], v248 offset:8192
  ds_read_b64_tr_b16 a[202:203], v248 offset:9216
  s_add_u32 m0, s41, 32768
  s_add_u32 s43, s41, 32768
  v_mfma_f32_32x32x16_bf16 v[112:127], a[220:223], v[40:43], v[112:127]
  buffer_load_dwordx4 v239, s[12:15], s43 offen offset:3072 lds
  v_mfma_f32_32x32x16_bf16 v[176:191], a[220:223], v[44:47], v[176:191]
  ds_read_b64_tr_b16 a[204:205], v249 offset:8192
  ds_read_b64_tr_b16 a[206:207], v249 offset:9216
  s_waitcnt vmcnt(30)
  s_waitcnt lgkmcnt(8)
  s_add_u32 s43, s48, 24576
  v_mfma_f32_32x32x16_bf16 v[64:79], a[224:227], v[48:51], v[64:79]
  buffer_load_dwordx4 v[40:43], v221, s[24:27], s43 offen offset:3072 sc1
  v_mfma_f32_32x32x16_bf16 v[128:143], a[224:227], v[52:55], v[128:143]
  ds_read_b64_tr_b16 a[208:209], v246 offset:12288
  ds_read_b64_tr_b16 a[210:211], v246 offset:13312
  s_add_u32 s43, s49, 24576
  v_mfma_f32_32x32x16_bf16 v[80:95], a[228:231], v[48:51], v[80:95]
  buffer_load_dwordx4 v[44:47], v221, s[24:27], s43 offen offset:3072 sc1
  v_mfma_f32_32x32x16_bf16 v[144:159], a[228:231], v[52:55], v[144:159]
  ds_read_b64_tr_b16 a[212:213], v247 offset:12288
  ds_read_b64_tr_b16 a[214:215], v247 offset:13312
  s_add_u32 m0, s41, 49152
  s_add_u32 s43, s41, 49152
  v_mfma_f32_32x32x16_bf16 v[96:111], a[232:235], v[48:51], v[96:111]
  buffer_load_dwordx4 v236, s[12:15], s43 offen offset:0 lds
  v_mfma_f32_32x32x16_bf16 v[160:175], a[232:235], v[52:55], v[160:175]
  ds_read_b64_tr_b16 a[216:217], v248 offset:12288
  ds_read_b64_tr_b16 a[218:219], v248 offset:13312
  s_add_u32 m0, s41, 49152
  s_add_u32 s43, s41, 49152
  v_mfma_f32_32x32x16_bf16 v[112:127], a[236:239], v[48:51], v[112:127]
  buffer_load_dwordx4 v237, s[12:15], s43 offen offset:1024 lds
  v_mfma_f32_32x32x16_bf16 v[176:191], a[236:239], v[52:55], v[176:191]
  ds_read_b64_tr_b16 a[220:221], v249 offset:12288
  ds_read_b64_tr_b16 a[222:223], v249 offset:13312
  s_waitcnt vmcnt(30)
  s_waitcnt lgkmcnt(8)
  s_add_u32 s43, s48, 28672
  v_mfma_f32_32x32x16_bf16 v[64:79], a[192:195], v[56:59], v[64:79]
  buffer_load_dwordx4 v[48:51], v221, s[24:27], s43 offen offset:0 sc1
  v_mfma_f32_32x32x16_bf16 v[128:143], a[192:195], v[60:63], v[128:143]
  ds_read_b64_tr_b16 a[224:225], v246 offset:16384
  ds_read_b64_tr_b16 a[226:227], v246 offset:17408
  s_add_u32 s43, s49, 28672
  v_mfma_f32_32x32x16_bf16 v[80:95], a[196:199], v[56:59], v[80:95]
  buffer_load_dwordx4 v[52:55], v221, s[24:27], s43 offen offset:0 sc1
  v_mfma_f32_32x32x16_bf16 v[144:159], a[196:199], v[60:63], v[144:159]
  ds_read_b64_tr_b16 a[228:229], v247 offset:16384
  ds_read_b64_tr_b16 a[230:231], v247 offset:17408
  s_add_u32 m0, s41, 49152
  s_add_u32 s43, s41, 49152
  v_mfma_f32_32x32x16_bf16 v[96:111], a[200:203], v[56:59], v[96:111]
  buffer_load_dwordx4 v238, s[12:15], s43 offen offset:2048 lds
  v_mfma_f32_32x32x16_bf16 v[160:175], a[200:203], v[60:63], v[160:175]
  ds_read_b64_tr_b16 a[232:233], v248 offset:16384
  ds_read_b64_tr_b16 a[234:235], v248 offset:17408
  s_add_u32 m0, s41, 49152
  s_add_u32 s43, s41, 49152
  v_mfma_f32_32x32x16_bf16 v[112:127], a[204:207], v[56:59], v[112:127]
  buffer_load_dwordx4 v239, s[12:15], s43 offen offset:3072 lds
  v_mfma_f32_32x32x16_bf16 v[176:191], a[204:207], v[60:63], v[176:191]
  ds_read_b64_tr_b16 a[236:237], v249 offset:16384
  ds_read_b64_tr_b16 a[238:239], v249 offset:17408
  s_waitcnt vmcnt(30)
  s_waitcnt lgkmcnt(8)
  s_add_u32 s43, s48, 28672
  v_mfma_f32_32x32x16_bf16 v[64:79], a[208:211], v[192:195], v[64:79]
  buffer_load_dwordx4 v[56:59], v221, s[24:27], s43 offen offset:1024 sc1
  v_mfma_f32_32x32x16_bf16 v[128:143], a[208:211], v[196:199], v[128:143]
  ds_read_b64_tr_b16 a[192:193], v246 offset:20480
  ds_read_b64_tr_b16 a[194:195], v246 offset:21504
  s_add_u32 s43, s49, 28672
  v_mfma_f32_32x32x16_bf16 v[80:95], a[212:215], v[192:195], v[80:95]
  buffer_load_dwordx4 v[60:63], v221, s[24:27], s43 offen offset:1024 sc1
  v_mfma_f32_32x32x16_bf16 v[144:159], a[212:215], v[196:199], v[144:159]
  ds_read_b64_tr_b16 a[196:197], v247 offset:20480
  ds_read_b64_tr_b16 a[198:199], v247 offset:21504
  v_mfma_f32_32x32x16_bf16 v[96:111], a[216:219], v[192:195], v[96:111]
  ds_read_b64_tr_b16 a[200:201], v248 offset:20480
  ds_read_b64_tr_b16 a[202:203], v248 offset:21504
  v_mfma_f32_32x32x16_bf16 v[160:175], a[216:219], v[196:199], v[160:175]
  ds_read_b64_tr_b16 a[204:205], v249 offset:20480
  ds_read_b64_tr_b16 a[206:207], v249 offset:21504
  v_mfma_f32_32x32x16_bf16 v[112:127], a[220:223], v[192:195], v[112:127]
  v_mfma_f32_32x32x16_bf16 v[176:191], a[220:223], v[196:199], v[176:191]
  s_waitcnt vmcnt(28)
  s_waitcnt lgkmcnt(8)
  s_add_u32 s43, s48, 28672
  v_mfma_f32_32x32x16_bf16 v[64:79], a[224:227], v[200:203], v[64:79]
  buffer_load_dwordx4 v[192:195], v221, s[24:27], s43 offen offset:2048 sc1
  v_mfma_f32_32x32x16_bf16 v[128:143], a[224:227], v[204:207], v[128:143]
  ds_read_b64_tr_b16 a[208:209], v246 offset:24576
  ds_read_b64_tr_b16 a[210:211], v246 offset:25600
  s_add_u32 s43, s49, 28672
  v_mfma_f32_32x32x16_bf16 v[80:95], a[228:231], v[200:203], v[80:95]
  buffer_load_dwordx4 v[196:199], v221, s[24:27], s43 offen offset:2048 sc1
  v_mfma_f32_32x32x16_bf16 v[144:159], a[228:231], v[204:207], v[144:159]
  ds_read_b64_tr_b16 a[212:213], v247 offset:24576
  ds_read_b64_tr_b16 a[214:215], v247 offset:25600
  v_mfma_f32_32x32x16_bf16 v[96:111], a[232:235], v[200:203], v[96:111]
  ds_read_b64_tr_b16 a[216:217], v248 offset:24576
  ds_read_b64_tr_b16 a[218:219], v248 offset:25600
  v_mfma_f32_32x32x16_bf16 v[160:175], a[232:235], v[204:207], v[160:175]
  ds_read_b64_tr_b16 a[220:221], v249 offset:24576
  ds_read_b64_tr_b16 a[222:223], v249 offset:25600
  v_mfma_f32_32x32x16_bf16 v[112:127], a[236:239], v[200:203], v[112:127]
  v_mfma_f32_32x32x16_bf16 v[176:191], a[236:239], v[204:207], v[176:191]
  s_waitcnt vmcnt(26)
  s_waitcnt lgkmcnt(8)
  s_add_u32 s43, s48, 28672
  v_mfma_f32_32x32x16_bf16 v[64:79], a[192:195], v[208:211], v[64:79]
  buffer_load_dwordx4 v[200:203], v221, s[24:27], s43 offen offset:3072 sc1
  v_mfma_f32_32x32x16_bf16 v[128:143], a[192:195], v[212:215], v[128:143]
  ds_read_b64_tr_b16 a[224:225], v246 offset:28672
  ds_read_b64_tr_b16 a[226:227], v246 offset:29696
  s_add_u32 s43, s49, 28672
  v_mfma_f32_32x32x16_bf16 v[80:95], a[196:199], v[208:211], v[80:95]
  buffer_load_dwordx4 v[204:207], v221, s[24:27], s43 offen offset:3072 sc1
  v_mfma_f32_32x32x16_bf16 v[144:159], a[196:199], v[212:215], v[144:159]
  ds_read_b64_tr_b16 a[228:229], v247 offset:28672
  ds_read_b64_tr_b16 a[230:231], v247 offset:29696
  v_mfma_f32_32x32x16_bf16 v[96:111], a[200:203], v[208:211], v[96:111]
  ds_read_b64_tr_b16 a[232:233], v248 offset:28672
  ds_read_b64_tr_b16 a[234:235], v248 offset:29696
  v_mfma_f32_32x32x16_bf16 v[160:175], a[200:203], v[212:215], v[160:175]
  ds_read_b64_tr_b16 a[236:237], v249 offset:28672
  ds_read_b64_tr_b16 a[238:239], v249 offset:29696
  v_mfma_f32_32x32x16_bf16 v[112:127], a[204:207], v[208:211], v[112:127]
  v_mfma_f32_32x32x16_bf16 v[176:191], a[204:207], v[212:215], v[176:191]
  s_waitcnt vmcnt(26)
  s_waitcnt lgkmcnt(8)
  v_mfma_f32_32x32x16_bf16 v[64:79], a[208:211], v[0:3], v[64:79]
  ds_read_b64_tr_b16 a[192:193], v246 offset:32768
  ds_read_b64_tr_b16 a[194:195], v246 offset:33792
  v_mfma_f32_32x32x16_bf16 v[128:143], a[208:211], v[4:7], v[128:143]
  ds_read_b64_tr_b16 a[196:197], v247 offset:32768
  ds_read_b64_tr_b16 a[198:199], v247 offset:33792
  v_mfma_f32_32x32x16_bf16 v[80:95], a[212:215], v[0:3], v[80:95]
  ds_read_b64_tr_b16 a[200:201], v248 offset:32768
  ds_read_b64_tr_b16 a[202:203], v248 offset:33792
  v_mfma_f32_32x32x16_bf16 v[144:159], a[212:215], v[4:7], v[144:159]
  ds_read_b64_tr_b16 a[204:205], v249 offset:32768
  ds_read_b64_tr_b16 a[206:207], v249 offset:33792
  v_mfma_f32_32x32x16_bf16 v[96:111], a[216:219], v[0:3], v[96:111]
  v_mfma_f32_32x32x16_bf16 v[160:175], a[216:219], v[4:7], v[160:175]
  v_mfma_f32_32x32x16_bf16 v[112:127], a[220:223], v[0:3], v[112:127]
  v_mfma_f32_32x32x16_bf16 v[176:191], a[220:223], v[4:7], v[176:191]
  s_waitcnt vmcnt(24)
  s_waitcnt lgkmcnt(0)
  s_barrier
  s_add_u32 m0, s41, 65536
  s_add_u32 s43, s41, 0
  v_mfma_f32_32x32x16_bf16 v[64:79], a[224:227], v[8:11], v[64:79]
  buffer_load_dwordx4 v240, s[16:19], s43 offen offset:0 lds
  v_mfma_f32_32x32x16_bf16 v[128:143], a[224:227], v[12:15], v[128:143]
  ds_read_b64_tr_b16 a[208:209], v246 offset:36864
  ds_read_b64_tr_b16 a[210:211], v246 offset:37888
  s_add_u32 m0, s41, 65536
  s_add_u32 s43, s41, 0
  v_mfma_f32_32x32x16_bf16 v[80:95], a[228:231], v[8:11], v[80:95]
  buffer_load_dwordx4 v240, s[16:19], s43 offen offset:1024 lds
  v_mfma_f32_32x32x16_bf16 v[144:159], a[228:231], v[12:15], v[144:159]
  ds_read_b64_tr_b16 a[212:213], v247 offset:36864
  ds_read_b64_tr_b16 a[214:215], v247 offset:37888
  s_add_u32 m0, s41, 65536
  s_add_u32 s43, s41, 0
  v_mfma_f32_32x32x16_bf16 v[96:111], a[232:235], v[8:11], v[96:111]
  buffer_load_dwordx4 v240, s[16:19], s43 offen offset:2048 lds
  v_mfma_f32_32x32x16_bf16 v[160:175], a[232:235], v[12:15], v[160:175]
  ds_read_b64_tr_b16 a[216:217], v248 offset:36864
  ds_read_b64_tr_b16 a[218:219], v248 offset:37888
  s_add_u32 m0, s41, 65536
  s_add_u32 s43, s41, 0
  v_mfma_f32_32x32x16_bf16 v[112:127], a[236:239], v[8:11], v[112:127]
  buffer_load_dwordx4 v240, s[16:19], s43 offen offset:3072 lds
  v_mfma_f32_32x32x16_bf16 v[176:191], a[236:239], v[12:15], v[176:191]
  ds_read_b64_tr_b16 a[220:221], v249 offset:36864
  ds_read_b64_tr_b16 a[222:223], v249 offset:37888
  s_waitcnt vmcnt(26)
  s_add_u32 m0, s41, 81920
  s_add_u32 s43, s41, 16384
  v_mfma_f32_32x32x16_bf16 v[64:79], a[192:195], v[16:19], v[64:79]
  buffer_load_dwordx4 v240, s[16:19], s43 offen offset:0 lds
  v_mfma_f32_32x32x16_bf16 v[128:143], a[192:195], v[20:23], v[128:143]
  ds_read_b64_tr_b16 a[224:225], v246 offset:40960
  ds_read_b64_tr_b16 a[226:227], v246 offset:41984
  s_add_u32 m0, s41, 81920
  s_add_u32 s43, s41, 16384
  v_mfma_f32_32x32x16_bf16 v[80:95], a[196:199], v[16:19], v[80:95]
  buffer_load_dwordx4 v240, s[16:19], s43 offen offset:1024 lds
  v_mfma_f32_32x32x16_bf16 v[144:159], a[196:199], v[20:23], v[144:159]
  ds_read_b64_tr_b16 a[228:229], v247 offset:40960
  ds_read_b64_tr_b16 a[230:231], v247 offset:41984
  s_add_u32 m0, s41, 81920
  s_add_u32 s43, s41, 16384
  v_mfma_f32_32x32x16_bf16 v[96:111], a[200:203], v[16:19], v[96:111]
  buffer_load_dwordx4 v240, s[16:19], s43 offen offset:2048 lds
  v_mfma_f32_32x32x16_bf16 v[160:175], a[200:203], v[20:23], v[160:175]
  ds_read_b64_tr_b16 a[232:233], v248 offset:40960
  ds_read_b64_tr_b16 a[234:235], v248 offset:41984
  s_add_u32 m0, s41, 81920
  s_add_u32 s43, s41, 16384
  v_mfma_f32_32x32x16_bf16 v[112:127], a[204:207], v[16:19], v[112:127]
  buffer_load_dwordx4 v240, s[16:19], s43 offen offset:3072 lds
  v_mfma_f32_32x32x16_bf16 v[176:191], a[204:207], v[20:23], v[176:191]
  ds_read_b64_tr_b16 a[236:237], v249 offset:40960
  ds_read_b64_tr_b16 a[238:239], v249 offset:41984
  s_waitcnt vmcnt(28)
  s_waitcnt lgkmcnt(8)
  v_mfma_f32_32x32x16_bf16 v[64:79], a[208:211], v[24:27], v[64:79]
  ds_read_b64_tr_b16 a[192:193], v246 offset:45056
  ds_read_b64_tr_b16 a[194:195], v246 offset:46080
  v_mfma_f32_32x32x16_bf16 v[128:143], a[208:211], v[28:31], v[128:143]
  ds_read_b64_tr_b16 a[196:197], v247 offset:45056
  ds_read_b64_tr_b16 a[198:199], v247 offset:46080
  v_mfma_f32_32x32x16_bf16 v[80:95], a[212:215], v[24:27], v[80:95]
  ds_read_b64_tr_b16 a[200:201], v248 offset:45056
  ds_read_b64_tr_b16 a[202:203], v248 offset:46080
  v_mfma_f32_32x32x16_bf16 v[144:159], a[212:215], v[28:31], v[144:159]
  ds_read_b64_tr_b16 a[204:205], v249 offset:45056
  ds_read_b64_tr_b16 a[206:207], v249 offset:46080
  v_mfma_f32_32x32x16_bf16 v[96:111], a[216:219], v[24:27], v[96:111]
  v_mfma_f32_32x32x16_bf16 v[160:175], a[216:219], v[28:31], v[160:175]
  v_mfma_f32_32x32x16_bf16 v[112:127], a[220:223], v[24:27], v[112:127]
  v_mfma_f32_32x32x16_bf16 v[176:191], a[220:223], v[28:31], v[176:191]
  s_waitcnt vmcnt(24)
  s_waitcnt lgkmcnt(8)
  v_mfma_f32_32x32x16_bf16 v[64:79], a[224:227], v[32:35], v[64:79]
  ds_read_b64_tr_b16 a[208:209], v246 offset:49152
  ds_read_b64_tr_b16 a[210:211], v246 offset:50176
  v_mfma_f32_32x32x16_bf16 v[128:143], a[224:227], v[36:39], v[128:143]
  ds_read_b64_tr_b16 a[212:213], v247 offset:49152
  ds_read_b64_tr_b16 a[214:215], v247 offset:50176
  v_mfma_f32_32x32x16_bf16 v[80:95], a[228:231], v[32:35], v[80:95]
  ds_read_b64_tr_b16 a[216:217], v248 offset:49152
  ds_read_b64_tr_b16 a[218:219], v248 offset:50176
  v_mfma_f32_32x32x16_bf16 v[144:159], a[228:231], v[36:39], v[144:159]
  ds_read_b64_tr_b16 a[220:221], v249 offset:49152
  ds_read_b64_tr_b16 a[222:223], v249 offset:50176
  v_mfma_f32_32x32x16_bf16 v[96:111], a[232:235], v[32:35], v[96:111]
  v_mfma_f32_32x32x16_bf16 v[160:175], a[232:235], v[36:39], v[160:175]
  v_mfma_f32_32x32x16_bf16 v[112:127], a[236:239], v[32:35], v[112:127]
  v_mfma_f32_32x32x16_bf16 v[176:191], a[236:239], v[36:39], v[176:191]
  s_waitcnt vmcnt(20)
  s_waitcnt lgkmcnt(8)
  v_mfma_f32_32x32x16_bf16 v[64:79], a[192:195], v[40:43], v[64:79]
  ds_read_b64_tr_b16 a[224:225], v246 offset:53248
  ds_read_b64_tr_b16 a[226:227], v246 offset:54272
  v_mfma_f32_32x32x16_bf16 v[128:143], a[192:195], v[44:47], v[128:143]
  ds_read_b64_tr_b16 a[228:229], v247 offset:53248
  ds_read_b64_tr_b16 a[230:231], v247 offset:54272
  v_mfma_f32_32x32x16_bf16 v[80:95], a[196:199], v[40:43], v[80:95]
  ds_read_b64_tr_b16 a[232:233], v248 offset:53248
  ds_read_b64_tr_b16 a[234:235], v248 offset:54272
  v_mfma_f32_32x32x16_bf16 v[144:159], a[196:199], v[44:47], v[144:159]
  ds_read_b64_tr_b16 a[236:237], v249 offset:53248
  ds_read_b64_tr_b16 a[238:239], v249 offset:54272
  v_mfma_f32_32x32x16_bf16 v[96:111], a[200:203], v[40:43], v[96:111]
  v_mfma_f32_32x32x16_bf16 v[160:175], a[200:203], v[44:47], v[160:175]
  v_mfma_f32_32x32x16_bf16 v[112:127], a[204:207], v[40:43], v[112:127]
  v_mfma_f32_32x32x16_bf16 v[176:191], a[204:207], v[44:47], v[176:191]
  s_waitcnt vmcnt(16)
  s_waitcnt lgkmcnt(8)
  v_mfma_f32_32x32x16_bf16 v[64:79], a[208:211], v[48:51], v[64:79]
  ds_read_b64_tr_b16 a[192:193], v246 offset:57344
  ds_read_b64_tr_b16 a[194:195], v246 offset:58368
  v_mfma_f32_32x32x16_bf16 v[128:143], a[208:211], v[52:55], v[128:143]
  ds_read_b64_tr_b16 a[196:197], v247 offset:57344
  ds_read_b64_tr_b16 a[198:199], v247 offset:58368
  v_mfma_f32_32x32x16_bf16 v[80:95], a[212:215], v[48:51], v[80:95]
  ds_read_b64_tr_b16 a[200:201], v248 offset:57344
  ds_read_b64_tr_b16 a[202:203], v248 offset:58368
  v_mfma_f32_32x32x16_bf16 v[144:159], a[212:215], v[52:55], v[144:159]
  ds_read_b64_tr_b16 a[204:205], v249 offset:57344
  ds_read_b64_tr_b16 a[206:207], v249 offset:58368
  v_mfma_f32_32x32x16_bf16 v[96:111], a[216:219], v[48:51], v[96:111]
  v_mfma_f32_32x32x16_bf16 v[160:175], a[216:219], v[52:55], v[160:175]
  v_mfma_f32_32x32x16_bf16 v[112:127], a[220:223], v[48:51], v[112:127]
  v_mfma_f32_32x32x16_bf16 v[176:191], a[220:223], v[52:55], v[176:191]
  s_waitcnt vmcnt(12)
  s_waitcnt lgkmcnt(8)
  v_mfma_f32_32x32x16_bf16 v[64:79], a[224:227], v[56:59], v[64:79]
  ds_read_b64_tr_b16 a[208:209], v246 offset:61440
  ds_read_b64_tr_b16 a[210:211], v246 offset:62464
  v_mfma_f32_32x32x16_bf16 v[128:143], a[224:227], v[60:63], v[128:143]
  ds_read_b64_tr_b16 a[212:213], v247 offset:61440
  ds_read_b64_tr_b16 a[214:215], v247 offset:62464
  v_mfma_f32_32x32x16_bf16 v[80:95], a[228:231], v[56:59], v[80:95]
  ds_read_b64_tr_b16 a[216:217], v248 offset:61440
  ds_read_b64_tr_b16 a[218:219], v248 offset:62464
  v_mfma_f32_32x32x16_bf16 v[144:159], a[228:231], v[60:63], v[144:159]
  ds_read_b64_tr_b16 a[220:221], v249 offset:61440
  ds_read_b64_tr_b16 a[222:223], v249 offset:62464
  v_mfma_f32_32x32x16_bf16 v[96:111], a[232:235], v[56:59], v[96:111]
  v_mfma_f32_32x32x16_bf16 v[160:175], a[232:235], v[60:63], v[160:175]
  v_mfma_f32_32x32x16_bf16 v[112:127], a[236:239], v[56:59], v[112:127]
  v_mfma_f32_32x32x16_bf16 v[176:191], a[236:239], v[60:63], v[176:191]
  s_waitcnt vmcnt(10)
  s_waitcnt lgkmcnt(8)
  v_mfma_f32_32x32x16_bf16 v[64:79], a[192:195], v[192:195], v[64:79]
  v_mfma_f32_32x32x16_bf16 v[128:143], a[192:195], v[196:199], v[128:143]
  v_mfma_f32_32x32x16_bf16 v[80:95], a[196:199], v[192:195], v[80:95]
  v_mfma_f32_32x32x16_bf16 v[144:159], a[196:199], v[196:199], v[144:159]
  v_mfma_f32_32x32x16_bf16 v[96:111], a[200:203], v[192:195], v[96:111]
  v_mfma_f32_32x32x16_bf16 v[160:175], a[200:203], v[196:199], v[160:175]
  v_mfma_f32_32x32x16_bf16 v[112:127], a[204:207], v[192:195], v[112:127]
  v_mfma_f32_32x32x16_bf16 v[176:191], a[204:207], v[196:199], v[176:191]
  s_waitcnt vmcnt(8)
  s_waitcnt lgkmcnt(0)
  s_barrier
  s_add_u32 m0, s41, 98304
  s_add_u32 s43, s41, 32768
  v_mfma_f32_32x32x16_bf16 v[64:79], a[208:211], v[200:203], v[64:79]
  buffer_load_dwordx4 v240, s[16:19], s43 offen offset:0 lds
  v_mfma_f32_32x32x16_bf16 v[128:143], a[208:211], v[204:207], v[128:143]
  s_add_u32 m0, s41, 98304
  s_add_u32 s43, s41, 32768
  v_mfma_f32_32x32x16_bf16 v[80:95], a[212:215], v[200:203], v[80:95]
  buffer_load_dwordx4 v240, s[16:19], s43 offen offset:1024 lds
  v_mfma_f32_32x32x16_bf16 v[144:159], a[212:215], v[204:207], v[144:159]
  s_add_u32 m0, s41, 98304
  s_add_u32 s43, s41, 32768
  v_mfma_f32_32x32x16_bf16 v[96:111], a[216:219], v[200:203], v[96:111]
  buffer_load_dwordx4 v240, s[16:19], s43 offen offset:2048 lds
  v_mfma_f32_32x32x16_bf16 v[160:175], a[216:219], v[204:207], v[160:175]
  s_add_u32 m0, s41, 98304
  s_add_u32 s43, s41, 32768
  v_mfma_f32_32x32x16_bf16 v[112:127], a[220:223], v[200:203], v[112:127]
  buffer_load_dwordx4 v240, s[16:19], s43 offen offset:3072 lds
  v_mfma_f32_32x32x16_bf16 v[176:191], a[220:223], v[204:207], v[176:191]
  s_add_u32 s39, s41, 65536
  s_add_u32 s40, s41, 49152
  s_waitcnt vmcnt(4)
  s_barrier
  ds_read_b128 a[192:195], v224 offset:0
  ds_read_b128 a[196:199], v225 offset:0
  ds_read_b128 a[200:203], v226 offset:0
  ds_read_b128 a[204:207], v227 offset:0
  ds_read_b128 a[208:211], v228 offset:0
  ds_read_b128 a[212:215], v229 offset:0
  ds_read_b128 a[216:219], v230 offset:0
  ds_read_b128 a[220:223], v231 offset:0
  v_mov_b32 v250, 1040356334
  v_mov_b32 v243, 0
  v_mov_b32 v244, 0
  s_nop 3
  v_pk_mul_f32 v[64:65], v[64:65], v[250:251] op_sel_hi:[1,0]
  v_pk_mul_f32 v[66:67], v[66:67], v[250:251] op_sel_hi:[1,0]
  v_pk_mul_f32 v[68:69], v[68:69], v[250:251] op_sel_hi:[1,0]
  v_pk_mul_f32 v[70:71], v[70:71], v[250:251] op_sel_hi:[1,0]
  v_pk_mul_f32 v[72:73], v[72:73], v[250:251] op_sel_hi:[1,0]
  v_pk_mul_f32 v[74:75], v[74:75], v[250:251] op_sel_hi:[1,0]
  v_pk_mul_f32 v[76:77], v[76:77], v[250:251] op_sel_hi:[1,0]
  v_pk_mul_f32 v[78:79], v[78:79], v[250:251] op_sel_hi:[1,0]
  v_cvt_pk_bf16_f32 v0, v64, v65
  v_cvt_pk_bf16_f32 v1, v66, v67
  v_cvt_pk_bf16_f32 v2, v68, v69
  v_cvt_pk_bf16_f32 v3, v70, v71
  v_accvgpr_write_b32 a128, v0
  v_accvgpr_write_b32 a129, v1
  v_accvgpr_write_b32 a130, v2
  v_accvgpr_write_b32 a131, v3
  v_cvt_pk_bf16_f32 v4, v72, v73
  v_cvt_pk_bf16_f32 v5, v74, v75
  v_cvt_pk_bf16_f32 v6, v76, v77
  v_cvt_pk_bf16_f32 v7, v78, v79
  v_accvgpr_write_b32 a132, v4
  v_accvgpr_write_b32 a133, v5
  v_accvgpr_write_b32 a134, v6
  v_accvgpr_write_b32 a135, v7
  v_pk_mul_f32 v[80:81], v[80:81], v[250:251] op_sel_hi:[1,0]
  v_pk_mul_f32 v[82:83], v[82:83], v[250:251] op_sel_hi:[1,0]
  v_pk_mul_f32 v[84:85], v[84:85], v[250:251] op_sel_hi:[1,0]
  v_pk_mul_f32 v[86:87], v[86:87], v[250:251] op_sel_hi:[1,0]
  v_pk_mul_f32 v[88:89], v[88:89], v[250:251] op_sel_hi:[1,0]
  v_pk_mul_f32 v[90:91], v[90:91], v[250:251] op_sel_hi:[1,0]
  v_pk_mul_f32 v[92:93], v[92:93], v[250:251] op_sel_hi:[1,0]
  v_pk_mul_f32 v[94:95], v[94:95], v[250:251] op_sel_hi:[1,0]
  v_cvt_pk_bf16_f32 v8, v80, v81
  v_cvt_pk_bf16_f32 v9, v82, v83
  v_cvt_pk_bf16_f32 v10, v84, v85
  v_cvt_pk_bf16_f32 v11, v86, v87
  v_accvgpr_write_b32 a136, v8
  v_accvgpr_write_b32 a137, v9
  v_accvgpr_write_b32 a138, v10
  v_accvgpr_write_b32 a139, v11
  v_cvt_pk_bf16_f32 v12, v88, v89
  v_cvt_pk_bf16_f32 v13, v90, v91
  v_cvt_pk_bf16_f32 v14, v92, v93
  v_cvt_pk_bf16_f32 v15, v94, v95
  v_accvgpr_write_b32 a140, v12
  v_accvgpr_write_b32 a141, v13
  v_accvgpr_write_b32 a142, v14
  v_accvgpr_write_b32 a143, v15
  v_pk_mul_f32 v[96:97], v[96:97], v[250:251] op_sel_hi:[1,0]
  v_pk_mul_f32 v[98:99], v[98:99], v[250:251] op_sel_hi:[1,0]
  v_pk_mul_f32 v[100:101], v[100:101], v[250:251] op_sel_hi:[1,0]
  v_pk_mul_f32 v[102:103], v[102:103], v[250:251] op_sel_hi:[1,0]
  v_pk_mul_f32 v[104:105], v[104:105], v[250:251] op_sel_hi:[1,0]
  v_pk_mul_f32 v[106:107], v[106:107], v[250:251] op_sel_hi:[1,0]
  v_pk_mul_f32 v[108:109], v[108:109], v[250:251] op_sel_hi:[1,0]
  v_pk_mul_f32 v[110:111], v[110:111], v[250:251] op_sel_hi:[1,0]
  v_cvt_pk_bf16_f32 v0, v96, v97
  v_cvt_pk_bf16_f32 v1, v98, v99
  v_cvt_pk_bf16_f32 v2, v100, v101
  v_cvt_pk_bf16_f32 v3, v102, v103
  v_accvgpr_write_b32 a144, v0
  v_accvgpr_write_b32 a145, v1
  v_accvgpr_write_b32 a146, v2
  v_accvgpr_write_b32 a147, v3
  v_cvt_pk_bf16_f32 v4, v104, v105
  v_cvt_pk_bf16_f32 v5, v106, v107
  v_cvt_pk_bf16_f32 v6, v108, v109
  v_cvt_pk_bf16_f32 v7, v110, v111
  v_accvgpr_write_b32 a148, v4
  v_accvgpr_write_b32 a149, v5
  v_accvgpr_write_b32 a150, v6
  v_accvgpr_write_b32 a151, v7
  v_pk_mul_f32 v[112:113], v[112:113], v[250:251] op_sel_hi:[1,0]
  v_pk_mul_f32 v[114:115], v[114:115], v[250:251] op_sel_hi:[1,0]
  v_pk_mul_f32 v[116:117], v[116:117], v[250:251] op_sel_hi:[1,0]
  v_pk_mul_f32 v[118:119], v[118:119], v[250:251] op_sel_hi:[1,0]
  v_pk_mul_f32 v[120:121], v[120:121], v[250:251] op_sel_hi:[1,0]
  v_pk_mul_f32 v[122:123], v[122:123], v[250:251] op_sel_hi:[1,0]
  v_pk_mul_f32 v[124:125], v[124:125], v[250:251] op_sel_hi:[1,0]
  v_pk_mul_f32 v[126:127], v[126:127], v[250:251] op_sel_hi:[1,0]
  v_cvt_pk_bf16_f32 v8, v112, v113
  v_cvt_pk_bf16_f32 v9, v114, v115
  v_cvt_pk_bf16_f32 v10, v116, v117
  v_cvt_pk_bf16_f32 v11, v118, v119
  v_accvgpr_write_b32 a152, v8
  v_accvgpr_write_b32 a153, v9
  v_accvgpr_write_b32 a154, v10
  v_accvgpr_write_b32 a155, v11
  v_cvt_pk_bf16_f32 v12, v120, v121
  v_cvt_pk_bf16_f32 v13, v122, v123
  v_cvt_pk_bf16_f32 v14, v124, v125
  v_cvt_pk_bf16_f32 v15, v126, v127
  v_accvgpr_write_b32 a156, v12
  v_accvgpr_write_b32 a157, v13
  v_accvgpr_write_b32 a158, v14
  v_accvgpr_write_b32 a159, v15
  v_pk_mul_f32 v[128:129], v[128:129], v[250:251] op_sel_hi:[1,0]
  v_pk_mul_f32 v[130:131], v[130:131], v[250:251] op_sel_hi:[1,0]
  v_pk_mul_f32 v[132:133], v[132:133], v[250:251] op_sel_hi:[1,0]
  v_pk_mul_f32 v[134:135], v[134:135], v[250:251] op_sel_hi:[1,0]
  v_pk_mul_f32 v[136:137], v[136:137], v[250:251] op_sel_hi:[1,0]
  v_pk_mul_f32 v[138:139], v[138:139], v[250:251] op_sel_hi:[1,0]
  v_pk_mul_f32 v[140:141], v[140:141], v[250:251] op_sel_hi:[1,0]
  v_pk_mul_f32 v[142:143], v[142:143], v[250:251] op_sel_hi:[1,0]
  v_cvt_pk_bf16_f32 v0, v128, v129
  v_cvt_pk_bf16_f32 v1, v130, v131
  v_cvt_pk_bf16_f32 v2, v132, v133
  v_cvt_pk_bf16_f32 v3, v134, v135
  v_accvgpr_write_b32 a160, v0
  v_accvgpr_write_b32 a161, v1
  v_accvgpr_write_b32 a162, v2
  v_accvgpr_write_b32 a163, v3
  v_cvt_pk_bf16_f32 v4, v136, v137
  v_cvt_pk_bf16_f32 v5, v138, v139
  v_cvt_pk_bf16_f32 v6, v140, v141
  v_cvt_pk_bf16_f32 v7, v142, v143
  v_accvgpr_write_b32 a164, v4
  v_accvgpr_write_b32 a165, v5
  v_accvgpr_write_b32 a166, v6
  v_accvgpr_write_b32 a167, v7
  v_pk_mul_f32 v[144:145], v[144:145], v[250:251] op_sel_hi:[1,0]
  v_pk_mul_f32 v[146:147], v[146:147], v[250:251] op_sel_hi:[1,0]
  v_pk_mul_f32 v[148:149], v[148:149], v[250:251] op_sel_hi:[1,0]
  v_pk_mul_f32 v[150:151], v[150:151], v[250:251] op_sel_hi:[1,0]
  v_pk_mul_f32 v[152:153], v[152:153], v[250:251] op_sel_hi:[1,0]
  v_pk_mul_f32 v[154:155], v[154:155], v[250:251] op_sel_hi:[1,0]
  v_pk_mul_f32 v[156:157], v[156:157], v[250:251] op_sel_hi:[1,0]
  v_pk_mul_f32 v[158:159], v[158:159], v[250:251] op_sel_hi:[1,0]
  v_cvt_pk_bf16_f32 v8, v144, v145
  v_cvt_pk_bf16_f32 v9, v146, v147
  v_cvt_pk_bf16_f32 v10, v148, v149
  v_cvt_pk_bf16_f32 v11, v150, v151
  v_accvgpr_write_b32 a168, v8
  v_accvgpr_write_b32 a169, v9
  v_accvgpr_write_b32 a170, v10
  v_accvgpr_write_b32 a171, v11
  v_cvt_pk_bf16_f32 v12, v152, v153
  v_cvt_pk_bf16_f32 v13, v154, v155
  v_cvt_pk_bf16_f32 v14, v156, v157
  v_cvt_pk_bf16_f32 v15, v158, v159
  v_accvgpr_write_b32 a172, v12
  v_accvgpr_write_b32 a173, v13
  v_accvgpr_write_b32 a174, v14
  v_accvgpr_write_b32 a175, v15
  v_pk_mul_f32 v[160:161], v[160:161], v[250:251] op_sel_hi:[1,0]
  v_pk_mul_f32 v[162:163], v[162:163], v[250:251] op_sel_hi:[1,0]
  v_pk_mul_f32 v[164:165], v[164:165], v[250:251] op_sel_hi:[1,0]
  v_pk_mul_f32 v[166:167], v[166:167], v[250:251] op_sel_hi:[1,0]
  v_pk_mul_f32 v[168:169], v[168:169], v[250:251] op_sel_hi:[1,0]
  v_pk_mul_f32 v[170:171], v[170:171], v[250:251] op_sel_hi:[1,0]
  v_pk_mul_f32 v[172:173], v[172:173], v[250:251] op_sel_hi:[1,0]
  v_pk_mul_f32 v[174:175], v[174:175], v[250:251] op_sel_hi:[1,0]
  v_cvt_pk_bf16_f32 v0, v160, v161
  v_cvt_pk_bf16_f32 v1, v162, v163
  v_cvt_pk_bf16_f32 v2, v164, v165
  v_cvt_pk_bf16_f32 v3, v166, v167
  v_accvgpr_write_b32 a176, v0
  v_accvgpr_write_b32 a177, v1
  v_accvgpr_write_b32 a178, v2
  v_accvgpr_write_b32 a179, v3
  v_cvt_pk_bf16_f32 v4, v168, v169
  v_cvt_pk_bf16_f32 v5, v170, v171
  v_cvt_pk_bf16_f32 v6, v172, v173
  v_cvt_pk_bf16_f32 v7, v174, v175
  v_accvgpr_write_b32 a180, v4
  v_accvgpr_write_b32 a181, v5
  v_accvgpr_write_b32 a182, v6
  v_accvgpr_write_b32 a183, v7
  v_pk_mul_f32 v[176:177], v[176:177], v[250:251] op_sel_hi:[1,0]
  v_pk_mul_f32 v[178:179], v[178:179], v[250:251] op_sel_hi:[1,0]
  v_pk_mul_f32 v[180:181], v[180:181], v[250:251] op_sel_hi:[1,0]
  v_pk_mul_f32 v[182:183], v[182:183], v[250:251] op_sel_hi:[1,0]
  v_pk_mul_f32 v[184:185], v[184:185], v[250:251] op_sel_hi:[1,0]
  v_pk_mul_f32 v[186:187], v[186:187], v[250:251] op_sel_hi:[1,0]
  v_pk_mul_f32 v[188:189], v[188:189], v[250:251] op_sel_hi:[1,0]
  v_pk_mul_f32 v[190:191], v[190:191], v[250:251] op_sel_hi:[1,0]
  v_cvt_pk_bf16_f32 v8, v176, v177
  v_cvt_pk_bf16_f32 v9, v178, v179
  v_cvt_pk_bf16_f32 v10, v180, v181
  v_cvt_pk_bf16_f32 v11, v182, v183
  v_accvgpr_write_b32 a184, v8
  v_accvgpr_write_b32 a185, v9
  v_accvgpr_write_b32 a186, v10
  v_accvgpr_write_b32 a187, v11
  v_cvt_pk_bf16_f32 v12, v184, v185
  v_cvt_pk_bf16_f32 v13, v186, v187
  v_cvt_pk_bf16_f32 v14, v188, v189
  v_cvt_pk_bf16_f32 v15, v190, v191
  v_accvgpr_write_b32 a188, v12
  v_accvgpr_write_b32 a189, v13
  v_accvgpr_write_b32 a190, v14
  v_accvgpr_write_b32 a191, v15
  s_waitcnt lgkmcnt(0)
  v_mfma_f32_32x32x16_bf16 v[0:15], a[192:195], a[128:131], 0
  v_mfma_f32_32x32x16_bf16 v[16:31], a[192:195], a[160:163], 0
  v_mfma_f32_32x32x16_bf16 v[0:15], a[196:199], a[132:135], v[0:15]
  v_mfma_f32_32x32x16_bf16 v[16:31], a[196:199], a[164:167], v[16:31]
  v_mfma_f32_32x32x16_bf16 v[0:15], a[200:203], a[136:139], v[0:15]
  v_mfma_f32_32x32x16_bf16 v[16:31], a[200:203], a[168:171], v[16:31]
  v_mfma_f32_32x32x16_bf16 v[0:15], a[204:207], a[140:143], v[0:15]
  v_mfma_f32_32x32x16_bf16 v[16:31], a[204:207], a[172:175], v[16:31]
  v_mfma_f32_32x32x16_bf16 v[0:15], a[208:211], a[144:147], v[0:15]
  v_mfma_f32_32x32x16_bf16 v[16:31], a[208:211], a[176:179], v[16:31]
  v_mfma_f32_32x32x16_bf16 v[0:15], a[212:215], a[148:151], v[0:15]
  v_mfma_f32_32x32x16_bf16 v[16:31], a[212:215], a[180:183], v[16:31]
  v_mfma_f32_32x32x16_bf16 v[0:15], a[216:219], a[152:155], v[0:15]
  v_mfma_f32_32x32x16_bf16 v[16:31], a[216:219], a[184:187], v[16:31]
  v_mfma_f32_32x32x16_bf16 v[0:15], a[220:223], a[156:159], v[0:15]
  v_mfma_f32_32x32x16_bf16 v[16:31], a[220:223], a[188:191], v[16:31]
  ds_read_b128 a[192:195], v224 offset:8192
  ds_read_b128 a[196:199], v225 offset:8192
  ds_read_b128 a[200:203], v226 offset:8192
  ds_read_b128 a[204:207], v227 offset:8192
  ds_read_b128 a[208:211], v228 offset:8192
  ds_read_b128 a[212:215], v229 offset:8192
  ds_read_b128 a[216:219], v230 offset:8192
  ds_read_b128 a[220:223], v231 offset:8192
  s_nop 15
  v_max3_f32 v247, v0, v1, v2
  v_max3_f32 v247, v247, v3, v4
  v_max3_f32 v247, v247, v5, v6
  v_max3_f32 v247, v247, v7, v8
  v_max3_f32 v247, v247, v9, v10
  v_max3_f32 v247, v247, v11, v12
  v_max3_f32 v247, v247, v13, v14
  v_max_f32 v247, v247, v15
  v_mov_b32 v248, v247
  s_nop 1
  v_permlane32_swap_b32 v248, v247
  s_nop 1
  v_max_f32 v247, v247, v248
  v_add_f32 v247, 1119879168, v247
  v_sub_f32 v64, 0, v247
  v_sub_f32 v0, v0, v247
  v_sub_f32 v65, 0, v247
  v_sub_f32 v1, v1, v247
  v_sub_f32 v66, 0, v247
  v_sub_f32 v2, v2, v247
  v_sub_f32 v67, 0, v247
  v_sub_f32 v3, v3, v247
  v_sub_f32 v68, 0, v247
  v_sub_f32 v4, v4, v247
  v_sub_f32 v69, 0, v247
  v_sub_f32 v5, v5, v247
  v_sub_f32 v70, 0, v247
  v_sub_f32 v6, v6, v247
  v_sub_f32 v71, 0, v247
  v_sub_f32 v7, v7, v247
  v_sub_f32 v72, 0, v247
  v_sub_f32 v8, v8, v247
  v_sub_f32 v73, 0, v247
  v_sub_f32 v9, v9, v247
  v_sub_f32 v74, 0, v247
  v_sub_f32 v10, v10, v247
  v_sub_f32 v75, 0, v247
  v_sub_f32 v11, v11, v247
  v_sub_f32 v76, 0, v247
  v_sub_f32 v12, v12, v247
  v_sub_f32 v77, 0, v247
  v_sub_f32 v13, v13, v247
  v_sub_f32 v78, 0, v247
  v_sub_f32 v14, v14, v247
  v_sub_f32 v79, 0, v247
  v_sub_f32 v15, v15, v247
  v_max3_f32 v247, v16, v17, v18
  v_max3_f32 v247, v247, v19, v20
  v_max3_f32 v247, v247, v21, v22
  v_max3_f32 v247, v247, v23, v24
  v_max3_f32 v247, v247, v25, v26
  v_max3_f32 v247, v247, v27, v28
  v_max3_f32 v247, v247, v29, v30
  v_max_f32 v247, v247, v31
  v_mov_b32 v248, v247
  s_nop 1
  v_permlane32_swap_b32 v248, v247
  s_nop 1
  v_max_f32 v247, v247, v248
  v_add_f32 v247, 1119879168, v247
  v_sub_f32 v80, 0, v247
  v_sub_f32 v16, v16, v247
  v_sub_f32 v81, 0, v247
  v_sub_f32 v17, v17, v247
  v_sub_f32 v82, 0, v247
  v_sub_f32 v18, v18, v247
  v_sub_f32 v83, 0, v247
  v_sub_f32 v19, v19, v247
  v_sub_f32 v84, 0, v247
  v_sub_f32 v20, v20, v247
  v_sub_f32 v85, 0, v247
  v_sub_f32 v21, v21, v247
  v_sub_f32 v86, 0, v247
  v_sub_f32 v22, v22, v247
  v_sub_f32 v87, 0, v247
  v_sub_f32 v23, v23, v247
  v_sub_f32 v88, 0, v247
  v_sub_f32 v24, v24, v247
  v_sub_f32 v89, 0, v247
  v_sub_f32 v25, v25, v247
  v_sub_f32 v90, 0, v247
  v_sub_f32 v26, v26, v247
  v_sub_f32 v91, 0, v247
  v_sub_f32 v27, v27, v247
  v_sub_f32 v92, 0, v247
  v_sub_f32 v28, v28, v247
  v_sub_f32 v93, 0, v247
  v_sub_f32 v29, v29, v247
  v_sub_f32 v94, 0, v247
  v_sub_f32 v30, v30, v247
  v_sub_f32 v95, 0, v247
  v_sub_f32 v31, v31, v247
  s_waitcnt lgkmcnt(0)
  v_mfma_f32_32x32x16_bf16 v[32:47], a[192:195], a[128:131], v[64:79]
  v_exp_f32 v128, v0
  v_exp_f32 v129, v1
  v_exp_f32 v130, v2
  v_mfma_f32_32x32x16_bf16 v[48:63], a[192:195], a[160:163], v[80:95]
  v_exp_f32 v131, v3
  v_add_f32 v241, v128, v129
  v_cvt_pk_bf16_f32 v96, v128, v129
  v_exp_f32 v132, v4
  v_mfma_f32_32x32x16_bf16 v[32:47], a[196:199], a[132:135], v[32:47]
  v_exp_f32 v133, v5
  v_add_f32 v241, v241, v130
  v_add_f32 v241, v241, v131
  v_cvt_pk_bf16_f32 v97, v130, v131
  v_mfma_f32_32x32x16_bf16 v[48:63], a[196:199], a[164:167], v[48:63]
  v_exp_f32 v134, v6
  v_add_f32 v241, v241, v132
  v_add_f32 v241, v241, v133
  v_cvt_pk_bf16_f32 v98, v132, v133
  v_mfma_f32_32x32x16_bf16 v[32:47], a[200:203], a[136:139], v[32:47]
  v_exp_f32 v135, v7
  v_exp_f32 v128, v8
  v_exp_f32 v129, v9
  v_mfma_f32_32x32x16_bf16 v[48:63], a[200:203], a[168:171], v[48:63]
  v_add_f32 v241, v241, v134
  v_add_f32 v241, v241, v135
  v_cvt_pk_bf16_f32 v99, v134, v135
  v_add_f32 v241, v241, v128
  v_add_f32 v241, v241, v129
  v_cvt_pk_bf16_f32 v100, v128, v129
  v_mfma_f32_32x32x16_bf16 v[32:47], a[204:207], a[140:143], v[32:47]
  v_exp_f32 v130, v10
  v_exp_f32 v131, v11
  v_exp_f32 v132, v12
  v_mfma_f32_32x32x16_bf16 v[48:63], a[204:207], a[172:175], v[48:63]
  v_exp_f32 v133, v13
  v_add_f32 v241, v241, v130
  v_add_f32 v241, v241, v131
  v_cvt_pk_bf16_f32 v101, v130, v131
  v_mfma_f32_32x32x16_bf16 v[32:47], a[208:211], a[144:147], v[32:47]
  v_exp_f32 v134, v14
  v_add_f32 v241, v241, v132
  v_add_f32 v241, v241, v133
  v_cvt_pk_bf16_f32 v102, v132, v133
  v_mfma_f32_32x32x16_bf16 v[48:63], a[208:211], a[176:179], v[48:63]
  v_exp_f32 v135, v15
  v_exp_f32 v128, v16
  v_exp_f32 v129, v17
  v_mfma_f32_32x32x16_bf16 v[32:47], a[212:215], a[148:151], v[32:47]
  v_add_f32 v241, v241, v134
  v_add_f32 v241, v241, v135
  v_cvt_pk_bf16_f32 v103, v134, v135
  v_add_f32 v242, v128, v129
  v_cvt_pk_bf16_f32 v104, v128, v129
  v_mfma_f32_32x32x16_bf16 v[48:63], a[212:215], a[180:183], v[48:63]
  v_exp_f32 v130, v18
  v_exp_f32 v131, v19
  v_exp_f32 v132, v20
  v_mfma_f32_32x32x16_bf16 v[32:47], a[216:219], a[152:155], v[32:47]
  v_exp_f32 v133, v21
  v_add_f32 v242, v242, v130
  v_add_f32 v242, v242, v131
  v_cvt_pk_bf16_f32 v105, v130, v131
  v_mfma_f32_32x32x16_bf16 v[48:63], a[216:219], a[184:187], v[48:63]
  v_exp_f32 v134, v22
  v_add_f32 v242, v242, v132
  v_add_f32 v242, v242, v133
  v_cvt_pk_bf16_f32 v106, v132, v133
  v_mfma_f32_32x32x16_bf16 v[32:47], a[220:223], a[156:159], v[32:47]
  v_exp_f32 v135, v23
  v_exp_f32 v128, v24
  v_exp_f32 v129, v25
  v_mfma_f32_32x32x16_bf16 v[48:63], a[220:223], a[188:191], v[48:63]
  v_add_f32 v242, v242, v134
  v_add_f32 v242, v242, v135
  v_cvt_pk_bf16_f32 v107, v134, v135
  v_add_f32 v242, v242, v128
  s_waitcnt vmcnt(63) lgkmcnt(0)
  s_barrier
  s_add_u32 m0, s41, 0
  v_exp_f32 v130, v26
  v_add_f32 v242, v242, v129
  v_cvt_pk_bf16_f32 v108, v128, v129
  buffer_load_dwordx4 v236, s[12:15], s39 offen offset:0 lds
  ds_read_b128 a[192:195], v224 offset:16384
  ds_read_b128 a[196:199], v225 offset:16384
  v_exp_f32 v131, v27
  v_exp_f32 v132, v28
  ds_read_b128 a[200:203], v226 offset:16384
  v_exp_f32 v133, v29
  v_add_f32 v242, v242, v130
  v_add_f32 v242, v242, v131
  v_cvt_pk_bf16_f32 v109, v130, v131
  buffer_load_dwordx4 v237, s[12:15], s39 offen offset:1024 lds
  v_exp_f32 v134, v30
  ds_read_b128 a[204:207], v227 offset:16384
  v_exp_f32 v135, v31
  v_add_f32 v242, v242, v132
  v_add_f32 v242, v242, v133
  v_cvt_pk_bf16_f32 v110, v132, v133
  ds_read_b128 a[208:211], v228 offset:16384
  v_add_f32 v242, v242, v134
  v_add_f32 v242, v242, v135
  v_cvt_pk_bf16_f32 v111, v134, v135
  ds_read_b128 a[212:215], v229 offset:16384
  buffer_load_dwordx4 v238, s[12:15], s39 offen offset:2048 lds
  ds_read_b128 a[216:219], v230 offset:16384
  ds_read_b128 a[220:223], v231 offset:16384
  buffer_load_dwordx4 v239, s[12:15], s39 offen offset:3072 lds
  s_add_u32 s39, s39, 16384
  v_max_f32 v246, v241, v242
  v_cmp_lt_f32 vcc, s44, v246
  s_cbranch_vccnz RSTUB_8
RBACK_9:
  s_waitcnt lgkmcnt(0)
  v_mfma_f32_32x32x16_bf16 v[0:15], a[192:195], a[128:131], v[64:79]
  ds_read_b64_tr_b16 a[224:225], v232 offset:0
  v_add_f32 v243, v243, v241
  v_add_f32 v244, v244, v242
  v_exp_f32 v128, v32
  v_mfma_f32_32x32x16_bf16 v[16:31], a[192:195], a[160:163], v[80:95]
  ds_read_b64_tr_b16 a[226:227], v232 offset:2048
  ds_read_b64_tr_b16 a[228:229], v233 offset:0
  v_exp_f32 v129, v33
  v_exp_f32 v130, v34
  v_mfma_f32_32x32x16_bf16 v[0:15], a[196:199], a[132:135], v[0:15]
  ds_read_b64_tr_b16 a[230:231], v233 offset:2048
  v_exp_f32 v131, v35
  v_add_f32 v241, v128, v129
  v_cvt_pk_bf16_f32 v112, v128, v129
  v_mfma_f32_32x32x16_bf16 v[16:31], a[196:199], a[164:167], v[16:31]
  ds_read_b64_tr_b16 a[232:233], v234 offset:0
  ds_read_b64_tr_b16 a[234:235], v234 offset:2048
  v_exp_f32 v132, v36
  v_add_f32 v241, v241, v130
  v_add_f32 v241, v241, v131
  v_mfma_f32_32x32x16_bf16 v[0:15], a[200:203], a[136:139], v[0:15]
  ds_read_b64_tr_b16 a[236:237], v235 offset:0
  v_exp_f32 v133, v37
  v_cvt_pk_bf16_f32 v113, v130, v131
  v_exp_f32 v134, v38
  v_mfma_f32_32x32x16_bf16 v[16:31], a[200:203], a[168:171], v[16:31]
  ds_read_b64_tr_b16 a[238:239], v235 offset:2048
  ds_read_b64_tr_b16 a[240:241], v232 offset:4096
  v_exp_f32 v135, v39
  v_add_f32 v241, v241, v132
  v_add_f32 v241, v241, v133
  v_mfma_f32_32x32x16_bf16 v[0:15], a[204:207], a[140:143], v[0:15]
  ds_read_b64_tr_b16 a[242:243], v232 offset:6144
  v_cvt_pk_bf16_f32 v114, v132, v133
  v_add_f32 v241, v241, v134
  v_add_f32 v241, v241, v135
  v_cvt_pk_bf16_f32 v115, v134, v135
  v_mfma_f32_32x32x16_bf16 v[16:31], a[204:207], a[172:175], v[16:31]
  ds_read_b64_tr_b16 a[244:245], v233 offset:4096
  ds_read_b64_tr_b16 a[246:247], v233 offset:6144
  v_exp_f32 v128, v40
  v_exp_f32 v129, v41
  v_mfma_f32_32x32x16_bf16 v[0:15], a[208:211], a[144:147], v[0:15]
  ds_read_b64_tr_b16 a[248:249], v234 offset:4096
  v_exp_f32 v130, v42
  v_add_f32 v241, v241, v128
  v_add_f32 v241, v241, v129
  v_cvt_pk_bf16_f32 v116, v128, v129
  v_mfma_f32_32x32x16_bf16 v[16:31], a[208:211], a[176:179], v[16:31]
  ds_read_b64_tr_b16 a[250:251], v234 offset:6144
  ds_read_b64_tr_b16 a[252:253], v235 offset:4096
  v_exp_f32 v131, v43
  v_exp_f32 v132, v44
  v_mfma_f32_32x32x16_bf16 v[0:15], a[212:215], a[148:151], v[0:15]
  ds_read_b64_tr_b16 a[254:255], v235 offset:6144
  v_exp_f32 v133, v45
  v_add_f32 v241, v241, v130
  v_add_f32 v241, v241, v131
  v_cvt_pk_bf16_f32 v117, v130, v131
  v_mfma_f32_32x32x16_bf16 v[16:31], a[212:215], a[180:183], v[16:31]
  s_mov_b32 m0, s51
  v_exp_f32 v134, v46
  v_add_f32 v241, v241, v132
  v_add_f32 v241, v241, v133
  v_cvt_pk_bf16_f32 v118, v132, v133
  v_mfma_f32_32x32x16_bf16 v[0:15], a[216:219], a[152:155], v[0:15]
  buffer_load_dwordx4 v221, s[56:59], s50 offen lds
  s_add_u32 s50, s50, 0x100000
  v_mfma_f32_32x32x16_bf16 v[16:31], a[216:219], a[184:187], v[16:31]
  v_exp_f32 v135, v47
  v_exp_f32 v128, v48
  v_exp_f32 v129, v49
  v_mfma_f32_32x32x16_bf16 v[0:15], a[220:223], a[156:159], v[0:15]
  v_add_f32 v241, v241, v134
  v_add_f32 v241, v241, v135
  v_cvt_pk_bf16_f32 v119, v134, v135
  v_add_f32 v242, v128, v129
  v_cvt_pk_bf16_f32 v120, v128, v129
  v_mfma_f32_32x32x16_bf16 v[16:31], a[220:223], a[188:191], v[16:31]
  v_exp_f32 v130, v50
  v_exp_f32 v131, v51
  s_waitcnt lgkmcnt(0)
  v_mfma_f32_32x32x16_bf16 a[0:15], a[224:227], v[96:99], 0
  s_add_u32 m0, s41, 114688
  v_exp_f32 v132, v52
  v_add_f32 v242, v242, v130
  v_add_f32 v242, v242, v131
  v_cvt_pk_bf16_f32 v121, v130, v131
  v_mfma_f32_32x32x16_bf16 a[64:79], a[224:227], v[104:107], 0
  buffer_load_dwordx4 v240, s[16:19], s40 offen offset:0 lds
  ds_read_b128 a[192:195], v224 offset:24576
  v_mfma_f32_32x32x16_bf16 a[16:31], a[228:231], v[96:99], 0
  ds_read_b128 a[196:199], v225 offset:24576
  v_exp_f32 v133, v53
  v_exp_f32 v134, v54
  v_mfma_f32_32x32x16_bf16 a[80:95], a[228:231], v[104:107], 0
  ds_read_b128 a[200:203], v226 offset:24576
  v_exp_f32 v135, v55
  v_add_f32 v242, v242, v132
  v_add_f32 v242, v242, v133
  v_cvt_pk_bf16_f32 v122, v132, v133
  v_mfma_f32_32x32x16_bf16 a[32:47], a[232:235], v[96:99], 0
  buffer_load_dwordx4 v240, s[16:19], s40 offen offset:1024 lds
  v_exp_f32 v128, v56
  v_mfma_f32_32x32x16_bf16 a[96:111], a[232:235], v[104:107], 0
  ds_read_b128 a[204:207], v227 offset:24576
  v_exp_f32 v129, v57
  v_add_f32 v242, v242, v134
  v_add_f32 v242, v242, v135
  v_cvt_pk_bf16_f32 v123, v134, v135
  v_mfma_f32_32x32x16_bf16 a[48:63], a[236:239], v[96:99], 0
  ds_read_b128 a[208:211], v228 offset:24576
  v_exp_f32 v130, v58
  v_add_f32 v242, v242, v128
  v_add_f32 v242, v242, v129
  v_cvt_pk_bf16_f32 v124, v128, v129
  v_mfma_f32_32x32x16_bf16 a[112:127], a[236:239], v[104:107], 0
  ds_read_b128 a[212:215], v229 offset:24576
  v_exp_f32 v131, v59
  v_exp_f32 v132, v60
  v_mfma_f32_32x32x16_bf16 a[0:15], a[240:243], v[100:103], a[0:15]
  buffer_load_dwordx4 v240, s[16:19], s40 offen offset:2048 lds
  v_exp_f32 v133, v61
  v_mfma_f32_32x32x16_bf16 a[64:79], a[240:243], v[108:111], a[64:79]
  ds_read_b128 a[216:219], v230 offset:24576
  v_add_f32 v242, v242, v130
  v_add_f32 v242, v242, v131
  v_cvt_pk_bf16_f32 v125, v130, v131
  v_add_f32 v242, v242, v132
  v_add_f32 v242, v242, v133
  v_mfma_f32_32x32x16_bf16 a[16:31], a[244:247], v[100:103], a[16:31]
  ds_read_b128 a[220:223], v231 offset:24576
  v_exp_f32 v134, v62
  v_cvt_pk_bf16_f32 v126, v132, v133
  v_exp_f32 v135, v63
  v_mfma_f32_32x32x16_bf16 a[80:95], a[244:247], v[108:111], a[80:95]
  v_add_f32 v242, v242, v134
  v_add_f32 v242, v242, v135
  v_cvt_pk_bf16_f32 v127, v134, v135
  v_mfma_f32_32x32x16_bf16 a[32:47], a[248:251], v[100:103], a[32:47]
  buffer_load_dwordx4 v240, s[16:19], s40 offen offset:3072 lds
  s_add_u32 s40, s40, 16384
  v_mfma_f32_32x32x16_bf16 a[96:111], a[248:251], v[108:111], a[96:111]
  v_max_f32 v246, v241, v242
  v_mfma_f32_32x32x16_bf16 a[48:63], a[252:255], v[100:103], a[48:63]
  v_mfma_f32_32x32x16_bf16 a[112:127], a[252:255], v[108:111], a[112:127]
  v_cmp_lt_f32 vcc, s44, v246
  s_cbranch_vccnz RSTUB_10
RBACK_11:
  s_mov_b32 s42, 7
.p2align 6
KB_LOOP0:
  s_waitcnt lgkmcnt(0)
  v_mfma_f32_32x32x16_bf16 v[32:47], a[192:195], a[128:131], v[64:79]
  ds_read_b64_tr_b16 a[224:225], v232 offset:8192
  v_add_f32 v243, v243, v241
  v_add_f32 v244, v244, v242
  v_exp_f32 v128, v0
  v_mfma_f32_32x32x16_bf16 v[48:63], a[192:195], a[160:163], v[80:95]
  ds_read_b64_tr_b16 a[226:227], v232 offset:10240
  ds_read_b64_tr_b16 a[228:229], v233 offset:8192
  v_exp_f32 v129, v1
  v_exp_f32 v130, v2
  v_mfma_f32_32x32x16_bf16 v[32:47], a[196:199], a[132:135], v[32:47]
  ds_read_b64_tr_b16 a[230:231], v233 offset:10240
  v_exp_f32 v131, v3
  v_add_f32 v241, v128, v129
  v_cvt_pk_bf16_f32 v96, v128, v129
  v_mfma_f32_32x32x16_bf16 v[48:63], a[196:199], a[164:167], v[48:63]
  ds_read_b64_tr_b16 a[232:233], v234 offset:8192
  ds_read_b64_tr_b16 a[234:235], v234 offset:10240
  v_exp_f32 v132, v4
  v_add_f32 v241, v241, v130
  v_add_f32 v241, v241, v131
  v_mfma_f32_32x32x16_bf16 v[32:47], a[200:203], a[136:139], v[32:47]
  ds_read_b64_tr_b16 a[236:237], v235 offset:8192
  v_exp_f32 v133, v5
  v_cvt_pk_bf16_f32 v97, v130, v131
  v_exp_f32 v134, v6
  v_mfma_f32_32x32x16_bf16 v[48:63], a[200:203], a[168:171], v[48:63]
  ds_read_b64_tr_b16 a[238:239], v235 offset:10240
  ds_read_b64_tr_b16 a[240:241], v232 offset:12288
  v_exp_f32 v135, v7
  v_add_f32 v241, v241, v132
  v_add_f32 v241, v241, v133
  v_mfma_f32_32x32x16_bf16 v[32:47], a[204:207], a[140:143], v[32:47]
  ds_read_b64_tr_b16 a[242:243], v232 offset:14336
  v_cvt_pk_bf16_f32 v98, v132, v133
  v_add_f32 v241, v241, v134
  v_add_f32 v241, v241, v135
  v_cvt_pk_bf16_f32 v99, v134, v135
  v_mfma_f32_32x32x16_bf16 v[48:63], a[204:207], a[172:175], v[48:63]
  ds_read_b64_tr_b16 a[244:245], v233 offset:12288
  ds_read_b64_tr_b16 a[246:247], v233 offset:14336
  v_exp_f32 v128, v8
  v_exp_f32 v129, v9
  v_mfma_f32_32x32x16_bf16 v[32:47], a[208:211], a[144:147], v[32:47]
  ds_read_b64_tr_b16 a[248:249], v234 offset:12288
  v_exp_f32 v130, v10
  v_add_f32 v241, v241, v128
  v_add_f32 v241, v241, v129
  v_cvt_pk_bf16_f32 v100, v128, v129
  v_mfma_f32_32x32x16_bf16 v[48:63], a[208:211], a[176:179], v[48:63]
  ds_read_b64_tr_b16 a[250:251], v234 offset:14336
  ds_read_b64_tr_b16 a[252:253], v235 offset:12288
  v_exp_f32 v131, v11
  v_exp_f32 v132, v12
  v_mfma_f32_32x32x16_bf16 v[32:47], a[212:215], a[148:151], v[32:47]
  ds_read_b64_tr_b16 a[254:255], v235 offset:14336
  v_exp_f32 v133, v13
  v_add_f32 v241, v241, v130
  v_add_f32 v241, v241, v131
  v_cvt_pk_bf16_f32 v101, v130, v131
  v_mfma_f32_32x32x16_bf16 v[48:63], a[212:215], a[180:183], v[48:63]
  v_exp_f32 v134, v14
  v_add_f32 v241, v241, v132
  v_add_f32 v241, v241, v133
  v_cvt_pk_bf16_f32 v102, v132, v133
  v_mfma_f32_32x32x16_bf16 v[32:47], a[216:219], a[152:155], v[32:47]
  v_exp_f32 v135, v15
  v_exp_f32 v128, v16
  v_exp_f32 v129, v17
  v_mfma_f32_32x32x16_bf16 v[48:63], a[216:219], a[184:187], v[48:63]
  v_add_f32 v241, v241, v134
  v_add_f32 v241, v241, v135
  v_cvt_pk_bf16_f32 v103, v134, v135
  v_add_f32 v242, v128, v129
  v_cvt_pk_bf16_f32 v104, v128, v129
  v_mfma_f32_32x32x16_bf16 v[32:47], a[220:223], a[156:159], v[32:47]
  v_exp_f32 v130, v18
  v_exp_f32 v131, v19
  v_exp_f32 v132, v20
  v_mfma_f32_32x32x16_bf16 v[48:63], a[220:223], a[188:191], v[48:63]
  v_exp_f32 v133, v21
  v_add_f32 v242, v242, v130
  v_add_f32 v242, v242, v131
  s_waitcnt vmcnt(18) lgkmcnt(0)
  s_barrier
  v_mfma_f32_32x32x16_bf16 a[0:15], a[224:227], v[112:115], a[0:15]
  s_add_u32 m0, s41, 16384
  v_cvt_pk_bf16_f32 v105, v130, v131
  v_add_f32 v242, v242, v132
  v_add_f32 v242, v242, v133
  v_cvt_pk_bf16_f32 v106, v132, v133
  v_mfma_f32_32x32x16_bf16 a[64:79], a[224:227], v[120:123], a[64:79]
  buffer_load_dwordx4 v236, s[12:15], s39 offen offset:0 lds
  ds_read_b128 a[192:195], v224 offset:32768
  v_mfma_f32_32x32x16_bf16 a[16:31], a[228:231], v[112:115], a[16:31]
  ds_read_b128 a[196:199], v225 offset:32768
  v_exp_f32 v134, v22
  v_exp_f32 v135, v23
  v_mfma_f32_32x32x16_bf16 a[80:95], a[228:231], v[120:123], a[80:95]
  ds_read_b128 a[200:203], v226 offset:32768
  v_exp_f32 v128, v24
  v_add_f32 v242, v242, v134
  v_add_f32 v242, v242, v135
  v_cvt_pk_bf16_f32 v107, v134, v135
  v_mfma_f32_32x32x16_bf16 a[32:47], a[232:235], v[112:115], a[32:47]
  buffer_load_dwordx4 v237, s[12:15], s39 offen offset:1024 lds
  v_exp_f32 v129, v25
  v_mfma_f32_32x32x16_bf16 a[96:111], a[232:235], v[120:123], a[96:111]
  ds_read_b128 a[204:207], v227 offset:32768
  v_exp_f32 v130, v26
  v_add_f32 v242, v242, v128
  v_add_f32 v242, v242, v129
  v_cvt_pk_bf16_f32 v108, v128, v129
  v_mfma_f32_32x32x16_bf16 a[48:63], a[236:239], v[112:115], a[48:63]
  ds_read_b128 a[208:211], v228 offset:32768
  v_exp_f32 v131, v27
  v_exp_f32 v132, v28
  v_mfma_f32_32x32x16_bf16 a[112:127], a[236:239], v[120:123], a[112:127]
  ds_read_b128 a[212:215], v229 offset:32768
  v_exp_f32 v133, v29
  v_add_f32 v242, v242, v130
  v_add_f32 v242, v242, v131
  v_cvt_pk_bf16_f32 v109, v130, v131
  v_mfma_f32_32x32x16_bf16 a[0:15], a[240:243], v[116:119], a[0:15]
  buffer_load_dwordx4 v238, s[12:15], s39 offen offset:2048 lds
  v_exp_f32 v134, v30
  v_mfma_f32_32x32x16_bf16 a[64:79], a[240:243], v[124:127], a[64:79]
  ds_read_b128 a[216:219], v230 offset:32768
  v_exp_f32 v135, v31
  v_add_f32 v242, v242, v132
  v_add_f32 v242, v242, v133
  v_cvt_pk_bf16_f32 v110, v132, v133
  v_mfma_f32_32x32x16_bf16 a[16:31], a[244:247], v[116:119], a[16:31]
  ds_read_b128 a[220:223], v231 offset:32768
  v_add_f32 v242, v242, v134
  v_add_f32 v242, v242, v135
  v_cvt_pk_bf16_f32 v111, v134, v135
  v_mfma_f32_32x32x16_bf16 a[80:95], a[244:247], v[124:127], a[80:95]
  v_mfma_f32_32x32x16_bf16 a[32:47], a[248:251], v[116:119], a[32:47]
  buffer_load_dwordx4 v239, s[12:15], s39 offen offset:3072 lds
  s_add_u32 s39, s39, 16384
  v_mfma_f32_32x32x16_bf16 a[96:111], a[248:251], v[124:127], a[96:111]
  v_max_f32 v246, v241, v242
  v_mfma_f32_32x32x16_bf16 a[48:63], a[252:255], v[116:119], a[48:63]
  v_mfma_f32_32x32x16_bf16 a[112:127], a[252:255], v[124:127], a[112:127]
  v_cmp_lt_f32 vcc, s44, v246
  s_cbranch_vccnz RSTUB_12
RBACK_13:
  s_waitcnt lgkmcnt(0)
  v_mfma_f32_32x32x16_bf16 v[0:15], a[192:195], a[128:131], v[64:79]
  ds_read_b64_tr_b16 a[224:225], v232 offset:16384
  v_add_f32 v243, v243, v241
  v_add_f32 v244, v244, v242
  v_exp_f32 v128, v32
  v_mfma_f32_32x32x16_bf16 v[16:31], a[192:195], a[160:163], v[80:95]
  ds_read_b64_tr_b16 a[226:227], v232 offset:18432
  ds_read_b64_tr_b16 a[228:229], v233 offset:16384
  v_exp_f32 v129, v33
  v_exp_f32 v130, v34
  v_mfma_f32_32x32x16_bf16 v[0:15], a[196:199], a[132:135], v[0:15]
  ds_read_b64_tr_b16 a[230:231], v233 offset:18432
  v_exp_f32 v131, v35
  v_add_f32 v241, v128, v129
  v_cvt_pk_bf16_f32 v112, v128, v129
  v_mfma_f32_32x32x16_bf16 v[16:31], a[196:199], a[164:167], v[16:31]
  ds_read_b64_tr_b16 a[232:233], v234 offset:16384
  ds_read_b64_tr_b16 a[234:235], v234 offset:18432
  v_exp_f32 v132, v36
  v_add_f32 v241, v241, v130
  v_add_f32 v241, v241, v131
  v_mfma_f32_32x32x16_bf16 v[0:15], a[200:203], a[136:139], v[0:15]
  ds_read_b64_tr_b16 a[236:237], v235 offset:16384
  v_exp_f32 v133, v37
  v_cvt_pk_bf16_f32 v113, v130, v131
  v_exp_f32 v134, v38
  v_mfma_f32_32x32x16_bf16 v[16:31], a[200:203], a[168:171], v[16:31]
  ds_read_b64_tr_b16 a[238:239], v235 offset:18432
  ds_read_b64_tr_b16 a[240:241], v232 offset:20480
  v_exp_f32 v135, v39
  v_add_f32 v241, v241, v132
  v_add_f32 v241, v241, v133
  v_mfma_f32_32x32x16_bf16 v[0:15], a[204:207], a[140:143], v[0:15]
  ds_read_b64_tr_b16 a[242:243], v232 offset:22528
  v_cvt_pk_bf16_f32 v114, v132, v133
  v_add_f32 v241, v241, v134
  v_add_f32 v241, v241, v135
  v_cvt_pk_bf16_f32 v115, v134, v135
  v_mfma_f32_32x32x16_bf16 v[16:31], a[204:207], a[172:175], v[16:31]
  ds_read_b64_tr_b16 a[244:245], v233 offset:20480
  ds_read_b64_tr_b16 a[246:247], v233 offset:22528
  v_exp_f32 v128, v40
  v_exp_f32 v129, v41
  v_mfma_f32_32x32x16_bf16 v[0:15], a[208:211], a[144:147], v[0:15]
  ds_read_b64_tr_b16 a[248:249], v234 offset:20480
  v_exp_f32 v130, v42
  v_add_f32 v241, v241, v128
  v_add_f32 v241, v241, v129
  v_cvt_pk_bf16_f32 v116, v128, v129
  v_mfma_f32_32x32x16_bf16 v[16:31], a[208:211], a[176:179], v[16:31]
  ds_read_b64_tr_b16 a[250:251], v234 offset:22528
  ds_read_b64_tr_b16 a[252:253], v235 offset:20480
  v_exp_f32 v131, v43
  v_exp_f32 v132, v44
  v_mfma_f32_32x32x16_bf16 v[0:15], a[212:215], a[148:151], v[0:15]
  ds_read_b64_tr_b16 a[254:255], v235 offset:22528
  v_exp_f32 v133, v45
  v_add_f32 v241, v241, v130
  v_add_f32 v241, v241, v131
  v_cvt_pk_bf16_f32 v117, v130, v131
  v_mfma_f32_32x32x16_bf16 v[16:31], a[212:215], a[180:183], v[16:31]
  s_mov_b32 m0, s51
  v_exp_f32 v134, v46
  v_add_f32 v241, v241, v132
  v_add_f32 v241, v241, v133
  v_cvt_pk_bf16_f32 v118, v132, v133
  v_mfma_f32_32x32x16_bf16 v[0:15], a[216:219], a[152:155], v[0:15]
  buffer_load_dwordx4 v221, s[56:59], s50 offen lds
  s_add_u32 s50, s50, 0x100000
  v_mfma_f32_32x32x16_bf16 v[16:31], a[216:219], a[184:187], v[16:31]
  v_exp_f32 v135, v47
  v_exp_f32 v128, v48
  v_exp_f32 v129, v49
  v_mfma_f32_32x32x16_bf16 v[0:15], a[220:223], a[156:159], v[0:15]
  v_add_f32 v241, v241, v134
  v_add_f32 v241, v241, v135
  v_cvt_pk_bf16_f32 v119, v134, v135
  v_add_f32 v242, v128, v129
  v_cvt_pk_bf16_f32 v120, v128, v129
  v_mfma_f32_32x32x16_bf16 v[16:31], a[220:223], a[188:191], v[16:31]
  v_exp_f32 v130, v50
  v_exp_f32 v131, v51
  s_waitcnt lgkmcnt(0)
  v_mfma_f32_32x32x16_bf16 a[0:15], a[224:227], v[96:99], a[0:15]
  s_add_u32 m0, s41, 65536
  v_exp_f32 v132, v52
  v_add_f32 v242, v242, v130
  v_add_f32 v242, v242, v131
  v_cvt_pk_bf16_f32 v121, v130, v131
  v_mfma_f32_32x32x16_bf16 a[64:79], a[224:227], v[104:107], a[64:79]
  buffer_load_dwordx4 v240, s[16:19], s40 offen offset:0 lds
  ds_read_b128 a[192:195], v224 offset:40960
  v_mfma_f32_32x32x16_bf16 a[16:31], a[228:231], v[96:99], a[16:31]
  ds_read_b128 a[196:199], v225 offset:40960
  v_exp_f32 v133, v53
  v_exp_f32 v134, v54
  v_mfma_f32_32x32x16_bf16 a[80:95], a[228:231], v[104:107], a[80:95]
  ds_read_b128 a[200:203], v226 offset:40960
  v_exp_f32 v135, v55
  v_add_f32 v242, v242, v132
  v_add_f32 v242, v242, v133
  v_cvt_pk_bf16_f32 v122, v132, v133
  v_mfma_f32_32x32x16_bf16 a[32:47], a[232:235], v[96:99], a[32:47]
  buffer_load_dwordx4 v240, s[16:19], s40 offen offset:1024 lds
  v_exp_f32 v128, v56
  v_mfma_f32_32x32x16_bf16 a[96:111], a[232:235], v[104:107], a[96:111]
  ds_read_b128 a[204:207], v227 offset:40960
  v_exp_f32 v129, v57
  v_add_f32 v242, v242, v134
  v_add_f32 v242, v242, v135
  v_cvt_pk_bf16_f32 v123, v134, v135
  v_mfma_f32_32x32x16_bf16 a[48:63], a[236:239], v[96:99], a[48:63]
  ds_read_b128 a[208:211], v228 offset:40960
  v_exp_f32 v130, v58
  v_add_f32 v242, v242, v128
  v_add_f32 v242, v242, v129
  v_cvt_pk_bf16_f32 v124, v128, v129
  v_mfma_f32_32x32x16_bf16 a[112:127], a[236:239], v[104:107], a[112:127]
  ds_read_b128 a[212:215], v229 offset:40960
  v_exp_f32 v131, v59
  v_exp_f32 v132, v60
  v_mfma_f32_32x32x16_bf16 a[0:15], a[240:243], v[100:103], a[0:15]
  buffer_load_dwordx4 v240, s[16:19], s40 offen offset:2048 lds
  v_exp_f32 v133, v61
  v_mfma_f32_32x32x16_bf16 a[64:79], a[240:243], v[108:111], a[64:79]
  ds_read_b128 a[216:219], v230 offset:40960
  v_add_f32 v242, v242, v130
  v_add_f32 v242, v242, v131
  v_cvt_pk_bf16_f32 v125, v130, v131
  v_add_f32 v242, v242, v132
  v_add_f32 v242, v242, v133
  v_mfma_f32_32x32x16_bf16 a[16:31], a[244:247], v[100:103], a[16:31]
  ds_read_b128 a[220:223], v231 offset:40960
  v_exp_f32 v134, v62
  v_cvt_pk_bf16_f32 v126, v132, v133
  v_exp_f32 v135, v63
  v_mfma_f32_32x32x16_bf16 a[80:95], a[244:247], v[108:111], a[80:95]
  v_add_f32 v242, v242, v134
  v_add_f32 v242, v242, v135
  v_cvt_pk_bf16_f32 v127, v134, v135
  v_mfma_f32_32x32x16_bf16 a[32:47], a[248:251], v[100:103], a[32:47]
  buffer_load_dwordx4 v240, s[16:19], s40 offen offset:3072 lds
  s_add_u32 s40, s40, 16384
  v_mfma_f32_32x32x16_bf16 a[96:111], a[248:251], v[108:111], a[96:111]
  v_max_f32 v246, v241, v242
  v_mfma_f32_32x32x16_bf16 a[48:63], a[252:255], v[100:103], a[48:63]
  v_mfma_f32_32x32x16_bf16 a[112:127], a[252:255], v[108:111], a[112:127]
  v_cmp_lt_f32 vcc, s44, v246
  s_cbranch_vccnz RSTUB_14
RBACK_15:
  s_waitcnt lgkmcnt(0)
  v_mfma_f32_32x32x16_bf16 v[32:47], a[192:195], a[128:131], v[64:79]
  ds_read_b64_tr_b16 a[224:225], v232 offset:24576
  v_add_f32 v243, v243, v241
  v_add_f32 v244, v244, v242
  v_exp_f32 v128, v0
  v_mfma_f32_32x32x16_bf16 v[48:63], a[192:195], a[160:163], v[80:95]
  ds_read_b64_tr_b16 a[226:227], v232 offset:26624
  ds_read_b64_tr_b16 a[228:229], v233 offset:24576
  v_exp_f32 v129, v1
  v_exp_f32 v130, v2
  v_mfma_f32_32x32x16_bf16 v[32:47], a[196:199], a[132:135], v[32:47]
  ds_read_b64_tr_b16 a[230:231], v233 offset:26624
  v_exp_f32 v131, v3
  v_add_f32 v241, v128, v129
  v_cvt_pk_bf16_f32 v96, v128, v129
  v_mfma_f32_32x32x16_bf16 v[48:63], a[196:199], a[164:167], v[48:63]
  ds_read_b64_tr_b16 a[232:233], v234 offset:24576
  ds_read_b64_tr_b16 a[234:235], v234 offset:26624
  v_exp_f32 v132, v4
  v_add_f32 v241, v241, v130
  v_add_f32 v241, v241, v131
  v_mfma_f32_32x32x16_bf16 v[32:47], a[200:203], a[136:139], v[32:47]
  ds_read_b64_tr_b16 a[236:237], v235 offset:24576
  v_exp_f32 v133, v5
  v_cvt_pk_bf16_f32 v97, v130, v131
  v_exp_f32 v134, v6
  v_mfma_f32_32x32x16_bf16 v[48:63], a[200:203], a[168:171], v[48:63]
  ds_read_b64_tr_b16 a[238:239], v235 offset:26624
  ds_read_b64_tr_b16 a[240:241], v232 offset:28672
  v_exp_f32 v135, v7
  v_add_f32 v241, v241, v132
  v_add_f32 v241, v241, v133
  v_mfma_f32_32x32x16_bf16 v[32:47], a[204:207], a[140:143], v[32:47]
  ds_read_b64_tr_b16 a[242:243], v232 offset:30720
  v_cvt_pk_bf16_f32 v98, v132, v133
  v_add_f32 v241, v241, v134
  v_add_f32 v241, v241, v135
  v_cvt_pk_bf16_f32 v99, v134, v135
  v_mfma_f32_32x32x16_bf16 v[48:63], a[204:207], a[172:175], v[48:63]
  ds_read_b64_tr_b16 a[244:245], v233 offset:28672
  ds_read_b64_tr_b16 a[246:247], v233 offset:30720
  v_exp_f32 v128, v8
  v_exp_f32 v129, v9
  v_mfma_f32_32x32x16_bf16 v[32:47], a[208:211], a[144:147], v[32:47]
  ds_read_b64_tr_b16 a[248:249], v234 offset:28672
  v_exp_f32 v130, v10
  v_add_f32 v241, v241, v128
  v_add_f32 v241, v241, v129
  v_cvt_pk_bf16_f32 v100, v128, v129
  v_mfma_f32_32x32x16_bf16 v[48:63], a[208:211], a[176:179], v[48:63]
  ds_read_b64_tr_b16 a[250:251], v234 offset:30720
  ds_read_b64_tr_b16 a[252:253], v235 offset:28672
  v_exp_f32 v131, v11
  v_exp_f32 v132, v12
  v_mfma_f32_32x32x16_bf16 v[32:47], a[212:215], a[148:151], v[32:47]
  ds_read_b64_tr_b16 a[254:255], v235 offset:30720
  v_exp_f32 v133, v13
  v_add_f32 v241, v241, v130
  v_add_f32 v241, v241, v131
  v_cvt_pk_bf16_f32 v101, v130, v131
  v_mfma_f32_32x32x16_bf16 v[48:63], a[212:215], a[180:183], v[48:63]
  v_exp_f32 v134, v14
  v_add_f32 v241, v241, v132
  v_add_f32 v241, v241, v133
  v_cvt_pk_bf16_f32 v102, v132, v133
  v_mfma_f32_32x32x16_bf16 v[32:47], a[216:219], a[152:155], v[32:47]
  v_exp_f32 v135, v15
  v_exp_f32 v128, v16
  v_exp_f32 v129, v17
  v_mfma_f32_32x32x16_bf16 v[48:63], a[216:219], a[184:187], v[48:63]
  v_add_f32 v241, v241, v134
  v_add_f32 v241, v241, v135
  v_cvt_pk_bf16_f32 v103, v134, v135
  v_add_f32 v242, v128, v129
  v_cvt_pk_bf16_f32 v104, v128, v129
  v_mfma_f32_32x32x16_bf16 v[32:47], a[220:223], a[156:159], v[32:47]
  v_exp_f32 v130, v18
  v_exp_f32 v131, v19
  v_exp_f32 v132, v20
  v_mfma_f32_32x32x16_bf16 v[48:63], a[220:223], a[188:191], v[48:63]
  v_exp_f32 v133, v21
  v_add_f32 v242, v242, v130
  v_add_f32 v242, v242, v131
  s_waitcnt vmcnt(18) lgkmcnt(0)
  s_barrier
  v_mfma_f32_32x32x16_bf16 a[0:15], a[224:227], v[112:115], a[0:15]
  s_add_u32 m0, s41, 32768
  v_cvt_pk_bf16_f32 v105, v130, v131
  v_add_f32 v242, v242, v132
  v_add_f32 v242, v242, v133
  v_cvt_pk_bf16_f32 v106, v132, v133
  v_mfma_f32_32x32x16_bf16 a[64:79], a[224:227], v[120:123], a[64:79]
  buffer_load_dwordx4 v236, s[12:15], s39 offen offset:0 lds
  ds_read_b128 a[192:195], v224 offset:49152
  v_mfma_f32_32x32x16_bf16 a[16:31], a[228:231], v[112:115], a[16:31]
  ds_read_b128 a[196:199], v225 offset:49152
  v_exp_f32 v134, v22
  v_exp_f32 v135, v23
  v_mfma_f32_32x32x16_bf16 a[80:95], a[228:231], v[120:123], a[80:95]
  ds_read_b128 a[200:203], v226 offset:49152
  v_exp_f32 v128, v24
  v_add_f32 v242, v242, v134
  v_add_f32 v242, v242, v135
  v_cvt_pk_bf16_f32 v107, v134, v135
  v_mfma_f32_32x32x16_bf16 a[32:47], a[232:235], v[112:115], a[32:47]
  buffer_load_dwordx4 v237, s[12:15], s39 offen offset:1024 lds
  v_exp_f32 v129, v25
  v_mfma_f32_32x32x16_bf16 a[96:111], a[232:235], v[120:123], a[96:111]
  ds_read_b128 a[204:207], v227 offset:49152
  v_exp_f32 v130, v26
  v_add_f32 v242, v242, v128
  v_add_f32 v242, v242, v129
  v_cvt_pk_bf16_f32 v108, v128, v129
  v_mfma_f32_32x32x16_bf16 a[48:63], a[236:239], v[112:115], a[48:63]
  ds_read_b128 a[208:211], v228 offset:49152
  v_exp_f32 v131, v27
  v_exp_f32 v132, v28
  v_mfma_f32_32x32x16_bf16 a[112:127], a[236:239], v[120:123], a[112:127]
  ds_read_b128 a[212:215], v229 offset:49152
  v_exp_f32 v133, v29
  v_add_f32 v242, v242, v130
  v_add_f32 v242, v242, v131
  v_cvt_pk_bf16_f32 v109, v130, v131
  v_mfma_f32_32x32x16_bf16 a[0:15], a[240:243], v[116:119], a[0:15]
  buffer_load_dwordx4 v238, s[12:15], s39 offen offset:2048 lds
  v_exp_f32 v134, v30
  v_mfma_f32_32x32x16_bf16 a[64:79], a[240:243], v[124:127], a[64:79]
  ds_read_b128 a[216:219], v230 offset:49152
  v_exp_f32 v135, v31
  v_add_f32 v242, v242, v132
  v_add_f32 v242, v242, v133
  v_cvt_pk_bf16_f32 v110, v132, v133
  v_mfma_f32_32x32x16_bf16 a[16:31], a[244:247], v[116:119], a[16:31]
  ds_read_b128 a[220:223], v231 offset:49152
  v_add_f32 v242, v242, v134
  v_add_f32 v242, v242, v135
  v_cvt_pk_bf16_f32 v111, v134, v135
  v_mfma_f32_32x32x16_bf16 a[80:95], a[244:247], v[124:127], a[80:95]
  v_mfma_f32_32x32x16_bf16 a[32:47], a[248:251], v[116:119], a[32:47]
  buffer_load_dwordx4 v239, s[12:15], s39 offen offset:3072 lds
  s_add_u32 s39, s39, 16384
  v_mfma_f32_32x32x16_bf16 a[96:111], a[248:251], v[124:127], a[96:111]
  v_max_f32 v246, v241, v242
  v_mfma_f32_32x32x16_bf16 a[48:63], a[252:255], v[116:119], a[48:63]
  v_mfma_f32_32x32x16_bf16 a[112:127], a[252:255], v[124:127], a[112:127]
  v_cmp_lt_f32 vcc, s44, v246
  s_cbranch_vccnz RSTUB_16
RBACK_17:
  s_waitcnt lgkmcnt(0)
  v_mfma_f32_32x32x16_bf16 v[0:15], a[192:195], a[128:131], v[64:79]
  ds_read_b64_tr_b16 a[224:225], v232 offset:32768
  v_add_f32 v243, v243, v241
  v_add_f32 v244, v244, v242
  v_exp_f32 v128, v32
  v_mfma_f32_32x32x16_bf16 v[16:31], a[192:195], a[160:163], v[80:95]
  ds_read_b64_tr_b16 a[226:227], v232 offset:34816
  ds_read_b64_tr_b16 a[228:229], v233 offset:32768
  v_exp_f32 v129, v33
  v_exp_f32 v130, v34
  v_mfma_f32_32x32x16_bf16 v[0:15], a[196:199], a[132:135], v[0:15]
  ds_read_b64_tr_b16 a[230:231], v233 offset:34816
  v_exp_f32 v131, v35
  v_add_f32 v241, v128, v129
  v_cvt_pk_bf16_f32 v112, v128, v129
  v_mfma_f32_32x32x16_bf16 v[16:31], a[196:199], a[164:167], v[16:31]
  ds_read_b64_tr_b16 a[232:233], v234 offset:32768
  ds_read_b64_tr_b16 a[234:235], v234 offset:34816
  v_exp_f32 v132, v36
  v_add_f32 v241, v241, v130
  v_add_f32 v241, v241, v131
  v_mfma_f32_32x32x16_bf16 v[0:15], a[200:203], a[136:139], v[0:15]
  ds_read_b64_tr_b16 a[236:237], v235 offset:32768
  v_exp_f32 v133, v37
  v_cvt_pk_bf16_f32 v113, v130, v131
  v_exp_f32 v134, v38
  v_mfma_f32_32x32x16_bf16 v[16:31], a[200:203], a[168:171], v[16:31]
  ds_read_b64_tr_b16 a[238:239], v235 offset:34816
  ds_read_b64_tr_b16 a[240:241], v232 offset:36864
  v_exp_f32 v135, v39
  v_add_f32 v241, v241, v132
  v_add_f32 v241, v241, v133
  v_mfma_f32_32x32x16_bf16 v[0:15], a[204:207], a[140:143], v[0:15]
  ds_read_b64_tr_b16 a[242:243], v232 offset:38912
  v_cvt_pk_bf16_f32 v114, v132, v133
  v_add_f32 v241, v241, v134
  v_add_f32 v241, v241, v135
  v_cvt_pk_bf16_f32 v115, v134, v135
  v_mfma_f32_32x32x16_bf16 v[16:31], a[204:207], a[172:175], v[16:31]
  ds_read_b64_tr_b16 a[244:245], v233 offset:36864
  ds_read_b64_tr_b16 a[246:247], v233 offset:38912
  v_exp_f32 v128, v40
  v_exp_f32 v129, v41
  v_mfma_f32_32x32x16_bf16 v[0:15], a[208:211], a[144:147], v[0:15]
  ds_read_b64_tr_b16 a[248:249], v234 offset:36864
  v_exp_f32 v130, v42
  v_add_f32 v241, v241, v128
  v_add_f32 v241, v241, v129
  v_cvt_pk_bf16_f32 v116, v128, v129
  v_mfma_f32_32x32x16_bf16 v[16:31], a[208:211], a[176:179], v[16:31]
  ds_read_b64_tr_b16 a[250:251], v234 offset:38912
  ds_read_b64_tr_b16 a[252:253], v235 offset:36864
  v_exp_f32 v131, v43
  v_exp_f32 v132, v44
  v_mfma_f32_32x32x16_bf16 v[0:15], a[212:215], a[148:151], v[0:15]
  ds_read_b64_tr_b16 a[254:255], v235 offset:38912
  v_exp_f32 v133, v45
  v_add_f32 v241, v241, v130
  v_add_f32 v241, v241, v131
  v_cvt_pk_bf16_f32 v117, v130, v131
  v_mfma_f32_32x32x16_bf16 v[16:31], a[212:215], a[180:183], v[16:31]
  s_mov_b32 m0, s51
  v_exp_f32 v134, v46
  v_add_f32 v241, v241, v132
  v_add_f32 v241, v241, v133
  v_cvt_pk_bf16_f32 v118, v132, v133
  v_mfma_f32_32x32x16_bf16 v[0:15], a[216:219], a[152:155], v[0:15]
  buffer_load_dwordx4 v221, s[56:59], s50 offen lds
  s_add_u32 s50, s50, 0x100000
  v_mfma_f32_32x32x16_bf16 v[16:31], a[216:219], a[184:187], v[16:31]
  v_exp_f32 v135, v47
  v_exp_f32 v128, v48
  v_exp_f32 v129, v49
  v_mfma_f32_32x32x16_bf16 v[0:15], a[220:223], a[156:159], v[0:15]
  v_add_f32 v241, v241, v134
  v_add_f32 v241, v241, v135
  v_cvt_pk_bf16_f32 v119, v134, v135
  v_add_f32 v242, v128, v129
  v_cvt_pk_bf16_f32 v120, v128, v129
  v_mfma_f32_32x32x16_bf16 v[16:31], a[220:223], a[188:191], v[16:31]
  v_exp_f32 v130, v50
  v_exp_f32 v131, v51
  s_waitcnt lgkmcnt(0)
  v_mfma_f32_32x32x16_bf16 a[0:15], a[224:227], v[96:99], a[0:15]
  s_add_u32 m0, s41, 81920
  v_exp_f32 v132, v52
  v_add_f32 v242, v242, v130
  v_add_f32 v242, v242, v131
  v_cvt_pk_bf16_f32 v121, v130, v131
  v_mfma_f32_32x32x16_bf16 a[64:79], a[224:227], v[104:107], a[64:79]
  buffer_load_dwordx4 v240, s[16:19], s40 offen offset:0 lds
  ds_read_b128 a[192:195], v224 offset:57344
  v_mfma_f32_32x32x16_bf16 a[16:31], a[228:231], v[96:99], a[16:31]
  ds_read_b128 a[196:199], v225 offset:57344
  v_exp_f32 v133, v53
  v_exp_f32 v134, v54
  v_mfma_f32_32x32x16_bf16 a[80:95], a[228:231], v[104:107], a[80:95]
  ds_read_b128 a[200:203], v226 offset:57344
  v_exp_f32 v135, v55
  v_add_f32 v242, v242, v132
  v_add_f32 v242, v242, v133
  v_cvt_pk_bf16_f32 v122, v132, v133
  v_mfma_f32_32x32x16_bf16 a[32:47], a[232:235], v[96:99], a[32:47]
  buffer_load_dwordx4 v240, s[16:19], s40 offen offset:1024 lds
  v_exp_f32 v128, v56
  v_mfma_f32_32x32x16_bf16 a[96:111], a[232:235], v[104:107], a[96:111]
  ds_read_b128 a[204:207], v227 offset:57344
  v_exp_f32 v129, v57
  v_add_f32 v242, v242, v134
  v_add_f32 v242, v242, v135
  v_cvt_pk_bf16_f32 v123, v134, v135
  v_mfma_f32_32x32x16_bf16 a[48:63], a[236:239], v[96:99], a[48:63]
  ds_read_b128 a[208:211], v228 offset:57344
  v_exp_f32 v130, v58
  v_add_f32 v242, v242, v128
  v_add_f32 v242, v242, v129
  v_cvt_pk_bf16_f32 v124, v128, v129
  v_mfma_f32_32x32x16_bf16 a[112:127], a[236:239], v[104:107], a[112:127]
  ds_read_b128 a[212:215], v229 offset:57344
  v_exp_f32 v131, v59
  v_exp_f32 v132, v60
  v_mfma_f32_32x32x16_bf16 a[0:15], a[240:243], v[100:103], a[0:15]
  buffer_load_dwordx4 v240, s[16:19], s40 offen offset:2048 lds
  v_exp_f32 v133, v61
  v_mfma_f32_32x32x16_bf16 a[64:79], a[240:243], v[108:111], a[64:79]
  ds_read_b128 a[216:219], v230 offset:57344
  v_add_f32 v242, v242, v130
  v_add_f32 v242, v242, v131
  v_cvt_pk_bf16_f32 v125, v130, v131
  v_add_f32 v242, v242, v132
  v_add_f32 v242, v242, v133
  v_mfma_f32_32x32x16_bf16 a[16:31], a[244:247], v[100:103], a[16:31]
  ds_read_b128 a[220:223], v231 offset:57344
  v_exp_f32 v134, v62
  v_cvt_pk_bf16_f32 v126, v132, v133
  v_exp_f32 v135, v63
  v_mfma_f32_32x32x16_bf16 a[80:95], a[244:247], v[108:111], a[80:95]
  v_add_f32 v242, v242, v134
  v_add_f32 v242, v242, v135
  v_cvt_pk_bf16_f32 v127, v134, v135
  v_mfma_f32_32x32x16_bf16 a[32:47], a[248:251], v[100:103], a[32:47]
  buffer_load_dwordx4 v240, s[16:19], s40 offen offset:3072 lds
  s_add_u32 s40, s40, 16384
  v_mfma_f32_32x32x16_bf16 a[96:111], a[248:251], v[108:111], a[96:111]
  v_max_f32 v246, v241, v242
  v_mfma_f32_32x32x16_bf16 a[48:63], a[252:255], v[100:103], a[48:63]
  v_mfma_f32_32x32x16_bf16 a[112:127], a[252:255], v[108:111], a[112:127]
  v_cmp_lt_f32 vcc, s44, v246
  s_cbranch_vccnz RSTUB_18
RBACK_19:
  s_waitcnt lgkmcnt(0)
  v_mfma_f32_32x32x16_bf16 v[32:47], a[192:195], a[128:131], v[64:79]
  ds_read_b64_tr_b16 a[224:225], v232 offset:40960
  v_add_f32 v243, v243, v241
  v_add_f32 v244, v244, v242
  v_exp_f32 v128, v0
  v_mfma_f32_32x32x16_bf16 v[48:63], a[192:195], a[160:163], v[80:95]
  ds_read_b64_tr_b16 a[226:227], v232 offset:43008
  ds_read_b64_tr_b16 a[228:229], v233 offset:40960
  v_exp_f32 v129, v1
  v_exp_f32 v130, v2
  v_mfma_f32_32x32x16_bf16 v[32:47], a[196:199], a[132:135], v[32:47]
  ds_read_b64_tr_b16 a[230:231], v233 offset:43008
  v_exp_f32 v131, v3
  v_add_f32 v241, v128, v129
  v_cvt_pk_bf16_f32 v96, v128, v129
  v_mfma_f32_32x32x16_bf16 v[48:63], a[196:199], a[164:167], v[48:63]
  ds_read_b64_tr_b16 a[232:233], v234 offset:40960
  ds_read_b64_tr_b16 a[234:235], v234 offset:43008
  v_exp_f32 v132, v4
  v_add_f32 v241, v241, v130
  v_add_f32 v241, v241, v131
  v_mfma_f32_32x32x16_bf16 v[32:47], a[200:203], a[136:139], v[32:47]
  ds_read_b64_tr_b16 a[236:237], v235 offset:40960
  v_exp_f32 v133, v5
  v_cvt_pk_bf16_f32 v97, v130, v131
  v_exp_f32 v134, v6
  v_mfma_f32_32x32x16_bf16 v[48:63], a[200:203], a[168:171], v[48:63]
  ds_read_b64_tr_b16 a[238:239], v235 offset:43008
  ds_read_b64_tr_b16 a[240:241], v232 offset:45056
  v_exp_f32 v135, v7
  v_add_f32 v241, v241, v132
  v_add_f32 v241, v241, v133
  v_mfma_f32_32x32x16_bf16 v[32:47], a[204:207], a[140:143], v[32:47]
  ds_read_b64_tr_b16 a[242:243], v232 offset:47104
  v_cvt_pk_bf16_f32 v98, v132, v133
  v_add_f32 v241, v241, v134
  v_add_f32 v241, v241, v135
  v_cvt_pk_bf16_f32 v99, v134, v135
  v_mfma_f32_32x32x16_bf16 v[48:63], a[204:207], a[172:175], v[48:63]
  ds_read_b64_tr_b16 a[244:245], v233 offset:45056
  ds_read_b64_tr_b16 a[246:247], v233 offset:47104
  v_exp_f32 v128, v8
  v_exp_f32 v129, v9
  v_mfma_f32_32x32x16_bf16 v[32:47], a[208:211], a[144:147], v[32:47]
  ds_read_b64_tr_b16 a[248:249], v234 offset:45056
  v_exp_f32 v130, v10
  v_add_f32 v241, v241, v128
  v_add_f32 v241, v241, v129
  v_cvt_pk_bf16_f32 v100, v128, v129
  v_mfma_f32_32x32x16_bf16 v[48:63], a[208:211], a[176:179], v[48:63]
  ds_read_b64_tr_b16 a[250:251], v234 offset:47104
  ds_read_b64_tr_b16 a[252:253], v235 offset:45056
  v_exp_f32 v131, v11
  v_exp_f32 v132, v12
  v_mfma_f32_32x32x16_bf16 v[32:47], a[212:215], a[148:151], v[32:47]
  ds_read_b64_tr_b16 a[254:255], v235 offset:47104
  v_exp_f32 v133, v13
  v_add_f32 v241, v241, v130
  v_add_f32 v241, v241, v131
  v_cvt_pk_bf16_f32 v101, v130, v131
  v_mfma_f32_32x32x16_bf16 v[48:63], a[212:215], a[180:183], v[48:63]
  v_exp_f32 v134, v14
  v_add_f32 v241, v241, v132
  v_add_f32 v241, v241, v133
  v_cvt_pk_bf16_f32 v102, v132, v133
  v_mfma_f32_32x32x16_bf16 v[32:47], a[216:219], a[152:155], v[32:47]
  v_exp_f32 v135, v15
  v_exp_f32 v128, v16
  v_exp_f32 v129, v17
  v_mfma_f32_32x32x16_bf16 v[48:63], a[216:219], a[184:187], v[48:63]
  v_add_f32 v241, v241, v134
  v_add_f32 v241, v241, v135
  v_cvt_pk_bf16_f32 v103, v134, v135
  v_add_f32 v242, v128, v129
  v_cvt_pk_bf16_f32 v104, v128, v129
  v_mfma_f32_32x32x16_bf16 v[32:47], a[220:223], a[156:159], v[32:47]
  v_exp_f32 v130, v18
  v_exp_f32 v131, v19
  v_exp_f32 v132, v20
  v_mfma_f32_32x32x16_bf16 v[48:63], a[220:223], a[188:191], v[48:63]
  v_exp_f32 v133, v21
  v_add_f32 v242, v242, v130
  v_add_f32 v242, v242, v131
  s_waitcnt vmcnt(18) lgkmcnt(0)
  s_barrier
  v_mfma_f32_32x32x16_bf16 a[0:15], a[224:227], v[112:115], a[0:15]
  s_add_u32 m0, s41, 49152
  v_cvt_pk_bf16_f32 v105, v130, v131
  v_add_f32 v242, v242, v132
  v_add_f32 v242, v242, v133
  v_cvt_pk_bf16_f32 v106, v132, v133
  v_mfma_f32_32x32x16_bf16 a[64:79], a[224:227], v[120:123], a[64:79]
  buffer_load_dwordx4 v236, s[12:15], s39 offen offset:0 lds
  ds_read_b128 a[192:195], v224 offset:0
  v_mfma_f32_32x32x16_bf16 a[16:31], a[228:231], v[112:115], a[16:31]
  ds_read_b128 a[196:199], v225 offset:0
  v_exp_f32 v134, v22
  v_exp_f32 v135, v23
  v_mfma_f32_32x32x16_bf16 a[80:95], a[228:231], v[120:123], a[80:95]
  ds_read_b128 a[200:203], v226 offset:0
  v_exp_f32 v128, v24
  v_add_f32 v242, v242, v134
  v_add_f32 v242, v242, v135
  v_cvt_pk_bf16_f32 v107, v134, v135
  v_mfma_f32_32x32x16_bf16 a[32:47], a[232:235], v[112:115], a[32:47]
  buffer_load_dwordx4 v237, s[12:15], s39 offen offset:1024 lds
  v_exp_f32 v129, v25
  v_mfma_f32_32x32x16_bf16 a[96:111], a[232:235], v[120:123], a[96:111]
  ds_read_b128 a[204:207], v227 offset:0
  v_exp_f32 v130, v26
  v_add_f32 v242, v242, v128
  v_add_f32 v242, v242, v129
  v_cvt_pk_bf16_f32 v108, v128, v129
  v_mfma_f32_32x32x16_bf16 a[48:63], a[236:239], v[112:115], a[48:63]
  ds_read_b128 a[208:211], v228 offset:0
  v_exp_f32 v131, v27
  v_exp_f32 v132, v28
  v_mfma_f32_32x32x16_bf16 a[112:127], a[236:239], v[120:123], a[112:127]
  ds_read_b128 a[212:215], v229 offset:0
  v_exp_f32 v133, v29
  v_add_f32 v242, v242, v130
  v_add_f32 v242, v242, v131
  v_cvt_pk_bf16_f32 v109, v130, v131
  v_mfma_f32_32x32x16_bf16 a[0:15], a[240:243], v[116:119], a[0:15]
  buffer_load_dwordx4 v238, s[12:15], s39 offen offset:2048 lds
  v_exp_f32 v134, v30
  v_mfma_f32_32x32x16_bf16 a[64:79], a[240:243], v[124:127], a[64:79]
  ds_read_b128 a[216:219], v230 offset:0
  v_exp_f32 v135, v31
  v_add_f32 v242, v242, v132
  v_add_f32 v242, v242, v133
  v_cvt_pk_bf16_f32 v110, v132, v133
  v_mfma_f32_32x32x16_bf16 a[16:31], a[244:247], v[116:119], a[16:31]
  ds_read_b128 a[220:223], v231 offset:0
  v_add_f32 v242, v242, v134
  v_add_f32 v242, v242, v135
  v_cvt_pk_bf16_f32 v111, v134, v135
  v_mfma_f32_32x32x16_bf16 a[80:95], a[244:247], v[124:127], a[80:95]
  v_mfma_f32_32x32x16_bf16 a[32:47], a[248:251], v[116:119], a[32:47]
  buffer_load_dwordx4 v239, s[12:15], s39 offen offset:3072 lds
  s_add_u32 s39, s39, 16384
  v_mfma_f32_32x32x16_bf16 a[96:111], a[248:251], v[124:127], a[96:111]
  v_max_f32 v246, v241, v242
  v_mfma_f32_32x32x16_bf16 a[48:63], a[252:255], v[116:119], a[48:63]
  v_mfma_f32_32x32x16_bf16 a[112:127], a[252:255], v[124:127], a[112:127]
  v_cmp_lt_f32 vcc, s44, v246
  s_cbranch_vccnz RSTUB_20
RBACK_21:
  s_waitcnt lgkmcnt(0)
  v_mfma_f32_32x32x16_bf16 v[0:15], a[192:195], a[128:131], v[64:79]
  ds_read_b64_tr_b16 a[224:225], v232 offset:49152
  v_add_f32 v243, v243, v241
  v_add_f32 v244, v244, v242
  v_exp_f32 v128, v32
  v_mfma_f32_32x32x16_bf16 v[16:31], a[192:195], a[160:163], v[80:95]
  ds_read_b64_tr_b16 a[226:227], v232 offset:51200
  ds_read_b64_tr_b16 a[228:229], v233 offset:49152
  v_exp_f32 v129, v33
  v_exp_f32 v130, v34
  v_mfma_f32_32x32x16_bf16 v[0:15], a[196:199], a[132:135], v[0:15]
  ds_read_b64_tr_b16 a[230:231], v233 offset:51200
  v_exp_f32 v131, v35
  v_add_f32 v241, v128, v129
  v_cvt_pk_bf16_f32 v112, v128, v129
  v_mfma_f32_32x32x16_bf16 v[16:31], a[196:199], a[164:167], v[16:31]
  ds_read_b64_tr_b16 a[232:233], v234 offset:49152
  ds_read_b64_tr_b16 a[234:235], v234 offset:51200
  v_exp_f32 v132, v36
  v_add_f32 v241, v241, v130
  v_add_f32 v241, v241, v131
  v_mfma_f32_32x32x16_bf16 v[0:15], a[200:203], a[136:139], v[0:15]
  ds_read_b64_tr_b16 a[236:237], v235 offset:49152
  v_exp_f32 v133, v37
  v_cvt_pk_bf16_f32 v113, v130, v131
  v_exp_f32 v134, v38
  v_mfma_f32_32x32x16_bf16 v[16:31], a[200:203], a[168:171], v[16:31]
  ds_read_b64_tr_b16 a[238:239], v235 offset:51200
  ds_read_b64_tr_b16 a[240:241], v232 offset:53248
  v_exp_f32 v135, v39
  v_add_f32 v241, v241, v132
  v_add_f32 v241, v241, v133
  v_mfma_f32_32x32x16_bf16 v[0:15], a[204:207], a[140:143], v[0:15]
  ds_read_b64_tr_b16 a[242:243], v232 offset:55296
  v_cvt_pk_bf16_f32 v114, v132, v133
  v_add_f32 v241, v241, v134
  v_add_f32 v241, v241, v135
  v_cvt_pk_bf16_f32 v115, v134, v135
  v_mfma_f32_32x32x16_bf16 v[16:31], a[204:207], a[172:175], v[16:31]
  ds_read_b64_tr_b16 a[244:245], v233 offset:53248
  ds_read_b64_tr_b16 a[246:247], v233 offset:55296
  v_exp_f32 v128, v40
  v_exp_f32 v129, v41
  v_mfma_f32_32x32x16_bf16 v[0:15], a[208:211], a[144:147], v[0:15]
  ds_read_b64_tr_b16 a[248:249], v234 offset:53248
  v_exp_f32 v130, v42
  v_add_f32 v241, v241, v128
  v_add_f32 v241, v241, v129
  v_cvt_pk_bf16_f32 v116, v128, v129
  v_mfma_f32_32x32x16_bf16 v[16:31], a[208:211], a[176:179], v[16:31]
  ds_read_b64_tr_b16 a[250:251], v234 offset:55296
  ds_read_b64_tr_b16 a[252:253], v235 offset:53248
  v_exp_f32 v131, v43
  v_exp_f32 v132, v44
  v_mfma_f32_32x32x16_bf16 v[0:15], a[212:215], a[148:151], v[0:15]
  ds_read_b64_tr_b16 a[254:255], v235 offset:55296
  v_exp_f32 v133, v45
  v_add_f32 v241, v241, v130
  v_add_f32 v241, v241, v131
  v_cvt_pk_bf16_f32 v117, v130, v131
  v_mfma_f32_32x32x16_bf16 v[16:31], a[212:215], a[180:183], v[16:31]
  s_mov_b32 m0, s51
  v_exp_f32 v134, v46
  v_add_f32 v241, v241, v132
  v_add_f32 v241, v241, v133
  v_cvt_pk_bf16_f32 v118, v132, v133
  v_mfma_f32_32x32x16_bf16 v[0:15], a[216:219], a[152:155], v[0:15]
  buffer_load_dwordx4 v221, s[56:59], s50 offen lds
  s_add_u32 s50, s50, 0x100000
  v_mfma_f32_32x32x16_bf16 v[16:31], a[216:219], a[184:187], v[16:31]
  v_exp_f32 v135, v47
  v_exp_f32 v128, v48
  v_exp_f32 v129, v49
  v_mfma_f32_32x32x16_bf16 v[0:15], a[220:223], a[156:159], v[0:15]
  v_add_f32 v241, v241, v134
  v_add_f32 v241, v241, v135
  v_cvt_pk_bf16_f32 v119, v134, v135
  v_add_f32 v242, v128, v129
  v_cvt_pk_bf16_f32 v120, v128, v129
  v_mfma_f32_32x32x16_bf16 v[16:31], a[220:223], a[188:191], v[16:31]
  v_exp_f32 v130, v50
  v_exp_f32 v131, v51
  s_waitcnt lgkmcnt(0)
  v_mfma_f32_32x32x16_bf16 a[0:15], a[224:227], v[96:99], a[0:15]
  s_add_u32 m0, s41, 98304
  v_exp_f32 v132, v52
  v_add_f32 v242, v242, v130
  v_add_f32 v242, v242, v131
  v_cvt_pk_bf16_f32 v121, v130, v131
  v_mfma_f32_32x32x16_bf16 a[64:79], a[224:227], v[104:107], a[64:79]
  buffer_load_dwordx4 v240, s[16:19], s40 offen offset:0 lds
  ds_read_b128 a[192:195], v224 offset:8192
  v_mfma_f32_32x32x16_bf16 a[16:31], a[228:231], v[96:99], a[16:31]
  ds_read_b128 a[196:199], v225 offset:8192
  v_exp_f32 v133, v53
  v_exp_f32 v134, v54
  v_mfma_f32_32x32x16_bf16 a[80:95], a[228:231], v[104:107], a[80:95]
  ds_read_b128 a[200:203], v226 offset:8192
  v_exp_f32 v135, v55
  v_add_f32 v242, v242, v132
  v_add_f32 v242, v242, v133
  v_cvt_pk_bf16_f32 v122, v132, v133
  v_mfma_f32_32x32x16_bf16 a[32:47], a[232:235], v[96:99], a[32:47]
  buffer_load_dwordx4 v240, s[16:19], s40 offen offset:1024 lds
  v_exp_f32 v128, v56
  v_mfma_f32_32x32x16_bf16 a[96:111], a[232:235], v[104:107], a[96:111]
  ds_read_b128 a[204:207], v227 offset:8192
  v_exp_f32 v129, v57
  v_add_f32 v242, v242, v134
  v_add_f32 v242, v242, v135
  v_cvt_pk_bf16_f32 v123, v134, v135
  v_mfma_f32_32x32x16_bf16 a[48:63], a[236:239], v[96:99], a[48:63]
  ds_read_b128 a[208:211], v228 offset:8192
  v_exp_f32 v130, v58
  v_add_f32 v242, v242, v128
  v_add_f32 v242, v242, v129
  v_cvt_pk_bf16_f32 v124, v128, v129
  v_mfma_f32_32x32x16_bf16 a[112:127], a[236:239], v[104:107], a[112:127]
  ds_read_b128 a[212:215], v229 offset:8192
  v_exp_f32 v131, v59
  v_exp_f32 v132, v60
  v_mfma_f32_32x32x16_bf16 a[0:15], a[240:243], v[100:103], a[0:15]
  buffer_load_dwordx4 v240, s[16:19], s40 offen offset:2048 lds
  v_exp_f32 v133, v61
  v_mfma_f32_32x32x16_bf16 a[64:79], a[240:243], v[108:111], a[64:79]
  ds_read_b128 a[216:219], v230 offset:8192
  v_add_f32 v242, v242, v130
  v_add_f32 v242, v242, v131
  v_cvt_pk_bf16_f32 v125, v130, v131
  v_add_f32 v242, v242, v132
  v_add_f32 v242, v242, v133
  v_mfma_f32_32x32x16_bf16 a[16:31], a[244:247], v[100:103], a[16:31]
  ds_read_b128 a[220:223], v231 offset:8192
  v_exp_f32 v134, v62
  v_cvt_pk_bf16_f32 v126, v132, v133
  v_exp_f32 v135, v63
  v_mfma_f32_32x32x16_bf16 a[80:95], a[244:247], v[108:111], a[80:95]
  v_add_f32 v242, v242, v134
  v_add_f32 v242, v242, v135
  v_cvt_pk_bf16_f32 v127, v134, v135
  v_mfma_f32_32x32x16_bf16 a[32:47], a[248:251], v[100:103], a[32:47]
  buffer_load_dwordx4 v240, s[16:19], s40 offen offset:3072 lds
  s_add_u32 s40, s40, 16384
  v_mfma_f32_32x32x16_bf16 a[96:111], a[248:251], v[108:111], a[96:111]
  v_max_f32 v246, v241, v242
  v_mfma_f32_32x32x16_bf16 a[48:63], a[252:255], v[100:103], a[48:63]
  v_mfma_f32_32x32x16_bf16 a[112:127], a[252:255], v[108:111], a[112:127]
  v_cmp_lt_f32 vcc, s44, v246
  s_cbranch_vccnz RSTUB_22
RBACK_23:
  s_waitcnt lgkmcnt(0)
  v_mfma_f32_32x32x16_bf16 v[32:47], a[192:195], a[128:131], v[64:79]
  ds_read_b64_tr_b16 a[224:225], v232 offset:57344
  v_add_f32 v243, v243, v241
  v_add_f32 v244, v244, v242
  v_exp_f32 v128, v0
  v_mfma_f32_32x32x16_bf16 v[48:63], a[192:195], a[160:163], v[80:95]
  ds_read_b64_tr_b16 a[226:227], v232 offset:59392
  ds_read_b64_tr_b16 a[228:229], v233 offset:57344
  v_exp_f32 v129, v1
  v_exp_f32 v130, v2
  v_mfma_f32_32x32x16_bf16 v[32:47], a[196:199], a[132:135], v[32:47]
  ds_read_b64_tr_b16 a[230:231], v233 offset:59392
  v_exp_f32 v131, v3
  v_add_f32 v241, v128, v129
  v_cvt_pk_bf16_f32 v96, v128, v129
  v_mfma_f32_32x32x16_bf16 v[48:63], a[196:199], a[164:167], v[48:63]
  ds_read_b64_tr_b16 a[232:233], v234 offset:57344
  ds_read_b64_tr_b16 a[234:235], v234 offset:59392
  v_exp_f32 v132, v4
  v_add_f32 v241, v241, v130
  v_add_f32 v241, v241, v131
  v_mfma_f32_32x32x16_bf16 v[32:47], a[200:203], a[136:139], v[32:47]
  ds_read_b64_tr_b16 a[236:237], v235 offset:57344
  v_exp_f32 v133, v5
  v_cvt_pk_bf16_f32 v97, v130, v131
  v_exp_f32 v134, v6
  v_mfma_f32_32x32x16_bf16 v[48:63], a[200:203], a[168:171], v[48:63]
  ds_read_b64_tr_b16 a[238:239], v235 offset:59392
  ds_read_b64_tr_b16 a[240:241], v232 offset:61440
  v_exp_f32 v135, v7
  v_add_f32 v241, v241, v132
  v_add_f32 v241, v241, v133
  v_mfma_f32_32x32x16_bf16 v[32:47], a[204:207], a[140:143], v[32:47]
  ds_read_b64_tr_b16 a[242:243], v232 offset:63488
  v_cvt_pk_bf16_f32 v98, v132, v133
  v_add_f32 v241, v241, v134
  v_add_f32 v241, v241, v135
  v_cvt_pk_bf16_f32 v99, v134, v135
  v_mfma_f32_32x32x16_bf16 v[48:63], a[204:207], a[172:175], v[48:63]
  ds_read_b64_tr_b16 a[244:245], v233 offset:61440
  ds_read_b64_tr_b16 a[246:247], v233 offset:63488
  v_exp_f32 v128, v8
  v_exp_f32 v129, v9
  v_mfma_f32_32x32x16_bf16 v[32:47], a[208:211], a[144:147], v[32:47]
  ds_read_b64_tr_b16 a[248:249], v234 offset:61440
  v_exp_f32 v130, v10
  v_add_f32 v241, v241, v128
  v_add_f32 v241, v241, v129
  v_cvt_pk_bf16_f32 v100, v128, v129
  v_mfma_f32_32x32x16_bf16 v[48:63], a[208:211], a[176:179], v[48:63]
  ds_read_b64_tr_b16 a[250:251], v234 offset:63488
  ds_read_b64_tr_b16 a[252:253], v235 offset:61440
  v_exp_f32 v131, v11
  v_exp_f32 v132, v12
  v_mfma_f32_32x32x16_bf16 v[32:47], a[212:215], a[148:151], v[32:47]
  ds_read_b64_tr_b16 a[254:255], v235 offset:63488
  v_exp_f32 v133, v13
  v_add_f32 v241, v241, v130
  v_add_f32 v241, v241, v131
  v_cvt_pk_bf16_f32 v101, v130, v131
  v_mfma_f32_32x32x16_bf16 v[48:63], a[212:215], a[180:183], v[48:63]
  v_exp_f32 v134, v14
  v_add_f32 v241, v241, v132
  v_add_f32 v241, v241, v133
  v_cvt_pk_bf16_f32 v102, v132, v133
  v_mfma_f32_32x32x16_bf16 v[32:47], a[216:219], a[152:155], v[32:47]
  v_exp_f32 v135, v15
  v_exp_f32 v128, v16
  v_exp_f32 v129, v17
  v_mfma_f32_32x32x16_bf16 v[48:63], a[216:219], a[184:187], v[48:63]
  v_add_f32 v241, v241, v134
  v_add_f32 v241, v241, v135
  v_cvt_pk_bf16_f32 v103, v134, v135
  v_add_f32 v242, v128, v129
  v_cvt_pk_bf16_f32 v104, v128, v129
  v_mfma_f32_32x32x16_bf16 v[32:47], a[220:223], a[156:159], v[32:47]
  v_exp_f32 v130, v18
  v_exp_f32 v131, v19
  v_exp_f32 v132, v20
  v_mfma_f32_32x32x16_bf16 v[48:63], a[220:223], a[188:191], v[48:63]
  v_exp_f32 v133, v21
  v_add_f32 v242, v242, v130
  v_add_f32 v242, v242, v131
  s_waitcnt vmcnt(18) lgkmcnt(0)
  s_barrier
  v_mfma_f32_32x32x16_bf16 a[0:15], a[224:227], v[112:115], a[0:15]
  s_add_u32 m0, s41, 0
  v_cvt_pk_bf16_f32 v105, v130, v131
  v_add_f32 v242, v242, v132
  v_add_f32 v242, v242, v133
  v_cvt_pk_bf16_f32 v106, v132, v133
  v_mfma_f32_32x32x16_bf16 a[64:79], a[224:227], v[120:123], a[64:79]
  buffer_load_dwordx4 v236, s[12:15], s39 offen offset:0 lds
  ds_read_b128 a[192:195], v224 offset:16384
  v_mfma_f32_32x32x16_bf16 a[16:31], a[228:231], v[112:115], a[16:31]
  ds_read_b128 a[196:199], v225 offset:16384
  v_exp_f32 v134, v22
  v_exp_f32 v135, v23
  v_mfma_f32_32x32x16_bf16 a[80:95], a[228:231], v[120:123], a[80:95]
  ds_read_b128 a[200:203], v226 offset:16384
  v_exp_f32 v128, v24
  v_add_f32 v242, v242, v134
  v_add_f32 v242, v242, v135
  v_cvt_pk_bf16_f32 v107, v134, v135
  v_mfma_f32_32x32x16_bf16 a[32:47], a[232:235], v[112:115], a[32:47]
  buffer_load_dwordx4 v237, s[12:15], s39 offen offset:1024 lds
  v_exp_f32 v129, v25
  v_mfma_f32_32x32x16_bf16 a[96:111], a[232:235], v[120:123], a[96:111]
  ds_read_b128 a[204:207], v227 offset:16384
  v_exp_f32 v130, v26
  v_add_f32 v242, v242, v128
  v_add_f32 v242, v242, v129
  v_cvt_pk_bf16_f32 v108, v128, v129
  v_mfma_f32_32x32x16_bf16 a[48:63], a[236:239], v[112:115], a[48:63]
  ds_read_b128 a[208:211], v228 offset:16384
  v_exp_f32 v131, v27
  v_exp_f32 v132, v28
  v_mfma_f32_32x32x16_bf16 a[112:127], a[236:239], v[120:123], a[112:127]
  ds_read_b128 a[212:215], v229 offset:16384
  v_exp_f32 v133, v29
  v_add_f32 v242, v242, v130
  v_add_f32 v242, v242, v131
  v_cvt_pk_bf16_f32 v109, v130, v131
  v_mfma_f32_32x32x16_bf16 a[0:15], a[240:243], v[116:119], a[0:15]
  buffer_load_dwordx4 v238, s[12:15], s39 offen offset:2048 lds
  v_exp_f32 v134, v30
  v_mfma_f32_32x32x16_bf16 a[64:79], a[240:243], v[124:127], a[64:79]
  ds_read_b128 a[216:219], v230 offset:16384
  v_exp_f32 v135, v31
  v_add_f32 v242, v242, v132
  v_add_f32 v242, v242, v133
  v_cvt_pk_bf16_f32 v110, v132, v133
  v_mfma_f32_32x32x16_bf16 a[16:31], a[244:247], v[116:119], a[16:31]
  ds_read_b128 a[220:223], v231 offset:16384
  v_add_f32 v242, v242, v134
  v_add_f32 v242, v242, v135
  v_cvt_pk_bf16_f32 v111, v134, v135
  v_mfma_f32_32x32x16_bf16 a[80:95], a[244:247], v[124:127], a[80:95]
  v_mfma_f32_32x32x16_bf16 a[32:47], a[248:251], v[116:119], a[32:47]
  buffer_load_dwordx4 v239, s[12:15], s39 offen offset:3072 lds
  s_add_u32 s39, s39, 16384
  v_mfma_f32_32x32x16_bf16 a[96:111], a[248:251], v[124:127], a[96:111]
  v_max_f32 v246, v241, v242
  v_mfma_f32_32x32x16_bf16 a[48:63], a[252:255], v[116:119], a[48:63]
  v_mfma_f32_32x32x16_bf16 a[112:127], a[252:255], v[124:127], a[112:127]
  v_cmp_lt_f32 vcc, s44, v246
  s_cbranch_vccnz RSTUB_24
RBACK_25:
  s_sub_u32 s50, s50, 0x400000
  s_mov_b32 s56, s90
  s_mov_b32 s57, s91
  s_mov_b32 s90, s92
  s_mov_b32 s91, s93
  s_mov_b32 s92, s94
  s_mov_b32 s93, s95
  s_mov_b32 s58, s96
  s_mov_b32 s96, s97
  s_mov_b32 s97, s98
  s_mov_b32 s98, 0
  s_waitcnt lgkmcnt(0)
  v_mfma_f32_32x32x16_bf16 v[0:15], a[192:195], a[128:131], v[64:79]
  ds_read_b64_tr_b16 a[224:225], v232 offset:0
  v_add_f32 v243, v243, v241
  v_add_f32 v244, v244, v242
  v_exp_f32 v128, v32
  v_mfma_f32_32x32x16_bf16 v[16:31], a[192:195], a[160:163], v[80:95]
  ds_read_b64_tr_b16 a[226:227], v232 offset:2048
  ds_read_b64_tr_b16 a[228:229], v233 offset:0
  v_exp_f32 v129, v33
  v_exp_f32 v130, v34
  v_mfma_f32_32x32x16_bf16 v[0:15], a[196:199], a[132:135], v[0:15]
  ds_read_b64_tr_b16 a[230:231], v233 offset:2048
  v_exp_f32 v131, v35
  v_add_f32 v241, v128, v129
  v_cvt_pk_bf16_f32 v112, v128, v129
  v_mfma_f32_32x32x16_bf16 v[16:31], a[196:199], a[164:167], v[16:31]
  ds_read_b64_tr_b16 a[232:233], v234 offset:0
  ds_read_b64_tr_b16 a[234:235], v234 offset:2048
  v_exp_f32 v132, v36
  v_add_f32 v241, v241, v130
  v_add_f32 v241, v241, v131
  v_mfma_f32_32x32x16_bf16 v[0:15], a[200:203], a[136:139], v[0:15]
  ds_read_b64_tr_b16 a[236:237], v235 offset:0
  v_exp_f32 v133, v37
  v_cvt_pk_bf16_f32 v113, v130, v131
  v_exp_f32 v134, v38
  v_mfma_f32_32x32x16_bf16 v[16:31], a[200:203], a[168:171], v[16:31]
  ds_read_b64_tr_b16 a[238:239], v235 offset:2048
  ds_read_b64_tr_b16 a[240:241], v232 offset:4096
  v_exp_f32 v135, v39
  v_add_f32 v241, v241, v132
  v_add_f32 v241, v241, v133
  v_mfma_f32_32x32x16_bf16 v[0:15], a[204:207], a[140:143], v[0:15]
  ds_read_b64_tr_b16 a[242:243], v232 offset:6144
  v_cvt_pk_bf16_f32 v114, v132, v133
  v_add_f32 v241, v241, v134
  v_add_f32 v241, v241, v135
  v_cvt_pk_bf16_f32 v115, v134, v135
  v_mfma_f32_32x32x16_bf16 v[16:31], a[204:207], a[172:175], v[16:31]
  ds_read_b64_tr_b16 a[244:245], v233 offset:4096
  ds_read_b64_tr_b16 a[246:247], v233 offset:6144
  v_exp_f32 v128, v40
  v_exp_f32 v129, v41
  v_mfma_f32_32x32x16_bf16 v[0:15], a[208:211], a[144:147], v[0:15]
  ds_read_b64_tr_b16 a[248:249], v234 offset:4096
  v_exp_f32 v130, v42
  v_add_f32 v241, v241, v128
  v_add_f32 v241, v241, v129
  v_cvt_pk_bf16_f32 v116, v128, v129
  v_mfma_f32_32x32x16_bf16 v[16:31], a[208:211], a[176:179], v[16:31]
  ds_read_b64_tr_b16 a[250:251], v234 offset:6144
  ds_read_b64_tr_b16 a[252:253], v235 offset:4096
  v_exp_f32 v131, v43
  v_exp_f32 v132, v44
  v_mfma_f32_32x32x16_bf16 v[0:15], a[212:215], a[148:151], v[0:15]
  ds_read_b64_tr_b16 a[254:255], v235 offset:6144
  v_exp_f32 v133, v45
  v_add_f32 v241, v241, v130
  v_add_f32 v241, v241, v131
  v_cvt_pk_bf16_f32 v117, v130, v131
  v_mfma_f32_32x32x16_bf16 v[16:31], a[212:215], a[180:183], v[16:31]
  s_mov_b32 m0, s51
  v_exp_f32 v134, v46
  v_add_f32 v241, v241, v132
  v_add_f32 v241, v241, v133
  v_cvt_pk_bf16_f32 v118, v132, v133
  v_mfma_f32_32x32x16_bf16 v[0:15], a[216:219], a[152:155], v[0:15]
  buffer_load_dwordx4 v221, s[56:59], s50 offen lds
  s_add_u32 s50, s50, 0x100000
  v_mfma_f32_32x32x16_bf16 v[16:31], a[216:219], a[184:187], v[16:31]
  v_exp_f32 v135, v47
  v_exp_f32 v128, v48
  v_exp_f32 v129, v49
  v_mfma_f32_32x32x16_bf16 v[0:15], a[220:223], a[156:159], v[0:15]
  v_add_f32 v241, v241, v134
  v_add_f32 v241, v241, v135
  v_cvt_pk_bf16_f32 v119, v134, v135
  v_add_f32 v242, v128, v129
  v_cvt_pk_bf16_f32 v120, v128, v129
  v_mfma_f32_32x32x16_bf16 v[16:31], a[220:223], a[188:191], v[16:31]
  v_exp_f32 v130, v50
  v_exp_f32 v131, v51
  s_waitcnt lgkmcnt(0)
  v_mfma_f32_32x32x16_bf16 a[0:15], a[224:227], v[96:99], a[0:15]
  s_add_u32 m0, s41, 114688
  v_exp_f32 v132, v52
  v_add_f32 v242, v242, v130
  v_add_f32 v242, v242, v131
  v_cvt_pk_bf16_f32 v121, v130, v131
  v_mfma_f32_32x32x16_bf16 a[64:79], a[224:227], v[104:107], a[64:79]
  buffer_load_dwordx4 v240, s[16:19], s40 offen offset:0 lds
  ds_read_b128 a[192:195], v224 offset:24576
  v_mfma_f32_32x32x16_bf16 a[16:31], a[228:231], v[96:99], a[16:31]
  ds_read_b128 a[196:199], v225 offset:24576
  v_exp_f32 v133, v53
  v_exp_f32 v134, v54
  v_mfma_f32_32x32x16_bf16 a[80:95], a[228:231], v[104:107], a[80:95]
  ds_read_b128 a[200:203], v226 offset:24576
  v_exp_f32 v135, v55
  v_add_f32 v242, v242, v132
  v_add_f32 v242, v242, v133
  v_cvt_pk_bf16_f32 v122, v132, v133
  v_mfma_f32_32x32x16_bf16 a[32:47], a[232:235], v[96:99], a[32:47]
  buffer_load_dwordx4 v240, s[16:19], s40 offen offset:1024 lds
  v_exp_f32 v128, v56
  v_mfma_f32_32x32x16_bf16 a[96:111], a[232:235], v[104:107], a[96:111]
  ds_read_b128 a[204:207], v227 offset:24576
  v_exp_f32 v129, v57
  v_add_f32 v242, v242, v134
  v_add_f32 v242, v242, v135
  v_cvt_pk_bf16_f32 v123, v134, v135
  v_mfma_f32_32x32x16_bf16 a[48:63], a[236:239], v[96:99], a[48:63]
  ds_read_b128 a[208:211], v228 offset:24576
  v_exp_f32 v130, v58
  v_add_f32 v242, v242, v128
  v_add_f32 v242, v242, v129
  v_cvt_pk_bf16_f32 v124, v128, v129
  v_mfma_f32_32x32x16_bf16 a[112:127], a[236:239], v[104:107], a[112:127]
  ds_read_b128 a[212:215], v229 offset:24576
  v_exp_f32 v131, v59
  v_exp_f32 v132, v60
  v_mfma_f32_32x32x16_bf16 a[0:15], a[240:243], v[100:103], a[0:15]
  buffer_load_dwordx4 v240, s[16:19], s40 offen offset:2048 lds
  v_exp_f32 v133, v61
  v_mfma_f32_32x32x16_bf16 a[64:79], a[240:243], v[108:111], a[64:79]
  ds_read_b128 a[216:219], v230 offset:24576
  v_add_f32 v242, v242, v130
  v_add_f32 v242, v242, v131
  v_cvt_pk_bf16_f32 v125, v130, v131
  v_add_f32 v242, v242, v132
  v_add_f32 v242, v242, v133
  v_mfma_f32_32x32x16_bf16 a[16:31], a[244:247], v[100:103], a[16:31]
  ds_read_b128 a[220:223], v231 offset:24576
  v_exp_f32 v134, v62
  v_cvt_pk_bf16_f32 v126, v132, v133
  v_exp_f32 v135, v63
  v_mfma_f32_32x32x16_bf16 a[80:95], a[244:247], v[108:111], a[80:95]
  v_add_f32 v242, v242, v134
  v_add_f32 v242, v242, v135
  v_cvt_pk_bf16_f32 v127, v134, v135
  v_mfma_f32_32x32x16_bf16 a[32:47], a[248:251], v[100:103], a[32:47]
  buffer_load_dwordx4 v240, s[16:19], s40 offen offset:3072 lds
  s_add_u32 s40, s40, 16384
  v_mfma_f32_32x32x16_bf16 a[96:111], a[248:251], v[108:111], a[96:111]
  v_max_f32 v246, v241, v242
  v_mfma_f32_32x32x16_bf16 a[48:63], a[252:255], v[100:103], a[48:63]
  v_mfma_f32_32x32x16_bf16 a[112:127], a[252:255], v[108:111], a[112:127]
  v_cmp_lt_f32 vcc, s44, v246
  s_cbranch_vccnz RSTUB_26
RBACK_27:
  s_sub_u32 s42, s42, 1
  s_cmp_lg_u32 s42, 0
  s_cbranch_scc1 KB_LOOP0
  s_waitcnt lgkmcnt(0)
  v_mfma_f32_32x32x16_bf16 v[32:47], a[192:195], a[128:131], v[64:79]
  ds_read_b64_tr_b16 a[224:225], v232 offset:8192
  v_add_f32 v243, v243, v241
  v_add_f32 v244, v244, v242
  v_exp_f32 v128, v0
  v_mfma_f32_32x32x16_bf16 v[48:63], a[192:195], a[160:163], v[80:95]
  ds_read_b64_tr_b16 a[226:227], v232 offset:10240
  ds_read_b64_tr_b16 a[228:229], v233 offset:8192
  v_exp_f32 v129, v1
  v_exp_f32 v130, v2
  v_mfma_f32_32x32x16_bf16 v[32:47], a[196:199], a[132:135], v[32:47]
  ds_read_b64_tr_b16 a[230:231], v233 offset:10240
  v_exp_f32 v131, v3
  v_add_f32 v241, v128, v129
  v_cvt_pk_bf16_f32 v96, v128, v129
  v_mfma_f32_32x32x16_bf16 v[48:63], a[196:199], a[164:167], v[48:63]
  ds_read_b64_tr_b16 a[232:233], v234 offset:8192
  ds_read_b64_tr_b16 a[234:235], v234 offset:10240
  v_exp_f32 v132, v4
  v_add_f32 v241, v241, v130
  v_add_f32 v241, v241, v131
  v_mfma_f32_32x32x16_bf16 v[32:47], a[200:203], a[136:139], v[32:47]
  ds_read_b64_tr_b16 a[236:237], v235 offset:8192
  v_exp_f32 v133, v5
  v_cvt_pk_bf16_f32 v97, v130, v131
  v_exp_f32 v134, v6
  v_mfma_f32_32x32x16_bf16 v[48:63], a[200:203], a[168:171], v[48:63]
  ds_read_b64_tr_b16 a[238:239], v235 offset:10240
  ds_read_b64_tr_b16 a[240:241], v232 offset:12288
  v_exp_f32 v135, v7
  v_add_f32 v241, v241, v132
  v_add_f32 v241, v241, v133
  v_mfma_f32_32x32x16_bf16 v[32:47], a[204:207], a[140:143], v[32:47]
  ds_read_b64_tr_b16 a[242:243], v232 offset:14336
  v_cvt_pk_bf16_f32 v98, v132, v133
  v_add_f32 v241, v241, v134
  v_add_f32 v241, v241, v135
  v_cvt_pk_bf16_f32 v99, v134, v135
  v_mfma_f32_32x32x16_bf16 v[48:63], a[204:207], a[172:175], v[48:63]
  ds_read_b64_tr_b16 a[244:245], v233 offset:12288
  ds_read_b64_tr_b16 a[246:247], v233 offset:14336
  v_exp_f32 v128, v8
  v_exp_f32 v129, v9
  v_mfma_f32_32x32x16_bf16 v[32:47], a[208:211], a[144:147], v[32:47]
  ds_read_b64_tr_b16 a[248:249], v234 offset:12288
  v_exp_f32 v130, v10
  v_add_f32 v241, v241, v128
  v_add_f32 v241, v241, v129
  v_cvt_pk_bf16_f32 v100, v128, v129
  v_mfma_f32_32x32x16_bf16 v[48:63], a[208:211], a[176:179], v[48:63]
  ds_read_b64_tr_b16 a[250:251], v234 offset:14336
  ds_read_b64_tr_b16 a[252:253], v235 offset:12288
  v_exp_f32 v131, v11
  v_exp_f32 v132, v12
  v_mfma_f32_32x32x16_bf16 v[32:47], a[212:215], a[148:151], v[32:47]
  ds_read_b64_tr_b16 a[254:255], v235 offset:14336
  v_exp_f32 v133, v13
  v_add_f32 v241, v241, v130
  v_add_f32 v241, v241, v131
  v_cvt_pk_bf16_f32 v101, v130, v131
  v_mfma_f32_32x32x16_bf16 v[48:63], a[212:215], a[180:183], v[48:63]
  v_exp_f32 v134, v14
  v_add_f32 v241, v241, v132
  v_add_f32 v241, v241, v133
  v_cvt_pk_bf16_f32 v102, v132, v133
  v_mfma_f32_32x32x16_bf16 v[32:47], a[216:219], a[152:155], v[32:47]
  v_exp_f32 v135, v15
  v_exp_f32 v128, v16
  v_exp_f32 v129, v17
  v_mfma_f32_32x32x16_bf16 v[48:63], a[216:219], a[184:187], v[48:63]
  v_add_f32 v241, v241, v134
  v_add_f32 v241, v241, v135
  v_cvt_pk_bf16_f32 v103, v134, v135
  v_add_f32 v242, v128, v129
  v_cvt_pk_bf16_f32 v104, v128, v129
  v_mfma_f32_32x32x16_bf16 v[32:47], a[220:223], a[156:159], v[32:47]
  v_exp_f32 v130, v18
  v_exp_f32 v131, v19
  v_exp_f32 v132, v20
  v_mfma_f32_32x32x16_bf16 v[48:63], a[220:223], a[188:191], v[48:63]
  v_exp_f32 v133, v21
  v_add_f32 v242, v242, v130
  v_add_f32 v242, v242, v131
  s_waitcnt vmcnt(9) lgkmcnt(0)
  s_barrier
  v_mfma_f32_32x32x16_bf16 a[0:15], a[224:227], v[112:115], a[0:15]
  v_cvt_pk_bf16_f32 v105, v130, v131
  v_add_f32 v242, v242, v132
  v_add_f32 v242, v242, v133
  v_cvt_pk_bf16_f32 v106, v132, v133
  v_exp_f32 v134, v22
  v_mfma_f32_32x32x16_bf16 a[64:79], a[224:227], v[120:123], a[64:79]
  ds_read_b128 a[192:195], v224 offset:32768
  v_exp_f32 v135, v23
  v_exp_f32 v128, v24
  v_mfma_f32_32x32x16_bf16 a[16:31], a[228:231], v[112:115], a[16:31]
  ds_read_b128 a[196:199], v225 offset:32768
  v_exp_f32 v129, v25
  v_add_f32 v242, v242, v134
  v_add_f32 v242, v242, v135
  v_cvt_pk_bf16_f32 v107, v134, v135
  v_mfma_f32_32x32x16_bf16 a[80:95], a[228:231], v[120:123], a[80:95]
  ds_read_b128 a[200:203], v226 offset:32768
  v_exp_f32 v130, v26
  v_add_f32 v242, v242, v128
  v_add_f32 v242, v242, v129
  v_cvt_pk_bf16_f32 v108, v128, v129
  v_mfma_f32_32x32x16_bf16 a[32:47], a[232:235], v[112:115], a[32:47]
  v_exp_f32 v131, v27
  v_exp_f32 v132, v28
  v_exp_f32 v133, v29
  v_mfma_f32_32x32x16_bf16 a[96:111], a[232:235], v[120:123], a[96:111]
  ds_read_b128 a[204:207], v227 offset:32768
  v_add_f32 v242, v242, v130
  v_add_f32 v242, v242, v131
  v_cvt_pk_bf16_f32 v109, v130, v131
  v_add_f32 v242, v242, v132
  v_add_f32 v242, v242, v133
  v_mfma_f32_32x32x16_bf16 a[48:63], a[236:239], v[112:115], a[48:63]
  ds_read_b128 a[208:211], v228 offset:32768
  v_exp_f32 v134, v30
  v_cvt_pk_bf16_f32 v110, v132, v133
  v_exp_f32 v135, v31
  v_mfma_f32_32x32x16_bf16 a[112:127], a[236:239], v[120:123], a[112:127]
  ds_read_b128 a[212:215], v229 offset:32768
  v_add_f32 v242, v242, v134
  v_add_f32 v242, v242, v135
  v_cvt_pk_bf16_f32 v111, v134, v135
  v_mfma_f32_32x32x16_bf16 a[0:15], a[240:243], v[116:119], a[0:15]
  v_mfma_f32_32x32x16_bf16 a[64:79], a[240:243], v[124:127], a[64:79]
  ds_read_b128 a[216:219], v230 offset:32768
  v_mfma_f32_32x32x16_bf16 a[16:31], a[244:247], v[116:119], a[16:31]
  ds_read_b128 a[220:223], v231 offset:32768
  v_mfma_f32_32x32x16_bf16 a[80:95], a[244:247], v[124:127], a[80:95]
  v_mfma_f32_32x32x16_bf16 a[32:47], a[248:251], v[116:119], a[32:47]
  v_mfma_f32_32x32x16_bf16 a[96:111], a[248:251], v[124:127], a[96:111]
  v_max_f32 v246, v241, v242
  v_mfma_f32_32x32x16_bf16 a[48:63], a[252:255], v[116:119], a[48:63]
  v_mfma_f32_32x32x16_bf16 a[112:127], a[252:255], v[124:127], a[112:127]
  v_cmp_lt_f32 vcc, s44, v246
  s_cbranch_vccnz RSTUB_28
RBACK_29:
  s_getpc_b64 s[92:93]
PC_REF2:
  s_lshr_b32 s94, s2, 3
  s_lshl_b32 s94, s94, 2
  s_add_u32 s94, s94, s3
  s_lshl_b32 s94, s94, 10
  s_cmp_ge_u32 s94, CODE_END-PC_REF2-1024
  s_cbranch_scc1 NO_CPF2
  v_add_u32 v140, s94, v221
  global_load_dwordx4 v[144:147], v140, s[92:93]
NO_CPF2:
  s_waitcnt lgkmcnt(0)
  v_mfma_f32_32x32x16_bf16 v[0:15], a[192:195], a[128:131], v[64:79]
  ds_read_b64_tr_b16 a[224:225], v232 offset:16384
  v_add_f32 v243, v243, v241
  v_add_f32 v244, v244, v242
  v_exp_f32 v128, v32
  v_mfma_f32_32x32x16_bf16 v[16:31], a[192:195], a[160:163], v[80:95]
  ds_read_b64_tr_b16 a[226:227], v232 offset:18432
  ds_read_b64_tr_b16 a[228:229], v233 offset:16384
  v_exp_f32 v129, v33
  v_exp_f32 v130, v34
  v_mfma_f32_32x32x16_bf16 v[0:15], a[196:199], a[132:135], v[0:15]
  ds_read_b64_tr_b16 a[230:231], v233 offset:18432
  v_exp_f32 v131, v35
  v_add_f32 v241, v128, v129
  v_cvt_pk_bf16_f32 v112, v128, v129
  v_mfma_f32_32x32x16_bf16 v[16:31], a[196:199], a[164:167], v[16:31]
  ds_read_b64_tr_b16 a[232:233], v234 offset:16384
  ds_read_b64_tr_b16 a[234:235], v234 offset:18432
  v_exp_f32 v132, v36
  v_add_f32 v241, v241, v130
  v_add_f32 v241, v241, v131
  v_mfma_f32_32x32x16_bf16 v[0:15], a[200:203], a[136:139], v[0:15]
  ds_read_b64_tr_b16 a[236:237], v235 offset:16384
  v_exp_f32 v133, v37
  v_cvt_pk_bf16_f32 v113, v130, v131
  v_exp_f32 v134, v38
  v_mfma_f32_32x32x16_bf16 v[16:31], a[200:203], a[168:171], v[16:31]
  ds_read_b64_tr_b16 a[238:239], v235 offset:18432
  ds_read_b64_tr_b16 a[240:241], v232 offset:20480
  v_exp_f32 v135, v39
  v_add_f32 v241, v241, v132
  v_add_f32 v241, v241, v133
  v_mfma_f32_32x32x16_bf16 v[0:15], a[204:207], a[140:143], v[0:15]
  ds_read_b64_tr_b16 a[242:243], v232 offset:22528
  v_cvt_pk_bf16_f32 v114, v132, v133
  v_add_f32 v241, v241, v134
  v_add_f32 v241, v241, v135
  v_cvt_pk_bf16_f32 v115, v134, v135
  v_mfma_f32_32x32x16_bf16 v[16:31], a[204:207], a[172:175], v[16:31]
  ds_read_b64_tr_b16 a[244:245], v233 offset:20480
  ds_read_b64_tr_b16 a[246:247], v233 offset:22528
  v_exp_f32 v128, v40
  v_exp_f32 v129, v41
  v_mfma_f32_32x32x16_bf16 v[0:15], a[208:211], a[144:147], v[0:15]
  ds_read_b64_tr_b16 a[248:249], v234 offset:20480
  v_exp_f32 v130, v42
  v_add_f32 v241, v241, v128
  v_add_f32 v241, v241, v129
  v_cvt_pk_bf16_f32 v116, v128, v129
  v_mfma_f32_32x32x16_bf16 v[16:31], a[208:211], a[176:179], v[16:31]
  ds_read_b64_tr_b16 a[250:251], v234 offset:22528
  ds_read_b64_tr_b16 a[252:253], v235 offset:20480
  v_exp_f32 v131, v43
  v_exp_f32 v132, v44
  v_mfma_f32_32x32x16_bf16 v[0:15], a[212:215], a[148:151], v[0:15]
  ds_read_b64_tr_b16 a[254:255], v235 offset:22528
  v_exp_f32 v133, v45
  v_add_f32 v241, v241, v130
  v_add_f32 v241, v241, v131
  v_cvt_pk_bf16_f32 v117, v130, v131
  v_mfma_f32_32x32x16_bf16 v[16:31], a[212:215], a[180:183], v[16:31]
  v_exp_f32 v134, v46
  v_add_f32 v241, v241, v132
  v_add_f32 v241, v241, v133
  v_cvt_pk_bf16_f32 v118, v132, v133
  v_mfma_f32_32x32x16_bf16 v[0:15], a[216:219], a[152:155], v[0:15]
  v_exp_f32 v135, v47
  v_exp_f32 v128, v48
  v_exp_f32 v129, v49
  v_mfma_f32_32x32x16_bf16 v[16:31], a[216:219], a[184:187], v[16:31]
  v_add_f32 v241, v241, v134
  v_add_f32 v241, v241, v135
  v_cvt_pk_bf16_f32 v119, v134, v135
  v_add_f32 v242, v128, v129
  v_cvt_pk_bf16_f32 v120, v128, v129
  v_mfma_f32_32x32x16_bf16 v[0:15], a[220:223], a[156:159], v[0:15]
  v_exp_f32 v130, v50
  v_exp_f32 v131, v51
  v_exp_f32 v132, v52
  v_mfma_f32_32x32x16_bf16 v[16:31], a[220:223], a[188:191], v[16:31]
  v_exp_f32 v133, v53
  v_add_f32 v242, v242, v130
  v_add_f32 v242, v242, v131
  v_cvt_pk_bf16_f32 v121, v130, v131
  s_waitcnt lgkmcnt(0)
  v_mfma_f32_32x32x16_bf16 a[0:15], a[224:227], v[96:99], a[0:15]
  v_exp_f32 v134, v54
  v_add_f32 v242, v242, v132
  v_add_f32 v242, v242, v133
  v_cvt_pk_bf16_f32 v122, v132, v133
  v_mfma_f32_32x32x16_bf16 a[64:79], a[224:227], v[104:107], a[64:79]
  ds_read_b128 a[192:195], v224 offset:40960
  v_exp_f32 v135, v55
  v_exp_f32 v128, v56
  v_mfma_f32_32x32x16_bf16 a[16:31], a[228:231], v[96:99], a[16:31]
  ds_read_b128 a[196:199], v225 offset:40960
  v_exp_f32 v129, v57
  v_add_f32 v242, v242, v134
  v_add_f32 v242, v242, v135
  v_cvt_pk_bf16_f32 v123, v134, v135
  v_mfma_f32_32x32x16_bf16 a[80:95], a[228:231], v[104:107], a[80:95]
  ds_read_b128 a[200:203], v226 offset:40960
  v_exp_f32 v130, v58
  v_add_f32 v242, v242, v128
  v_add_f32 v242, v242, v129
  v_cvt_pk_bf16_f32 v124, v128, v129
  v_mfma_f32_32x32x16_bf16 a[32:47], a[232:235], v[96:99], a[32:47]
  v_exp_f32 v131, v59
  v_exp_f32 v132, v60
  v_exp_f32 v133, v61
  v_mfma_f32_32x32x16_bf16 a[96:111], a[232:235], v[104:107], a[96:111]
  ds_read_b128 a[204:207], v227 offset:40960
  v_add_f32 v242, v242, v130
  v_add_f32 v242, v242, v131
  v_cvt_pk_bf16_f32 v125, v130, v131
  v_add_f32 v242, v242, v132
  v_add_f32 v242, v242, v133
  v_mfma_f32_32x32x16_bf16 a[48:63], a[236:239], v[96:99], a[48:63]
  ds_read_b128 a[208:211], v228 offset:40960
  v_exp_f32 v134, v62
  v_cvt_pk_bf16_f32 v126, v132, v133
  v_exp_f32 v135, v63
  v_mfma_f32_32x32x16_bf16 a[112:127], a[236:239], v[104:107], a[112:127]
  ds_read_b128 a[212:215], v229 offset:40960
  v_add_f32 v242, v242, v134
  v_add_f32 v242, v242, v135
  v_cvt_pk_bf16_f32 v127, v134, v135
  v_mfma_f32_32x32x16_bf16 a[0:15], a[240:243], v[100:103], a[0:15]
  v_mfma_f32_32x32x16_bf16 a[64:79], a[240:243], v[108:111], a[64:79]
  ds_read_b128 a[216:219], v230 offset:40960
  v_mfma_f32_32x32x16_bf16 a[16:31], a[244:247], v[100:103], a[16:31]
  ds_read_b128 a[220:223], v231 offset:40960
  v_mfma_f32_32x32x16_bf16 a[80:95], a[244:247], v[108:111], a[80:95]
  v_mfma_f32_32x32x16_bf16 a[32:47], a[248:251], v[100:103], a[32:47]
  v_mfma_f32_32x32x16_bf16 a[96:111], a[248:251], v[108:111], a[96:111]
  v_max_f32 v246, v241, v242
  v_mfma_f32_32x32x16_bf16 a[48:63], a[252:255], v[100:103], a[48:63]
  v_mfma_f32_32x32x16_bf16 a[112:127], a[252:255], v[108:111], a[112:127]
  v_cmp_lt_f32 vcc, s44, v246
  s_cbranch_vccnz RSTUB_30
RBACK_31:
  s_waitcnt lgkmcnt(0)
  v_mfma_f32_32x32x16_bf16 v[32:47], a[192:195], a[128:131], v[64:79]
  ds_read_b64_tr_b16 a[224:225], v232 offset:24576
  v_add_f32 v243, v243, v241
  v_add_f32 v244, v244, v242
  v_exp_f32 v128, v0
  v_mfma_f32_32x32x16_bf16 v[48:63], a[192:195], a[160:163], v[80:95]
  ds_read_b64_tr_b16 a[226:227], v232 offset:26624
  ds_read_b64_tr_b16 a[228:229], v233 offset:24576
  v_exp_f32 v129, v1
  v_exp_f32 v130, v2
  v_mfma_f32_32x32x16_bf16 v[32:47], a[196:199], a[132:135], v[32:47]
  ds_read_b64_tr_b16 a[230:231], v233 offset:26624
  v_exp_f32 v131, v3
  v_add_f32 v241, v128, v129
  v_cvt_pk_bf16_f32 v96, v128, v129
  v_mfma_f32_32x32x16_bf16 v[48:63], a[196:199], a[164:167], v[48:63]
  ds_read_b64_tr_b16 a[232:233], v234 offset:24576
  ds_read_b64_tr_b16 a[234:235], v234 offset:26624
  v_exp_f32 v132, v4
  v_add_f32 v241, v241, v130
  v_add_f32 v241, v241, v131
  v_mfma_f32_32x32x16_bf16 v[32:47], a[200:203], a[136:139], v[32:47]
  ds_read_b64_tr_b16 a[236:237], v235 offset:24576
  v_exp_f32 v133, v5
  v_cvt_pk_bf16_f32 v97, v130, v131
  v_exp_f32 v134, v6
  v_mfma_f32_32x32x16_bf16 v[48:63], a[200:203], a[168:171], v[48:63]
  ds_read_b64_tr_b16 a[238:239], v235 offset:26624
  ds_read_b64_tr_b16 a[240:241], v232 offset:28672
  v_exp_f32 v135, v7
  v_add_f32 v241, v241, v132
  v_add_f32 v241, v241, v133
  v_mfma_f32_32x32x16_bf16 v[32:47], a[204:207], a[140:143], v[32:47]
  ds_read_b64_tr_b16 a[242:243], v232 offset:30720
  v_cvt_pk_bf16_f32 v98, v132, v133
  v_add_f32 v241, v241, v134
  v_add_f32 v241, v241, v135
  v_cvt_pk_bf16_f32 v99, v134, v135
  v_mfma_f32_32x32x16_bf16 v[48:63], a[204:207], a[172:175], v[48:63]
  ds_read_b64_tr_b16 a[244:245], v233 offset:28672
  ds_read_b64_tr_b16 a[246:247], v233 offset:30720
  v_exp_f32 v128, v8
  v_exp_f32 v129, v9
  v_mfma_f32_32x32x16_bf16 v[32:47], a[208:211], a[144:147], v[32:47]
  ds_read_b64_tr_b16 a[248:249], v234 offset:28672
  v_exp_f32 v130, v10
  v_add_f32 v241, v241, v128
  v_add_f32 v241, v241, v129
  v_cvt_pk_bf16_f32 v100, v128, v129
  v_mfma_f32_32x32x16_bf16 v[48:63], a[208:211], a[176:179], v[48:63]
  ds_read_b64_tr_b16 a[250:251], v234 offset:30720
  ds_read_b64_tr_b16 a[252:253], v235 offset:28672
  v_exp_f32 v131, v11
  v_exp_f32 v132, v12
  v_mfma_f32_32x32x16_bf16 v[32:47], a[212:215], a[148:151], v[32:47]
  ds_read_b64_tr_b16 a[254:255], v235 offset:30720
  v_exp_f32 v133, v13
  v_add_f32 v241, v241, v130
  v_add_f32 v241, v241, v131
  v_cvt_pk_bf16_f32 v101, v130, v131
  v_mfma_f32_32x32x16_bf16 v[48:63], a[212:215], a[180:183], v[48:63]
  v_exp_f32 v134, v14
  v_add_f32 v241, v241, v132
  v_add_f32 v241, v241, v133
  v_cvt_pk_bf16_f32 v102, v132, v133
  v_mfma_f32_32x32x16_bf16 v[32:47], a[216:219], a[152:155], v[32:47]
  v_exp_f32 v135, v15
  v_exp_f32 v128, v16
  v_exp_f32 v129, v17
  v_mfma_f32_32x32x16_bf16 v[48:63], a[216:219], a[184:187], v[48:63]
  v_add_f32 v241, v241, v134
  v_add_f32 v241, v241, v135
  v_cvt_pk_bf16_f32 v103, v134, v135
  v_add_f32 v242, v128, v129
  v_cvt_pk_bf16_f32 v104, v128, v129
  v_mfma_f32_32x32x16_bf16 v[32:47], a[220:223], a[156:159], v[32:47]
  v_exp_f32 v130, v18
  v_exp_f32 v131, v19
  v_exp_f32 v132, v20
  v_mfma_f32_32x32x16_bf16 v[48:63], a[220:223], a[188:191], v[48:63]
  v_exp_f32 v133, v21
  v_add_f32 v242, v242, v130
  v_add_f32 v242, v242, v131
  s_waitcnt vmcnt(0) lgkmcnt(0)
  s_barrier
  v_mfma_f32_32x32x16_bf16 a[0:15], a[224:227], v[112:115], a[0:15]
  v_cvt_pk_bf16_f32 v105, v130, v131
  v_add_f32 v242, v242, v132
  v_add_f32 v242, v242, v133
  v_cvt_pk_bf16_f32 v106, v132, v133
  v_exp_f32 v134, v22
  v_mfma_f32_32x32x16_bf16 a[64:79], a[224:227], v[120:123], a[64:79]
  ds_read_b128 a[192:195], v224 offset:49152
  v_exp_f32 v135, v23
  v_exp_f32 v128, v24
  v_mfma_f32_32x32x16_bf16 a[16:31], a[228:231], v[112:115], a[16:31]
  ds_read_b128 a[196:199], v225 offset:49152
  v_exp_f32 v129, v25
  v_add_f32 v242, v242, v134
  v_add_f32 v242, v242, v135
  v_cvt_pk_bf16_f32 v107, v134, v135
  v_mfma_f32_32x32x16_bf16 a[80:95], a[228:231], v[120:123], a[80:95]
  ds_read_b128 a[200:203], v226 offset:49152
  v_exp_f32 v130, v26
  v_add_f32 v242, v242, v128
  v_add_f32 v242, v242, v129
  v_cvt_pk_bf16_f32 v108, v128, v129
  v_mfma_f32_32x32x16_bf16 a[32:47], a[232:235], v[112:115], a[32:47]
  v_exp_f32 v131, v27
  v_exp_f32 v132, v28
  v_exp_f32 v133, v29
  v_mfma_f32_32x32x16_bf16 a[96:111], a[232:235], v[120:123], a[96:111]
  ds_read_b128 a[204:207], v227 offset:49152
  v_add_f32 v242, v242, v130
  v_add_f32 v242, v242, v131
  v_cvt_pk_bf16_f32 v109, v130, v131
  v_add_f32 v242, v242, v132
  v_add_f32 v242, v242, v133
  v_mfma_f32_32x32x16_bf16 a[48:63], a[236:239], v[112:115], a[48:63]
  ds_read_b128 a[208:211], v228 offset:49152
  v_exp_f32 v134, v30
  v_cvt_pk_bf16_f32 v110, v132, v133
  v_exp_f32 v135, v31
  v_mfma_f32_32x32x16_bf16 a[112:127], a[236:239], v[120:123], a[112:127]
  ds_read_b128 a[212:215], v229 offset:49152
  v_add_f32 v242, v242, v134
  v_add_f32 v242, v242, v135
  v_cvt_pk_bf16_f32 v111, v134, v135
  v_mfma_f32_32x32x16_bf16 a[0:15], a[240:243], v[116:119], a[0:15]
  v_mfma_f32_32x32x16_bf16 a[64:79], a[240:243], v[124:127], a[64:79]
  ds_read_b128 a[216:219], v230 offset:49152
  v_mfma_f32_32x32x16_bf16 a[16:31], a[244:247], v[116:119], a[16:31]
  ds_read_b128 a[220:223], v231 offset:49152
  v_mfma_f32_32x32x16_bf16 a[80:95], a[244:247], v[124:127], a[80:95]
  v_mfma_f32_32x32x16_bf16 a[32:47], a[248:251], v[116:119], a[32:47]
  v_mfma_f32_32x32x16_bf16 a[96:111], a[248:251], v[124:127], a[96:111]
  v_max_f32 v246, v241, v242
  v_mfma_f32_32x32x16_bf16 a[48:63], a[252:255], v[116:119], a[48:63]
  v_mfma_f32_32x32x16_bf16 a[112:127], a[252:255], v[124:127], a[112:127]
  v_cmp_lt_f32 vcc, s44, v246
  s_cbranch_vccnz RSTUB_32
RBACK_33:
  s_waitcnt lgkmcnt(0)
  v_mfma_f32_32x32x16_bf16 v[0:15], a[192:195], a[128:131], v[64:79]
  ds_read_b64_tr_b16 a[224:225], v232 offset:32768
  v_add_f32 v243, v243, v241
  v_add_f32 v244, v244, v242
  v_exp_f32 v128, v32
  v_mfma_f32_32x32x16_bf16 v[16:31], a[192:195], a[160:163], v[80:95]
  ds_read_b64_tr_b16 a[226:227], v232 offset:34816
  ds_read_b64_tr_b16 a[228:229], v233 offset:32768
  v_exp_f32 v129, v33
  v_exp_f32 v130, v34
  v_mfma_f32_32x32x16_bf16 v[0:15], a[196:199], a[132:135], v[0:15]
  ds_read_b64_tr_b16 a[230:231], v233 offset:34816
  v_exp_f32 v131, v35
  v_add_f32 v241, v128, v129
  v_cvt_pk_bf16_f32 v112, v128, v129
  v_mfma_f32_32x32x16_bf16 v[16:31], a[196:199], a[164:167], v[16:31]
  ds_read_b64_tr_b16 a[232:233], v234 offset:32768
  ds_read_b64_tr_b16 a[234:235], v234 offset:34816
  v_exp_f32 v132, v36
  v_add_f32 v241, v241, v130
  v_add_f32 v241, v241, v131
  v_mfma_f32_32x32x16_bf16 v[0:15], a[200:203], a[136:139], v[0:15]
  ds_read_b64_tr_b16 a[236:237], v235 offset:32768
  v_exp_f32 v133, v37
  v_cvt_pk_bf16_f32 v113, v130, v131
  v_exp_f32 v134, v38
  v_mfma_f32_32x32x16_bf16 v[16:31], a[200:203], a[168:171], v[16:31]
  ds_read_b64_tr_b16 a[238:239], v235 offset:34816
  ds_read_b64_tr_b16 a[240:241], v232 offset:36864
  v_exp_f32 v135, v39
  v_add_f32 v241, v241, v132
  v_add_f32 v241, v241, v133
  v_mfma_f32_32x32x16_bf16 v[0:15], a[204:207], a[140:143], v[0:15]
  ds_read_b64_tr_b16 a[242:243], v232 offset:38912
  v_cvt_pk_bf16_f32 v114, v132, v133
  v_add_f32 v241, v241, v134
  v_add_f32 v241, v241, v135
  v_cvt_pk_bf16_f32 v115, v134, v135
  v_mfma_f32_32x32x16_bf16 v[16:31], a[204:207], a[172:175], v[16:31]
  ds_read_b64_tr_b16 a[244:245], v233 offset:36864
  ds_read_b64_tr_b16 a[246:247], v233 offset:38912
  v_exp_f32 v128, v40
  v_exp_f32 v129, v41
  v_mfma_f32_32x32x16_bf16 v[0:15], a[208:211], a[144:147], v[0:15]
  ds_read_b64_tr_b16 a[248:249], v234 offset:36864
  v_exp_f32 v130, v42
  v_add_f32 v241, v241, v128
  v_add_f32 v241, v241, v129
  v_cvt_pk_bf16_f32 v116, v128, v129
  v_mfma_f32_32x32x16_bf16 v[16:31], a[208:211], a[176:179], v[16:31]
  ds_read_b64_tr_b16 a[250:251], v234 offset:38912
  ds_read_b64_tr_b16 a[252:253], v235 offset:36864
  v_exp_f32 v131, v43
  v_exp_f32 v132, v44
  v_mfma_f32_32x32x16_bf16 v[0:15], a[212:215], a[148:151], v[0:15]
  ds_read_b64_tr_b16 a[254:255], v235 offset:38912
  v_exp_f32 v133, v45
  v_add_f32 v241, v241, v130
  v_add_f32 v241, v241, v131
  v_cvt_pk_bf16_f32 v117, v130, v131
  v_mfma_f32_32x32x16_bf16 v[16:31], a[212:215], a[180:183], v[16:31]
  v_exp_f32 v134, v46
  v_add_f32 v241, v241, v132
  v_add_f32 v241, v241, v133
  v_cvt_pk_bf16_f32 v118, v132, v133
  v_mfma_f32_32x32x16_bf16 v[0:15], a[216:219], a[152:155], v[0:15]
  v_exp_f32 v135, v47
  v_exp_f32 v128, v48
  v_exp_f32 v129, v49
  v_mfma_f32_32x32x16_bf16 v[16:31], a[216:219], a[184:187], v[16:31]
  v_add_f32 v241, v241, v134
  v_add_f32 v241, v241, v135
  v_cvt_pk_bf16_f32 v119, v134, v135
  v_add_f32 v242, v128, v129
  v_cvt_pk_bf16_f32 v120, v128, v129
  v_mfma_f32_32x32x16_bf16 v[0:15], a[220:223], a[156:159], v[0:15]
  v_exp_f32 v130, v50
  v_exp_f32 v131, v51
  v_exp_f32 v132, v52
  v_mfma_f32_32x32x16_bf16 v[16:31], a[220:223], a[188:191], v[16:31]
  v_exp_f32 v133, v53
  v_add_f32 v242, v242, v130
  v_add_f32 v242, v242, v131
  v_cvt_pk_bf16_f32 v121, v130, v131
  s_waitcnt lgkmcnt(0)
  v_mfma_f32_32x32x16_bf16 a[0:15], a[224:227], v[96:99], a[0:15]
  v_exp_f32 v134, v54
  v_add_f32 v242, v242, v132
  v_add_f32 v242, v242, v133
  v_cvt_pk_bf16_f32 v122, v132, v133
  v_mfma_f32_32x32x16_bf16 a[64:79], a[224:227], v[104:107], a[64:79]
  ds_read_b128 a[192:195], v224 offset:57344
  v_exp_f32 v135, v55
  v_exp_f32 v128, v56
  v_mfma_f32_32x32x16_bf16 a[16:31], a[228:231], v[96:99], a[16:31]
  ds_read_b128 a[196:199], v225 offset:57344
  v_exp_f32 v129, v57
  v_add_f32 v242, v242, v134
  v_add_f32 v242, v242, v135
  v_cvt_pk_bf16_f32 v123, v134, v135
  v_mfma_f32_32x32x16_bf16 a[80:95], a[228:231], v[104:107], a[80:95]
  ds_read_b128 a[200:203], v226 offset:57344
  v_exp_f32 v130, v58
  v_add_f32 v242, v242, v128
  v_add_f32 v242, v242, v129
  v_cvt_pk_bf16_f32 v124, v128, v129
  v_mfma_f32_32x32x16_bf16 a[32:47], a[232:235], v[96:99], a[32:47]
  v_exp_f32 v131, v59
  v_exp_f32 v132, v60
  v_exp_f32 v133, v61
  v_mfma_f32_32x32x16_bf16 a[96:111], a[232:235], v[104:107], a[96:111]
  ds_read_b128 a[204:207], v227 offset:57344
  v_add_f32 v242, v242, v130
  v_add_f32 v242, v242, v131
  v_cvt_pk_bf16_f32 v125, v130, v131
  v_add_f32 v242, v242, v132
  v_add_f32 v242, v242, v133
  v_mfma_f32_32x32x16_bf16 a[48:63], a[236:239], v[96:99], a[48:63]
  ds_read_b128 a[208:211], v228 offset:57344
  v_exp_f32 v134, v62
  v_cvt_pk_bf16_f32 v126, v132, v133
  v_exp_f32 v135, v63
  v_mfma_f32_32x32x16_bf16 a[112:127], a[236:239], v[104:107], a[112:127]
  ds_read_b128 a[212:215], v229 offset:57344
  v_add_f32 v242, v242, v134
  v_add_f32 v242, v242, v135
  v_cvt_pk_bf16_f32 v127, v134, v135
  v_mfma_f32_32x32x16_bf16 a[0:15], a[240:243], v[100:103], a[0:15]
  v_mfma_f32_32x32x16_bf16 a[64:79], a[240:243], v[108:111], a[64:79]
  ds_read_b128 a[216:219], v230 offset:57344
  v_mfma_f32_32x32x16_bf16 a[16:31], a[244:247], v[100:103], a[16:31]
  ds_read_b128 a[220:223], v231 offset:57344
  v_mfma_f32_32x32x16_bf16 a[80:95], a[244:247], v[108:111], a[80:95]
  v_mfma_f32_32x32x16_bf16 a[32:47], a[248:251], v[100:103], a[32:47]
  v_mfma_f32_32x32x16_bf16 a[96:111], a[248:251], v[108:111], a[96:111]
  v_max_f32 v246, v241, v242
  v_mfma_f32_32x32x16_bf16 a[48:63], a[252:255], v[100:103], a[48:63]
  v_mfma_f32_32x32x16_bf16 a[112:127], a[252:255], v[108:111], a[112:127]
  v_cmp_lt_f32 vcc, s44, v246
  s_cbranch_vccnz RSTUB_34
RBACK_35:
  s_waitcnt lgkmcnt(0)
  v_mfma_f32_32x32x16_bf16 v[32:47], a[192:195], a[128:131], v[64:79]
  ds_read_b64_tr_b16 a[224:225], v232 offset:40960
  v_add_f32 v243, v243, v241
  v_add_f32 v244, v244, v242
  v_exp_f32 v128, v0
  v_mfma_f32_32x32x16_bf16 v[48:63], a[192:195], a[160:163], v[80:95]
  ds_read_b64_tr_b16 a[226:227], v232 offset:43008
  ds_read_b64_tr_b16 a[228:229], v233 offset:40960
  v_exp_f32 v129, v1
  v_exp_f32 v130, v2
  v_mfma_f32_32x32x16_bf16 v[32:47], a[196:199], a[132:135], v[32:47]
  ds_read_b64_tr_b16 a[230:231], v233 offset:43008
  v_exp_f32 v131, v3
  v_add_f32 v241, v128, v129
  v_cvt_pk_bf16_f32 v96, v128, v129
  v_mfma_f32_32x32x16_bf16 v[48:63], a[196:199], a[164:167], v[48:63]
  ds_read_b64_tr_b16 a[232:233], v234 offset:40960
  ds_read_b64_tr_b16 a[234:235], v234 offset:43008
  v_exp_f32 v132, v4
  v_add_f32 v241, v241, v130
  v_add_f32 v241, v241, v131
  v_mfma_f32_32x32x16_bf16 v[32:47], a[200:203], a[136:139], v[32:47]
  ds_read_b64_tr_b16 a[236:237], v235 offset:40960
  v_exp_f32 v133, v5
  v_cvt_pk_bf16_f32 v97, v130, v131
  v_exp_f32 v134, v6
  v_mfma_f32_32x32x16_bf16 v[48:63], a[200:203], a[168:171], v[48:63]
  ds_read_b64_tr_b16 a[238:239], v235 offset:43008
  ds_read_b64_tr_b16 a[240:241], v232 offset:45056
  v_exp_f32 v135, v7
  v_add_f32 v241, v241, v132
  v_add_f32 v241, v241, v133
  v_mfma_f32_32x32x16_bf16 v[32:47], a[204:207], a[140:143], v[32:47]
  ds_read_b64_tr_b16 a[242:243], v232 offset:47104
  v_cvt_pk_bf16_f32 v98, v132, v133
  v_add_f32 v241, v241, v134
  v_add_f32 v241, v241, v135
  v_cvt_pk_bf16_f32 v99, v134, v135
  v_mfma_f32_32x32x16_bf16 v[48:63], a[204:207], a[172:175], v[48:63]
  ds_read_b64_tr_b16 a[244:245], v233 offset:45056
  ds_read_b64_tr_b16 a[246:247], v233 offset:47104
  v_exp_f32 v128, v8
  v_exp_f32 v129, v9
  v_mfma_f32_32x32x16_bf16 v[32:47], a[208:211], a[144:147], v[32:47]
  ds_read_b64_tr_b16 a[248:249], v234 offset:45056
  v_exp_f32 v130, v10
  v_add_f32 v241, v241, v128
  v_add_f32 v241, v241, v129
  v_cvt_pk_bf16_f32 v100, v128, v129
  v_mfma_f32_32x32x16_bf16 v[48:63], a[208:211], a[176:179], v[48:63]
  ds_read_b64_tr_b16 a[250:251], v234 offset:47104
  ds_read_b64_tr_b16 a[252:253], v235 offset:45056
  v_exp_f32 v131, v11
  v_exp_f32 v132, v12
  v_mfma_f32_32x32x16_bf16 v[32:47], a[212:215], a[148:151], v[32:47]
  ds_read_b64_tr_b16 a[254:255], v235 offset:47104
  v_exp_f32 v133, v13
  v_add_f32 v241, v241, v130
  v_add_f32 v241, v241, v131
  v_cvt_pk_bf16_f32 v101, v130, v131
  v_mfma_f32_32x32x16_bf16 v[48:63], a[212:215], a[180:183], v[48:63]
  v_exp_f32 v134, v14
  v_add_f32 v241, v241, v132
  v_add_f32 v241, v241, v133
  v_cvt_pk_bf16_f32 v102, v132, v133
  v_mfma_f32_32x32x16_bf16 v[32:47], a[216:219], a[152:155], v[32:47]
  v_exp_f32 v135, v15
  v_exp_f32 v128, v16
  v_exp_f32 v129, v17
  v_mfma_f32_32x32x16_bf16 v[48:63], a[216:219], a[184:187], v[48:63]
  v_add_f32 v241, v241, v134
  v_add_f32 v241, v241, v135
  v_cvt_pk_bf16_f32 v103, v134, v135
  v_add_f32 v242, v128, v129
  v_cvt_pk_bf16_f32 v104, v128, v129
  v_mfma_f32_32x32x16_bf16 v[32:47], a[220:223], a[156:159], v[32:47]
  v_exp_f32 v130, v18
  v_exp_f32 v131, v19
  v_exp_f32 v132, v20
  v_mfma_f32_32x32x16_bf16 v[48:63], a[220:223], a[188:191], v[48:63]
  v_exp_f32 v133, v21
  v_add_f32 v242, v242, v130
  v_add_f32 v242, v242, v131
  v_cvt_pk_bf16_f32 v105, v130, v131
  s_waitcnt lgkmcnt(0)
  v_mfma_f32_32x32x16_bf16 a[0:15], a[224:227], v[112:115], a[0:15]
  v_exp_f32 v134, v22
  v_add_f32 v242, v242, v132
  v_add_f32 v242, v242, v133
  v_cvt_pk_bf16_f32 v106, v132, v133
  v_mfma_f32_32x32x16_bf16 a[64:79], a[224:227], v[120:123], a[64:79]
  v_exp_f32 v135, v23
  v_exp_f32 v128, v24
  v_exp_f32 v129, v25
  v_mfma_f32_32x32x16_bf16 a[16:31], a[228:231], v[112:115], a[16:31]
  v_add_f32 v242, v242, v134
  v_add_f32 v242, v242, v135
  v_cvt_pk_bf16_f32 v107, v134, v135
  v_add_f32 v242, v242, v128
  v_add_f32 v242, v242, v129
  v_cvt_pk_bf16_f32 v108, v128, v129
  v_mfma_f32_32x32x16_bf16 a[80:95], a[228:231], v[120:123], a[80:95]
  v_exp_f32 v130, v26
  v_exp_f32 v131, v27
  v_exp_f32 v132, v28
  v_mfma_f32_32x32x16_bf16 a[32:47], a[232:235], v[112:115], a[32:47]
  v_exp_f32 v133, v29
  v_add_f32 v242, v242, v130
  v_add_f32 v242, v242, v131
  v_cvt_pk_bf16_f32 v109, v130, v131
  v_mfma_f32_32x32x16_bf16 a[96:111], a[232:235], v[120:123], a[96:111]
  v_exp_f32 v134, v30
  v_add_f32 v242, v242, v132
  v_add_f32 v242, v242, v133
  v_cvt_pk_bf16_f32 v110, v132, v133
  v_mfma_f32_32x32x16_bf16 a[48:63], a[236:239], v[112:115], a[48:63]
  v_exp_f32 v135, v31
  v_mfma_f32_32x32x16_bf16 a[112:127], a[236:239], v[120:123], a[112:127]
  v_add_f32 v242, v242, v134
  v_add_f32 v242, v242, v135
  v_cvt_pk_bf16_f32 v111, v134, v135
  v_mfma_f32_32x32x16_bf16 a[0:15], a[240:243], v[116:119], a[0:15]
  v_mfma_f32_32x32x16_bf16 a[64:79], a[240:243], v[124:127], a[64:79]
  v_mfma_f32_32x32x16_bf16 a[16:31], a[244:247], v[116:119], a[16:31]
  v_mfma_f32_32x32x16_bf16 a[80:95], a[244:247], v[124:127], a[80:95]
  v_mfma_f32_32x32x16_bf16 a[32:47], a[248:251], v[116:119], a[32:47]
  v_mfma_f32_32x32x16_bf16 a[96:111], a[248:251], v[124:127], a[96:111]
  v_max_f32 v246, v241, v242
  v_mfma_f32_32x32x16_bf16 a[48:63], a[252:255], v[116:119], a[48:63]
  v_mfma_f32_32x32x16_bf16 a[112:127], a[252:255], v[124:127], a[112:127]
  v_cmp_lt_f32 vcc, s44, v246
  s_cbranch_vccnz RSTUB_36
RBACK_37:
  s_waitcnt lgkmcnt(0)
  ds_read_b64_tr_b16 a[224:225], v232 offset:49152
  v_add_f32 v243, v243, v241
  v_add_f32 v244, v244, v242
  v_exp_f32 v128, v32
  ds_read_b64_tr_b16 a[226:227], v232 offset:51200
  ds_read_b64_tr_b16 a[228:229], v233 offset:49152
  v_exp_f32 v129, v33
  v_exp_f32 v130, v34
  ds_read_b64_tr_b16 a[230:231], v233 offset:51200
  v_exp_f32 v131, v35
  v_add_f32 v241, v128, v129
  v_cvt_pk_bf16_f32 v112, v128, v129
  ds_read_b64_tr_b16 a[232:233], v234 offset:49152
  ds_read_b64_tr_b16 a[234:235], v234 offset:51200
  v_exp_f32 v132, v36
  v_add_f32 v241, v241, v130
  v_add_f32 v241, v241, v131
  ds_read_b64_tr_b16 a[236:237], v235 offset:49152
  v_exp_f32 v133, v37
  v_cvt_pk_bf16_f32 v113, v130, v131
  v_exp_f32 v134, v38
  ds_read_b64_tr_b16 a[238:239], v235 offset:51200
  ds_read_b64_tr_b16 a[240:241], v232 offset:53248
  v_exp_f32 v135, v39
  v_add_f32 v241, v241, v132
  v_add_f32 v241, v241, v133
  ds_read_b64_tr_b16 a[242:243], v232 offset:55296
  v_cvt_pk_bf16_f32 v114, v132, v133
  v_add_f32 v241, v241, v134
  v_add_f32 v241, v241, v135
  v_cvt_pk_bf16_f32 v115, v134, v135
  ds_read_b64_tr_b16 a[244:245], v233 offset:53248
  ds_read_b64_tr_b16 a[246:247], v233 offset:55296
  v_exp_f32 v128, v40
  v_exp_f32 v129, v41
  ds_read_b64_tr_b16 a[248:249], v234 offset:53248
  v_exp_f32 v130, v42
  v_add_f32 v241, v241, v128
  v_add_f32 v241, v241, v129
  v_cvt_pk_bf16_f32 v116, v128, v129
  ds_read_b64_tr_b16 a[250:251], v234 offset:55296
  ds_read_b64_tr_b16 a[252:253], v235 offset:53248
  v_exp_f32 v131, v43
  v_exp_f32 v132, v44
  ds_read_b64_tr_b16 a[254:255], v235 offset:55296
  v_exp_f32 v133, v45
  v_add_f32 v241, v241, v130
  v_add_f32 v241, v241, v131
  v_cvt_pk_bf16_f32 v117, v130, v131
  v_exp_f32 v134, v46
  v_add_f32 v241, v241, v132
  v_add_f32 v241, v241, v133
  v_cvt_pk_bf16_f32 v118, v132, v133
  v_exp_f32 v135, v47
  v_exp_f32 v128, v48
  v_exp_f32 v129, v49
  v_add_f32 v241, v241, v134
  v_add_f32 v241, v241, v135
  v_cvt_pk_bf16_f32 v119, v134, v135
  v_add_f32 v242, v128, v129
  v_cvt_pk_bf16_f32 v120, v128, v129
  v_exp_f32 v130, v50
  v_exp_f32 v131, v51
  v_exp_f32 v132, v52
  v_exp_f32 v133, v53
  v_add_f32 v242, v242, v130
  v_add_f32 v242, v242, v131
  v_cvt_pk_bf16_f32 v121, v130, v131
  s_waitcnt lgkmcnt(0)
  v_mfma_f32_32x32x16_bf16 a[0:15], a[224:227], v[96:99], a[0:15]
  v_exp_f32 v134, v54
  v_add_f32 v242, v242, v132
  v_add_f32 v242, v242, v133
  v_cvt_pk_bf16_f32 v122, v132, v133
  v_mfma_f32_32x32x16_bf16 a[64:79], a[224:227], v[104:107], a[64:79]
  v_exp_f32 v135, v55
  v_exp_f32 v128, v56
  v_exp_f32 v129, v57
  v_mfma_f32_32x32x16_bf16 a[16:31], a[228:231], v[96:99], a[16:31]
  v_add_f32 v242, v242, v134
  v_add_f32 v242, v242, v135
  v_cvt_pk_bf16_f32 v123, v134, v135
  v_add_f32 v242, v242, v128
  v_add_f32 v242, v242, v129
  v_cvt_pk_bf16_f32 v124, v128, v129
  v_mfma_f32_32x32x16_bf16 a[80:95], a[228:231], v[104:107], a[80:95]
  v_exp_f32 v130, v58
  v_exp_f32 v131, v59
  v_exp_f32 v132, v60
  v_mfma_f32_32x32x16_bf16 a[32:47], a[232:235], v[96:99], a[32:47]
  v_exp_f32 v133, v61
  v_add_f32 v242, v242, v130
  v_add_f32 v242, v242, v131
  v_cvt_pk_bf16_f32 v125, v130, v131
  v_mfma_f32_32x32x16_bf16 a[96:111], a[232:235], v[104:107], a[96:111]
  v_exp_f32 v134, v62
  v_add_f32 v242, v242, v132
  v_add_f32 v242, v242, v133
  v_cvt_pk_bf16_f32 v126, v132, v133
  v_mfma_f32_32x32x16_bf16 a[48:63], a[236:239], v[96:99], a[48:63]
  v_exp_f32 v135, v63
  v_mfma_f32_32x32x16_bf16 a[112:127], a[236:239], v[104:107], a[112:127]
  v_add_f32 v242, v242, v134
  v_add_f32 v242, v242, v135
  v_cvt_pk_bf16_f32 v127, v134, v135
  v_mfma_f32_32x32x16_bf16 a[0:15], a[240:243], v[100:103], a[0:15]
  v_mfma_f32_32x32x16_bf16 a[64:79], a[240:243], v[108:111], a[64:79]
  v_mfma_f32_32x32x16_bf16 a[16:31], a[244:247], v[100:103], a[16:31]
  v_mfma_f32_32x32x16_bf16 a[80:95], a[244:247], v[108:111], a[80:95]
  v_mfma_f32_32x32x16_bf16 a[32:47], a[248:251], v[100:103], a[32:47]
  v_mfma_f32_32x32x16_bf16 a[96:111], a[248:251], v[108:111], a[96:111]
  v_max_f32 v246, v241, v242
  v_mfma_f32_32x32x16_bf16 a[48:63], a[252:255], v[100:103], a[48:63]
  v_mfma_f32_32x32x16_bf16 a[112:127], a[252:255], v[108:111], a[112:127]
  v_cmp_lt_f32 vcc, s44, v246
  s_cbranch_vccnz RSTUB_38
RBACK_39:
  v_add_f32 v243, v243, v241
  v_add_f32 v244, v244, v242
  ds_read_b64_tr_b16 a[224:225], v232 offset:57344
  ds_read_b64_tr_b16 a[226:227], v232 offset:59392
  ds_read_b64_tr_b16 a[228:229], v233 offset:57344
  ds_read_b64_tr_b16 a[230:231], v233 offset:59392
  ds_read_b64_tr_b16 a[232:233], v234 offset:57344
  ds_read_b64_tr_b16 a[234:235], v234 offset:59392
  ds_read_b64_tr_b16 a[236:237], v235 offset:57344
  ds_read_b64_tr_b16 a[238:239], v235 offset:59392
  ds_read_b64_tr_b16 a[240:241], v232 offset:61440
  ds_read_b64_tr_b16 a[242:243], v232 offset:63488
  ds_read_b64_tr_b16 a[244:245], v233 offset:61440
  ds_read_b64_tr_b16 a[246:247], v233 offset:63488
  ds_read_b64_tr_b16 a[248:249], v234 offset:61440
  ds_read_b64_tr_b16 a[250:251], v234 offset:63488
  ds_read_b64_tr_b16 a[252:253], v235 offset:61440
  ds_read_b64_tr_b16 a[254:255], v235 offset:63488
  s_nop 0
  v_mov_b32 v246, v243
  s_nop 1
  v_permlane32_swap_b32 v246, v243
  s_nop 1
  v_add_f32 v243, v243, v246
  v_rcp_f32 v243, v243
  v_mov_b32 v246, v244
  s_nop 1
  v_permlane32_swap_b32 v246, v244
  s_nop 1
  v_add_f32 v244, v244, v246
  v_rcp_f32 v244, v244
  s_lshl_b32 s43, s38, 18
  s_lshl_b32 s45, s36, 13
  s_add_u32 s48, s43, s45
  s_add_u32 s49, s48, 262144
  s_waitcnt lgkmcnt(0)
  s_barrier
  v_mfma_f32_32x32x16_bf16 a[0:15], a[224:227], v[112:115], a[0:15]
  v_mfma_f32_32x32x16_bf16 a[16:31], a[228:231], v[112:115], a[16:31]
  v_mfma_f32_32x32x16_bf16 a[32:47], a[232:235], v[112:115], a[32:47]
  v_mfma_f32_32x32x16_bf16 a[48:63], a[236:239], v[112:115], a[48:63]
  v_mfma_f32_32x32x16_bf16 a[0:15], a[240:243], v[116:119], a[0:15]
  v_mfma_f32_32x32x16_bf16 a[16:31], a[244:247], v[116:119], a[16:31]
  v_mfma_f32_32x32x16_bf16 a[32:47], a[248:251], v[116:119], a[32:47]
  v_mfma_f32_32x32x16_bf16 a[48:63], a[252:255], v[116:119], a[48:63]
  v_mfma_f32_32x32x16_bf16 a[64:79], a[224:227], v[120:123], a[64:79]
  v_mfma_f32_32x32x16_bf16 a[80:95], a[228:231], v[120:123], a[80:95]
  v_mfma_f32_32x32x16_bf16 a[96:111], a[232:235], v[120:123], a[96:111]
  v_mfma_f32_32x32x16_bf16 a[112:127], a[236:239], v[120:123], a[112:127]
  v_mfma_f32_32x32x16_bf16 a[64:79], a[240:243], v[124:127], a[64:79]
  v_mfma_f32_32x32x16_bf16 a[80:95], a[244:247], v[124:127], a[80:95]
  v_mfma_f32_32x32x16_bf16 a[96:111], a[248:251], v[124:127], a[96:111]
  v_mfma_f32_32x32x16_bf16 a[112:127], a[252:255], v[124:127], a[112:127]
  s_nop 4
  v_mov_b32 v250, v243
  v_accvgpr_read_b32 v0, a0
  v_accvgpr_read_b32 v1, a1
  v_accvgpr_read_b32 v2, a2
  v_accvgpr_read_b32 v3, a3
  v_accvgpr_read_b32 v4, a4
  v_accvgpr_read_b32 v5, a5
  v_accvgpr_read_b32 v6, a6
  v_accvgpr_read_b32 v7, a7
  v_pk_mul_f32 v[0:1], v[0:1], v[250:251] op_sel_hi:[1,0]
  v_pk_mul_f32 v[2:3], v[2:3], v[250:251] op_sel_hi:[1,0]
  v_pk_mul_f32 v[4:5], v[4:5], v[250:251] op_sel_hi:[1,0]
  v_pk_mul_f32 v[6:7], v[6:7], v[250:251] op_sel_hi:[1,0]
  v_cvt_pk_bf16_f32 v8, v0, v1
  v_cvt_pk_bf16_f32 v9, v2, v3
  v_cvt_pk_bf16_f32 v10, v4, v5
  v_cvt_pk_bf16_f32 v11, v6, v7
  s_add_u32 s43, s48, 0
  buffer_store_dwordx4 v[8:11], v221, s[28:31], s43 offen offset:0 sc1
  v_accvgpr_read_b32 v16, a8
  v_accvgpr_read_b32 v17, a9
  v_accvgpr_read_b32 v18, a10
  v_accvgpr_read_b32 v19, a11
  v_accvgpr_read_b32 v20, a12
  v_accvgpr_read_b32 v21, a13
  v_accvgpr_read_b32 v22, a14
  v_accvgpr_read_b32 v23, a15
  v_pk_mul_f32 v[16:17], v[16:17], v[250:251] op_sel_hi:[1,0]
  v_pk_mul_f32 v[18:19], v[18:19], v[250:251] op_sel_hi:[1,0]
  v_pk_mul_f32 v[20:21], v[20:21], v[250:251] op_sel_hi:[1,0]
  v_pk_mul_f32 v[22:23], v[22:23], v[250:251] op_sel_hi:[1,0]
  v_cvt_pk_bf16_f32 v24, v16, v17
  v_cvt_pk_bf16_f32 v25, v18, v19
  v_cvt_pk_bf16_f32 v26, v20, v21
  v_cvt_pk_bf16_f32 v27, v22, v23
  s_add_u32 s43, s48, 0
  buffer_store_dwordx4 v[24:27], v221, s[28:31], s43 offen offset:1024 sc1
  v_accvgpr_read_b32 v32, a16
  v_accvgpr_read_b32 v33, a17
  v_accvgpr_read_b32 v34, a18
  v_accvgpr_read_b32 v35, a19
  v_accvgpr_read_b32 v36, a20
  v_accvgpr_read_b32 v37, a21
  v_accvgpr_read_b32 v38, a22
  v_accvgpr_read_b32 v39, a23
  v_pk_mul_f32 v[32:33], v[32:33], v[250:251] op_sel_hi:[1,0]
  v_pk_mul_f32 v[34:35], v[34:35], v[250:251] op_sel_hi:[1,0]
  v_pk_mul_f32 v[36:37], v[36:37], v[250:251] op_sel_hi:[1,0]
  v_pk_mul_f32 v[38:39], v[38:39], v[250:251] op_sel_hi:[1,0]
  v_cvt_pk_bf16_f32 v40, v32, v33
  v_cvt_pk_bf16_f32 v41, v34, v35
  v_cvt_pk_bf16_f32 v42, v36, v37
  v_cvt_pk_bf16_f32 v43, v38, v39
  s_add_u32 s43, s48, 0
  buffer_store_dwordx4 v[40:43], v221, s[28:31], s43 offen offset:2048 sc1
  v_accvgpr_read_b32 v48, a24
  v_accvgpr_read_b32 v49, a25
  v_accvgpr_read_b32 v50, a26
  v_accvgpr_read_b32 v51, a27
  v_accvgpr_read_b32 v52, a28
  v_accvgpr_read_b32 v53, a29
  v_accvgpr_read_b32 v54, a30
  v_accvgpr_read_b32 v55, a31
  v_pk_mul_f32 v[48:49], v[48:49], v[250:251] op_sel_hi:[1,0]
  v_pk_mul_f32 v[50:51], v[50:51], v[250:251] op_sel_hi:[1,0]
  v_pk_mul_f32 v[52:53], v[52:53], v[250:251] op_sel_hi:[1,0]
  v_pk_mul_f32 v[54:55], v[54:55], v[250:251] op_sel_hi:[1,0]
  v_cvt_pk_bf16_f32 v56, v48, v49
  v_cvt_pk_bf16_f32 v57, v50, v51
  v_cvt_pk_bf16_f32 v58, v52, v53
  v_cvt_pk_bf16_f32 v59, v54, v55
  s_add_u32 s43, s48, 0
  buffer_store_dwordx4 v[56:59], v221, s[28:31], s43 offen offset:3072 sc1
  v_accvgpr_read_b32 v0, a32
  v_accvgpr_read_b32 v1, a33
  v_accvgpr_read_b32 v2, a34
  v_accvgpr_read_b32 v3, a35
  v_accvgpr_read_b32 v4, a36
  v_accvgpr_read_b32 v5, a37
  v_accvgpr_read_b32 v6, a38
  v_accvgpr_read_b32 v7, a39
  v_pk_mul_f32 v[0:1], v[0:1], v[250:251] op_sel_hi:[1,0]
  v_pk_mul_f32 v[2:3], v[2:3], v[250:251] op_sel_hi:[1,0]
  v_pk_mul_f32 v[4:5], v[4:5], v[250:251] op_sel_hi:[1,0]
  v_pk_mul_f32 v[6:7], v[6:7], v[250:251] op_sel_hi:[1,0]
  v_cvt_pk_bf16_f32 v8, v0, v1
  v_cvt_pk_bf16_f32 v9, v2, v3
  v_cvt_pk_bf16_f32 v10, v4, v5
  v_cvt_pk_bf16_f32 v11, v6, v7
  s_add_u32 s43, s48, 4096
  buffer_store_dwordx4 v[8:11], v221, s[28:31], s43 offen offset:0 sc1
  v_accvgpr_read_b32 v16, a40
  v_accvgpr_read_b32 v17, a41
  v_accvgpr_read_b32 v18, a42
  v_accvgpr_read_b32 v19, a43
  v_accvgpr_read_b32 v20, a44
  v_accvgpr_read_b32 v21, a45
  v_accvgpr_read_b32 v22, a46
  v_accvgpr_read_b32 v23, a47
  v_pk_mul_f32 v[16:17], v[16:17], v[250:251] op_sel_hi:[1,0]
  v_pk_mul_f32 v[18:19], v[18:19], v[250:251] op_sel_hi:[1,0]
  v_pk_mul_f32 v[20:21], v[20:21], v[250:251] op_sel_hi:[1,0]
  v_pk_mul_f32 v[22:23], v[22:23], v[250:251] op_sel_hi:[1,0]
  v_cvt_pk_bf16_f32 v24, v16, v17
  v_cvt_pk_bf16_f32 v25, v18, v19
  v_cvt_pk_bf16_f32 v26, v20, v21
  v_cvt_pk_bf16_f32 v27, v22, v23
  s_add_u32 s43, s48, 4096
  buffer_store_dwordx4 v[24:27], v221, s[28:31], s43 offen offset:1024 sc1
  v_accvgpr_read_b32 v32, a48
  v_accvgpr_read_b32 v33, a49
  v_accvgpr_read_b32 v34, a50
  v_accvgpr_read_b32 v35, a51
  v_accvgpr_read_b32 v36, a52
  v_accvgpr_read_b32 v37, a53
  v_accvgpr_read_b32 v38, a54
  v_accvgpr_read_b32 v39, a55
  v_pk_mul_f32 v[32:33], v[32:33], v[250:251] op_sel_hi:[1,0]
  v_pk_mul_f32 v[34:35], v[34:35], v[250:251] op_sel_hi:[1,0]
  v_pk_mul_f32 v[36:37], v[36:37], v[250:251] op_sel_hi:[1,0]
  v_pk_mul_f32 v[38:39], v[38:39], v[250:251] op_sel_hi:[1,0]
  v_cvt_pk_bf16_f32 v40, v32, v33
  v_cvt_pk_bf16_f32 v41, v34, v35
  v_cvt_pk_bf16_f32 v42, v36, v37
  v_cvt_pk_bf16_f32 v43, v38, v39
  s_add_u32 s43, s48, 4096
  buffer_store_dwordx4 v[40:43], v221, s[28:31], s43 offen offset:2048 sc1
  v_accvgpr_read_b32 v48, a56
  v_accvgpr_read_b32 v49, a57
  v_accvgpr_read_b32 v50, a58
  v_accvgpr_read_b32 v51, a59
  v_accvgpr_read_b32 v52, a60
  v_accvgpr_read_b32 v53, a61
  v_accvgpr_read_b32 v54, a62
  v_accvgpr_read_b32 v55, a63
  v_pk_mul_f32 v[48:49], v[48:49], v[250:251] op_sel_hi:[1,0]
  v_pk_mul_f32 v[50:51], v[50:51], v[250:251] op_sel_hi:[1,0]
  v_pk_mul_f32 v[52:53], v[52:53], v[250:251] op_sel_hi:[1,0]
  v_pk_mul_f32 v[54:55], v[54:55], v[250:251] op_sel_hi:[1,0]
  v_cvt_pk_bf16_f32 v56, v48, v49
  v_cvt_pk_bf16_f32 v57, v50, v51
  v_cvt_pk_bf16_f32 v58, v52, v53
  v_cvt_pk_bf16_f32 v59, v54, v55
  s_add_u32 s43, s48, 4096
  buffer_store_dwordx4 v[56:59], v221, s[28:31], s43 offen offset:3072 sc1
  v_mov_b32 v250, v244
  v_accvgpr_read_b32 v0, a64
  v_accvgpr_read_b32 v1, a65
  v_accvgpr_read_b32 v2, a66
  v_accvgpr_read_b32 v3, a67
  v_accvgpr_read_b32 v4, a68
  v_accvgpr_read_b32 v5, a69
  v_accvgpr_read_b32 v6, a70
  v_accvgpr_read_b32 v7, a71
  v_pk_mul_f32 v[0:1], v[0:1], v[250:251] op_sel_hi:[1,0]
  v_pk_mul_f32 v[2:3], v[2:3], v[250:251] op_sel_hi:[1,0]
  v_pk_mul_f32 v[4:5], v[4:5], v[250:251] op_sel_hi:[1,0]
  v_pk_mul_f32 v[6:7], v[6:7], v[250:251] op_sel_hi:[1,0]
  v_cvt_pk_bf16_f32 v8, v0, v1
  v_cvt_pk_bf16_f32 v9, v2, v3
  v_cvt_pk_bf16_f32 v10, v4, v5
  v_cvt_pk_bf16_f32 v11, v6, v7
  s_add_u32 s43, s49, 0
  buffer_store_dwordx4 v[8:11], v221, s[28:31], s43 offen offset:0 sc1
  v_accvgpr_read_b32 v16, a72
  v_accvgpr_read_b32 v17, a73
  v_accvgpr_read_b32 v18, a74
  v_accvgpr_read_b32 v19, a75
  v_accvgpr_read_b32 v20, a76
  v_accvgpr_read_b32 v21, a77
  v_accvgpr_read_b32 v22, a78
  v_accvgpr_read_b32 v23, a79
  v_pk_mul_f32 v[16:17], v[16:17], v[250:251] op_sel_hi:[1,0]
  v_pk_mul_f32 v[18:19], v[18:19], v[250:251] op_sel_hi:[1,0]
  v_pk_mul_f32 v[20:21], v[20:21], v[250:251] op_sel_hi:[1,0]
  v_pk_mul_f32 v[22:23], v[22:23], v[250:251] op_sel_hi:[1,0]
  v_cvt_pk_bf16_f32 v24, v16, v17
  v_cvt_pk_bf16_f32 v25, v18, v19
  v_cvt_pk_bf16_f32 v26, v20, v21
  v_cvt_pk_bf16_f32 v27, v22, v23
  s_add_u32 s43, s49, 0
  buffer_store_dwordx4 v[24:27], v221, s[28:31], s43 offen offset:1024 sc1
  v_accvgpr_read_b32 v32, a80
  v_accvgpr_read_b32 v33, a81
  v_accvgpr_read_b32 v34, a82
  v_accvgpr_read_b32 v35, a83
  v_accvgpr_read_b32 v36, a84
  v_accvgpr_read_b32 v37, a85
  v_accvgpr_read_b32 v38, a86
  v_accvgpr_read_b32 v39, a87
  v_pk_mul_f32 v[32:33], v[32:33], v[250:251] op_sel_hi:[1,0]
  v_pk_mul_f32 v[34:35], v[34:35], v[250:251] op_sel_hi:[1,0]
  v_pk_mul_f32 v[36:37], v[36:37], v[250:251] op_sel_hi:[1,0]
  v_pk_mul_f32 v[38:39], v[38:39], v[250:251] op_sel_hi:[1,0]
  v_cvt_pk_bf16_f32 v40, v32, v33
  v_cvt_pk_bf16_f32 v41, v34, v35
  v_cvt_pk_bf16_f32 v42, v36, v37
  v_cvt_pk_bf16_f32 v43, v38, v39
  s_add_u32 s43, s49, 0
  buffer_store_dwordx4 v[40:43], v221, s[28:31], s43 offen offset:2048 sc1
  v_accvgpr_read_b32 v48, a88
  v_accvgpr_read_b32 v49, a89
  v_accvgpr_read_b32 v50, a90
  v_accvgpr_read_b32 v51, a91
  v_accvgpr_read_b32 v52, a92
  v_accvgpr_read_b32 v53, a93
  v_accvgpr_read_b32 v54, a94
  v_accvgpr_read_b32 v55, a95
  v_pk_mul_f32 v[48:49], v[48:49], v[250:251] op_sel_hi:[1,0]
  v_pk_mul_f32 v[50:51], v[50:51], v[250:251] op_sel_hi:[1,0]
  v_pk_mul_f32 v[52:53], v[52:53], v[250:251] op_sel_hi:[1,0]
  v_pk_mul_f32 v[54:55], v[54:55], v[250:251] op_sel_hi:[1,0]
  v_cvt_pk_bf16_f32 v56, v48, v49
  v_cvt_pk_bf16_f32 v57, v50, v51
  v_cvt_pk_bf16_f32 v58, v52, v53
  v_cvt_pk_bf16_f32 v59, v54, v55
  s_add_u32 s43, s49, 0
  buffer_store_dwordx4 v[56:59], v221, s[28:31], s43 offen offset:3072 sc1
  v_accvgpr_read_b32 v0, a96
  v_accvgpr_read_b32 v1, a97
  v_accvgpr_read_b32 v2, a98
  v_accvgpr_read_b32 v3, a99
  v_accvgpr_read_b32 v4, a100
  v_accvgpr_read_b32 v5, a101
  v_accvgpr_read_b32 v6, a102
  v_accvgpr_read_b32 v7, a103
  v_pk_mul_f32 v[0:1], v[0:1], v[250:251] op_sel_hi:[1,0]
  v_pk_mul_f32 v[2:3], v[2:3], v[250:251] op_sel_hi:[1,0]
  v_pk_mul_f32 v[4:5], v[4:5], v[250:251] op_sel_hi:[1,0]
  v_pk_mul_f32 v[6:7], v[6:7], v[250:251] op_sel_hi:[1,0]
  v_cvt_pk_bf16_f32 v8, v0, v1
  v_cvt_pk_bf16_f32 v9, v2, v3
  v_cvt_pk_bf16_f32 v10, v4, v5
  v_cvt_pk_bf16_f32 v11, v6, v7
  s_add_u32 s43, s49, 4096
  buffer_store_dwordx4 v[8:11], v221, s[28:31], s43 offen offset:0 sc1
  v_accvgpr_read_b32 v16, a104
  v_accvgpr_read_b32 v17, a105
  v_accvgpr_read_b32 v18, a106
  v_accvgpr_read_b32 v19, a107
  v_accvgpr_read_b32 v20, a108
  v_accvgpr_read_b32 v21, a109
  v_accvgpr_read_b32 v22, a110
  v_accvgpr_read_b32 v23, a111
  v_pk_mul_f32 v[16:17], v[16:17], v[250:251] op_sel_hi:[1,0]
  v_pk_mul_f32 v[18:19], v[18:19], v[250:251] op_sel_hi:[1,0]
  v_pk_mul_f32 v[20:21], v[20:21], v[250:251] op_sel_hi:[1,0]
  v_pk_mul_f32 v[22:23], v[22:23], v[250:251] op_sel_hi:[1,0]
  v_cvt_pk_bf16_f32 v24, v16, v17
  v_cvt_pk_bf16_f32 v25, v18, v19
  v_cvt_pk_bf16_f32 v26, v20, v21
  v_cvt_pk_bf16_f32 v27, v22, v23
  s_add_u32 s43, s49, 4096
  buffer_store_dwordx4 v[24:27], v221, s[28:31], s43 offen offset:1024 sc1
  v_accvgpr_read_b32 v32, a112
  v_accvgpr_read_b32 v33, a113
  v_accvgpr_read_b32 v34, a114
  v_accvgpr_read_b32 v35, a115
  v_accvgpr_read_b32 v36, a116
  v_accvgpr_read_b32 v37, a117
  v_accvgpr_read_b32 v38, a118
  v_accvgpr_read_b32 v39, a119
  v_pk_mul_f32 v[32:33], v[32:33], v[250:251] op_sel_hi:[1,0]
  v_pk_mul_f32 v[34:35], v[34:35], v[250:251] op_sel_hi:[1,0]
  v_pk_mul_f32 v[36:37], v[36:37], v[250:251] op_sel_hi:[1,0]
  v_pk_mul_f32 v[38:39], v[38:39], v[250:251] op_sel_hi:[1,0]
  v_cvt_pk_bf16_f32 v40, v32, v33
  v_cvt_pk_bf16_f32 v41, v34, v35
  v_cvt_pk_bf16_f32 v42, v36, v37
  v_cvt_pk_bf16_f32 v43, v38, v39
  s_add_u32 s43, s49, 4096
  buffer_store_dwordx4 v[40:43], v221, s[28:31], s43 offen offset:2048 sc1
  v_accvgpr_read_b32 v48, a120
  v_accvgpr_read_b32 v49, a121
  v_accvgpr_read_b32 v50, a122
  v_accvgpr_read_b32 v51, a123
  v_accvgpr_read_b32 v52, a124
  v_accvgpr_read_b32 v53, a125
  v_accvgpr_read_b32 v54, a126
  v_accvgpr_read_b32 v55, a127
  v_pk_mul_f32 v[48:49], v[48:49], v[250:251] op_sel_hi:[1,0]
  v_pk_mul_f32 v[50:51], v[50:51], v[250:251] op_sel_hi:[1,0]
  v_pk_mul_f32 v[52:53], v[52:53], v[250:251] op_sel_hi:[1,0]
  v_pk_mul_f32 v[54:55], v[54:55], v[250:251] op_sel_hi:[1,0]
  v_cvt_pk_bf16_f32 v56, v48, v49
  v_cvt_pk_bf16_f32 v57, v50, v51
  v_cvt_pk_bf16_f32 v58, v52, v53
  v_cvt_pk_bf16_f32 v59, v54, v55
  s_add_u32 s43, s49, 4096
  buffer_store_dwordx4 v[56:59], v221, s[28:31], s43 offen offset:3072 sc1
  s_load_dwordx2 s[6:7], s[0:1], 32
  s_load_dwordx2 s[86:87], s[0:1], 64
  v_lshrrev_b32 v213, 3, v245
  v_lshlrev_b32 v213, 10, v213
  v_bfe_u32 v214, v245, 4, 1
  v_lshlrev_b32 v214, 2, v214
  v_and_b32 v215, 7, v245
  v_xor_b32 v214, v214, v215
  v_lshlrev_b32 v214, 4, v214
  v_add_u32 v213, v213, v214
  v_lshlrev_b32 v214, 4, v245
  s_mul_i32 s88, s2, 7
  s_lshl_b32 s82, s3, 1
  s_add_u32 s88, s88, s82
  s_lshr_b32 s70, s2, 5
  s_lshl_b32 s70, s70, 2
  s_bfe_u32 s71, s2, 0x20003
  s_add_u32 s70, s70, s71
  s_add_u32 s70, s70, 16
  s_lshl_b32 s70, s70, 8
  s_and_b32 s34, s2, 7
  s_lshr_b32 s35, s2, 3
  s_and_b32 s33, s34, 3
  s_lshr_b32 s34, s34, 2
  s_lshl_b32 s34, s34, 3
  s_and_b32 s36, s35, 7
  s_add_u32 s36, s36, s34
  s_lshr_b32 s37, s35, 3
  v_lshlrev_b32 v209, 4, v245
  v_lshrrev_b32 v128, 4, v245
  v_lshrrev_b32 v129, 5, v245
  v_and_b32 v130, 1, v128
  v_bfe_u32 v131, v245, 2, 2
  v_and_b32 v132, 3, v245
  v_and_b32 v133, 15, v245
  v_lshlrev_b32 v134, 2, v128
  v_xor_b32 v134, v133, v134
  v_lshlrev_b32 v134, 4, v134
  v_mul_u32_u24 v208, 1024, v128
  v_add_u32 v208, v208, v134
  v_xor_b32 v133, 0, v131
  v_lshlrev_b32 v133, 2, v133
  v_lshlrev_b32 v134, 1, v130
  v_add_u32 v133, v133, v134
  v_lshrrev_b32 v134, 1, v132
  v_add_u32 v134, v133, v134
  v_lshlrev_b32 v134, 4, v134
  v_and_b32 v135, 1, v132
  v_lshlrev_b32 v135, 3, v135
  v_add_u32 v134, v134, v135
  v_lshlrev_b32 v135, 2, v129
  v_add_u32 v135, v135, v131
  v_lshlrev_b32 v135, 8, v135
  v_add_u32 v200, v134, v135
  v_add_u32 v204, 65536, v200
  v_xor_b32 v133, 1, v131
  v_lshlrev_b32 v133, 2, v133
  v_lshlrev_b32 v134, 1, v130
  v_add_u32 v133, v133, v134
  v_lshrrev_b32 v134, 1, v132
  v_add_u32 v134, v133, v134
  v_lshlrev_b32 v134, 4, v134
  v_and_b32 v135, 1, v132
  v_lshlrev_b32 v135, 3, v135
  v_add_u32 v134, v134, v135
  v_lshlrev_b32 v135, 2, v129
  v_add_u32 v135, v135, v131
  v_lshlrev_b32 v135, 8, v135
  v_add_u32 v201, v134, v135
  v_add_u32 v205, 65536, v201
  v_xor_b32 v133, 2, v131
  v_lshlrev_b32 v133, 2, v133
  v_lshlrev_b32 v134, 1, v130
  v_add_u32 v133, v133, v134
  v_lshrrev_b32 v134, 1, v132
  v_add_u32 v134, v133, v134
  v_lshlrev_b32 v134, 4, v134
  v_and_b32 v135, 1, v132
  v_lshlrev_b32 v135, 3, v135
  v_add_u32 v134, v134, v135
  v_lshlrev_b32 v135, 2, v129
  v_add_u32 v135, v135, v131
  v_lshlrev_b32 v135, 8, v135
  v_add_u32 v202, v134, v135
  v_add_u32 v206, 65536, v202
  v_xor_b32 v133, 3, v131
  v_lshlrev_b32 v133, 2, v133
  v_lshlrev_b32 v134, 1, v130
  v_add_u32 v133, v133, v134
  v_lshrrev_b32 v134, 1, v132
  v_add_u32 v134, v133, v134
  v_lshlrev_b32 v134, 4, v134
  v_and_b32 v135, 1, v132
  v_lshlrev_b32 v135, 3, v135
  v_add_u32 v134, v134, v135
  v_lshlrev_b32 v135, 2, v129
  v_add_u32 v135, v135, v131
  v_lshlrev_b32 v135, 8, v135
  v_add_u32 v203, v134, v135
  v_add_u32 v207, 65536, v203
  s_lshl_b32 s39, s36, 2
  s_add_u32 s39, s39, s3
  s_lshl_b32 s41, s33, 20
  s_lshl_b32 s38, s3, 12
  s_add_u32 s41, s41, s38
  s_lshl_b32 s38, s37, 8
  s_add_u32 s41, s41, s38
  s_lshl_b32 s42, s3, 10
  s_lshl_b32 s45, s39, 18
  s_lshl_b32 s38, s33, 16
  s_add_u32 s45, s45, s38
  s_lshr_b32 s71, s36, 1
  s_lshl_b32 s71, s71, 2
  s_add_u32 s71, s71, s33
  s_add_u32 s71, s71, 16
  s_lshl_b32 s71, s71, 8
  s_waitcnt lgkmcnt(0)
  s_mov_b32 s12, s6
  s_mov_b32 s13, s7
  s_mov_b32 s14, 4194304
  s_mov_b32 s15, 0x00020000
  s_add_u32 s16, s4, 4194304
  s_addc_u32 s17, s5, 0
  s_mov_b32 s18, 16777216
  s_mov_b32 s19, 0x00020000
  s_add_u32 s20, s4, 50331648
  s_addc_u32 s21, s5, 0
  s_mov_b32 s22, 8388608
  s_mov_b32 s23, 0x00020000
  s_add_u32 s64, s4, 2228224
  s_addc_u32 s65, s5, 0
  s_mov_b32 s66, 8192
  s_mov_b32 s67, 0x00020000
  s_mov_b32 s76, s86
  s_mov_b32 s77, s87
  s_mov_b32 s78, 1835008
  s_mov_b32 s79, 0x00020000
  s_add_u32 s48, s4, 41943040
  s_addc_u32 s49, s5, 0
  s_mov_b32 s50, 1835008
  s_mov_b32 s51, 0x00020000
  v_add_u32 v241, 16384, v208
  v_add_u32 v242, 32768, v208
  v_add_u32 v243, 49152, v208
  s_waitcnt vmcnt(0)
  s_barrier
  s_cmp_lg_u32 s3, 0
  s_cbranch_scc1 HO_41
  s_mov_b64 exec, 1
  v_mov_b32 v251, 1
  v_mov_b32 v252, s70
  buffer_atomic_add v251, v252, s[60:63], 0 offen sc1
  s_mov_b64 exec, -1
  s_add_u32 m0, s42, 0
  s_add_u32 s53, s41, 0
  buffer_load_dwordx4 v208, s[12:15], s53 offen lds
  s_add_u32 m0, s42, 4096
  s_nop 0
  buffer_load_dwordx4 v241, s[12:15], s53 offen lds
  s_add_u32 m0, s42, 8192
  s_nop 0
  buffer_load_dwordx4 v242, s[12:15], s53 offen lds
  s_add_u32 m0, s42, 12288
  s_nop 0
  buffer_load_dwordx4 v243, s[12:15], s53 offen lds
  s_add_u32 m0, s42, 16384
  s_add_u32 s53, s41, 65536
  buffer_load_dwordx4 v208, s[12:15], s53 offen lds
  s_add_u32 m0, s42, 20480
  s_nop 0
  buffer_load_dwordx4 v241, s[12:15], s53 offen lds
  s_add_u32 m0, s42, 24576
  s_nop 0
  buffer_load_dwordx4 v242, s[12:15], s53 offen lds
  s_add_u32 m0, s42, 28672
  s_nop 0
  buffer_load_dwordx4 v243, s[12:15], s53 offen lds
  s_mov_b64 exec, 0x1ff
  v_and_b32 v252, 63, v255
  v_add_u32 v252, 7, v252
  v_lshlrev_b32 v252, 8, v252
  v_writelane_b32 v252, s71, 0
  v_mov_b32 v250, 32
  s_mov_b32 s69, 8
  s_nop 0
  v_writelane_b32 v250, s69, 0
  s_mov_b32 s68, 0
POLL_44:
  buffer_load_dword v251, v252, s[60:63], 0 offen sc1
  s_waitcnt vmcnt(0)
  v_cmp_le_u32 vcc, v250, v251
  s_add_u32 s68, s68, 1
  s_cmp_eq_u64 vcc, exec
  s_cbranch_scc1 POK_45
  s_cmp_gt_u32 s68, 200000
  s_cbranch_scc1 POK_45
  s_sleep 1
  s_branch POLL_44
POK_45:
  s_mov_b64 exec, -1
  s_branch HW_40
HO_41:
  s_add_u32 m0, s42, 0
  s_add_u32 s53, s41, 0
  buffer_load_dwordx4 v208, s[12:15], s53 offen lds
  s_add_u32 m0, s42, 4096
  s_nop 0
  buffer_load_dwordx4 v241, s[12:15], s53 offen lds
  s_add_u32 m0, s42, 8192
  s_nop 0
  buffer_load_dwordx4 v242, s[12:15], s53 offen lds
  s_add_u32 m0, s42, 12288
  s_nop 0
  buffer_load_dwordx4 v243, s[12:15], s53 offen lds
  s_add_u32 m0, s42, 16384
  s_add_u32 s53, s41, 65536
  buffer_load_dwordx4 v208, s[12:15], s53 offen lds
  s_add_u32 m0, s42, 20480
  s_nop 0
  buffer_load_dwordx4 v241, s[12:15], s53 offen lds
  s_add_u32 m0, s42, 24576
  s_nop 0
  buffer_load_dwordx4 v242, s[12:15], s53 offen lds
  s_add_u32 m0, s42, 28672
  s_nop 0
  buffer_load_dwordx4 v243, s[12:15], s53 offen lds
  s_add_u32 m0, s42, 32768
  s_add_u32 s53, s41, 131072
  buffer_load_dwordx4 v208, s[12:15], s53 offen lds
  s_add_u32 m0, s42, 36864
  s_nop 0
  buffer_load_dwordx4 v241, s[12:15], s53 offen lds
  s_add_u32 m0, s42, 40960
  s_nop 0
  buffer_load_dwordx4 v242, s[12:15], s53 offen lds
  s_add_u32 m0, s42, 45056
  s_nop 0
  buffer_load_dwordx4 v243, s[12:15], s53 offen lds
  s_add_u32 m0, s42, 49152
  s_add_u32 s53, s41, 196608
  buffer_load_dwordx4 v208, s[12:15], s53 offen lds
  s_add_u32 m0, s42, 53248
  s_nop 0
  buffer_load_dwordx4 v241, s[12:15], s53 offen lds
  s_add_u32 m0, s42, 57344
  s_nop 0
  buffer_load_dwordx4 v242, s[12:15], s53 offen lds
  s_add_u32 m0, s42, 61440
  s_nop 0
  buffer_load_dwordx4 v243, s[12:15], s53 offen lds
  s_add_u32 m0, s42, 65536
  s_add_u32 s53, s41, 262144
  buffer_load_dwordx4 v208, s[12:15], s53 offen lds
  s_add_u32 m0, s42, 69632
  s_nop 0
  buffer_load_dwordx4 v241, s[12:15], s53 offen lds
  s_add_u32 m0, s42, 73728
  s_nop 0
  buffer_load_dwordx4 v242, s[12:15], s53 offen lds
  s_add_u32 m0, s42, 77824
  s_nop 0
  buffer_load_dwordx4 v243, s[12:15], s53 offen lds
  s_add_u32 m0, s42, 81920
  s_add_u32 s53, s41, 327680
  buffer_load_dwordx4 v208, s[12:15], s53 offen lds
  s_add_u32 m0, s42, 86016
  s_nop 0
  buffer_load_dwordx4 v241, s[12:15], s53 offen lds
  s_add_u32 m0, s42, 90112
  s_nop 0
  buffer_load_dwordx4 v242, s[12:15], s53 offen lds
  s_add_u32 m0, s42, 94208
  s_nop 0
  buffer_load_dwordx4 v243, s[12:15], s53 offen lds
  s_add_u32 m0, s42, 98304
  s_add_u32 s53, s41, 393216
  buffer_load_dwordx4 v208, s[12:15], s53 offen lds
  s_add_u32 m0, s42, 102400
  s_nop 0
  buffer_load_dwordx4 v241, s[12:15], s53 offen lds
  s_add_u32 m0, s42, 106496
  s_nop 0
  buffer_load_dwordx4 v242, s[12:15], s53 offen lds
  s_add_u32 m0, s42, 110592
  s_nop 0
  buffer_load_dwordx4 v243, s[12:15], s53 offen lds
  s_add_u32 m0, s42, 114688
  s_add_u32 s53, s41, 458752
  buffer_load_dwordx4 v208, s[12:15], s53 offen lds
  s_add_u32 m0, s42, 118784
  s_nop 0
  buffer_load_dwordx4 v241, s[12:15], s53 offen lds
  s_add_u32 m0, s42, 122880
  s_nop 0
  buffer_load_dwordx4 v242, s[12:15], s53 offen lds
  s_add_u32 m0, s42, 126976
  s_nop 0
  buffer_load_dwordx4 v243, s[12:15], s53 offen lds
HW_40:
  s_barrier
  s_cmp_lg_u32 s3, 0
  s_cbranch_scc1 HL_46
  s_add_u32 m0, s42, 32768
  s_add_u32 s53, s41, 131072
  buffer_load_dwordx4 v208, s[12:15], s53 offen lds
  s_add_u32 m0, s42, 36864
  s_nop 0
  buffer_load_dwordx4 v241, s[12:15], s53 offen lds
  s_add_u32 m0, s42, 40960
  s_nop 0
  buffer_load_dwordx4 v242, s[12:15], s53 offen lds
  s_add_u32 m0, s42, 45056
  s_nop 0
  buffer_load_dwordx4 v243, s[12:15], s53 offen lds
  s_add_u32 m0, s42, 49152
  s_add_u32 s53, s41, 196608
  buffer_load_dwordx4 v208, s[12:15], s53 offen lds
  s_add_u32 m0, s42, 53248
  s_nop 0
  buffer_load_dwordx4 v241, s[12:15], s53 offen lds
  s_add_u32 m0, s42, 57344
  s_nop 0
  buffer_load_dwordx4 v242, s[12:15], s53 offen lds
  s_add_u32 m0, s42, 61440
  s_nop 0
  buffer_load_dwordx4 v243, s[12:15], s53 offen lds
  s_add_u32 m0, s42, 65536
  s_add_u32 s53, s41, 262144
  buffer_load_dwordx4 v208, s[12:15], s53 offen lds
  s_add_u32 m0, s42, 69632
  s_nop 0
  buffer_load_dwordx4 v241, s[12:15], s53 offen lds
  s_add_u32 m0, s42, 73728
  s_nop 0
  buffer_load_dwordx4 v242, s[12:15], s53 offen lds
  s_add_u32 m0, s42, 77824
  s_nop 0
  buffer_load_dwordx4 v243, s[12:15], s53 offen lds
  s_add_u32 m0, s42, 81920
  s_add_u32 s53, s41, 327680
  buffer_load_dwordx4 v208, s[12:15], s53 offen lds
  s_add_u32 m0, s42, 86016
  s_nop 0
  buffer_load_dwordx4 v241, s[12:15], s53 offen lds
  s_add_u32 m0, s42, 90112
  s_nop 0
  buffer_load_dwordx4 v242, s[12:15], s53 offen lds
  s_add_u32 m0, s42, 94208
  s_nop 0
  buffer_load_dwordx4 v243, s[12:15], s53 offen lds
  s_add_u32 m0, s42, 98304
  s_add_u32 s53, s41, 393216
  buffer_load_dwordx4 v208, s[12:15], s53 offen lds
  s_add_u32 m0, s42, 102400
  s_nop 0
  buffer_load_dwordx4 v241, s[12:15], s53 offen lds
  s_add_u32 m0, s42, 106496
  s_nop 0
  buffer_load_dwordx4 v242, s[12:15], s53 offen lds
  s_add_u32 m0, s42, 110592
  s_nop 0
  buffer_load_dwordx4 v243, s[12:15], s53 offen lds
  s_add_u32 m0, s42, 114688
  s_add_u32 s53, s41, 458752
  buffer_load_dwordx4 v208, s[12:15], s53 offen lds
  s_add_u32 m0, s42, 118784
  s_nop 0
  buffer_load_dwordx4 v241, s[12:15], s53 offen lds
  s_add_u32 m0, s42, 122880
  s_nop 0
  buffer_load_dwordx4 v242, s[12:15], s53 offen lds
  s_add_u32 m0, s42, 126976
  s_nop 0
  buffer_load_dwordx4 v243, s[12:15], s53 offen lds
HL_46:
  s_add_u32 s54, s45, 0
  buffer_load_dwordx4 v[0:3], v209, s[16:19], s54 offen offset:0 sc1
  buffer_load_dwordx4 v[4:7], v209, s[16:19], s54 offen offset:1024 sc1
  buffer_load_dwordx4 v[8:11], v209, s[16:19], s54 offen offset:2048 sc1
  buffer_load_dwordx4 v[12:15], v209, s[16:19], s54 offen offset:3072 sc1
  s_add_u32 s54, s45, 4096
  buffer_load_dwordx4 v[16:19], v209, s[16:19], s54 offen offset:0 sc1
  buffer_load_dwordx4 v[20:23], v209, s[16:19], s54 offen offset:1024 sc1
  buffer_load_dwordx4 v[24:27], v209, s[16:19], s54 offen offset:2048 sc1
  buffer_load_dwordx4 v[28:31], v209, s[16:19], s54 offen offset:3072 sc1
  s_add_u32 s54, s45, 8192
  buffer_load_dwordx4 v[32:35], v209, s[16:19], s54 offen offset:0 sc1
  buffer_load_dwordx4 v[36:39], v209, s[16:19], s54 offen offset:1024 sc1
  buffer_load_dwordx4 v[40:43], v209, s[16:19], s54 offen offset:2048 sc1
  buffer_load_dwordx4 v[44:47], v209, s[16:19], s54 offen offset:3072 sc1
  v_lshlrev_b32 v210, 3, v255
  v_add_u32 v211, 4096, v210
  buffer_load_dwordx2 v[192:193], v210, s[64:67], 0 offen sc1
  buffer_load_dwordx2 v[194:195], v210, s[64:67], 0 offen offset:2048 sc1
  buffer_load_dwordx2 v[196:197], v211, s[64:67], 0 offen sc1
  buffer_load_dwordx2 v[198:199], v211, s[64:67], 0 offen offset:2048 sc1
  s_add_u32 s82, s88, 0
  s_lshr_b32 s80, s82, 1
  s_mul_i32 s81, s80, 9363
  s_lshr_b32 s81, s81, 20
  s_mul_i32 s75, s81, 112
  s_sub_u32 s80, s80, s75
  s_lshl_b32 s80, s80, 14
  s_and_b32 s82, s82, 1
  s_lshl_b32 s82, s82, 13
  s_add_u32 s80, s80, s82
  s_lshl_b32 s81, s81, 7
  s_add_u32 s80, s80, s81
  buffer_load_dwordx4 v[216:219], v213, s[76:79], s80 offen
  s_add_u32 s82, s88, 1
  s_lshr_b32 s80, s82, 1
  s_mul_i32 s81, s80, 9363
  s_lshr_b32 s81, s81, 20
  s_mul_i32 s75, s81, 112
  s_sub_u32 s80, s80, s75
  s_lshl_b32 s80, s80, 14
  s_and_b32 s82, s82, 1
  s_lshl_b32 s82, s82, 13
  s_add_u32 s80, s80, s82
  s_lshl_b32 s81, s81, 7
  s_add_u32 s80, s80, s81
  buffer_load_dwordx4 v[220:223], v213, s[76:79], s80 offen
  s_waitcnt vmcnt(46)
  s_barrier
  ds_read_b64_tr_b16 a[0:1], v200 offset:0
  ds_read_b64_tr_b16 a[2:3], v200 offset:2048
  ds_read_b64_tr_b16 a[4:5], v201 offset:0
  ds_read_b64_tr_b16 a[6:7], v201 offset:2048
  ds_read_b64_tr_b16 a[8:9], v202 offset:0
  ds_read_b64_tr_b16 a[10:11], v202 offset:2048
  ds_read_b64_tr_b16 a[12:13], v203 offset:0
  ds_read_b64_tr_b16 a[14:15], v203 offset:2048
  ds_read_b64_tr_b16 a[16:17], v200 offset:4096
  ds_read_b64_tr_b16 a[18:19], v200 offset:6144
  ds_read_b64_tr_b16 a[20:21], v201 offset:4096
  ds_read_b64_tr_b16 a[22:23], v201 offset:6144
  ds_read_b64_tr_b16 a[24:25], v202 offset:4096
  ds_read_b64_tr_b16 a[26:27], v202 offset:6144
  ds_read_b64_tr_b16 a[28:29], v203 offset:4096
  ds_read_b64_tr_b16 a[30:31], v203 offset:6144
  s_waitcnt vmcnt(17) lgkmcnt(8)
  v_mfma_f32_32x32x16_bf16 v[128:143], a[0:3], v[0:3], 0
  ds_read_b64_tr_b16 a[32:33], v200 offset:8192
  ds_read_b64_tr_b16 a[34:35], v200 offset:10240
  ds_read_b64_tr_b16 a[36:37], v201 offset:8192
  s_add_u32 s54, s45, 12288
  v_mfma_f32_32x32x16_bf16 v[144:159], a[4:7], v[0:3], 0
  buffer_load_dwordx4 v[48:51], v209, s[16:19], s54 offen offset:0 sc1
  ds_read_b64_tr_b16 a[38:39], v201 offset:10240
  ds_read_b64_tr_b16 a[40:41], v202 offset:8192
  v_mfma_f32_32x32x16_bf16 v[160:175], a[8:11], v[0:3], 0
  buffer_load_dwordx4 v[52:55], v209, s[16:19], s54 offen offset:1024 sc1
  ds_read_b64_tr_b16 a[42:43], v202 offset:10240
  ds_read_b64_tr_b16 a[44:45], v203 offset:8192
  v_mfma_f32_32x32x16_bf16 v[176:191], a[12:15], v[0:3], 0
  buffer_load_dwordx4 v[56:59], v209, s[16:19], s54 offen offset:2048 sc1
  ds_read_b64_tr_b16 a[46:47], v203 offset:10240
  s_waitcnt vmcnt(19) lgkmcnt(8)
  v_mfma_f32_32x32x16_bf16 v[128:143], a[16:19], v[4:7], v[128:143]
  ds_read_b64_tr_b16 a[0:1], v200 offset:12288
  ds_read_b64_tr_b16 a[2:3], v200 offset:14336
  ds_read_b64_tr_b16 a[4:5], v201 offset:12288
  v_mfma_f32_32x32x16_bf16 v[144:159], a[20:23], v[4:7], v[144:159]
  buffer_load_dwordx4 v[60:63], v209, s[16:19], s54 offen offset:3072 sc1
  ds_read_b64_tr_b16 a[6:7], v201 offset:14336
  ds_read_b64_tr_b16 a[8:9], v202 offset:12288
  s_add_u32 s54, s45, 16384
  v_mfma_f32_32x32x16_bf16 v[160:175], a[24:27], v[4:7], v[160:175]
  buffer_load_dwordx4 v[64:67], v209, s[16:19], s54 offen offset:0 sc1
  ds_read_b64_tr_b16 a[10:11], v202 offset:14336
  ds_read_b64_tr_b16 a[12:13], v203 offset:12288
  v_mfma_f32_32x32x16_bf16 v[176:191], a[28:31], v[4:7], v[176:191]
  buffer_load_dwordx4 v[68:71], v209, s[16:19], s54 offen offset:1024 sc1
  ds_read_b64_tr_b16 a[14:15], v203 offset:14336
  s_waitcnt vmcnt(21) lgkmcnt(0)
  s_barrier
  v_mfma_f32_32x32x16_bf16 v[128:143], a[32:35], v[8:11], v[128:143]
  ds_read_b64_tr_b16 a[16:17], v200 offset:16384
  ds_read_b64_tr_b16 a[18:19], v200 offset:18432
  ds_read_b64_tr_b16 a[20:21], v201 offset:16384
  v_mfma_f32_32x32x16_bf16 v[144:159], a[36:39], v[8:11], v[144:159]
  buffer_load_dwordx4 v[72:75], v209, s[16:19], s54 offen offset:2048 sc1
  ds_read_b64_tr_b16 a[22:23], v201 offset:18432
  ds_read_b64_tr_b16 a[24:25], v202 offset:16384
  v_mfma_f32_32x32x16_bf16 v[160:175], a[40:43], v[8:11], v[160:175]
  buffer_load_dwordx4 v[76:79], v209, s[16:19], s54 offen offset:3072 sc1
  ds_read_b64_tr_b16 a[26:27], v202 offset:18432
  ds_read_b64_tr_b16 a[28:29], v203 offset:16384
  s_add_u32 s54, s45, 20480
  v_mfma_f32_32x32x16_bf16 v[176:191], a[44:47], v[8:11], v[176:191]
  buffer_load_dwordx4 v[80:83], v209, s[16:19], s54 offen offset:0 sc1
  ds_read_b64_tr_b16 a[30:31], v203 offset:18432
  s_waitcnt vmcnt(23)
  v_mfma_f32_32x32x16_bf16 v[128:143], a[0:3], v[12:15], v[128:143]
  ds_read_b64_tr_b16 a[32:33], v200 offset:20480
  ds_read_b64_tr_b16 a[34:35], v200 offset:22528
  ds_read_b64_tr_b16 a[36:37], v201 offset:20480
  v_mfma_f32_32x32x16_bf16 v[144:159], a[4:7], v[12:15], v[144:159]
  buffer_load_dwordx4 v[84:87], v209, s[16:19], s54 offen offset:1024 sc1
  ds_read_b64_tr_b16 a[38:39], v201 offset:22528
  ds_read_b64_tr_b16 a[40:41], v202 offset:20480
  v_mfma_f32_32x32x16_bf16 v[160:175], a[8:11], v[12:15], v[160:175]
  buffer_load_dwordx4 v[88:91], v209, s[16:19], s54 offen offset:2048 sc1
  ds_read_b64_tr_b16 a[42:43], v202 offset:22528
  ds_read_b64_tr_b16 a[44:45], v203 offset:20480
  v_mfma_f32_32x32x16_bf16 v[176:191], a[12:15], v[12:15], v[176:191]
  buffer_load_dwordx4 v[92:95], v209, s[16:19], s54 offen offset:3072 sc1
  ds_read_b64_tr_b16 a[46:47], v203 offset:22528
  s_waitcnt vmcnt(25) lgkmcnt(8)
  v_mfma_f32_32x32x16_bf16 v[128:143], a[16:19], v[16:19], v[128:143]
  ds_read_b64_tr_b16 a[0:1], v200 offset:24576
  ds_read_b64_tr_b16 a[2:3], v200 offset:26624
  ds_read_b64_tr_b16 a[4:5], v201 offset:24576
  s_add_u32 s54, s45, 24576
  v_mfma_f32_32x32x16_bf16 v[144:159], a[20:23], v[16:19], v[144:159]
  buffer_load_dwordx4 v[96:99], v209, s[16:19], s54 offen offset:0 sc1
  ds_read_b64_tr_b16 a[6:7], v201 offset:26624
  ds_read_b64_tr_b16 a[8:9], v202 offset:24576
  v_mfma_f32_32x32x16_bf16 v[160:175], a[24:27], v[16:19], v[160:175]
  buffer_load_dwordx4 v[100:103], v209, s[16:19], s54 offen offset:1024 sc1
  ds_read_b64_tr_b16 a[10:11], v202 offset:26624
  ds_read_b64_tr_b16 a[12:13], v203 offset:24576
  v_mfma_f32_32x32x16_bf16 v[176:191], a[28:31], v[16:19], v[176:191]
  buffer_load_dwordx4 v[104:107], v209, s[16:19], s54 offen offset:2048 sc1
  ds_read_b64_tr_b16 a[14:15], v203 offset:26624
  s_waitcnt vmcnt(27) lgkmcnt(8)
  v_mfma_f32_32x32x16_bf16 v[128:143], a[32:35], v[20:23], v[128:143]
  ds_read_b64_tr_b16 a[16:17], v200 offset:28672
  ds_read_b64_tr_b16 a[18:19], v200 offset:30720
  ds_read_b64_tr_b16 a[20:21], v201 offset:28672
  s_add_u32 m0, s42, 0
  s_add_u32 s53, s41, 524288
  v_mfma_f32_32x32x16_bf16 v[144:159], a[36:39], v[20:23], v[144:159]
  buffer_load_dwordx4 v208, s[12:15], s53 offen lds
  ds_read_b64_tr_b16 a[22:23], v201 offset:30720
  ds_read_b64_tr_b16 a[24:25], v202 offset:28672
  s_add_u32 m0, s42, 4096
  v_mfma_f32_32x32x16_bf16 v[160:175], a[40:43], v[20:23], v[160:175]
  buffer_load_dwordx4 v241, s[12:15], s53 offen lds
  ds_read_b64_tr_b16 a[26:27], v202 offset:30720
  ds_read_b64_tr_b16 a[28:29], v203 offset:28672
  s_add_u32 m0, s42, 8192
  v_mfma_f32_32x32x16_bf16 v[176:191], a[44:47], v[20:23], v[176:191]
  buffer_load_dwordx4 v242, s[12:15], s53 offen lds
  ds_read_b64_tr_b16 a[30:31], v203 offset:30720
  s_waitcnt vmcnt(29) lgkmcnt(0)
  s_barrier
  v_mfma_f32_32x32x16_bf16 v[128:143], a[0:3], v[24:27], v[128:143]
  ds_read_b64_tr_b16 a[32:33], v200 offset:32768
  ds_read_b64_tr_b16 a[34:35], v200 offset:34816
  ds_read_b64_tr_b16 a[36:37], v201 offset:32768
  s_add_u32 m0, s42, 12288
  v_mfma_f32_32x32x16_bf16 v[144:159], a[4:7], v[24:27], v[144:159]
  buffer_load_dwordx4 v243, s[12:15], s53 offen lds
  ds_read_b64_tr_b16 a[38:39], v201 offset:34816
  ds_read_b64_tr_b16 a[40:41], v202 offset:32768
  v_mfma_f32_32x32x16_bf16 v[160:175], a[8:11], v[24:27], v[160:175]
  buffer_load_dwordx4 v[108:111], v209, s[16:19], s54 offen offset:3072 sc1
  ds_read_b64_tr_b16 a[42:43], v202 offset:34816
  ds_read_b64_tr_b16 a[44:45], v203 offset:32768
  s_add_u32 s54, s45, 28672
  v_mfma_f32_32x32x16_bf16 v[176:191], a[12:15], v[24:27], v[176:191]
  buffer_load_dwordx4 v[112:115], v209, s[16:19], s54 offen offset:0 sc1
  ds_read_b64_tr_b16 a[46:47], v203 offset:34816
  s_waitcnt vmcnt(31)
  v_mfma_f32_32x32x16_bf16 v[128:143], a[16:19], v[28:31], v[128:143]
  ds_read_b64_tr_b16 a[0:1], v200 offset:36864
  ds_read_b64_tr_b16 a[2:3], v200 offset:38912
  ds_read_b64_tr_b16 a[4:5], v201 offset:36864
  v_mfma_f32_32x32x16_bf16 v[144:159], a[20:23], v[28:31], v[144:159]
  buffer_load_dwordx4 v[116:119], v209, s[16:19], s54 offen offset:1024 sc1
  ds_read_b64_tr_b16 a[6:7], v201 offset:38912
  ds_read_b64_tr_b16 a[8:9], v202 offset:36864
  v_mfma_f32_32x32x16_bf16 v[160:175], a[24:27], v[28:31], v[160:175]
  buffer_load_dwordx4 v[120:123], v209, s[16:19], s54 offen offset:2048 sc1
  ds_read_b64_tr_b16 a[10:11], v202 offset:38912
  ds_read_b64_tr_b16 a[12:13], v203 offset:36864
  s_add_u32 m0, s42, 16384
  s_add_u32 s53, s41, 589824
  v_mfma_f32_32x32x16_bf16 v[176:191], a[28:31], v[28:31], v[176:191]
  buffer_load_dwordx4 v208, s[12:15], s53 offen lds
  ds_read_b64_tr_b16 a[14:15], v203 offset:38912
  s_waitcnt vmcnt(33) lgkmcnt(8)
  v_mfma_f32_32x32x16_bf16 v[128:143], a[32:35], v[32:35], v[128:143]
  ds_read_b64_tr_b16 a[16:17], v200 offset:40960
  ds_read_b64_tr_b16 a[18:19], v200 offset:43008
  ds_read_b64_tr_b16 a[20:21], v201 offset:40960
  s_add_u32 m0, s42, 20480
  v_mfma_f32_32x32x16_bf16 v[144:159], a[36:39], v[32:35], v[144:159]
  buffer_load_dwordx4 v241, s[12:15], s53 offen lds
  ds_read_b64_tr_b16 a[22:23], v201 offset:43008
  ds_read_b64_tr_b16 a[24:25], v202 offset:40960
  s_add_u32 m0, s42, 24576
  v_mfma_f32_32x32x16_bf16 v[160:175], a[40:43], v[32:35], v[160:175]
  buffer_load_dwordx4 v242, s[12:15], s53 offen lds
  ds_read_b64_tr_b16 a[26:27], v202 offset:43008
  ds_read_b64_tr_b16 a[28:29], v203 offset:40960
  s_add_u32 m0, s42, 28672
  v_mfma_f32_32x32x16_bf16 v[176:191], a[44:47], v[32:35], v[176:191]
  buffer_load_dwordx4 v243, s[12:15], s53 offen lds
  ds_read_b64_tr_b16 a[30:31], v203 offset:43008
  s_waitcnt vmcnt(35) lgkmcnt(8)
  v_mfma_f32_32x32x16_bf16 v[128:143], a[0:3], v[36:39], v[128:143]
  ds_read_b64_tr_b16 a[32:33], v200 offset:45056
  ds_read_b64_tr_b16 a[34:35], v200 offset:47104
  ds_read_b64_tr_b16 a[36:37], v201 offset:45056
  v_mfma_f32_32x32x16_bf16 v[144:159], a[4:7], v[36:39], v[144:159]
  buffer_load_dwordx4 v[124:127], v209, s[16:19], s54 offen offset:3072 sc1
  ds_read_b64_tr_b16 a[38:39], v201 offset:47104
  ds_read_b64_tr_b16 a[40:41], v202 offset:45056
  s_add_u32 s54, s45, 32768
  v_mfma_f32_32x32x16_bf16 v[160:175], a[8:11], v[36:39], v[160:175]
  buffer_load_dwordx4 v[0:3], v209, s[16:19], s54 offen offset:0 sc1
  ds_read_b64_tr_b16 a[42:43], v202 offset:47104
  ds_read_b64_tr_b16 a[44:45], v203 offset:45056
  v_mfma_f32_32x32x16_bf16 v[176:191], a[12:15], v[36:39], v[176:191]
  buffer_load_dwordx4 v[4:7], v209, s[16:19], s54 offen offset:1024 sc1
  ds_read_b64_tr_b16 a[46:47], v203 offset:47104
  s_waitcnt vmcnt(37) lgkmcnt(0)
  s_barrier
  v_mfma_f32_32x32x16_bf16 v[128:143], a[16:19], v[40:43], v[128:143]
  ds_read_b64_tr_b16 a[0:1], v200 offset:49152
  ds_read_b64_tr_b16 a[2:3], v200 offset:51200
  ds_read_b64_tr_b16 a[4:5], v201 offset:49152
  v_mfma_f32_32x32x16_bf16 v[144:159], a[20:23], v[40:43], v[144:159]
  buffer_load_dwordx4 v[8:11], v209, s[16:19], s54 offen offset:2048 sc1
  ds_read_b64_tr_b16 a[6:7], v201 offset:51200
  ds_read_b64_tr_b16 a[8:9], v202 offset:49152
  s_add_u32 m0, s42, 32768
  s_add_u32 s53, s41, 655360
  v_mfma_f32_32x32x16_bf16 v[160:175], a[24:27], v[40:43], v[160:175]
  buffer_load_dwordx4 v208, s[12:15], s53 offen lds
  ds_read_b64_tr_b16 a[10:11], v202 offset:51200
  ds_read_b64_tr_b16 a[12:13], v203 offset:49152
  s_add_u32 m0, s42, 36864
  v_mfma_f32_32x32x16_bf16 v[176:191], a[28:31], v[40:43], v[176:191]
  buffer_load_dwordx4 v241, s[12:15], s53 offen lds
  ds_read_b64_tr_b16 a[14:15], v203 offset:51200
  s_waitcnt vmcnt(39)
  v_mfma_f32_32x32x16_bf16 v[128:143], a[32:35], v[44:47], v[128:143]
  ds_read_b64_tr_b16 a[16:17], v200 offset:53248
  ds_read_b64_tr_b16 a[18:19], v200 offset:55296
  ds_read_b64_tr_b16 a[20:21], v201 offset:53248
  s_add_u32 m0, s42, 40960
  v_mfma_f32_32x32x16_bf16 v[144:159], a[36:39], v[44:47], v[144:159]
  buffer_load_dwordx4 v242, s[12:15], s53 offen lds
  ds_read_b64_tr_b16 a[22:23], v201 offset:55296
  ds_read_b64_tr_b16 a[24:25], v202 offset:53248
  s_add_u32 m0, s42, 45056
  v_mfma_f32_32x32x16_bf16 v[160:175], a[40:43], v[44:47], v[160:175]
  buffer_load_dwordx4 v243, s[12:15], s53 offen lds
  ds_read_b64_tr_b16 a[26:27], v202 offset:55296
  ds_read_b64_tr_b16 a[28:29], v203 offset:53248
  v_mfma_f32_32x32x16_bf16 v[176:191], a[44:47], v[44:47], v[176:191]
  buffer_load_dwordx4 v[12:15], v209, s[16:19], s54 offen offset:3072 sc1
  ds_read_b64_tr_b16 a[30:31], v203 offset:55296
  s_waitcnt vmcnt(35) lgkmcnt(8)
  v_mfma_f32_32x32x16_bf16 v[128:143], a[0:3], v[48:51], v[128:143]
  ds_read_b64_tr_b16 a[32:33], v200 offset:57344
  ds_read_b64_tr_b16 a[34:35], v200 offset:59392
  ds_read_b64_tr_b16 a[36:37], v201 offset:57344
  s_add_u32 s54, s45, 36864
  v_mfma_f32_32x32x16_bf16 v[144:159], a[4:7], v[48:51], v[144:159]
  buffer_load_dwordx4 v[16:19], v209, s[16:19], s54 offen offset:0 sc1
  ds_read_b64_tr_b16 a[38:39], v201 offset:59392
  ds_read_b64_tr_b16 a[40:41], v202 offset:57344
  v_mfma_f32_32x32x16_bf16 v[160:175], a[8:11], v[48:51], v[160:175]
  buffer_load_dwordx4 v[20:23], v209, s[16:19], s54 offen offset:1024 sc1
  ds_read_b64_tr_b16 a[42:43], v202 offset:59392
  ds_read_b64_tr_b16 a[44:45], v203 offset:57344
  v_mfma_f32_32x32x16_bf16 v[176:191], a[12:15], v[48:51], v[176:191]
  buffer_load_dwordx4 v[24:27], v209, s[16:19], s54 offen offset:2048 sc1
  ds_read_b64_tr_b16 a[46:47], v203 offset:59392
  s_waitcnt vmcnt(37) lgkmcnt(8)
  v_mfma_f32_32x32x16_bf16 v[128:143], a[16:19], v[52:55], v[128:143]
  ds_read_b64_tr_b16 a[0:1], v200 offset:61440
  ds_read_b64_tr_b16 a[2:3], v200 offset:63488
  ds_read_b64_tr_b16 a[4:5], v201 offset:61440
  v_mfma_f32_32x32x16_bf16 v[144:159], a[20:23], v[52:55], v[144:159]
  buffer_load_dwordx4 v[28:31], v209, s[16:19], s54 offen offset:3072 sc1
  ds_read_b64_tr_b16 a[6:7], v201 offset:63488
  ds_read_b64_tr_b16 a[8:9], v202 offset:61440
  s_add_u32 s54, s45, 40960
  v_mfma_f32_32x32x16_bf16 v[160:175], a[24:27], v[52:55], v[160:175]
  buffer_load_dwordx4 v[32:35], v209, s[16:19], s54 offen offset:0 sc1
  ds_read_b64_tr_b16 a[10:11], v202 offset:63488
  ds_read_b64_tr_b16 a[12:13], v203 offset:61440
  v_mfma_f32_32x32x16_bf16 v[176:191], a[28:31], v[52:55], v[176:191]
  buffer_load_dwordx4 v[36:39], v209, s[16:19], s54 offen offset:1024 sc1
  ds_read_b64_tr_b16 a[14:15], v203 offset:63488
  s_waitcnt vmcnt(39) lgkmcnt(0)
  s_barrier
  v_mfma_f32_32x32x16_bf16 v[128:143], a[32:35], v[56:59], v[128:143]
  ds_read_b64_tr_b16 a[16:17], v204 offset:0
  ds_read_b64_tr_b16 a[18:19], v204 offset:2048
  ds_read_b64_tr_b16 a[20:21], v205 offset:0
  s_add_u32 m0, s42, 49152
  s_add_u32 s53, s41, 720896
  v_mfma_f32_32x32x16_bf16 v[144:159], a[36:39], v[56:59], v[144:159]
  buffer_load_dwordx4 v208, s[12:15], s53 offen lds
  ds_read_b64_tr_b16 a[22:23], v205 offset:2048
  ds_read_b64_tr_b16 a[24:25], v206 offset:0
  s_add_u32 m0, s42, 53248
  v_mfma_f32_32x32x16_bf16 v[160:175], a[40:43], v[56:59], v[160:175]
  buffer_load_dwordx4 v241, s[12:15], s53 offen lds
  ds_read_b64_tr_b16 a[26:27], v206 offset:2048
  ds_read_b64_tr_b16 a[28:29], v207 offset:0
  s_add_u32 m0, s42, 57344
  v_mfma_f32_32x32x16_bf16 v[176:191], a[44:47], v[56:59], v[176:191]
  buffer_load_dwordx4 v242, s[12:15], s53 offen lds
  ds_read_b64_tr_b16 a[30:31], v207 offset:2048
  s_waitcnt vmcnt(41)
  v_mfma_f32_32x32x16_bf16 v[128:143], a[0:3], v[60:63], v[128:143]
  ds_read_b64_tr_b16 a[32:33], v204 offset:4096
  ds_read_b64_tr_b16 a[34:35], v204 offset:6144
  ds_read_b64_tr_b16 a[36:37], v205 offset:4096
  s_add_u32 m0, s42, 61440
  v_mfma_f32_32x32x16_bf16 v[144:159], a[4:7], v[60:63], v[144:159]
  buffer_load_dwordx4 v243, s[12:15], s53 offen lds
  ds_read_b64_tr_b16 a[38:39], v205 offset:6144
  ds_read_b64_tr_b16 a[40:41], v206 offset:4096
  v_mfma_f32_32x32x16_bf16 v[160:175], a[8:11], v[60:63], v[160:175]
  buffer_load_dwordx4 v[40:43], v209, s[16:19], s54 offen offset:2048 sc1
  ds_read_b64_tr_b16 a[42:43], v206 offset:6144
  ds_read_b64_tr_b16 a[44:45], v207 offset:4096
  v_mfma_f32_32x32x16_bf16 v[176:191], a[12:15], v[60:63], v[176:191]
  buffer_load_dwordx4 v[44:47], v209, s[16:19], s54 offen offset:3072 sc1
  ds_read_b64_tr_b16 a[46:47], v207 offset:6144
  s_waitcnt vmcnt(43) lgkmcnt(8)
  v_mfma_f32_32x32x16_bf16 v[128:143], a[16:19], v[64:67], v[128:143]
  ds_read_b64_tr_b16 a[0:1], v204 offset:8192
  ds_read_b64_tr_b16 a[2:3], v204 offset:10240
  ds_read_b64_tr_b16 a[4:5], v205 offset:8192
  s_add_u32 s54, s45, 45056
  v_mfma_f32_32x32x16_bf16 v[144:159], a[20:23], v[64:67], v[144:159]
  buffer_load_dwordx4 v[48:51], v209, s[16:19], s54 offen offset:0 sc1
  ds_read_b64_tr_b16 a[6:7], v205 offset:10240
  ds_read_b64_tr_b16 a[8:9], v206 offset:8192
  v_mfma_f32_32x32x16_bf16 v[160:175], a[24:27], v[64:67], v[160:175]
  buffer_load_dwordx4 v[52:55], v209, s[16:19], s54 offen offset:1024 sc1
  ds_read_b64_tr_b16 a[10:11], v206 offset:10240
  ds_read_b64_tr_b16 a[12:13], v207 offset:8192
  v_mfma_f32_32x32x16_bf16 v[176:191], a[28:31], v[64:67], v[176:191]
  buffer_load_dwordx4 v[56:59], v209, s[16:19], s54 offen offset:2048 sc1
  ds_read_b64_tr_b16 a[14:15], v207 offset:10240
  s_waitcnt vmcnt(45) lgkmcnt(8)
  v_mfma_f32_32x32x16_bf16 v[128:143], a[32:35], v[68:71], v[128:143]
  ds_read_b64_tr_b16 a[16:17], v204 offset:12288
  ds_read_b64_tr_b16 a[18:19], v204 offset:14336
  ds_read_b64_tr_b16 a[20:21], v205 offset:12288
  v_mfma_f32_32x32x16_bf16 v[144:159], a[36:39], v[68:71], v[144:159]
  ds_read_b64_tr_b16 a[22:23], v205 offset:14336
  ds_read_b64_tr_b16 a[24:25], v206 offset:12288
  ds_read_b64_tr_b16 a[26:27], v206 offset:14336
  v_mfma_f32_32x32x16_bf16 v[160:175], a[40:43], v[68:71], v[160:175]
  buffer_load_dwordx4 v[60:63], v209, s[16:19], s54 offen offset:3072 sc1
  ds_read_b64_tr_b16 a[28:29], v207 offset:12288
  s_add_u32 s54, s45, 49152
  v_mfma_f32_32x32x16_bf16 v[176:191], a[44:47], v[68:71], v[176:191]
  buffer_load_dwordx4 v[64:67], v209, s[16:19], s54 offen offset:0 sc1
  ds_read_b64_tr_b16 a[30:31], v207 offset:14336
  s_waitcnt vmcnt(46) lgkmcnt(0)
  s_barrier
  v_mfma_f32_32x32x16_bf16 v[128:143], a[0:3], v[72:75], v[128:143]
  ds_read_b64_tr_b16 a[32:33], v204 offset:16384
  ds_read_b64_tr_b16 a[34:35], v204 offset:18432
  ds_read_b64_tr_b16 a[36:37], v205 offset:16384
  s_add_u32 m0, s42, 65536
  s_add_u32 s53, s41, 786432
  v_mfma_f32_32x32x16_bf16 v[144:159], a[4:7], v[72:75], v[144:159]
  buffer_load_dwordx4 v208, s[12:15], s53 offen lds
  ds_read_b64_tr_b16 a[38:39], v205 offset:18432
  ds_read_b64_tr_b16 a[40:41], v206 offset:16384
  s_add_u32 m0, s42, 69632
  v_mfma_f32_32x32x16_bf16 v[160:175], a[8:11], v[72:75], v[160:175]
  buffer_load_dwordx4 v241, s[12:15], s53 offen lds
  ds_read_b64_tr_b16 a[42:43], v206 offset:18432
  ds_read_b64_tr_b16 a[44:45], v207 offset:16384
  s_add_u32 m0, s42, 73728
  v_mfma_f32_32x32x16_bf16 v[176:191], a[12:15], v[72:75], v[176:191]
  buffer_load_dwordx4 v242, s[12:15], s53 offen lds
  ds_read_b64_tr_b16 a[46:47], v207 offset:18432
  s_waitcnt vmcnt(48)
  v_mfma_f32_32x32x16_bf16 v[128:143], a[16:19], v[76:79], v[128:143]
  ds_read_b64_tr_b16 a[0:1], v204 offset:20480
  ds_read_b64_tr_b16 a[2:3], v204 offset:22528
  ds_read_b64_tr_b16 a[4:5], v205 offset:20480
  s_add_u32 m0, s42, 77824
  v_mfma_f32_32x32x16_bf16 v[144:159], a[20:23], v[76:79], v[144:159]
  buffer_load_dwordx4 v243, s[12:15], s53 offen lds
  ds_read_b64_tr_b16 a[6:7], v205 offset:22528
  ds_read_b64_tr_b16 a[8:9], v206 offset:20480
  v_mfma_f32_32x32x16_bf16 v[160:175], a[24:27], v[76:79], v[160:175]
  buffer_load_dwordx4 v[68:71], v209, s[16:19], s54 offen offset:1024 sc1
  ds_read_b64_tr_b16 a[10:11], v206 offset:22528
  ds_read_b64_tr_b16 a[12:13], v207 offset:20480
  v_mfma_f32_32x32x16_bf16 v[176:191], a[28:31], v[76:79], v[176:191]
  buffer_load_dwordx4 v[72:75], v209, s[16:19], s54 offen offset:2048 sc1
  ds_read_b64_tr_b16 a[14:15], v207 offset:22528
  s_waitcnt vmcnt(50) lgkmcnt(8)
  v_mfma_f32_32x32x16_bf16 v[128:143], a[32:35], v[80:83], v[128:143]
  ds_read_b64_tr_b16 a[16:17], v204 offset:24576
  ds_read_b64_tr_b16 a[18:19], v204 offset:26624
  ds_read_b64_tr_b16 a[20:21], v205 offset:24576
  v_mfma_f32_32x32x16_bf16 v[144:159], a[36:39], v[80:83], v[144:159]
  ds_read_b64_tr_b16 a[22:23], v205 offset:26624
  ds_read_b64_tr_b16 a[24:25], v206 offset:24576
  v_mfma_f32_32x32x16_bf16 v[160:175], a[40:43], v[80:83], v[160:175]
  ds_read_b64_tr_b16 a[26:27], v206 offset:26624
  ds_read_b64_tr_b16 a[28:29], v207 offset:24576
  v_mfma_f32_32x32x16_bf16 v[176:191], a[44:47], v[80:83], v[176:191]
  buffer_load_dwordx4 v[76:79], v209, s[16:19], s54 offen offset:3072 sc1
  ds_read_b64_tr_b16 a[30:31], v207 offset:26624
  s_waitcnt vmcnt(50) lgkmcnt(8)
  v_mfma_f32_32x32x16_bf16 v[128:143], a[0:3], v[84:87], v[128:143]
  ds_read_b64_tr_b16 a[32:33], v204 offset:28672
  ds_read_b64_tr_b16 a[34:35], v204 offset:30720
  ds_read_b64_tr_b16 a[36:37], v205 offset:28672
  v_mfma_f32_32x32x16_bf16 v[144:159], a[4:7], v[84:87], v[144:159]
  ds_read_b64_tr_b16 a[38:39], v205 offset:30720
  ds_read_b64_tr_b16 a[40:41], v206 offset:28672
  v_mfma_f32_32x32x16_bf16 v[160:175], a[8:11], v[84:87], v[160:175]
  ds_read_b64_tr_b16 a[42:43], v206 offset:30720
  ds_read_b64_tr_b16 a[44:45], v207 offset:28672
  s_add_u32 s54, s45, 53248
  v_mfma_f32_32x32x16_bf16 v[176:191], a[12:15], v[84:87], v[176:191]
  buffer_load_dwordx4 v[80:83], v209, s[16:19], s54 offen offset:0 sc1
  ds_read_b64_tr_b16 a[46:47], v207 offset:30720
  s_waitcnt vmcnt(50) lgkmcnt(0)
  s_barrier
  v_mfma_f32_32x32x16_bf16 v[128:143], a[16:19], v[88:91], v[128:143]
  ds_read_b64_tr_b16 a[0:1], v204 offset:32768
  ds_read_b64_tr_b16 a[2:3], v204 offset:34816
  ds_read_b64_tr_b16 a[4:5], v205 offset:32768
  s_add_u32 m0, s42, 81920
  s_add_u32 s53, s41, 851968
  v_mfma_f32_32x32x16_bf16 v[144:159], a[20:23], v[88:91], v[144:159]
  buffer_load_dwordx4 v208, s[12:15], s53 offen lds
  ds_read_b64_tr_b16 a[6:7], v205 offset:34816
  ds_read_b64_tr_b16 a[8:9], v206 offset:32768
  s_add_u32 m0, s42, 86016
  v_mfma_f32_32x32x16_bf16 v[160:175], a[24:27], v[88:91], v[160:175]
  buffer_load_dwordx4 v241, s[12:15], s53 offen lds
  ds_read_b64_tr_b16 a[10:11], v206 offset:34816
  ds_read_b64_tr_b16 a[12:13], v207 offset:32768
  s_add_u32 m0, s42, 90112
  v_mfma_f32_32x32x16_bf16 v[176:191], a[28:31], v[88:91], v[176:191]
  buffer_load_dwordx4 v242, s[12:15], s53 offen lds
  ds_read_b64_tr_b16 a[14:15], v207 offset:34816
  s_waitcnt vmcnt(52)
  v_mfma_f32_32x32x16_bf16 v[128:143], a[32:35], v[92:95], v[128:143]
  ds_read_b64_tr_b16 a[16:17], v204 offset:36864
  ds_read_b64_tr_b16 a[18:19], v204 offset:38912
  ds_read_b64_tr_b16 a[20:21], v205 offset:36864
  s_add_u32 m0, s42, 94208
  v_mfma_f32_32x32x16_bf16 v[144:159], a[36:39], v[92:95], v[144:159]
  buffer_load_dwordx4 v243, s[12:15], s53 offen lds
  ds_read_b64_tr_b16 a[22:23], v205 offset:38912
  ds_read_b64_tr_b16 a[24:25], v206 offset:36864
  v_mfma_f32_32x32x16_bf16 v[160:175], a[40:43], v[92:95], v[160:175]
  buffer_load_dwordx4 v[84:87], v209, s[16:19], s54 offen offset:1024 sc1
  ds_read_b64_tr_b16 a[26:27], v206 offset:38912
  ds_read_b64_tr_b16 a[28:29], v207 offset:36864
  v_mfma_f32_32x32x16_bf16 v[176:191], a[44:47], v[92:95], v[176:191]
  buffer_load_dwordx4 v[88:91], v209, s[16:19], s54 offen offset:2048 sc1
  ds_read_b64_tr_b16 a[30:31], v207 offset:38912
  s_waitcnt vmcnt(54) lgkmcnt(8)
  v_mfma_f32_32x32x16_bf16 v[128:143], a[0:3], v[96:99], v[128:143]
  ds_read_b64_tr_b16 a[32:33], v204 offset:40960
  ds_read_b64_tr_b16 a[34:35], v204 offset:43008
  ds_read_b64_tr_b16 a[36:37], v205 offset:40960
  v_mfma_f32_32x32x16_bf16 v[144:159], a[4:7], v[96:99], v[144:159]
  ds_read_b64_tr_b16 a[38:39], v205 offset:43008
  ds_read_b64_tr_b16 a[40:41], v206 offset:40960
  v_mfma_f32_32x32x16_bf16 v[160:175], a[8:11], v[96:99], v[160:175]
  ds_read_b64_tr_b16 a[42:43], v206 offset:43008
  ds_read_b64_tr_b16 a[44:45], v207 offset:40960
  v_mfma_f32_32x32x16_bf16 v[176:191], a[12:15], v[96:99], v[176:191]
  buffer_load_dwordx4 v[92:95], v209, s[16:19], s54 offen offset:3072 sc1
  ds_read_b64_tr_b16 a[46:47], v207 offset:43008
  s_waitcnt vmcnt(54) lgkmcnt(8)
  v_mfma_f32_32x32x16_bf16 v[128:143], a[16:19], v[100:103], v[128:143]
  ds_read_b64_tr_b16 a[0:1], v204 offset:45056
  ds_read_b64_tr_b16 a[2:3], v204 offset:47104
  ds_read_b64_tr_b16 a[4:5], v205 offset:45056
  v_mfma_f32_32x32x16_bf16 v[144:159], a[20:23], v[100:103], v[144:159]
  ds_read_b64_tr_b16 a[6:7], v205 offset:47104
  ds_read_b64_tr_b16 a[8:9], v206 offset:45056
  v_mfma_f32_32x32x16_bf16 v[160:175], a[24:27], v[100:103], v[160:175]
  ds_read_b64_tr_b16 a[10:11], v206 offset:47104
  ds_read_b64_tr_b16 a[12:13], v207 offset:45056
  s_add_u32 s54, s45, 57344
  v_mfma_f32_32x32x16_bf16 v[176:191], a[28:31], v[100:103], v[176:191]
  buffer_load_dwordx4 v[96:99], v209, s[16:19], s54 offen offset:0 sc1
  ds_read_b64_tr_b16 a[14:15], v207 offset:47104
  s_waitcnt vmcnt(54) lgkmcnt(0)
  s_barrier
  v_mfma_f32_32x32x16_bf16 v[128:143], a[32:35], v[104:107], v[128:143]
  ds_read_b64_tr_b16 a[16:17], v204 offset:49152
  ds_read_b64_tr_b16 a[18:19], v204 offset:51200
  ds_read_b64_tr_b16 a[20:21], v205 offset:49152
  s_add_u32 m0, s42, 98304
  s_add_u32 s53, s41, 917504
  v_mfma_f32_32x32x16_bf16 v[144:159], a[36:39], v[104:107], v[144:159]
  buffer_load_dwordx4 v208, s[12:15], s53 offen lds
  ds_read_b64_tr_b16 a[22:23], v205 offset:51200
  ds_read_b64_tr_b16 a[24:25], v206 offset:49152
  s_add_u32 m0, s42, 102400
  v_mfma_f32_32x32x16_bf16 v[160:175], a[40:43], v[104:107], v[160:175]
  buffer_load_dwordx4 v241, s[12:15], s53 offen lds
  ds_read_b64_tr_b16 a[26:27], v206 offset:51200
  ds_read_b64_tr_b16 a[28:29], v207 offset:49152
  s_add_u32 m0, s42, 106496
  v_mfma_f32_32x32x16_bf16 v[176:191], a[44:47], v[104:107], v[176:191]
  buffer_load_dwordx4 v242, s[12:15], s53 offen lds
  ds_read_b64_tr_b16 a[30:31], v207 offset:51200
  s_waitcnt vmcnt(52)
  v_mfma_f32_32x32x16_bf16 v[128:143], a[0:3], v[108:111], v[128:143]
  ds_read_b64_tr_b16 a[32:33], v204 offset:53248
  ds_read_b64_tr_b16 a[34:35], v204 offset:55296
  ds_read_b64_tr_b16 a[36:37], v205 offset:53248
  s_add_u32 m0, s42, 110592
  v_mfma_f32_32x32x16_bf16 v[144:159], a[4:7], v[108:111], v[144:159]
  buffer_load_dwordx4 v243, s[12:15], s53 offen lds
  ds_read_b64_tr_b16 a[38:39], v205 offset:55296
  ds_read_b64_tr_b16 a[40:41], v206 offset:53248
  v_mfma_f32_32x32x16_bf16 v[160:175], a[8:11], v[108:111], v[160:175]
  buffer_load_dwordx4 v[100:103], v209, s[16:19], s54 offen offset:1024 sc1
  ds_read_b64_tr_b16 a[42:43], v206 offset:55296
  ds_read_b64_tr_b16 a[44:45], v207 offset:53248
  v_mfma_f32_32x32x16_bf16 v[176:191], a[12:15], v[108:111], v[176:191]
  buffer_load_dwordx4 v[104:107], v209, s[16:19], s54 offen offset:2048 sc1
  ds_read_b64_tr_b16 a[46:47], v207 offset:55296
  s_waitcnt vmcnt(54) lgkmcnt(8)
  v_mfma_f32_32x32x16_bf16 v[128:143], a[16:19], v[112:115], v[128:143]
  ds_read_b64_tr_b16 a[0:1], v204 offset:57344
  ds_read_b64_tr_b16 a[2:3], v204 offset:59392
  ds_read_b64_tr_b16 a[4:5], v205 offset:57344
  v_mfma_f32_32x32x16_bf16 v[144:159], a[20:23], v[112:115], v[144:159]
  ds_read_b64_tr_b16 a[6:7], v205 offset:59392
  ds_read_b64_tr_b16 a[8:9], v206 offset:57344
  v_mfma_f32_32x32x16_bf16 v[160:175], a[24:27], v[112:115], v[160:175]
  ds_read_b64_tr_b16 a[10:11], v206 offset:59392
  ds_read_b64_tr_b16 a[12:13], v207 offset:57344
  v_mfma_f32_32x32x16_bf16 v[176:191], a[28:31], v[112:115], v[176:191]
  buffer_load_dwordx4 v[108:111], v209, s[16:19], s54 offen offset:3072 sc1
  ds_read_b64_tr_b16 a[14:15], v207 offset:59392
  s_waitcnt vmcnt(54) lgkmcnt(8)
  v_mfma_f32_32x32x16_bf16 v[128:143], a[32:35], v[116:119], v[128:143]
  ds_read_b64_tr_b16 a[16:17], v204 offset:61440
  ds_read_b64_tr_b16 a[18:19], v204 offset:63488
  ds_read_b64_tr_b16 a[20:21], v205 offset:61440
  v_mfma_f32_32x32x16_bf16 v[144:159], a[36:39], v[116:119], v[144:159]
  ds_read_b64_tr_b16 a[22:23], v205 offset:63488
  ds_read_b64_tr_b16 a[24:25], v206 offset:61440
  v_mfma_f32_32x32x16_bf16 v[160:175], a[40:43], v[116:119], v[160:175]
  ds_read_b64_tr_b16 a[26:27], v206 offset:63488
  ds_read_b64_tr_b16 a[28:29], v207 offset:61440
  s_add_u32 s54, s45, 61440
  v_mfma_f32_32x32x16_bf16 v[176:191], a[44:47], v[116:119], v[176:191]
  buffer_load_dwordx4 v[112:115], v209, s[16:19], s54 offen offset:0 sc1
  ds_read_b64_tr_b16 a[30:31], v207 offset:63488
  s_waitcnt vmcnt(54) lgkmcnt(0)
  s_barrier
  v_mfma_f32_32x32x16_bf16 v[128:143], a[0:3], v[120:123], v[128:143]
  ds_read_b64_tr_b16 a[32:33], v200 offset:0
  ds_read_b64_tr_b16 a[34:35], v200 offset:2048
  ds_read_b64_tr_b16 a[36:37], v201 offset:0
  s_add_u32 m0, s42, 114688
  s_add_u32 s53, s41, 983040
  v_mfma_f32_32x32x16_bf16 v[144:159], a[4:7], v[120:123], v[144:159]
  buffer_load_dwordx4 v208, s[12:15], s53 offen lds
  ds_read_b64_tr_b16 a[38:39], v201 offset:2048
  ds_read_b64_tr_b16 a[40:41], v202 offset:0
  s_add_u32 m0, s42, 118784
  v_mfma_f32_32x32x16_bf16 v[160:175], a[8:11], v[120:123], v[160:175]
  buffer_load_dwordx4 v241, s[12:15], s53 offen lds
  ds_read_b64_tr_b16 a[42:43], v202 offset:2048
  ds_read_b64_tr_b16 a[44:45], v203 offset:0
  s_add_u32 m0, s42, 122880
  v_mfma_f32_32x32x16_bf16 v[176:191], a[12:15], v[120:123], v[176:191]
  buffer_load_dwordx4 v242, s[12:15], s53 offen lds
  ds_read_b64_tr_b16 a[46:47], v203 offset:2048
  s_waitcnt vmcnt(52)
  v_mfma_f32_32x32x16_bf16 v[128:143], a[16:19], v[124:127], v[128:143]
  ds_read_b64_tr_b16 a[0:1], v200 offset:4096
  ds_read_b64_tr_b16 a[2:3], v200 offset:6144
  ds_read_b64_tr_b16 a[4:5], v201 offset:4096
  s_add_u32 m0, s42, 126976
  v_mfma_f32_32x32x16_bf16 v[144:159], a[20:23], v[124:127], v[144:159]
  buffer_load_dwordx4 v243, s[12:15], s53 offen lds
  ds_read_b64_tr_b16 a[6:7], v201 offset:6144
  ds_read_b64_tr_b16 a[8:9], v202 offset:4096
  v_mfma_f32_32x32x16_bf16 v[160:175], a[24:27], v[124:127], v[160:175]
  buffer_load_dwordx4 v[116:119], v209, s[16:19], s54 offen offset:1024 sc1
  ds_read_b64_tr_b16 a[10:11], v202 offset:6144
  ds_read_b64_tr_b16 a[12:13], v203 offset:4096
  v_mfma_f32_32x32x16_bf16 v[176:191], a[28:31], v[124:127], v[176:191]
  buffer_load_dwordx4 v[120:123], v209, s[16:19], s54 offen offset:2048 sc1
  ds_read_b64_tr_b16 a[14:15], v203 offset:6144
  s_waitcnt vmcnt(54) lgkmcnt(8)
  v_mfma_f32_32x32x16_bf16 v[128:143], a[32:35], v[0:3], v[128:143]
  ds_read_b64_tr_b16 a[16:17], v200 offset:8192
  ds_read_b64_tr_b16 a[18:19], v200 offset:10240
  ds_read_b64_tr_b16 a[20:21], v201 offset:8192
  v_mfma_f32_32x32x16_bf16 v[144:159], a[36:39], v[0:3], v[144:159]
  ds_read_b64_tr_b16 a[22:23], v201 offset:10240
  ds_read_b64_tr_b16 a[24:25], v202 offset:8192
  v_mfma_f32_32x32x16_bf16 v[160:175], a[40:43], v[0:3], v[160:175]
  ds_read_b64_tr_b16 a[26:27], v202 offset:10240
  ds_read_b64_tr_b16 a[28:29], v203 offset:8192
  v_mfma_f32_32x32x16_bf16 v[176:191], a[44:47], v[0:3], v[176:191]
  buffer_load_dwordx4 v[124:127], v209, s[16:19], s54 offen offset:3072 sc1
  ds_read_b64_tr_b16 a[30:31], v203 offset:10240
  s_waitcnt vmcnt(54) lgkmcnt(8)
  v_mfma_f32_32x32x16_bf16 v[128:143], a[0:3], v[4:7], v[128:143]
  ds_read_b64_tr_b16 a[32:33], v200 offset:12288
  ds_read_b64_tr_b16 a[34:35], v200 offset:14336
  v_mfma_f32_32x32x16_bf16 v[144:159], a[4:7], v[4:7], v[144:159]
  ds_read_b64_tr_b16 a[36:37], v201 offset:12288
  ds_read_b64_tr_b16 a[38:39], v201 offset:14336
  v_mfma_f32_32x32x16_bf16 v[160:175], a[8:11], v[4:7], v[160:175]
  ds_read_b64_tr_b16 a[40:41], v202 offset:12288
  ds_read_b64_tr_b16 a[42:43], v202 offset:14336
  v_mfma_f32_32x32x16_bf16 v[176:191], a[12:15], v[4:7], v[176:191]
  ds_read_b64_tr_b16 a[44:45], v203 offset:12288
  ds_read_b64_tr_b16 a[46:47], v203 offset:14336
  s_waitcnt vmcnt(53) lgkmcnt(0)
  s_barrier
  v_mfma_f32_32x32x16_bf16 v[128:143], a[16:19], v[8:11], v[128:143]
  ds_read_b64_tr_b16 a[0:1], v200 offset:16384
  ds_read_b64_tr_b16 a[2:3], v200 offset:18432
  v_mfma_f32_32x32x16_bf16 v[144:159], a[20:23], v[8:11], v[144:159]
  ds_read_b64_tr_b16 a[4:5], v201 offset:16384
  ds_read_b64_tr_b16 a[6:7], v201 offset:18432
  v_mfma_f32_32x32x16_bf16 v[160:175], a[24:27], v[8:11], v[160:175]
  ds_read_b64_tr_b16 a[8:9], v202 offset:16384
  ds_read_b64_tr_b16 a[10:11], v202 offset:18432
  v_mfma_f32_32x32x16_bf16 v[176:191], a[28:31], v[8:11], v[176:191]
  ds_read_b64_tr_b16 a[12:13], v203 offset:16384
  ds_read_b64_tr_b16 a[14:15], v203 offset:18432
  s_waitcnt vmcnt(48)
  v_mfma_f32_32x32x16_bf16 v[128:143], a[32:35], v[12:15], v[128:143]
  ds_read_b64_tr_b16 a[16:17], v200 offset:20480
  ds_read_b64_tr_b16 a[18:19], v200 offset:22528
  v_mfma_f32_32x32x16_bf16 v[144:159], a[36:39], v[12:15], v[144:159]
  ds_read_b64_tr_b16 a[20:21], v201 offset:20480
  ds_read_b64_tr_b16 a[22:23], v201 offset:22528
  v_mfma_f32_32x32x16_bf16 v[160:175], a[40:43], v[12:15], v[160:175]
  ds_read_b64_tr_b16 a[24:25], v202 offset:20480
  ds_read_b64_tr_b16 a[26:27], v202 offset:22528
  v_mfma_f32_32x32x16_bf16 v[176:191], a[44:47], v[12:15], v[176:191]
  ds_read_b64_tr_b16 a[28:29], v203 offset:20480
  ds_read_b64_tr_b16 a[30:31], v203 offset:22528
  s_waitcnt vmcnt(47) lgkmcnt(8)
  v_mfma_f32_32x32x16_bf16 v[128:143], a[0:3], v[16:19], v[128:143]
  ds_read_b64_tr_b16 a[32:33], v200 offset:24576
  ds_read_b64_tr_b16 a[34:35], v200 offset:26624
  v_mfma_f32_32x32x16_bf16 v[144:159], a[4:7], v[16:19], v[144:159]
  ds_read_b64_tr_b16 a[36:37], v201 offset:24576
  ds_read_b64_tr_b16 a[38:39], v201 offset:26624
  v_mfma_f32_32x32x16_bf16 v[160:175], a[8:11], v[16:19], v[160:175]
  ds_read_b64_tr_b16 a[40:41], v202 offset:24576
  ds_read_b64_tr_b16 a[42:43], v202 offset:26624
  v_mfma_f32_32x32x16_bf16 v[176:191], a[12:15], v[16:19], v[176:191]
  ds_read_b64_tr_b16 a[44:45], v203 offset:24576
  ds_read_b64_tr_b16 a[46:47], v203 offset:26624
  s_waitcnt vmcnt(46) lgkmcnt(8)
  v_mfma_f32_32x32x16_bf16 v[128:143], a[16:19], v[20:23], v[128:143]
  ds_read_b64_tr_b16 a[0:1], v200 offset:28672
  ds_read_b64_tr_b16 a[2:3], v200 offset:30720
  v_mfma_f32_32x32x16_bf16 v[144:159], a[20:23], v[20:23], v[144:159]
  ds_read_b64_tr_b16 a[4:5], v201 offset:28672
  ds_read_b64_tr_b16 a[6:7], v201 offset:30720
  v_mfma_f32_32x32x16_bf16 v[160:175], a[24:27], v[20:23], v[160:175]
  ds_read_b64_tr_b16 a[8:9], v202 offset:28672
  ds_read_b64_tr_b16 a[10:11], v202 offset:30720
  v_mfma_f32_32x32x16_bf16 v[176:191], a[28:31], v[20:23], v[176:191]
  ds_read_b64_tr_b16 a[12:13], v203 offset:28672
  ds_read_b64_tr_b16 a[14:15], v203 offset:30720
  s_waitcnt vmcnt(45) lgkmcnt(0)
  s_barrier
  v_mfma_f32_32x32x16_bf16 v[128:143], a[32:35], v[24:27], v[128:143]
  ds_read_b64_tr_b16 a[16:17], v200 offset:32768
  ds_read_b64_tr_b16 a[18:19], v200 offset:34816
  v_mfma_f32_32x32x16_bf16 v[144:159], a[36:39], v[24:27], v[144:159]
  ds_read_b64_tr_b16 a[20:21], v201 offset:32768
  ds_read_b64_tr_b16 a[22:23], v201 offset:34816
  v_mfma_f32_32x32x16_bf16 v[160:175], a[40:43], v[24:27], v[160:175]
  ds_read_b64_tr_b16 a[24:25], v202 offset:32768
  ds_read_b64_tr_b16 a[26:27], v202 offset:34816
  v_mfma_f32_32x32x16_bf16 v[176:191], a[44:47], v[24:27], v[176:191]
  ds_read_b64_tr_b16 a[28:29], v203 offset:32768
  ds_read_b64_tr_b16 a[30:31], v203 offset:34816
  s_waitcnt vmcnt(44)
  v_mfma_f32_32x32x16_bf16 v[128:143], a[0:3], v[28:31], v[128:143]
  ds_read_b64_tr_b16 a[32:33], v200 offset:36864
  ds_read_b64_tr_b16 a[34:35], v200 offset:38912
  v_mfma_f32_32x32x16_bf16 v[144:159], a[4:7], v[28:31], v[144:159]
  ds_read_b64_tr_b16 a[36:37], v201 offset:36864
  ds_read_b64_tr_b16 a[38:39], v201 offset:38912
  v_mfma_f32_32x32x16_bf16 v[160:175], a[8:11], v[28:31], v[160:175]
  ds_read_b64_tr_b16 a[40:41], v202 offset:36864
  ds_read_b64_tr_b16 a[42:43], v202 offset:38912
  v_mfma_f32_32x32x16_bf16 v[176:191], a[12:15], v[28:31], v[176:191]
  ds_read_b64_tr_b16 a[44:45], v203 offset:36864
  ds_read_b64_tr_b16 a[46:47], v203 offset:38912
  s_waitcnt vmcnt(43) lgkmcnt(8)
  v_mfma_f32_32x32x16_bf16 v[128:143], a[16:19], v[32:35], v[128:143]
  ds_read_b64_tr_b16 a[0:1], v200 offset:40960
  ds_read_b64_tr_b16 a[2:3], v200 offset:43008
  v_mfma_f32_32x32x16_bf16 v[144:159], a[20:23], v[32:35], v[144:159]
  ds_read_b64_tr_b16 a[4:5], v201 offset:40960
  ds_read_b64_tr_b16 a[6:7], v201 offset:43008
  v_mfma_f32_32x32x16_bf16 v[160:175], a[24:27], v[32:35], v[160:175]
  ds_read_b64_tr_b16 a[8:9], v202 offset:40960
  ds_read_b64_tr_b16 a[10:11], v202 offset:43008
  v_mfma_f32_32x32x16_bf16 v[176:191], a[28:31], v[32:35], v[176:191]
  ds_read_b64_tr_b16 a[12:13], v203 offset:40960
  ds_read_b64_tr_b16 a[14:15], v203 offset:43008
  s_waitcnt vmcnt(42) lgkmcnt(8)
  v_mfma_f32_32x32x16_bf16 v[128:143], a[32:35], v[36:39], v[128:143]
  ds_read_b64_tr_b16 a[16:17], v200 offset:45056
  ds_read_b64_tr_b16 a[18:19], v200 offset:47104
  v_mfma_f32_32x32x16_bf16 v[144:159], a[36:39], v[36:39], v[144:159]
  ds_read_b64_tr_b16 a[20:21], v201 offset:45056
  ds_read_b64_tr_b16 a[22:23], v201 offset:47104
  v_mfma_f32_32x32x16_bf16 v[160:175], a[40:43], v[36:39], v[160:175]
  ds_read_b64_tr_b16 a[24:25], v202 offset:45056
  ds_read_b64_tr_b16 a[26:27], v202 offset:47104
  v_mfma_f32_32x32x16_bf16 v[176:191], a[44:47], v[36:39], v[176:191]
  ds_read_b64_tr_b16 a[28:29], v203 offset:45056
  ds_read_b64_tr_b16 a[30:31], v203 offset:47104
  s_waitcnt vmcnt(37) lgkmcnt(0)
  s_barrier
  v_mfma_f32_32x32x16_bf16 v[128:143], a[0:3], v[40:43], v[128:143]
  ds_read_b64_tr_b16 a[32:33], v200 offset:49152
  ds_read_b64_tr_b16 a[34:35], v200 offset:51200
  v_mfma_f32_32x32x16_bf16 v[144:159], a[4:7], v[40:43], v[144:159]
  ds_read_b64_tr_b16 a[36:37], v201 offset:49152
  ds_read_b64_tr_b16 a[38:39], v201 offset:51200
  v_mfma_f32_32x32x16_bf16 v[160:175], a[8:11], v[40:43], v[160:175]
  ds_read_b64_tr_b16 a[40:41], v202 offset:49152
  ds_read_b64_tr_b16 a[42:43], v202 offset:51200
  v_mfma_f32_32x32x16_bf16 v[176:191], a[12:15], v[40:43], v[176:191]
  ds_read_b64_tr_b16 a[44:45], v203 offset:49152
  ds_read_b64_tr_b16 a[46:47], v203 offset:51200
  s_waitcnt vmcnt(36)
  v_mfma_f32_32x32x16_bf16 v[128:143], a[16:19], v[44:47], v[128:143]
  ds_read_b64_tr_b16 a[0:1], v200 offset:53248
  ds_read_b64_tr_b16 a[2:3], v200 offset:55296
  v_mfma_f32_32x32x16_bf16 v[144:159], a[20:23], v[44:47], v[144:159]
  ds_read_b64_tr_b16 a[4:5], v201 offset:53248
  ds_read_b64_tr_b16 a[6:7], v201 offset:55296
  v_mfma_f32_32x32x16_bf16 v[160:175], a[24:27], v[44:47], v[160:175]
  ds_read_b64_tr_b16 a[8:9], v202 offset:53248
  ds_read_b64_tr_b16 a[10:11], v202 offset:55296
  v_mfma_f32_32x32x16_bf16 v[176:191], a[28:31], v[44:47], v[176:191]
  ds_read_b64_tr_b16 a[12:13], v203 offset:53248
  ds_read_b64_tr_b16 a[14:15], v203 offset:55296
  s_waitcnt vmcnt(35) lgkmcnt(8)
  v_mfma_f32_32x32x16_bf16 v[128:143], a[32:35], v[48:51], v[128:143]
  ds_read_b64_tr_b16 a[16:17], v200 offset:57344
  ds_read_b64_tr_b16 a[18:19], v200 offset:59392
  v_mfma_f32_32x32x16_bf16 v[144:159], a[36:39], v[48:51], v[144:159]
  ds_read_b64_tr_b16 a[20:21], v201 offset:57344
  ds_read_b64_tr_b16 a[22:23], v201 offset:59392
  v_mfma_f32_32x32x16_bf16 v[160:175], a[40:43], v[48:51], v[160:175]
  ds_read_b64_tr_b16 a[24:25], v202 offset:57344
  ds_read_b64_tr_b16 a[26:27], v202 offset:59392
  v_mfma_f32_32x32x16_bf16 v[176:191], a[44:47], v[48:51], v[176:191]
  ds_read_b64_tr_b16 a[28:29], v203 offset:57344
  ds_read_b64_tr_b16 a[30:31], v203 offset:59392
  s_waitcnt vmcnt(34) lgkmcnt(8)
  v_mfma_f32_32x32x16_bf16 v[128:143], a[0:3], v[52:55], v[128:143]
  ds_read_b64_tr_b16 a[32:33], v200 offset:61440
  ds_read_b64_tr_b16 a[34:35], v200 offset:63488
  v_mfma_f32_32x32x16_bf16 v[144:159], a[4:7], v[52:55], v[144:159]
  ds_read_b64_tr_b16 a[36:37], v201 offset:61440
  ds_read_b64_tr_b16 a[38:39], v201 offset:63488
  v_mfma_f32_32x32x16_bf16 v[160:175], a[8:11], v[52:55], v[160:175]
  ds_read_b64_tr_b16 a[40:41], v202 offset:61440
  ds_read_b64_tr_b16 a[42:43], v202 offset:63488
  v_mfma_f32_32x32x16_bf16 v[176:191], a[12:15], v[52:55], v[176:191]
  ds_read_b64_tr_b16 a[44:45], v203 offset:61440
  ds_read_b64_tr_b16 a[46:47], v203 offset:63488
  s_waitcnt vmcnt(27) lgkmcnt(0)
  s_barrier
  v_mfma_f32_32x32x16_bf16 v[128:143], a[16:19], v[56:59], v[128:143]
  ds_read_b64_tr_b16 a[0:1], v204 offset:0
  ds_read_b64_tr_b16 a[2:3], v204 offset:2048
  v_mfma_f32_32x32x16_bf16 v[144:159], a[20:23], v[56:59], v[144:159]
  ds_read_b64_tr_b16 a[4:5], v205 offset:0
  ds_read_b64_tr_b16 a[6:7], v205 offset:2048
  v_mfma_f32_32x32x16_bf16 v[160:175], a[24:27], v[56:59], v[160:175]
  ds_read_b64_tr_b16 a[8:9], v206 offset:0
  ds_read_b64_tr_b16 a[10:11], v206 offset:2048
  v_mfma_f32_32x32x16_bf16 v[176:191], a[28:31], v[56:59], v[176:191]
  ds_read_b64_tr_b16 a[12:13], v207 offset:0
  ds_read_b64_tr_b16 a[14:15], v207 offset:2048
  v_mfma_f32_32x32x16_bf16 v[128:143], a[32:35], v[60:63], v[128:143]
  ds_read_b64_tr_b16 a[16:17], v204 offset:4096
  ds_read_b64_tr_b16 a[18:19], v204 offset:6144
  v_mfma_f32_32x32x16_bf16 v[144:159], a[36:39], v[60:63], v[144:159]
  ds_read_b64_tr_b16 a[20:21], v205 offset:4096
  ds_read_b64_tr_b16 a[22:23], v205 offset:6144
  v_mfma_f32_32x32x16_bf16 v[160:175], a[40:43], v[60:63], v[160:175]
  ds_read_b64_tr_b16 a[24:25], v206 offset:4096
  ds_read_b64_tr_b16 a[26:27], v206 offset:6144
  v_mfma_f32_32x32x16_bf16 v[176:191], a[44:47], v[60:63], v[176:191]
  ds_read_b64_tr_b16 a[28:29], v207 offset:4096
  ds_read_b64_tr_b16 a[30:31], v207 offset:6144
  s_waitcnt lgkmcnt(8)
  v_mfma_f32_32x32x16_bf16 v[128:143], a[0:3], v[64:67], v[128:143]
  ds_read_b64_tr_b16 a[32:33], v204 offset:8192
  ds_read_b64_tr_b16 a[34:35], v204 offset:10240
  v_mfma_f32_32x32x16_bf16 v[144:159], a[4:7], v[64:67], v[144:159]
  ds_read_b64_tr_b16 a[36:37], v205 offset:8192
  ds_read_b64_tr_b16 a[38:39], v205 offset:10240
  v_mfma_f32_32x32x16_bf16 v[160:175], a[8:11], v[64:67], v[160:175]
  ds_read_b64_tr_b16 a[40:41], v206 offset:8192
  ds_read_b64_tr_b16 a[42:43], v206 offset:10240
  v_mfma_f32_32x32x16_bf16 v[176:191], a[12:15], v[64:67], v[176:191]
  ds_read_b64_tr_b16 a[44:45], v207 offset:8192
  ds_read_b64_tr_b16 a[46:47], v207 offset:10240
  s_waitcnt vmcnt(26) lgkmcnt(8)
  v_mfma_f32_32x32x16_bf16 v[128:143], a[16:19], v[68:71], v[128:143]
  ds_read_b64_tr_b16 a[0:1], v204 offset:12288
  ds_read_b64_tr_b16 a[2:3], v204 offset:14336
  v_mfma_f32_32x32x16_bf16 v[144:159], a[20:23], v[68:71], v[144:159]
  ds_read_b64_tr_b16 a[4:5], v205 offset:12288
  ds_read_b64_tr_b16 a[6:7], v205 offset:14336
  v_mfma_f32_32x32x16_bf16 v[160:175], a[24:27], v[68:71], v[160:175]
  ds_read_b64_tr_b16 a[8:9], v206 offset:12288
  ds_read_b64_tr_b16 a[10:11], v206 offset:14336
  v_mfma_f32_32x32x16_bf16 v[176:191], a[28:31], v[68:71], v[176:191]
  ds_read_b64_tr_b16 a[12:13], v207 offset:12288
  ds_read_b64_tr_b16 a[14:15], v207 offset:14336
  s_waitcnt vmcnt(19) lgkmcnt(0)
  s_barrier
  v_mfma_f32_32x32x16_bf16 v[128:143], a[32:35], v[72:75], v[128:143]
  ds_read_b64_tr_b16 a[16:17], v204 offset:16384
  ds_read_b64_tr_b16 a[18:19], v204 offset:18432
  v_mfma_f32_32x32x16_bf16 v[144:159], a[36:39], v[72:75], v[144:159]
  ds_read_b64_tr_b16 a[20:21], v205 offset:16384
  ds_read_b64_tr_b16 a[22:23], v205 offset:18432
  v_mfma_f32_32x32x16_bf16 v[160:175], a[40:43], v[72:75], v[160:175]
  ds_read_b64_tr_b16 a[24:25], v206 offset:16384
  ds_read_b64_tr_b16 a[26:27], v206 offset:18432
  v_mfma_f32_32x32x16_bf16 v[176:191], a[44:47], v[72:75], v[176:191]
  ds_read_b64_tr_b16 a[28:29], v207 offset:16384
  ds_read_b64_tr_b16 a[30:31], v207 offset:18432
  v_mfma_f32_32x32x16_bf16 v[128:143], a[0:3], v[76:79], v[128:143]
  ds_read_b64_tr_b16 a[32:33], v204 offset:20480
  ds_read_b64_tr_b16 a[34:35], v204 offset:22528
  v_mfma_f32_32x32x16_bf16 v[144:159], a[4:7], v[76:79], v[144:159]
  ds_read_b64_tr_b16 a[36:37], v205 offset:20480
  ds_read_b64_tr_b16 a[38:39], v205 offset:22528
  v_mfma_f32_32x32x16_bf16 v[160:175], a[8:11], v[76:79], v[160:175]
  ds_read_b64_tr_b16 a[40:41], v206 offset:20480
  ds_read_b64_tr_b16 a[42:43], v206 offset:22528
  v_mfma_f32_32x32x16_bf16 v[176:191], a[12:15], v[76:79], v[176:191]
  ds_read_b64_tr_b16 a[44:45], v207 offset:20480
  ds_read_b64_tr_b16 a[46:47], v207 offset:22528
  s_waitcnt lgkmcnt(8)
  v_mfma_f32_32x32x16_bf16 v[128:143], a[16:19], v[80:83], v[128:143]
  ds_read_b64_tr_b16 a[0:1], v204 offset:24576
  ds_read_b64_tr_b16 a[2:3], v204 offset:26624
  v_mfma_f32_32x32x16_bf16 v[144:159], a[20:23], v[80:83], v[144:159]
  ds_read_b64_tr_b16 a[4:5], v205 offset:24576
  ds_read_b64_tr_b16 a[6:7], v205 offset:26624
  v_mfma_f32_32x32x16_bf16 v[160:175], a[24:27], v[80:83], v[160:175]
  ds_read_b64_tr_b16 a[8:9], v206 offset:24576
  ds_read_b64_tr_b16 a[10:11], v206 offset:26624
  v_mfma_f32_32x32x16_bf16 v[176:191], a[28:31], v[80:83], v[176:191]
  ds_read_b64_tr_b16 a[12:13], v207 offset:24576
  ds_read_b64_tr_b16 a[14:15], v207 offset:26624
  s_waitcnt vmcnt(18) lgkmcnt(8)
  v_mfma_f32_32x32x16_bf16 v[128:143], a[32:35], v[84:87], v[128:143]
  ds_read_b64_tr_b16 a[16:17], v204 offset:28672
  ds_read_b64_tr_b16 a[18:19], v204 offset:30720
  v_mfma_f32_32x32x16_bf16 v[144:159], a[36:39], v[84:87], v[144:159]
  ds_read_b64_tr_b16 a[20:21], v205 offset:28672
  ds_read_b64_tr_b16 a[22:23], v205 offset:30720
  v_mfma_f32_32x32x16_bf16 v[160:175], a[40:43], v[84:87], v[160:175]
  ds_read_b64_tr_b16 a[24:25], v206 offset:28672
  ds_read_b64_tr_b16 a[26:27], v206 offset:30720
  v_mfma_f32_32x32x16_bf16 v[176:191], a[44:47], v[84:87], v[176:191]
  ds_read_b64_tr_b16 a[28:29], v207 offset:28672
  ds_read_b64_tr_b16 a[30:31], v207 offset:30720
  s_waitcnt vmcnt(11) lgkmcnt(0)
  s_barrier
  v_mfma_f32_32x32x16_bf16 v[128:143], a[0:3], v[88:91], v[128:143]
  ds_read_b64_tr_b16 a[32:33], v204 offset:32768
  ds_read_b64_tr_b16 a[34:35], v204 offset:34816
  v_mfma_f32_32x32x16_bf16 v[144:159], a[4:7], v[88:91], v[144:159]
  ds_read_b64_tr_b16 a[36:37], v205 offset:32768
  ds_read_b64_tr_b16 a[38:39], v205 offset:34816
  v_mfma_f32_32x32x16_bf16 v[160:175], a[8:11], v[88:91], v[160:175]
  ds_read_b64_tr_b16 a[40:41], v206 offset:32768
  ds_read_b64_tr_b16 a[42:43], v206 offset:34816
  v_mfma_f32_32x32x16_bf16 v[176:191], a[12:15], v[88:91], v[176:191]
  ds_read_b64_tr_b16 a[44:45], v207 offset:32768
  ds_read_b64_tr_b16 a[46:47], v207 offset:34816
  v_mfma_f32_32x32x16_bf16 v[128:143], a[16:19], v[92:95], v[128:143]
  ds_read_b64_tr_b16 a[0:1], v204 offset:36864
  ds_read_b64_tr_b16 a[2:3], v204 offset:38912
  v_mfma_f32_32x32x16_bf16 v[144:159], a[20:23], v[92:95], v[144:159]
  ds_read_b64_tr_b16 a[4:5], v205 offset:36864
  ds_read_b64_tr_b16 a[6:7], v205 offset:38912
  v_mfma_f32_32x32x16_bf16 v[160:175], a[24:27], v[92:95], v[160:175]
  ds_read_b64_tr_b16 a[8:9], v206 offset:36864
  ds_read_b64_tr_b16 a[10:11], v206 offset:38912
  v_mfma_f32_32x32x16_bf16 v[176:191], a[28:31], v[92:95], v[176:191]
  ds_read_b64_tr_b16 a[12:13], v207 offset:36864
  ds_read_b64_tr_b16 a[14:15], v207 offset:38912
  s_waitcnt lgkmcnt(8)
  v_mfma_f32_32x32x16_bf16 v[128:143], a[32:35], v[96:99], v[128:143]
  ds_read_b64_tr_b16 a[16:17], v204 offset:40960
  ds_read_b64_tr_b16 a[18:19], v204 offset:43008
  v_mfma_f32_32x32x16_bf16 v[144:159], a[36:39], v[96:99], v[144:159]
  ds_read_b64_tr_b16 a[20:21], v205 offset:40960
  ds_read_b64_tr_b16 a[22:23], v205 offset:43008
  v_mfma_f32_32x32x16_bf16 v[160:175], a[40:43], v[96:99], v[160:175]
  ds_read_b64_tr_b16 a[24:25], v206 offset:40960
  ds_read_b64_tr_b16 a[26:27], v206 offset:43008
  v_mfma_f32_32x32x16_bf16 v[176:191], a[44:47], v[96:99], v[176:191]
  ds_read_b64_tr_b16 a[28:29], v207 offset:40960
  ds_read_b64_tr_b16 a[30:31], v207 offset:43008
  s_waitcnt vmcnt(10) lgkmcnt(8)
  v_mfma_f32_32x32x16_bf16 v[128:143], a[0:3], v[100:103], v[128:143]
  ds_read_b64_tr_b16 a[32:33], v204 offset:45056
  ds_read_b64_tr_b16 a[34:35], v204 offset:47104
  v_mfma_f32_32x32x16_bf16 v[144:159], a[4:7], v[100:103], v[144:159]
  ds_read_b64_tr_b16 a[36:37], v205 offset:45056
  ds_read_b64_tr_b16 a[38:39], v205 offset:47104
  v_mfma_f32_32x32x16_bf16 v[160:175], a[8:11], v[100:103], v[160:175]
  ds_read_b64_tr_b16 a[40:41], v206 offset:45056
  ds_read_b64_tr_b16 a[42:43], v206 offset:47104
  v_mfma_f32_32x32x16_bf16 v[176:191], a[12:15], v[100:103], v[176:191]
  ds_read_b64_tr_b16 a[44:45], v207 offset:45056
  ds_read_b64_tr_b16 a[46:47], v207 offset:47104
  s_waitcnt vmcnt(3) lgkmcnt(0)
  s_barrier
  v_mfma_f32_32x32x16_bf16 v[128:143], a[16:19], v[104:107], v[128:143]
  ds_read_b64_tr_b16 a[0:1], v204 offset:49152
  ds_read_b64_tr_b16 a[2:3], v204 offset:51200
  v_mfma_f32_32x32x16_bf16 v[144:159], a[20:23], v[104:107], v[144:159]
  ds_read_b64_tr_b16 a[4:5], v205 offset:49152
  ds_read_b64_tr_b16 a[6:7], v205 offset:51200
  v_mfma_f32_32x32x16_bf16 v[160:175], a[24:27], v[104:107], v[160:175]
  ds_read_b64_tr_b16 a[8:9], v206 offset:49152
  ds_read_b64_tr_b16 a[10:11], v206 offset:51200
  v_mfma_f32_32x32x16_bf16 v[176:191], a[28:31], v[104:107], v[176:191]
  ds_read_b64_tr_b16 a[12:13], v207 offset:49152
  ds_read_b64_tr_b16 a[14:15], v207 offset:51200
  v_mfma_f32_32x32x16_bf16 v[128:143], a[32:35], v[108:111], v[128:143]
  ds_read_b64_tr_b16 a[16:17], v204 offset:53248
  ds_read_b64_tr_b16 a[18:19], v204 offset:55296
  v_mfma_f32_32x32x16_bf16 v[144:159], a[36:39], v[108:111], v[144:159]
  ds_read_b64_tr_b16 a[20:21], v205 offset:53248
  ds_read_b64_tr_b16 a[22:23], v205 offset:55296
  v_mfma_f32_32x32x16_bf16 v[160:175], a[40:43], v[108:111], v[160:175]
  ds_read_b64_tr_b16 a[24:25], v206 offset:53248
  ds_read_b64_tr_b16 a[26:27], v206 offset:55296
  v_mfma_f32_32x32x16_bf16 v[176:191], a[44:47], v[108:111], v[176:191]
  ds_read_b64_tr_b16 a[28:29], v207 offset:53248
  ds_read_b64_tr_b16 a[30:31], v207 offset:55296
  s_waitcnt lgkmcnt(8)
  v_mfma_f32_32x32x16_bf16 v[128:143], a[0:3], v[112:115], v[128:143]
  ds_read_b64_tr_b16 a[32:33], v204 offset:57344
  ds_read_b64_tr_b16 a[34:35], v204 offset:59392
  v_mfma_f32_32x32x16_bf16 v[144:159], a[4:7], v[112:115], v[144:159]
  ds_read_b64_tr_b16 a[36:37], v205 offset:57344
  ds_read_b64_tr_b16 a[38:39], v205 offset:59392
  v_mfma_f32_32x32x16_bf16 v[160:175], a[8:11], v[112:115], v[160:175]
  ds_read_b64_tr_b16 a[40:41], v206 offset:57344
  ds_read_b64_tr_b16 a[42:43], v206 offset:59392
  v_mfma_f32_32x32x16_bf16 v[176:191], a[12:15], v[112:115], v[176:191]
  ds_read_b64_tr_b16 a[44:45], v207 offset:57344
  ds_read_b64_tr_b16 a[46:47], v207 offset:59392
  s_waitcnt vmcnt(2) lgkmcnt(8)
  v_mfma_f32_32x32x16_bf16 v[128:143], a[16:19], v[116:119], v[128:143]
  ds_read_b64_tr_b16 a[0:1], v204 offset:61440
  ds_read_b64_tr_b16 a[2:3], v204 offset:63488
  v_mfma_f32_32x32x16_bf16 v[144:159], a[20:23], v[116:119], v[144:159]
  ds_read_b64_tr_b16 a[4:5], v205 offset:61440
  ds_read_b64_tr_b16 a[6:7], v205 offset:63488
  v_mfma_f32_32x32x16_bf16 v[160:175], a[24:27], v[116:119], v[160:175]
  ds_read_b64_tr_b16 a[8:9], v206 offset:61440
  ds_read_b64_tr_b16 a[10:11], v206 offset:63488
  v_mfma_f32_32x32x16_bf16 v[176:191], a[28:31], v[116:119], v[176:191]
  ds_read_b64_tr_b16 a[12:13], v207 offset:61440
  ds_read_b64_tr_b16 a[14:15], v207 offset:63488
  s_waitcnt vmcnt(1) lgkmcnt(8)
  v_mfma_f32_32x32x16_bf16 v[128:143], a[32:35], v[120:123], v[128:143]
  v_mfma_f32_32x32x16_bf16 v[144:159], a[36:39], v[120:123], v[144:159]
  v_mfma_f32_32x32x16_bf16 v[160:175], a[40:43], v[120:123], v[160:175]
  v_mfma_f32_32x32x16_bf16 v[176:191], a[44:47], v[120:123], v[176:191]
  s_waitcnt vmcnt(0) lgkmcnt(0)
  v_mfma_f32_32x32x16_bf16 v[128:143], a[0:3], v[124:127], v[128:143]
  v_mfma_f32_32x32x16_bf16 v[144:159], a[4:7], v[124:127], v[144:159]
  v_mfma_f32_32x32x16_bf16 v[160:175], a[8:11], v[124:127], v[160:175]
  v_mfma_f32_32x32x16_bf16 v[176:191], a[12:15], v[124:127], v[176:191]
  v_add_u32 v210, 139264, v210
  ds_write_b64 v210, v[192:193]
  ds_write_b64 v210, v[196:197] offset:2048
  ds_write_b64 v210, v[194:195] offset:4096
  ds_write_b64 v210, v[198:199] offset:6144
  s_waitcnt lgkmcnt(0)
  s_barrier
  s_nop 2
  s_lshl_b32 s45, s33, 21
  s_lshl_b32 s38, s39, 15
  s_add_u32 s45, s45, s38
  s_lshl_b32 s38, s37, 13
  s_add_u32 s45, s45, s38
  s_add_u32 s38, s45, 0
  v_cvt_pk_bf16_f32 v0, v128, v129
  v_cvt_pk_bf16_f32 v1, v130, v131
  v_cvt_pk_bf16_f32 v2, v132, v133
  v_cvt_pk_bf16_f32 v3, v134, v135
  buffer_store_dwordx4 v[0:3], v209, s[20:23], s38 offen offset:0 sc1
  v_cvt_pk_bf16_f32 v4, v136, v137
  v_cvt_pk_bf16_f32 v5, v138, v139
  v_cvt_pk_bf16_f32 v6, v140, v141
  v_cvt_pk_bf16_f32 v7, v142, v143
  buffer_store_dwordx4 v[4:7], v209, s[20:23], s38 offen offset:1024 sc1
  v_cvt_pk_bf16_f32 v8, v144, v145
  v_cvt_pk_bf16_f32 v9, v146, v147
  v_cvt_pk_bf16_f32 v10, v148, v149
  v_cvt_pk_bf16_f32 v11, v150, v151
  buffer_store_dwordx4 v[8:11], v209, s[20:23], s38 offen offset:2048 sc1
  v_cvt_pk_bf16_f32 v12, v152, v153
  v_cvt_pk_bf16_f32 v13, v154, v155
  v_cvt_pk_bf16_f32 v14, v156, v157
  v_cvt_pk_bf16_f32 v15, v158, v159
  buffer_store_dwordx4 v[12:15], v209, s[20:23], s38 offen offset:3072 sc1
  s_add_u32 s38, s45, 4096
  v_cvt_pk_bf16_f32 v16, v160, v161
  v_cvt_pk_bf16_f32 v17, v162, v163
  v_cvt_pk_bf16_f32 v18, v164, v165
  v_cvt_pk_bf16_f32 v19, v166, v167
  buffer_store_dwordx4 v[16:19], v209, s[20:23], s38 offen offset:0 sc1
  v_cvt_pk_bf16_f32 v20, v168, v169
  v_cvt_pk_bf16_f32 v21, v170, v171
  v_cvt_pk_bf16_f32 v22, v172, v173
  v_cvt_pk_bf16_f32 v23, v174, v175
  buffer_store_dwordx4 v[20:23], v209, s[20:23], s38 offen offset:1024 sc1
  v_cvt_pk_bf16_f32 v24, v176, v177
  v_cvt_pk_bf16_f32 v25, v178, v179
  v_cvt_pk_bf16_f32 v26, v180, v181
  v_cvt_pk_bf16_f32 v27, v182, v183
  buffer_store_dwordx4 v[24:27], v209, s[20:23], s38 offen offset:2048 sc1
  v_cvt_pk_bf16_f32 v28, v184, v185
  v_cvt_pk_bf16_f32 v29, v186, v187
  v_cvt_pk_bf16_f32 v30, v188, v189
  v_cvt_pk_bf16_f32 v31, v190, v191
  buffer_store_dwordx4 v[28:31], v209, s[20:23], s38 offen offset:3072 sc1
  s_lshl_b32 s80, s88, 10
  buffer_store_dwordx4 v[216:219], v214, s[48:51], s80 offen sc1
  buffer_store_dwordx4 v[220:223], v214, s[48:51], s80 offen offset:1024 sc1
  s_add_u32 s74, s36, 48
  s_lshl_b32 s74, s74, 8
  s_and_b32 s75, s2, 7
  s_add_u32 s75, s75, 104
  s_lshl_b32 s75, s75, 8
  s_cmp_ge_u32 s2, 224
  s_cbranch_scc1 NO_DS
  s_load_dwordx2 s[6:7], s[0:1], 48
  s_load_dwordx2 s[8:9], s[0:1], 56
  s_and_b32 s33, s2, 7
  s_lshr_b32 s34, s2, 3
  s_and_b32 s36, s34, 3
  s_lshr_b32 s35, s33, 1
  s_lshl_b32 s35, s35, 2
  s_add_u32 s36, s36, s35
  s_lshr_b32 s37, s34, 2
  s_and_b32 s35, s33, 1
  s_mul_i32 s35, s35, 7
  s_add_u32 s37, s37, s35
  v_lshrrev_b32 v128, 4, v245
  v_lshrrev_b32 v129, 5, v245
  v_and_b32 v130, 1, v128
  v_bfe_u32 v131, v245, 2, 2
  v_and_b32 v132, 3, v245
  v_and_b32 v133, 15, v245
  v_lshlrev_b32 v134, 2, v128
  v_xor_b32 v134, v133, v134
  v_lshlrev_b32 v134, 4, v134
  v_mul_u32_u24 v208, 3584, v128
  v_add_u32 v208, v208, v134
  v_xor_b32 v133, 0, v131
  v_lshlrev_b32 v133, 2, v133
  v_lshlrev_b32 v134, 1, v130
  v_add_u32 v133, v133, v134
  v_lshrrev_b32 v134, 1, v132
  v_add_u32 v134, v133, v134
  v_lshlrev_b32 v134, 4, v134
  v_and_b32 v135, 1, v132
  v_lshlrev_b32 v135, 3, v135
  v_add_u32 v134, v134, v135
  v_lshlrev_b32 v135, 2, v129
  v_add_u32 v135, v135, v131
  v_lshlrev_b32 v135, 8, v135
  v_add_u32 v200, v134, v135
  v_add_u32 v204, 65536, v200
  v_xor_b32 v133, 1, v131
  v_lshlrev_b32 v133, 2, v133
  v_lshlrev_b32 v134, 1, v130
  v_add_u32 v133, v133, v134
  v_lshrrev_b32 v134, 1, v132
  v_add_u32 v134, v133, v134
  v_lshlrev_b32 v134, 4, v134
  v_and_b32 v135, 1, v132
  v_lshlrev_b32 v135, 3, v135
  v_add_u32 v134, v134, v135
  v_lshlrev_b32 v135, 2, v129
  v_add_u32 v135, v135, v131
  v_lshlrev_b32 v135, 8, v135
  v_add_u32 v201, v134, v135
  v_add_u32 v205, 65536, v201
  v_xor_b32 v133, 2, v131
  v_lshlrev_b32 v133, 2, v133
  v_lshlrev_b32 v134, 1, v130
  v_add_u32 v133, v133, v134
  v_lshrrev_b32 v134, 1, v132
  v_add_u32 v134, v133, v134
  v_lshlrev_b32 v134, 4, v134
  v_and_b32 v135, 1, v132
  v_lshlrev_b32 v135, 3, v135
  v_add_u32 v134, v134, v135
  v_lshlrev_b32 v135, 2, v129
  v_add_u32 v135, v135, v131
  v_lshlrev_b32 v135, 8, v135
  v_add_u32 v202, v134, v135
  v_add_u32 v206, 65536, v202
  v_xor_b32 v133, 3, v131
  v_lshlrev_b32 v133, 2, v133
  v_lshlrev_b32 v134, 1, v130
  v_add_u32 v133, v133, v134
  v_lshrrev_b32 v134, 1, v132
  v_add_u32 v134, v133, v134
  v_lshlrev_b32 v134, 4, v134
  v_and_b32 v135, 1, v132
  v_lshlrev_b32 v135, 3, v135
  v_add_u32 v134, v134, v135
  v_lshlrev_b32 v135, 2, v129
  v_add_u32 v135, v135, v131
  v_lshlrev_b32 v135, 8, v135
  v_add_u32 v203, v134, v135
  v_add_u32 v207, 65536, v203
  s_lshl_b32 s39, s36, 2
  s_add_u32 s39, s39, s3
  s_lshl_b32 s41, s37, 8
  s_mul_i32 s38, s3, 14336
  s_add_u32 s41, s41, s38
  s_lshl_b32 s42, s3, 10
  s_lshl_b32 s45, s39, 15
  s_waitcnt lgkmcnt(0)
  s_mov_b32 s12, s6
  s_mov_b32 s13, s7
  s_mov_b32 s14, 1835008
  s_mov_b32 s15, 0x00020000
  s_mov_b32 s16, s8
  s_mov_b32 s17, s9
  s_mov_b32 s18, 1835008
  s_mov_b32 s19, 0x00020000
NO_DS:
  s_load_dwordx2 s[6:7], s[0:1], 0
  v_and_b32 v2, 7, v255
  v_bfe_u32 v3, v255, 3, 1
  v_lshrrev_b32 v4, 4, v255
  s_lshr_b32 s80, s2, 2
  s_and_b32 s81, s2, 3
  s_lshl_b32 s81, s81, 3
  v_lshlrev_b32 v5, 5, v3
  v_add_u32 v5, v5, v2
  v_add_u32 v5, s81, v5
  v_lshlrev_b32 v5, 4, v5
  v_lshlrev_b32 v6, 10, v4
  v_add_u32 v6, v6, v5
  v_lshlrev_b32 v7, 11, v4
  v_add_u32 v7, v7, v5
  v_add_u32 v8, s81, v2
  v_lshlrev_b32 v8, 10, v8
  v_lshlrev_b32 v9, 5, v4
  v_add_u32 v8, v8, v9
  v_lshlrev_b32 v9, 3, v3
  v_add_u32 v8, v8, v9
  v_lshlrev_b32 v10, 3, v255
  s_waitcnt lgkmcnt(0)
  s_add_u32 s20, s4, 50331648
  s_addc_u32 s21, s5, 0
  s_mov_b32 s22, 8388608
  s_mov_b32 s23, 0x00020000
  s_mov_b32 s24, s6
  s_mov_b32 s25, s7
  s_mov_b32 s26, 2097152
  s_mov_b32 s27, 0x00020000
  s_add_u32 s28, s4, 2228224
  s_addc_u32 s29, s5, 0
  s_mov_b32 s30, 65536
  s_mov_b32 s31, 0x00020000
  s_add_u32 s64, s4, 20971520
  s_addc_u32 s65, s5, 0
  s_mov_b32 s66, 2097152
  s_mov_b32 s67, 0x00020000
  s_add_u32 s76, s4, 23068672
  s_addc_u32 s77, s5, 0
  s_mov_b32 s78, 2097152
  s_mov_b32 s79, 0x00020000
  s_lshl_b32 s82, s80, 15
  s_add_u32 s83, s82, 0
  buffer_load_dwordx2 v[112:113], v8, s[24:27], s83 offen
  buffer_load_dwordx2 v[114:115], v8, s[24:27], s83 offen offset:16
  s_add_u32 s83, s82, 512
  buffer_load_dwordx2 v[116:117], v8, s[24:27], s83 offen
  buffer_load_dwordx2 v[118:119], v8, s[24:27], s83 offen offset:16
  v_lshlrev_b32 v12, 6, v4
  v_lshlrev_b32 v13, 4, v3
  v_add_u32 v12, v12, v13
  v_add_u32 v12, 139264, v12
  ds_read_b128 v[120:123], v12 offset:0
  ds_read_b128 v[124:127], v12 offset:32
  ds_read_b128 v[128:131], v12 offset:1024
  ds_read_b128 v[132:135], v12 offset:1056
  ds_read_b128 v[136:139], v12 offset:2048
  ds_read_b128 v[140:143], v12 offset:2080
  ds_read_b128 v[144:147], v12 offset:3072
  ds_read_b128 v[148:151], v12 offset:3104
  ds_read_b128 v[152:155], v12 offset:4096
  ds_read_b128 v[156:159], v12 offset:4128
  ds_read_b128 v[160:163], v12 offset:5120
  ds_read_b128 v[164:167], v12 offset:5152
  s_lshr_b32 s70, s2, 4
  s_add_u32 s70, s70, 48
  s_lshl_b32 s70, s70, 8
  s_waitcnt vmcnt(4)
  s_barrier
  s_cmp_lg_u32 s3, 0
  s_cbranch_scc1 HO_48
  s_mov_b64 exec, 1
  v_mov_b32 v251, 1
  v_mov_b32 v252, s74
  buffer_atomic_add v251, v252, s[60:63], 0 offen sc1
  v_mov_b32 v252, s75
  buffer_atomic_add v251, v252, s[60:63], 0 offen sc1
  s_mov_b64 exec, 1
  v_mov_b32 v252, s70
  s_mov_b32 s68, 0
POLL_51:
  buffer_load_dword v251, v252, s[60:63], 0 offen sc1
  s_waitcnt vmcnt(0)
  v_cmp_le_u32 vcc, 16, v251
  s_add_u32 s68, s68, 1
  s_cmp_eq_u64 vcc, exec
  s_cbranch_scc1 POK_52
  s_cmp_gt_u32 s68, 200000
  s_cbranch_scc1 POK_52
  s_sleep 1
  s_branch POLL_51
POK_52:
  s_mov_b64 exec, -1
  s_branch HW_47
HO_48:
  s_cmp_ge_u32 s2, 224
  s_cbranch_scc1 HW_47
  s_add_u32 m0, s42, 0
  s_add_u32 s38, s41, 0
  buffer_load_dwordx4 v208, s[12:15], s38 offen lds
  s_add_u32 m0, s42, 16384
  s_add_u32 s38, s41, 0
  buffer_load_dwordx4 v208, s[16:19], s38 offen lds
  s_add_u32 m0, s42, 4096
  s_add_u32 s38, s41, 57344
  buffer_load_dwordx4 v208, s[12:15], s38 offen lds
  s_add_u32 m0, s42, 20480
  s_add_u32 s38, s41, 57344
  buffer_load_dwordx4 v208, s[16:19], s38 offen lds
  s_add_u32 m0, s42, 8192
  s_add_u32 s38, s41, 114688
  buffer_load_dwordx4 v208, s[12:15], s38 offen lds
  s_add_u32 m0, s42, 24576
  s_add_u32 s38, s41, 114688
  buffer_load_dwordx4 v208, s[16:19], s38 offen lds
  s_add_u32 m0, s42, 12288
  s_add_u32 s38, s41, 172032
  buffer_load_dwordx4 v208, s[12:15], s38 offen lds
  s_add_u32 m0, s42, 28672
  s_add_u32 s38, s41, 172032
  buffer_load_dwordx4 v208, s[16:19], s38 offen lds
  s_add_u32 m0, s42, 32768
  s_add_u32 s38, s41, 229376
  buffer_load_dwordx4 v208, s[12:15], s38 offen lds
  s_add_u32 m0, s42, 49152
  s_add_u32 s38, s41, 229376
  buffer_load_dwordx4 v208, s[16:19], s38 offen lds
  s_add_u32 m0, s42, 36864
  s_add_u32 s38, s41, 286720
  buffer_load_dwordx4 v208, s[12:15], s38 offen lds
  s_add_u32 m0, s42, 53248
  s_add_u32 s38, s41, 286720
  buffer_load_dwordx4 v208, s[16:19], s38 offen lds
  s_add_u32 m0, s42, 40960
  s_add_u32 s38, s41, 344064
  buffer_load_dwordx4 v208, s[12:15], s38 offen lds
  s_add_u32 m0, s42, 57344
  s_add_u32 s38, s41, 344064
  buffer_load_dwordx4 v208, s[16:19], s38 offen lds
  s_add_u32 m0, s42, 45056
  s_add_u32 s38, s41, 401408
  buffer_load_dwordx4 v208, s[12:15], s38 offen lds
  s_add_u32 m0, s42, 61440
  s_add_u32 s38, s41, 401408
  buffer_load_dwordx4 v208, s[16:19], s38 offen lds
  s_add_u32 m0, s42, 65536
  s_add_u32 s38, s41, 458752
  buffer_load_dwordx4 v208, s[12:15], s38 offen lds
  s_add_u32 m0, s42, 81920
  s_add_u32 s38, s41, 458752
  buffer_load_dwordx4 v208, s[16:19], s38 offen lds
  s_add_u32 m0, s42, 69632
  s_add_u32 s38, s41, 516096
  buffer_load_dwordx4 v208, s[12:15], s38 offen lds
  s_add_u32 m0, s42, 86016
  s_add_u32 s38, s41, 516096
  buffer_load_dwordx4 v208, s[16:19], s38 offen lds
  s_add_u32 m0, s42, 73728
  s_add_u32 s38, s41, 573440
  buffer_load_dwordx4 v208, s[12:15], s38 offen lds
  s_add_u32 m0, s42, 90112
  s_add_u32 s38, s41, 573440
  buffer_load_dwordx4 v208, s[16:19], s38 offen lds
  s_add_u32 m0, s42, 77824
  s_add_u32 s38, s41, 630784
  buffer_load_dwordx4 v208, s[12:15], s38 offen lds
  s_add_u32 m0, s42, 94208
  s_add_u32 s38, s41, 630784
  buffer_load_dwordx4 v208, s[16:19], s38 offen lds
  s_add_u32 m0, s42, 98304
  s_add_u32 s38, s41, 688128
  buffer_load_dwordx4 v208, s[12:15], s38 offen lds
  s_add_u32 m0, s42, 114688
  s_add_u32 s38, s41, 688128
  buffer_load_dwordx4 v208, s[16:19], s38 offen lds
  s_add_u32 m0, s42, 102400
  s_add_u32 s38, s41, 745472
  buffer_load_dwordx4 v208, s[12:15], s38 offen lds
  s_add_u32 m0, s42, 118784
  s_add_u32 s38, s41, 745472
  buffer_load_dwordx4 v208, s[16:19], s38 offen lds
  s_add_u32 m0, s42, 106496
  s_add_u32 s38, s41, 802816
  buffer_load_dwordx4 v208, s[12:15], s38 offen lds
  s_add_u32 m0, s42, 122880
  s_add_u32 s38, s41, 802816
  buffer_load_dwordx4 v208, s[16:19], s38 offen lds
  s_add_u32 m0, s42, 110592
  s_add_u32 s38, s41, 860160
  buffer_load_dwordx4 v208, s[12:15], s38 offen lds
  s_add_u32 m0, s42, 126976
  s_add_u32 s38, s41, 860160
  buffer_load_dwordx4 v208, s[16:19], s38 offen lds
HW_47:
  s_barrier
  s_lshl_b32 s84, s80, 15
  s_add_u32 s83, s84, 0
  buffer_load_dwordx4 v[80:83], v6, s[20:23], s83 offen sc1
  s_add_u32 s83, s84, 2097152
  buffer_load_dwordx4 v[84:87], v6, s[20:23], s83 offen sc1
  s_add_u32 s83, s84, 4194304
  buffer_load_dwordx4 v[88:91], v6, s[20:23], s83 offen sc1
  s_add_u32 s83, s84, 6291456
  buffer_load_dwordx4 v[92:95], v6, s[20:23], s83 offen sc1
  s_add_u32 s83, s84, 16384
  buffer_load_dwordx4 v[96:99], v6, s[20:23], s83 offen sc1
  s_add_u32 s83, s84, 2113536
  buffer_load_dwordx4 v[100:103], v6, s[20:23], s83 offen sc1
  s_add_u32 s83, s84, 4210688
  buffer_load_dwordx4 v[104:107], v6, s[20:23], s83 offen sc1
  s_add_u32 s83, s84, 6307840
  buffer_load_dwordx4 v[108:111], v6, s[20:23], s83 offen sc1
  s_cmp_lg_u32 s3, 0
  s_cbranch_scc1 HL_53
  s_cmp_ge_u32 s2, 224
  s_cbranch_scc1 HL_53
  s_add_u32 m0, s42, 0
  s_add_u32 s38, s41, 0
  buffer_load_dwordx4 v208, s[12:15], s38 offen lds
  s_add_u32 m0, s42, 16384
  s_add_u32 s38, s41, 0
  buffer_load_dwordx4 v208, s[16:19], s38 offen lds
  s_add_u32 m0, s42, 4096
  s_add_u32 s38, s41, 57344
  buffer_load_dwordx4 v208, s[12:15], s38 offen lds
  s_add_u32 m0, s42, 20480
  s_add_u32 s38, s41, 57344
  buffer_load_dwordx4 v208, s[16:19], s38 offen lds
  s_add_u32 m0, s42, 8192
  s_add_u32 s38, s41, 114688
  buffer_load_dwordx4 v208, s[12:15], s38 offen lds
  s_add_u32 m0, s42, 24576
  s_add_u32 s38, s41, 114688
  buffer_load_dwordx4 v208, s[16:19], s38 offen lds
  s_add_u32 m0, s42, 12288
  s_add_u32 s38, s41, 172032
  buffer_load_dwordx4 v208, s[12:15], s38 offen lds
  s_add_u32 m0, s42, 28672
  s_add_u32 s38, s41, 172032
  buffer_load_dwordx4 v208, s[16:19], s38 offen lds
  s_add_u32 m0, s42, 32768
  s_add_u32 s38, s41, 229376
  buffer_load_dwordx4 v208, s[12:15], s38 offen lds
  s_add_u32 m0, s42, 49152
  s_add_u32 s38, s41, 229376
  buffer_load_dwordx4 v208, s[16:19], s38 offen lds
  s_add_u32 m0, s42, 36864
  s_add_u32 s38, s41, 286720
  buffer_load_dwordx4 v208, s[12:15], s38 offen lds
  s_add_u32 m0, s42, 53248
  s_add_u32 s38, s41, 286720
  buffer_load_dwordx4 v208, s[16:19], s38 offen lds
  s_add_u32 m0, s42, 40960
  s_add_u32 s38, s41, 344064
  buffer_load_dwordx4 v208, s[12:15], s38 offen lds
  s_add_u32 m0, s42, 57344
  s_add_u32 s38, s41, 344064
  buffer_load_dwordx4 v208, s[16:19], s38 offen lds
  s_add_u32 m0, s42, 45056
  s_add_u32 s38, s41, 401408
  buffer_load_dwordx4 v208, s[12:15], s38 offen lds
  s_add_u32 m0, s42, 61440
  s_add_u32 s38, s41, 401408
  buffer_load_dwordx4 v208, s[16:19], s38 offen lds
  s_add_u32 m0, s42, 65536
  s_add_u32 s38, s41, 458752
  buffer_load_dwordx4 v208, s[12:15], s38 offen lds
  s_add_u32 m0, s42, 81920
  s_add_u32 s38, s41, 458752
  buffer_load_dwordx4 v208, s[16:19], s38 offen lds
  s_add_u32 m0, s42, 69632
  s_add_u32 s38, s41, 516096
  buffer_load_dwordx4 v208, s[12:15], s38 offen lds
  s_add_u32 m0, s42, 86016
  s_add_u32 s38, s41, 516096
  buffer_load_dwordx4 v208, s[16:19], s38 offen lds
  s_add_u32 m0, s42, 73728
  s_add_u32 s38, s41, 573440
  buffer_load_dwordx4 v208, s[12:15], s38 offen lds
  s_add_u32 m0, s42, 90112
  s_add_u32 s38, s41, 573440
  buffer_load_dwordx4 v208, s[16:19], s38 offen lds
  s_add_u32 m0, s42, 77824
  s_add_u32 s38, s41, 630784
  buffer_load_dwordx4 v208, s[12:15], s38 offen lds
  s_add_u32 m0, s42, 94208
  s_add_u32 s38, s41, 630784
  buffer_load_dwordx4 v208, s[16:19], s38 offen lds
  s_add_u32 m0, s42, 98304
  s_add_u32 s38, s41, 688128
  buffer_load_dwordx4 v208, s[12:15], s38 offen lds
  s_add_u32 m0, s42, 114688
  s_add_u32 s38, s41, 688128
  buffer_load_dwordx4 v208, s[16:19], s38 offen lds
  s_add_u32 m0, s42, 102400
  s_add_u32 s38, s41, 745472
  buffer_load_dwordx4 v208, s[12:15], s38 offen lds
  s_add_u32 m0, s42, 118784
  s_add_u32 s38, s41, 745472
  buffer_load_dwordx4 v208, s[16:19], s38 offen lds
  s_add_u32 m0, s42, 106496
  s_add_u32 s38, s41, 802816
  buffer_load_dwordx4 v208, s[12:15], s38 offen lds
  s_add_u32 m0, s42, 122880
  s_add_u32 s38, s41, 802816
  buffer_load_dwordx4 v208, s[16:19], s38 offen lds
  s_add_u32 m0, s42, 110592
  s_add_u32 s38, s41, 860160
  buffer_load_dwordx4 v208, s[12:15], s38 offen lds
  s_add_u32 m0, s42, 126976
  s_add_u32 s38, s41, 860160
  buffer_load_dwordx4 v208, s[16:19], s38 offen lds
HL_53:
  s_cmp_lg_u32 s3, 0
  s_cbranch_scc1 WP_54
  s_cmp_ge_u32 s2, 224
  s_cbranch_scc1 WP_54
  s_waitcnt vmcnt(32)
  s_branch WP_55
WP_54:
  s_waitcnt vmcnt(0)
WP_55:
  s_waitcnt lgkmcnt(0)
  v_lshlrev_b32 v48, 16, v80
  v_and_b32 v49, 0xffff0000, v80
  v_lshlrev_b32 v40, 16, v84
  v_and_b32 v41, 0xffff0000, v84
  v_pk_add_f32 v[48:49], v[48:49], v[40:41]
  v_lshlrev_b32 v40, 16, v88
  v_and_b32 v41, 0xffff0000, v88
  v_pk_add_f32 v[48:49], v[48:49], v[40:41]
  v_lshlrev_b32 v40, 16, v92
  v_and_b32 v41, 0xffff0000, v92
  v_pk_add_f32 v[48:49], v[48:49], v[40:41]
  v_lshlrev_b32 v50, 16, v81
  v_and_b32 v51, 0xffff0000, v81
  v_lshlrev_b32 v40, 16, v85
  v_and_b32 v41, 0xffff0000, v85
  v_pk_add_f32 v[50:51], v[50:51], v[40:41]
  v_lshlrev_b32 v40, 16, v89
  v_and_b32 v41, 0xffff0000, v89
  v_pk_add_f32 v[50:51], v[50:51], v[40:41]
  v_lshlrev_b32 v40, 16, v93
  v_and_b32 v41, 0xffff0000, v93
  v_pk_add_f32 v[50:51], v[50:51], v[40:41]
  v_lshlrev_b32 v52, 16, v82
  v_and_b32 v53, 0xffff0000, v82
  v_lshlrev_b32 v40, 16, v86
  v_and_b32 v41, 0xffff0000, v86
  v_pk_add_f32 v[52:53], v[52:53], v[40:41]
  v_lshlrev_b32 v40, 16, v90
  v_and_b32 v41, 0xffff0000, v90
  v_pk_add_f32 v[52:53], v[52:53], v[40:41]
  v_lshlrev_b32 v40, 16, v94
  v_and_b32 v41, 0xffff0000, v94
  v_pk_add_f32 v[52:53], v[52:53], v[40:41]
  v_lshlrev_b32 v54, 16, v83
  v_and_b32 v55, 0xffff0000, v83
  v_lshlrev_b32 v40, 16, v87
  v_and_b32 v41, 0xffff0000, v87
  v_pk_add_f32 v[54:55], v[54:55], v[40:41]
  v_lshlrev_b32 v40, 16, v91
  v_and_b32 v41, 0xffff0000, v91
  v_pk_add_f32 v[54:55], v[54:55], v[40:41]
  v_lshlrev_b32 v40, 16, v95
  v_and_b32 v41, 0xffff0000, v95
  v_pk_add_f32 v[54:55], v[54:55], v[40:41]
  v_lshlrev_b32 v80, 16, v96
  v_and_b32 v81, 0xffff0000, v96
  v_lshlrev_b32 v40, 16, v100
  v_and_b32 v41, 0xffff0000, v100
  v_pk_add_f32 v[80:81], v[80:81], v[40:41]
  v_lshlrev_b32 v40, 16, v104
  v_and_b32 v41, 0xffff0000, v104
  v_pk_add_f32 v[80:81], v[80:81], v[40:41]
  v_lshlrev_b32 v40, 16, v108
  v_and_b32 v41, 0xffff0000, v108
  v_pk_add_f32 v[80:81], v[80:81], v[40:41]
  v_lshlrev_b32 v82, 16, v97
  v_and_b32 v83, 0xffff0000, v97
  v_lshlrev_b32 v40, 16, v101
  v_and_b32 v41, 0xffff0000, v101
  v_pk_add_f32 v[82:83], v[82:83], v[40:41]
  v_lshlrev_b32 v40, 16, v105
  v_and_b32 v41, 0xffff0000, v105
  v_pk_add_f32 v[82:83], v[82:83], v[40:41]
  v_lshlrev_b32 v40, 16, v109
  v_and_b32 v41, 0xffff0000, v109
  v_pk_add_f32 v[82:83], v[82:83], v[40:41]
  v_lshlrev_b32 v84, 16, v98
  v_and_b32 v85, 0xffff0000, v98
  v_lshlrev_b32 v40, 16, v102
  v_and_b32 v41, 0xffff0000, v102
  v_pk_add_f32 v[84:85], v[84:85], v[40:41]
  v_lshlrev_b32 v40, 16, v106
  v_and_b32 v41, 0xffff0000, v106
  v_pk_add_f32 v[84:85], v[84:85], v[40:41]
  v_lshlrev_b32 v40, 16, v110
  v_and_b32 v41, 0xffff0000, v110
  v_pk_add_f32 v[84:85], v[84:85], v[40:41]
  v_lshlrev_b32 v86, 16, v99
  v_and_b32 v87, 0xffff0000, v99
  v_lshlrev_b32 v40, 16, v103
  v_and_b32 v41, 0xffff0000, v103
  v_pk_add_f32 v[86:87], v[86:87], v[40:41]
  v_lshlrev_b32 v40, 16, v107
  v_and_b32 v41, 0xffff0000, v107
  v_pk_add_f32 v[86:87], v[86:87], v[40:41]
  v_lshlrev_b32 v40, 16, v111
  v_and_b32 v41, 0xffff0000, v111
  v_pk_add_f32 v[86:87], v[86:87], v[40:41]
  v_lshlrev_b32 v40, 16, v112
  v_and_b32 v41, 0xffff0000, v112
  v_pk_fma_f32 v[48:49], v[48:49], v[120:121], v[40:41]
  v_cvt_pk_bf16_f32 v32, v48, v49
  v_lshlrev_b32 v16, 16, v32
  v_and_b32 v17, 0xffff0000, v32
  v_lshlrev_b32 v40, 16, v113
  v_and_b32 v41, 0xffff0000, v113
  v_pk_fma_f32 v[50:51], v[50:51], v[122:123], v[40:41]
  v_cvt_pk_bf16_f32 v33, v50, v51
  v_lshlrev_b32 v18, 16, v33
  v_and_b32 v19, 0xffff0000, v33
  v_lshlrev_b32 v40, 16, v114
  v_and_b32 v41, 0xffff0000, v114
  v_pk_fma_f32 v[52:53], v[52:53], v[124:125], v[40:41]
  v_cvt_pk_bf16_f32 v34, v52, v53
  v_lshlrev_b32 v20, 16, v34
  v_and_b32 v21, 0xffff0000, v34
  v_lshlrev_b32 v40, 16, v115
  v_and_b32 v41, 0xffff0000, v115
  v_pk_fma_f32 v[54:55], v[54:55], v[126:127], v[40:41]
  v_cvt_pk_bf16_f32 v35, v54, v55
  v_lshlrev_b32 v22, 16, v35
  v_and_b32 v23, 0xffff0000, v35
  v_lshlrev_b32 v40, 16, v116
  v_and_b32 v41, 0xffff0000, v116
  v_pk_fma_f32 v[80:81], v[80:81], v[128:129], v[40:41]
  v_cvt_pk_bf16_f32 v36, v80, v81
  v_lshlrev_b32 v24, 16, v36
  v_and_b32 v25, 0xffff0000, v36
  v_lshlrev_b32 v40, 16, v117
  v_and_b32 v41, 0xffff0000, v117
  v_pk_fma_f32 v[82:83], v[82:83], v[130:131], v[40:41]
  v_cvt_pk_bf16_f32 v37, v82, v83
  v_lshlrev_b32 v26, 16, v37
  v_and_b32 v27, 0xffff0000, v37
  v_lshlrev_b32 v40, 16, v118
  v_and_b32 v41, 0xffff0000, v118
  v_pk_fma_f32 v[84:85], v[84:85], v[132:133], v[40:41]
  v_cvt_pk_bf16_f32 v38, v84, v85
  v_lshlrev_b32 v28, 16, v38
  v_and_b32 v29, 0xffff0000, v38
  v_lshlrev_b32 v40, 16, v119
  v_and_b32 v41, 0xffff0000, v119
  v_pk_fma_f32 v[86:87], v[86:87], v[134:135], v[40:41]
  v_cvt_pk_bf16_f32 v39, v86, v87
  v_lshlrev_b32 v30, 16, v39
  v_and_b32 v31, 0xffff0000, v39
  s_lshl_b32 s82, s80, 15
  s_add_u32 s83, s82, 16384
  buffer_store_dwordx4 v[32:35], v6, s[64:67], s82 offen sc1
  buffer_store_dwordx4 v[36:39], v6, s[64:67], s83 offen sc1
  v_lshlrev_b32 v45, 3, v2
  v_add_u32 v45, 135168, v45
  s_lshl_b32 s85, s3, 6
  v_add_u32 v44, s85, v45
  v_add_f32 v46, v16, v17
  v_mul_f32 v47, v16, v16
  v_fmac_f32 v47, v17, v17
  v_add_f32 v46, v46, v18
  v_fmac_f32 v47, v18, v18
  v_add_f32 v46, v46, v19
  v_fmac_f32 v47, v19, v19
  v_add_f32 v46, v46, v20
  v_fmac_f32 v47, v20, v20
  v_add_f32 v46, v46, v21
  v_fmac_f32 v47, v21, v21
  v_add_f32 v46, v46, v22
  v_fmac_f32 v47, v22, v22
  v_add_f32 v46, v46, v23
  v_fmac_f32 v47, v23, v23
  v_add_f32 v46, v46, v24
  v_fmac_f32 v47, v24, v24
  v_add_f32 v46, v46, v25
  v_fmac_f32 v47, v25, v25
  v_add_f32 v46, v46, v26
  v_fmac_f32 v47, v26, v26
  v_add_f32 v46, v46, v27
  v_fmac_f32 v47, v27, v27
  v_add_f32 v46, v46, v28
  v_fmac_f32 v47, v28, v28
  v_add_f32 v46, v46, v29
  v_fmac_f32 v47, v29, v29
  v_add_f32 v46, v46, v30
  v_fmac_f32 v47, v30, v30
  v_add_f32 v46, v46, v31
  v_fmac_f32 v47, v31, v31
  s_nop 1
  v_add_f32_dpp v46, v46, v46 row_ror:8 row_mask:0xf bank_mask:0xf
  v_add_f32_dpp v47, v47, v47 row_ror:8 row_mask:0xf bank_mask:0xf
  v_mov_b32 v42, v46
  v_mov_b32 v43, v47
  s_nop 1
  v_permlane16_swap_b32 v42, v46
  v_permlane16_swap_b32 v43, v47
  s_nop 1
  v_add_f32 v46, v46, v42
  v_add_f32 v47, v47, v43
  v_mov_b32 v42, v46
  v_mov_b32 v43, v47
  s_nop 1
  v_permlane32_swap_b32 v42, v46
  v_permlane32_swap_b32 v43, v47
  s_nop 1
  v_add_f32 v46, v46, v42
  v_add_f32 v47, v47, v43
  ds_write_b64 v44, v[46:47]
  s_waitcnt lgkmcnt(0)
  s_barrier
  ds_read_b64 v[168:169], v45 offset:0
  ds_read_b64 v[170:171], v45 offset:64
  ds_read_b64 v[172:173], v45 offset:128
  ds_read_b64 v[174:175], v45 offset:192
  s_waitcnt lgkmcnt(0)
  v_add_f32 v168, v168, v170
  v_add_f32 v172, v172, v174
  v_add_f32 v46, v168, v172
  v_add_f32 v169, v169, v171
  v_add_f32 v173, v173, v175
  v_add_f32 v43, v169, v173
  v_mul_f32 v46, 989855744, v46
  v_mul_f32 v43, 989855744, v43
  v_fma_f32 v43, -v46, v46, v43
  v_max_f32 v43, 0, v43
  v_cvt_pk_bf16_f32 v47, v43, v43
  v_and_b32 v43, 0xffff0000, v47
  v_add_f32 v43, 925353388, v43
  v_cvt_pk_bf16_f32 v47, v43, v43
  v_and_b32 v43, 0xffff0000, v47
  v_sqrt_f32 v43, v43
  s_nop 0
  v_cvt_pk_bf16_f32 v47, v43, v43
  v_and_b32 v43, 0xffff0000, v47
  v_rcp_f32 v43, v43
  v_cvt_pk_bf16_f32 v47, v46, v46
  v_and_b32 v46, 0xffff0000, v47
  v_mul_f32 v44, v46, v43
  v_sub_f32 v44, 0, v44
  v_mov_b32 v42, v43
  v_pk_fma_f32 v[16:17], v[16:17], v[42:43], v[44:45] op_sel_hi:[1,0,0]
  v_pk_fma_f32 v[16:17], v[16:17], v[136:137], v[152:153]
  v_cvt_pk_bf16_f32 v48, v16, v17
  v_pk_fma_f32 v[18:19], v[18:19], v[42:43], v[44:45] op_sel_hi:[1,0,0]
  v_pk_fma_f32 v[18:19], v[18:19], v[138:139], v[154:155]
  v_cvt_pk_bf16_f32 v49, v18, v19
  v_pk_fma_f32 v[20:21], v[20:21], v[42:43], v[44:45] op_sel_hi:[1,0,0]
  v_pk_fma_f32 v[20:21], v[20:21], v[140:141], v[156:157]
  v_cvt_pk_bf16_f32 v50, v20, v21
  v_pk_fma_f32 v[22:23], v[22:23], v[42:43], v[44:45] op_sel_hi:[1,0,0]
  v_pk_fma_f32 v[22:23], v[22:23], v[142:143], v[158:159]
  v_cvt_pk_bf16_f32 v51, v22, v23
  v_pk_fma_f32 v[24:25], v[24:25], v[42:43], v[44:45] op_sel_hi:[1,0,0]
  v_pk_fma_f32 v[24:25], v[24:25], v[144:145], v[160:161]
  v_cvt_pk_bf16_f32 v52, v24, v25
  v_pk_fma_f32 v[26:27], v[26:27], v[42:43], v[44:45] op_sel_hi:[1,0,0]
  v_pk_fma_f32 v[26:27], v[26:27], v[146:147], v[162:163]
  v_cvt_pk_bf16_f32 v53, v26, v27
  v_pk_fma_f32 v[28:29], v[28:29], v[42:43], v[44:45] op_sel_hi:[1,0,0]
  v_pk_fma_f32 v[28:29], v[28:29], v[148:149], v[164:165]
  v_cvt_pk_bf16_f32 v54, v28, v29
  v_pk_fma_f32 v[30:31], v[30:31], v[42:43], v[44:45] op_sel_hi:[1,0,0]
  v_pk_fma_f32 v[30:31], v[30:31], v[150:151], v[166:167]
  v_cvt_pk_bf16_f32 v55, v30, v31
  buffer_store_dwordx4 v[48:51], v6, s[76:79], s82 offen sc1
  buffer_store_dwordx4 v[52:55], v6, s[76:79], s83 offen sc1
  s_lshr_b32 s70, s2, 4
  s_add_u32 s70, s70, 64
  s_lshl_b32 s70, s70, 8
  s_waitcnt vmcnt(0)
  s_barrier
  s_cmp_lg_u32 s3, 0
  s_cbranch_scc1 SIG_56
  s_mov_b64 exec, 1
  v_mov_b32 v251, 1
  v_mov_b32 v252, s70
  buffer_atomic_add v251, v252, s[60:63], 0 offen sc1
  s_mov_b64 exec, -1
SIG_56:
  s_cmp_lt_u32 s2, 224
  s_cbranch_scc1 DO_D
  s_mov_b32 s70, 26624
  s_cmp_lg_u32 s3, 0
  s_cbranch_scc1 WDONE_57
  s_mov_b64 exec, 255
  v_and_b32 v252, 63, v255
  v_lshlrev_b32 v252, 8, v252
  v_add_u32 v252, s70, v252
  s_mov_b32 s68, 0
POLL_60:
  buffer_load_dword v251, v252, s[60:63], 0 offen sc1
  s_waitcnt vmcnt(0)
  v_cmp_le_u32 vcc, 32, v251
  s_add_u32 s68, s68, 1
  s_cmp_eq_u64 vcc, exec
  s_cbranch_scc1 POK_61
  s_cmp_gt_u32 s68, 200000
  s_cbranch_scc1 POK_61
  s_sleep 1
  s_branch POLL_60
POK_61:
  s_mov_b64 exec, -1
WDONE_57:
  s_barrier
  s_branch E_PRE
DO_D:
  v_lshlrev_b32 v209, 4, v245
  s_add_u32 s20, s4, 23068672
  s_addc_u32 s21, s5, 0
  s_mov_b32 s22, 2097152
  s_mov_b32 s23, 0x00020000
  s_add_u32 s28, s4, 25165824
  s_addc_u32 s29, s5, 0
  s_mov_b32 s30, 7340032
  s_mov_b32 s31, 0x00020000
  s_add_u32 s70, s36, 64
  s_lshl_b32 s70, s70, 8
  s_waitcnt vmcnt(63)
  s_barrier
  s_cmp_lg_u32 s3, 0
  s_cbranch_scc1 HO_63
  s_mov_b64 exec, 0x1ff
  v_and_b32 v252, 63, v255
  v_add_u32 v252, 103, v252
  v_lshlrev_b32 v252, 8, v252
  v_writelane_b32 v252, s70, 0
  v_mov_b32 v250, 32
  s_mov_b32 s69, 16
  s_nop 0
  v_writelane_b32 v250, s69, 0
  s_mov_b32 s68, 0
POLL_66:
  buffer_load_dword v251, v252, s[60:63], 0 offen sc1
  s_waitcnt vmcnt(0)
  v_cmp_le_u32 vcc, v250, v251
  s_add_u32 s68, s68, 1
  s_cmp_eq_u64 vcc, exec
  s_cbranch_scc1 POK_67
  s_cmp_gt_u32 s68, 200000
  s_cbranch_scc1 POK_67
  s_sleep 1
  s_branch POLL_66
POK_67:
  s_mov_b64 exec, -1
  s_branch HW_62
HO_63:
HW_62:
  s_barrier
  s_add_u32 s54, s45, 0
  buffer_load_dwordx4 v[0:3], v209, s[20:23], s54 offen offset:0 sc1
  buffer_load_dwordx4 v[4:7], v209, s[20:23], s54 offen offset:1024 sc1
  buffer_load_dwordx4 v[8:11], v209, s[20:23], s54 offen offset:2048 sc1
  buffer_load_dwordx4 v[12:15], v209, s[20:23], s54 offen offset:3072 sc1
  s_add_u32 s54, s45, 4096
  buffer_load_dwordx4 v[16:19], v209, s[20:23], s54 offen offset:0 sc1
  buffer_load_dwordx4 v[20:23], v209, s[20:23], s54 offen offset:1024 sc1
  buffer_load_dwordx4 v[24:27], v209, s[20:23], s54 offen offset:2048 sc1
  buffer_load_dwordx4 v[28:31], v209, s[20:23], s54 offen offset:3072 sc1
  s_add_u32 s54, s45, 8192
  buffer_load_dwordx4 v[32:35], v209, s[20:23], s54 offen offset:0 sc1
  buffer_load_dwordx4 v[36:39], v209, s[20:23], s54 offen offset:1024 sc1
  buffer_load_dwordx4 v[40:43], v209, s[20:23], s54 offen offset:2048 sc1
  buffer_load_dwordx4 v[44:47], v209, s[20:23], s54 offen offset:3072 sc1
  s_barrier
  ds_read_b64_tr_b16 a[128:129], v200 offset:0
  ds_read_b64_tr_b16 a[130:131], v200 offset:2048
  ds_read_b64_tr_b16 a[132:133], v201 offset:0
  ds_read_b64_tr_b16 a[134:135], v201 offset:2048
  ds_read_b64_tr_b16 a[136:137], v202 offset:0
  ds_read_b64_tr_b16 a[138:139], v202 offset:2048
  ds_read_b64_tr_b16 a[140:141], v203 offset:0
  ds_read_b64_tr_b16 a[142:143], v203 offset:2048
  ds_read_b64_tr_b16 a[144:145], v200 offset:16384
  ds_read_b64_tr_b16 a[146:147], v200 offset:18432
  ds_read_b64_tr_b16 a[148:149], v201 offset:16384
  ds_read_b64_tr_b16 a[150:151], v201 offset:18432
  ds_read_b64_tr_b16 a[152:153], v202 offset:16384
  ds_read_b64_tr_b16 a[154:155], v202 offset:18432
  ds_read_b64_tr_b16 a[156:157], v203 offset:16384
  ds_read_b64_tr_b16 a[158:159], v203 offset:18432
  ds_read_b64_tr_b16 a[160:161], v200 offset:4096
  ds_read_b64_tr_b16 a[162:163], v200 offset:6144
  ds_read_b64_tr_b16 a[164:165], v201 offset:4096
  ds_read_b64_tr_b16 a[166:167], v201 offset:6144
  ds_read_b64_tr_b16 a[168:169], v202 offset:4096
  ds_read_b64_tr_b16 a[170:171], v202 offset:6144
  ds_read_b64_tr_b16 a[172:173], v203 offset:4096
  ds_read_b64_tr_b16 a[174:175], v203 offset:6144
  ds_read_b64_tr_b16 a[176:177], v200 offset:20480
  ds_read_b64_tr_b16 a[178:179], v200 offset:22528
  ds_read_b64_tr_b16 a[180:181], v201 offset:20480
  ds_read_b64_tr_b16 a[182:183], v201 offset:22528
  ds_read_b64_tr_b16 a[184:185], v202 offset:20480
  ds_read_b64_tr_b16 a[186:187], v202 offset:22528
  ds_read_b64_tr_b16 a[188:189], v203 offset:20480
  ds_read_b64_tr_b16 a[190:191], v203 offset:22528
  s_waitcnt vmcnt(11) lgkmcnt(15)
  v_mfma_f32_32x32x16_bf16 v[64:79], a[128:131], v[0:3], 0
  ds_read_b64_tr_b16 a[192:193], v200 offset:8192
  ds_read_b64_tr_b16 a[194:195], v200 offset:10240
  ds_read_b64_tr_b16 a[196:197], v201 offset:8192
  v_mfma_f32_32x32x16_bf16 v[80:95], a[132:135], v[0:3], 0
  ds_read_b64_tr_b16 a[198:199], v201 offset:10240
  ds_read_b64_tr_b16 a[200:201], v202 offset:8192
  ds_read_b64_tr_b16 a[202:203], v202 offset:10240
  v_mfma_f32_32x32x16_bf16 v[96:111], a[136:139], v[0:3], 0
  ds_read_b64_tr_b16 a[204:205], v203 offset:8192
  ds_read_b64_tr_b16 a[206:207], v203 offset:10240
  ds_read_b64_tr_b16 a[208:209], v200 offset:24576
  s_add_u32 s54, s45, 12288
  v_mfma_f32_32x32x16_bf16 v[112:127], a[140:143], v[0:3], 0
  buffer_load_dwordx4 v[48:51], v209, s[20:23], s54 offen offset:0 sc1
  ds_read_b64_tr_b16 a[210:211], v200 offset:26624
  v_mfma_f32_32x32x16_bf16 v[128:143], a[144:147], v[0:3], 0
  ds_read_b64_tr_b16 a[212:213], v201 offset:24576
  ds_read_b64_tr_b16 a[214:215], v201 offset:26624
  v_mfma_f32_32x32x16_bf16 v[144:159], a[148:151], v[0:3], 0
  buffer_load_dwordx4 v[52:55], v209, s[20:23], s54 offen offset:1024 sc1
  ds_read_b64_tr_b16 a[216:217], v202 offset:24576
  v_mfma_f32_32x32x16_bf16 v[160:175], a[152:155], v[0:3], 0
  ds_read_b64_tr_b16 a[218:219], v202 offset:26624
  ds_read_b64_tr_b16 a[220:221], v203 offset:24576
  v_mfma_f32_32x32x16_bf16 v[176:191], a[156:159], v[0:3], 0
  buffer_load_dwordx4 v[56:59], v209, s[20:23], s54 offen offset:2048 sc1
  ds_read_b64_tr_b16 a[222:223], v203 offset:26624
  s_waitcnt vmcnt(13) lgkmcnt(15)
  v_mfma_f32_32x32x16_bf16 v[64:79], a[160:163], v[4:7], v[64:79]
  ds_read_b64_tr_b16 a[128:129], v200 offset:12288
  ds_read_b64_tr_b16 a[130:131], v200 offset:14336
  ds_read_b64_tr_b16 a[132:133], v201 offset:12288
  v_mfma_f32_32x32x16_bf16 v[80:95], a[164:167], v[4:7], v[80:95]
  ds_read_b64_tr_b16 a[134:135], v201 offset:14336
  ds_read_b64_tr_b16 a[136:137], v202 offset:12288
  ds_read_b64_tr_b16 a[138:139], v202 offset:14336
  v_mfma_f32_32x32x16_bf16 v[96:111], a[168:171], v[4:7], v[96:111]
  ds_read_b64_tr_b16 a[140:141], v203 offset:12288
  ds_read_b64_tr_b16 a[142:143], v203 offset:14336
  v_mfma_f32_32x32x16_bf16 v[112:127], a[172:175], v[4:7], v[112:127]
  ds_read_b64_tr_b16 a[144:145], v200 offset:28672
  ds_read_b64_tr_b16 a[146:147], v200 offset:30720
  v_mfma_f32_32x32x16_bf16 v[128:143], a[176:179], v[4:7], v[128:143]
  ds_read_b64_tr_b16 a[148:149], v201 offset:28672
  ds_read_b64_tr_b16 a[150:151], v201 offset:30720
  v_mfma_f32_32x32x16_bf16 v[144:159], a[180:183], v[4:7], v[144:159]
  buffer_load_dwordx4 v[60:63], v209, s[20:23], s54 offen offset:3072 sc1
  ds_read_b64_tr_b16 a[152:153], v202 offset:28672
  v_mfma_f32_32x32x16_bf16 v[160:175], a[184:187], v[4:7], v[160:175]
  ds_read_b64_tr_b16 a[154:155], v202 offset:30720
  ds_read_b64_tr_b16 a[156:157], v203 offset:28672
  s_add_u32 s54, s45, 16384
  v_mfma_f32_32x32x16_bf16 v[176:191], a[188:191], v[4:7], v[176:191]
  buffer_load_dwordx4 v[0:3], v209, s[20:23], s54 offen offset:0 sc1
  ds_read_b64_tr_b16 a[158:159], v203 offset:30720
  s_waitcnt vmcnt(14) lgkmcnt(0)
  s_barrier
  v_mfma_f32_32x32x16_bf16 v[64:79], a[192:195], v[8:11], v[64:79]
  ds_read_b64_tr_b16 a[160:161], v200 offset:32768
  ds_read_b64_tr_b16 a[162:163], v200 offset:34816
  ds_read_b64_tr_b16 a[164:165], v201 offset:32768
  v_mfma_f32_32x32x16_bf16 v[80:95], a[196:199], v[8:11], v[80:95]
  ds_read_b64_tr_b16 a[166:167], v201 offset:34816
  ds_read_b64_tr_b16 a[168:169], v202 offset:32768
  ds_read_b64_tr_b16 a[170:171], v202 offset:34816
  v_mfma_f32_32x32x16_bf16 v[96:111], a[200:203], v[8:11], v[96:111]
  ds_read_b64_tr_b16 a[172:173], v203 offset:32768
  ds_read_b64_tr_b16 a[174:175], v203 offset:34816
  ds_read_b64_tr_b16 a[176:177], v200 offset:49152
  s_add_u32 m0, s42, 0
  s_add_u32 s38, s41, 917504
  v_mfma_f32_32x32x16_bf16 v[112:127], a[204:207], v[8:11], v[112:127]
  buffer_load_dwordx4 v208, s[12:15], s38 offen lds
  ds_read_b64_tr_b16 a[178:179], v200 offset:51200
  v_mfma_f32_32x32x16_bf16 v[128:143], a[208:211], v[8:11], v[128:143]
  ds_read_b64_tr_b16 a[180:181], v201 offset:49152
  ds_read_b64_tr_b16 a[182:183], v201 offset:51200
  s_add_u32 m0, s42, 16384
  s_add_u32 s38, s41, 917504
  v_mfma_f32_32x32x16_bf16 v[144:159], a[212:215], v[8:11], v[144:159]
  buffer_load_dwordx4 v208, s[16:19], s38 offen lds
  ds_read_b64_tr_b16 a[184:185], v202 offset:49152
  v_mfma_f32_32x32x16_bf16 v[160:175], a[216:219], v[8:11], v[160:175]
  ds_read_b64_tr_b16 a[186:187], v202 offset:51200
  ds_read_b64_tr_b16 a[188:189], v203 offset:49152
  s_add_u32 m0, s42, 4096
  s_add_u32 s38, s41, 974848
  v_mfma_f32_32x32x16_bf16 v[176:191], a[220:223], v[8:11], v[176:191]
  buffer_load_dwordx4 v208, s[12:15], s38 offen lds
  ds_read_b64_tr_b16 a[190:191], v203 offset:51200
  s_waitcnt vmcnt(16)
  v_mfma_f32_32x32x16_bf16 v[64:79], a[128:131], v[12:15], v[64:79]
  ds_read_b64_tr_b16 a[192:193], v200 offset:36864
  ds_read_b64_tr_b16 a[194:195], v200 offset:38912
  ds_read_b64_tr_b16 a[196:197], v201 offset:36864
  v_mfma_f32_32x32x16_bf16 v[80:95], a[132:135], v[12:15], v[80:95]
  ds_read_b64_tr_b16 a[198:199], v201 offset:38912
  ds_read_b64_tr_b16 a[200:201], v202 offset:36864
  ds_read_b64_tr_b16 a[202:203], v202 offset:38912
  v_mfma_f32_32x32x16_bf16 v[96:111], a[136:139], v[12:15], v[96:111]
  ds_read_b64_tr_b16 a[204:205], v203 offset:36864
  ds_read_b64_tr_b16 a[206:207], v203 offset:38912
  ds_read_b64_tr_b16 a[208:209], v200 offset:53248
  s_add_u32 m0, s42, 20480
  s_add_u32 s38, s41, 974848
  v_mfma_f32_32x32x16_bf16 v[112:127], a[140:143], v[12:15], v[112:127]
  buffer_load_dwordx4 v208, s[16:19], s38 offen lds
  ds_read_b64_tr_b16 a[210:211], v200 offset:55296
  v_mfma_f32_32x32x16_bf16 v[128:143], a[144:147], v[12:15], v[128:143]
  ds_read_b64_tr_b16 a[212:213], v201 offset:53248
  ds_read_b64_tr_b16 a[214:215], v201 offset:55296
  s_add_u32 m0, s42, 8192
  s_add_u32 s38, s41, 1032192
  v_mfma_f32_32x32x16_bf16 v[144:159], a[148:151], v[12:15], v[144:159]
  buffer_load_dwordx4 v208, s[12:15], s38 offen lds
  ds_read_b64_tr_b16 a[216:217], v202 offset:53248
  v_mfma_f32_32x32x16_bf16 v[160:175], a[152:155], v[12:15], v[160:175]
  ds_read_b64_tr_b16 a[218:219], v202 offset:55296
  ds_read_b64_tr_b16 a[220:221], v203 offset:53248
  s_add_u32 m0, s42, 24576
  s_add_u32 s38, s41, 1032192
  v_mfma_f32_32x32x16_bf16 v[176:191], a[156:159], v[12:15], v[176:191]
  buffer_load_dwordx4 v208, s[16:19], s38 offen lds
  ds_read_b64_tr_b16 a[222:223], v203 offset:55296
  s_waitcnt vmcnt(18) lgkmcnt(15)
  v_mfma_f32_32x32x16_bf16 v[64:79], a[160:163], v[16:19], v[64:79]
  ds_read_b64_tr_b16 a[128:129], v200 offset:40960
  ds_read_b64_tr_b16 a[130:131], v200 offset:43008
  ds_read_b64_tr_b16 a[132:133], v201 offset:40960
  v_mfma_f32_32x32x16_bf16 v[80:95], a[164:167], v[16:19], v[80:95]
  ds_read_b64_tr_b16 a[134:135], v201 offset:43008
  ds_read_b64_tr_b16 a[136:137], v202 offset:40960
  ds_read_b64_tr_b16 a[138:139], v202 offset:43008
  v_mfma_f32_32x32x16_bf16 v[96:111], a[168:171], v[16:19], v[96:111]
  ds_read_b64_tr_b16 a[140:141], v203 offset:40960
  ds_read_b64_tr_b16 a[142:143], v203 offset:43008
  ds_read_b64_tr_b16 a[144:145], v200 offset:57344
  s_add_u32 m0, s42, 12288
  s_add_u32 s38, s41, 1089536
  v_mfma_f32_32x32x16_bf16 v[112:127], a[172:175], v[16:19], v[112:127]
  buffer_load_dwordx4 v208, s[12:15], s38 offen lds
  ds_read_b64_tr_b16 a[146:147], v200 offset:59392
  v_mfma_f32_32x32x16_bf16 v[128:143], a[176:179], v[16:19], v[128:143]
  ds_read_b64_tr_b16 a[148:149], v201 offset:57344
  ds_read_b64_tr_b16 a[150:151], v201 offset:59392
  s_add_u32 m0, s42, 28672
  s_add_u32 s38, s41, 1089536
  v_mfma_f32_32x32x16_bf16 v[144:159], a[180:183], v[16:19], v[144:159]
  buffer_load_dwordx4 v208, s[16:19], s38 offen lds
  ds_read_b64_tr_b16 a[152:153], v202 offset:57344
  v_mfma_f32_32x32x16_bf16 v[160:175], a[184:187], v[16:19], v[160:175]
  ds_read_b64_tr_b16 a[154:155], v202 offset:59392
  ds_read_b64_tr_b16 a[156:157], v203 offset:57344
  v_mfma_f32_32x32x16_bf16 v[176:191], a[188:191], v[16:19], v[176:191]
  buffer_load_dwordx4 v[4:7], v209, s[20:23], s54 offen offset:1024 sc1
  ds_read_b64_tr_b16 a[158:159], v203 offset:59392
  s_waitcnt vmcnt(20) lgkmcnt(15)
  v_mfma_f32_32x32x16_bf16 v[64:79], a[192:195], v[20:23], v[64:79]
  ds_read_b64_tr_b16 a[160:161], v200 offset:45056
  ds_read_b64_tr_b16 a[162:163], v200 offset:47104
  ds_read_b64_tr_b16 a[164:165], v201 offset:45056
  v_mfma_f32_32x32x16_bf16 v[80:95], a[196:199], v[20:23], v[80:95]
  ds_read_b64_tr_b16 a[166:167], v201 offset:47104
  ds_read_b64_tr_b16 a[168:169], v202 offset:45056
  ds_read_b64_tr_b16 a[170:171], v202 offset:47104
  v_mfma_f32_32x32x16_bf16 v[96:111], a[200:203], v[20:23], v[96:111]
  ds_read_b64_tr_b16 a[172:173], v203 offset:45056
  ds_read_b64_tr_b16 a[174:175], v203 offset:47104
  ds_read_b64_tr_b16 a[176:177], v200 offset:61440
  v_mfma_f32_32x32x16_bf16 v[112:127], a[204:207], v[20:23], v[112:127]
  buffer_load_dwordx4 v[8:11], v209, s[20:23], s54 offen offset:2048 sc1
  ds_read_b64_tr_b16 a[178:179], v200 offset:63488
  v_mfma_f32_32x32x16_bf16 v[128:143], a[208:211], v[20:23], v[128:143]
  ds_read_b64_tr_b16 a[180:181], v201 offset:61440
  ds_read_b64_tr_b16 a[182:183], v201 offset:63488
  v_mfma_f32_32x32x16_bf16 v[144:159], a[212:215], v[20:23], v[144:159]
  buffer_load_dwordx4 v[12:15], v209, s[20:23], s54 offen offset:3072 sc1
  ds_read_b64_tr_b16 a[184:185], v202 offset:61440
  v_mfma_f32_32x32x16_bf16 v[160:175], a[216:219], v[20:23], v[160:175]
  ds_read_b64_tr_b16 a[186:187], v202 offset:63488
  ds_read_b64_tr_b16 a[188:189], v203 offset:61440
  s_add_u32 s54, s45, 20480
  v_mfma_f32_32x32x16_bf16 v[176:191], a[220:223], v[20:23], v[176:191]
  buffer_load_dwordx4 v[16:19], v209, s[20:23], s54 offen offset:0 sc1
  ds_read_b64_tr_b16 a[190:191], v203 offset:63488
  s_waitcnt vmcnt(22) lgkmcnt(0)
  s_barrier
  v_mfma_f32_32x32x16_bf16 v[64:79], a[128:131], v[24:27], v[64:79]
  ds_read_b64_tr_b16 a[192:193], v204 offset:0
  ds_read_b64_tr_b16 a[194:195], v204 offset:2048
  ds_read_b64_tr_b16 a[196:197], v205 offset:0
  v_mfma_f32_32x32x16_bf16 v[80:95], a[132:135], v[24:27], v[80:95]
  ds_read_b64_tr_b16 a[198:199], v205 offset:2048
  ds_read_b64_tr_b16 a[200:201], v206 offset:0
  ds_read_b64_tr_b16 a[202:203], v206 offset:2048
  v_mfma_f32_32x32x16_bf16 v[96:111], a[136:139], v[24:27], v[96:111]
  ds_read_b64_tr_b16 a[204:205], v207 offset:0
  ds_read_b64_tr_b16 a[206:207], v207 offset:2048
  ds_read_b64_tr_b16 a[208:209], v204 offset:16384
  s_add_u32 m0, s42, 32768
  s_add_u32 s38, s41, 1146880
  v_mfma_f32_32x32x16_bf16 v[112:127], a[140:143], v[24:27], v[112:127]
  buffer_load_dwordx4 v208, s[12:15], s38 offen lds
  ds_read_b64_tr_b16 a[210:211], v204 offset:18432
  v_mfma_f32_32x32x16_bf16 v[128:143], a[144:147], v[24:27], v[128:143]
  ds_read_b64_tr_b16 a[212:213], v205 offset:16384
  ds_read_b64_tr_b16 a[214:215], v205 offset:18432
  s_add_u32 m0, s42, 49152
  s_add_u32 s38, s41, 1146880
  v_mfma_f32_32x32x16_bf16 v[144:159], a[148:151], v[24:27], v[144:159]
  buffer_load_dwordx4 v208, s[16:19], s38 offen lds
  ds_read_b64_tr_b16 a[216:217], v206 offset:16384
  v_mfma_f32_32x32x16_bf16 v[160:175], a[152:155], v[24:27], v[160:175]
  ds_read_b64_tr_b16 a[218:219], v206 offset:18432
  ds_read_b64_tr_b16 a[220:221], v207 offset:16384
  s_add_u32 m0, s42, 36864
  s_add_u32 s38, s41, 1204224
  v_mfma_f32_32x32x16_bf16 v[176:191], a[156:159], v[24:27], v[176:191]
  buffer_load_dwordx4 v208, s[12:15], s38 offen lds
  ds_read_b64_tr_b16 a[222:223], v207 offset:18432
  s_waitcnt vmcnt(24)
  v_mfma_f32_32x32x16_bf16 v[64:79], a[160:163], v[28:31], v[64:79]
  ds_read_b64_tr_b16 a[128:129], v204 offset:4096
  ds_read_b64_tr_b16 a[130:131], v204 offset:6144
  ds_read_b64_tr_b16 a[132:133], v205 offset:4096
  v_mfma_f32_32x32x16_bf16 v[80:95], a[164:167], v[28:31], v[80:95]
  ds_read_b64_tr_b16 a[134:135], v205 offset:6144
  ds_read_b64_tr_b16 a[136:137], v206 offset:4096
  ds_read_b64_tr_b16 a[138:139], v206 offset:6144
  v_mfma_f32_32x32x16_bf16 v[96:111], a[168:171], v[28:31], v[96:111]
  ds_read_b64_tr_b16 a[140:141], v207 offset:4096
  ds_read_b64_tr_b16 a[142:143], v207 offset:6144
  ds_read_b64_tr_b16 a[144:145], v204 offset:20480
  s_add_u32 m0, s42, 53248
  s_add_u32 s38, s41, 1204224
  v_mfma_f32_32x32x16_bf16 v[112:127], a[172:175], v[28:31], v[112:127]
  buffer_load_dwordx4 v208, s[16:19], s38 offen lds
  ds_read_b64_tr_b16 a[146:147], v204 offset:22528
  v_mfma_f32_32x32x16_bf16 v[128:143], a[176:179], v[28:31], v[128:143]
  ds_read_b64_tr_b16 a[148:149], v205 offset:20480
  ds_read_b64_tr_b16 a[150:151], v205 offset:22528
  s_add_u32 m0, s42, 40960
  s_add_u32 s38, s41, 1261568
  v_mfma_f32_32x32x16_bf16 v[144:159], a[180:183], v[28:31], v[144:159]
  buffer_load_dwordx4 v208, s[12:15], s38 offen lds
  ds_read_b64_tr_b16 a[152:153], v206 offset:20480
  v_mfma_f32_32x32x16_bf16 v[160:175], a[184:187], v[28:31], v[160:175]
  ds_read_b64_tr_b16 a[154:155], v206 offset:22528
  ds_read_b64_tr_b16 a[156:157], v207 offset:20480
  s_add_u32 m0, s42, 57344
  s_add_u32 s38, s41, 1261568
  v_mfma_f32_32x32x16_bf16 v[176:191], a[188:191], v[28:31], v[176:191]
  buffer_load_dwordx4 v208, s[16:19], s38 offen lds
  ds_read_b64_tr_b16 a[158:159], v207 offset:22528
  s_waitcnt vmcnt(26) lgkmcnt(15)
  v_mfma_f32_32x32x16_bf16 v[64:79], a[192:195], v[32:35], v[64:79]
  ds_read_b64_tr_b16 a[160:161], v204 offset:8192
  ds_read_b64_tr_b16 a[162:163], v204 offset:10240
  ds_read_b64_tr_b16 a[164:165], v205 offset:8192
  v_mfma_f32_32x32x16_bf16 v[80:95], a[196:199], v[32:35], v[80:95]
  ds_read_b64_tr_b16 a[166:167], v205 offset:10240
  ds_read_b64_tr_b16 a[168:169], v206 offset:8192
  ds_read_b64_tr_b16 a[170:171], v206 offset:10240
  v_mfma_f32_32x32x16_bf16 v[96:111], a[200:203], v[32:35], v[96:111]
  ds_read_b64_tr_b16 a[172:173], v207 offset:8192
  ds_read_b64_tr_b16 a[174:175], v207 offset:10240
  ds_read_b64_tr_b16 a[176:177], v204 offset:24576
  s_add_u32 m0, s42, 45056
  s_add_u32 s38, s41, 1318912
  v_mfma_f32_32x32x16_bf16 v[112:127], a[204:207], v[32:35], v[112:127]
  buffer_load_dwordx4 v208, s[12:15], s38 offen lds
  ds_read_b64_tr_b16 a[178:179], v204 offset:26624
  v_mfma_f32_32x32x16_bf16 v[128:143], a[208:211], v[32:35], v[128:143]
  ds_read_b64_tr_b16 a[180:181], v205 offset:24576
  ds_read_b64_tr_b16 a[182:183], v205 offset:26624
  s_add_u32 m0, s42, 61440
  s_add_u32 s38, s41, 1318912
  v_mfma_f32_32x32x16_bf16 v[144:159], a[212:215], v[32:35], v[144:159]
  buffer_load_dwordx4 v208, s[16:19], s38 offen lds
  ds_read_b64_tr_b16 a[184:185], v206 offset:24576
  v_mfma_f32_32x32x16_bf16 v[160:175], a[216:219], v[32:35], v[160:175]
  ds_read_b64_tr_b16 a[186:187], v206 offset:26624
  ds_read_b64_tr_b16 a[188:189], v207 offset:24576
  v_mfma_f32_32x32x16_bf16 v[176:191], a[220:223], v[32:35], v[176:191]
  buffer_load_dwordx4 v[20:23], v209, s[20:23], s54 offen offset:1024 sc1
  ds_read_b64_tr_b16 a[190:191], v207 offset:26624
  s_waitcnt vmcnt(28) lgkmcnt(15)
  v_mfma_f32_32x32x16_bf16 v[64:79], a[128:131], v[36:39], v[64:79]
  ds_read_b64_tr_b16 a[192:193], v204 offset:12288
  ds_read_b64_tr_b16 a[194:195], v204 offset:14336
  ds_read_b64_tr_b16 a[196:197], v205 offset:12288
  v_mfma_f32_32x32x16_bf16 v[80:95], a[132:135], v[36:39], v[80:95]
  ds_read_b64_tr_b16 a[198:199], v205 offset:14336
  ds_read_b64_tr_b16 a[200:201], v206 offset:12288
  ds_read_b64_tr_b16 a[202:203], v206 offset:14336
  v_mfma_f32_32x32x16_bf16 v[96:111], a[136:139], v[36:39], v[96:111]
  ds_read_b64_tr_b16 a[204:205], v207 offset:12288
  ds_read_b64_tr_b16 a[206:207], v207 offset:14336
  ds_read_b64_tr_b16 a[208:209], v204 offset:28672
  v_mfma_f32_32x32x16_bf16 v[112:127], a[140:143], v[36:39], v[112:127]
  buffer_load_dwordx4 v[24:27], v209, s[20:23], s54 offen offset:2048 sc1
  ds_read_b64_tr_b16 a[210:211], v204 offset:30720
  v_mfma_f32_32x32x16_bf16 v[128:143], a[144:147], v[36:39], v[128:143]
  ds_read_b64_tr_b16 a[212:213], v205 offset:28672
  ds_read_b64_tr_b16 a[214:215], v205 offset:30720
  v_mfma_f32_32x32x16_bf16 v[144:159], a[148:151], v[36:39], v[144:159]
  buffer_load_dwordx4 v[28:31], v209, s[20:23], s54 offen offset:3072 sc1
  ds_read_b64_tr_b16 a[216:217], v206 offset:28672
  v_mfma_f32_32x32x16_bf16 v[160:175], a[152:155], v[36:39], v[160:175]
  ds_read_b64_tr_b16 a[218:219], v206 offset:30720
  ds_read_b64_tr_b16 a[220:221], v207 offset:28672
  s_add_u32 s54, s45, 24576
  v_mfma_f32_32x32x16_bf16 v[176:191], a[156:159], v[36:39], v[176:191]
  buffer_load_dwordx4 v[32:35], v209, s[20:23], s54 offen offset:0 sc1
  ds_read_b64_tr_b16 a[222:223], v207 offset:30720
  s_waitcnt vmcnt(30) lgkmcnt(0)
  s_barrier
  v_mfma_f32_32x32x16_bf16 v[64:79], a[160:163], v[40:43], v[64:79]
  ds_read_b64_tr_b16 a[128:129], v204 offset:32768
  ds_read_b64_tr_b16 a[130:131], v204 offset:34816
  ds_read_b64_tr_b16 a[132:133], v205 offset:32768
  v_mfma_f32_32x32x16_bf16 v[80:95], a[164:167], v[40:43], v[80:95]
  ds_read_b64_tr_b16 a[134:135], v205 offset:34816
  ds_read_b64_tr_b16 a[136:137], v206 offset:32768
  ds_read_b64_tr_b16 a[138:139], v206 offset:34816
  v_mfma_f32_32x32x16_bf16 v[96:111], a[168:171], v[40:43], v[96:111]
  ds_read_b64_tr_b16 a[140:141], v207 offset:32768
  ds_read_b64_tr_b16 a[142:143], v207 offset:34816
  ds_read_b64_tr_b16 a[144:145], v204 offset:49152
  s_add_u32 m0, s42, 65536
  s_add_u32 s38, s41, 1376256
  v_mfma_f32_32x32x16_bf16 v[112:127], a[172:175], v[40:43], v[112:127]
  buffer_load_dwordx4 v208, s[12:15], s38 offen lds
  ds_read_b64_tr_b16 a[146:147], v204 offset:51200
  v_mfma_f32_32x32x16_bf16 v[128:143], a[176:179], v[40:43], v[128:143]
  ds_read_b64_tr_b16 a[148:149], v205 offset:49152
  ds_read_b64_tr_b16 a[150:151], v205 offset:51200
  s_add_u32 m0, s42, 81920
  s_add_u32 s38, s41, 1376256
  v_mfma_f32_32x32x16_bf16 v[144:159], a[180:183], v[40:43], v[144:159]
  buffer_load_dwordx4 v208, s[16:19], s38 offen lds
  ds_read_b64_tr_b16 a[152:153], v206 offset:49152
  v_mfma_f32_32x32x16_bf16 v[160:175], a[184:187], v[40:43], v[160:175]
  ds_read_b64_tr_b16 a[154:155], v206 offset:51200
  ds_read_b64_tr_b16 a[156:157], v207 offset:49152
  s_add_u32 m0, s42, 69632
  s_add_u32 s38, s41, 1433600
  v_mfma_f32_32x32x16_bf16 v[176:191], a[188:191], v[40:43], v[176:191]
  buffer_load_dwordx4 v208, s[12:15], s38 offen lds
  ds_read_b64_tr_b16 a[158:159], v207 offset:51200
  s_waitcnt vmcnt(32)
  v_mfma_f32_32x32x16_bf16 v[64:79], a[192:195], v[44:47], v[64:79]
  ds_read_b64_tr_b16 a[160:161], v204 offset:36864
  ds_read_b64_tr_b16 a[162:163], v204 offset:38912
  ds_read_b64_tr_b16 a[164:165], v205 offset:36864
  v_mfma_f32_32x32x16_bf16 v[80:95], a[196:199], v[44:47], v[80:95]
  ds_read_b64_tr_b16 a[166:167], v205 offset:38912
  ds_read_b64_tr_b16 a[168:169], v206 offset:36864
  ds_read_b64_tr_b16 a[170:171], v206 offset:38912
  v_mfma_f32_32x32x16_bf16 v[96:111], a[200:203], v[44:47], v[96:111]
  ds_read_b64_tr_b16 a[172:173], v207 offset:36864
  ds_read_b64_tr_b16 a[174:175], v207 offset:38912
  ds_read_b64_tr_b16 a[176:177], v204 offset:53248
  s_add_u32 m0, s42, 86016
  s_add_u32 s38, s41, 1433600
  v_mfma_f32_32x32x16_bf16 v[112:127], a[204:207], v[44:47], v[112:127]
  buffer_load_dwordx4 v208, s[16:19], s38 offen lds
  ds_read_b64_tr_b16 a[178:179], v204 offset:55296
  v_mfma_f32_32x32x16_bf16 v[128:143], a[208:211], v[44:47], v[128:143]
  ds_read_b64_tr_b16 a[180:181], v205 offset:53248
  ds_read_b64_tr_b16 a[182:183], v205 offset:55296
  s_add_u32 m0, s42, 73728
  s_add_u32 s38, s41, 1490944
  v_mfma_f32_32x32x16_bf16 v[144:159], a[212:215], v[44:47], v[144:159]
  buffer_load_dwordx4 v208, s[12:15], s38 offen lds
  ds_read_b64_tr_b16 a[184:185], v206 offset:53248
  v_mfma_f32_32x32x16_bf16 v[160:175], a[216:219], v[44:47], v[160:175]
  ds_read_b64_tr_b16 a[186:187], v206 offset:55296
  ds_read_b64_tr_b16 a[188:189], v207 offset:53248
  s_add_u32 m0, s42, 90112
  s_add_u32 s38, s41, 1490944
  v_mfma_f32_32x32x16_bf16 v[176:191], a[220:223], v[44:47], v[176:191]
  buffer_load_dwordx4 v208, s[16:19], s38 offen lds
  ds_read_b64_tr_b16 a[190:191], v207 offset:55296
  s_waitcnt vmcnt(34) lgkmcnt(15)
  v_mfma_f32_32x32x16_bf16 v[64:79], a[128:131], v[48:51], v[64:79]
  ds_read_b64_tr_b16 a[192:193], v204 offset:40960
  ds_read_b64_tr_b16 a[194:195], v204 offset:43008
  ds_read_b64_tr_b16 a[196:197], v205 offset:40960
  v_mfma_f32_32x32x16_bf16 v[80:95], a[132:135], v[48:51], v[80:95]
  ds_read_b64_tr_b16 a[198:199], v205 offset:43008
  ds_read_b64_tr_b16 a[200:201], v206 offset:40960
  ds_read_b64_tr_b16 a[202:203], v206 offset:43008
  v_mfma_f32_32x32x16_bf16 v[96:111], a[136:139], v[48:51], v[96:111]
  ds_read_b64_tr_b16 a[204:205], v207 offset:40960
  ds_read_b64_tr_b16 a[206:207], v207 offset:43008
  ds_read_b64_tr_b16 a[208:209], v204 offset:57344
  s_add_u32 m0, s42, 77824
  s_add_u32 s38, s41, 1548288
  v_mfma_f32_32x32x16_bf16 v[112:127], a[140:143], v[48:51], v[112:127]
  buffer_load_dwordx4 v208, s[12:15], s38 offen lds
  ds_read_b64_tr_b16 a[210:211], v204 offset:59392
  v_mfma_f32_32x32x16_bf16 v[128:143], a[144:147], v[48:51], v[128:143]
  ds_read_b64_tr_b16 a[212:213], v205 offset:57344
  ds_read_b64_tr_b16 a[214:215], v205 offset:59392
  s_add_u32 m0, s42, 94208
  s_add_u32 s38, s41, 1548288
  v_mfma_f32_32x32x16_bf16 v[144:159], a[148:151], v[48:51], v[144:159]
  buffer_load_dwordx4 v208, s[16:19], s38 offen lds
  ds_read_b64_tr_b16 a[216:217], v206 offset:57344
  v_mfma_f32_32x32x16_bf16 v[160:175], a[152:155], v[48:51], v[160:175]
  ds_read_b64_tr_b16 a[218:219], v206 offset:59392
  ds_read_b64_tr_b16 a[220:221], v207 offset:57344
  v_mfma_f32_32x32x16_bf16 v[176:191], a[156:159], v[48:51], v[176:191]
  buffer_load_dwordx4 v[36:39], v209, s[20:23], s54 offen offset:1024 sc1
  ds_read_b64_tr_b16 a[222:223], v207 offset:59392
  s_waitcnt vmcnt(36) lgkmcnt(15)
  v_mfma_f32_32x32x16_bf16 v[64:79], a[160:163], v[52:55], v[64:79]
  ds_read_b64_tr_b16 a[128:129], v204 offset:45056
  ds_read_b64_tr_b16 a[130:131], v204 offset:47104
  ds_read_b64_tr_b16 a[132:133], v205 offset:45056
  v_mfma_f32_32x32x16_bf16 v[80:95], a[164:167], v[52:55], v[80:95]
  ds_read_b64_tr_b16 a[134:135], v205 offset:47104
  ds_read_b64_tr_b16 a[136:137], v206 offset:45056
  ds_read_b64_tr_b16 a[138:139], v206 offset:47104
  v_mfma_f32_32x32x16_bf16 v[96:111], a[168:171], v[52:55], v[96:111]
  ds_read_b64_tr_b16 a[140:141], v207 offset:45056
  ds_read_b64_tr_b16 a[142:143], v207 offset:47104
  ds_read_b64_tr_b16 a[144:145], v204 offset:61440
  v_mfma_f32_32x32x16_bf16 v[112:127], a[172:175], v[52:55], v[112:127]
  buffer_load_dwordx4 v[40:43], v209, s[20:23], s54 offen offset:2048 sc1
  ds_read_b64_tr_b16 a[146:147], v204 offset:63488
  v_mfma_f32_32x32x16_bf16 v[128:143], a[176:179], v[52:55], v[128:143]
  ds_read_b64_tr_b16 a[148:149], v205 offset:61440
  ds_read_b64_tr_b16 a[150:151], v205 offset:63488
  v_mfma_f32_32x32x16_bf16 v[144:159], a[180:183], v[52:55], v[144:159]
  buffer_load_dwordx4 v[44:47], v209, s[20:23], s54 offen offset:3072 sc1
  ds_read_b64_tr_b16 a[152:153], v206 offset:61440
  v_mfma_f32_32x32x16_bf16 v[160:175], a[184:187], v[52:55], v[160:175]
  ds_read_b64_tr_b16 a[154:155], v206 offset:63488
  ds_read_b64_tr_b16 a[156:157], v207 offset:61440
  s_add_u32 s54, s45, 28672
  v_mfma_f32_32x32x16_bf16 v[176:191], a[188:191], v[52:55], v[176:191]
  buffer_load_dwordx4 v[48:51], v209, s[20:23], s54 offen offset:0 sc1
  ds_read_b64_tr_b16 a[158:159], v207 offset:63488
  s_waitcnt vmcnt(28) lgkmcnt(0)
  s_barrier
  v_mfma_f32_32x32x16_bf16 v[64:79], a[192:195], v[56:59], v[64:79]
  ds_read_b64_tr_b16 a[160:161], v200 offset:0
  ds_read_b64_tr_b16 a[162:163], v200 offset:2048
  ds_read_b64_tr_b16 a[164:165], v201 offset:0
  v_mfma_f32_32x32x16_bf16 v[80:95], a[196:199], v[56:59], v[80:95]
  ds_read_b64_tr_b16 a[166:167], v201 offset:2048
  ds_read_b64_tr_b16 a[168:169], v202 offset:0
  ds_read_b64_tr_b16 a[170:171], v202 offset:2048
  v_mfma_f32_32x32x16_bf16 v[96:111], a[200:203], v[56:59], v[96:111]
  ds_read_b64_tr_b16 a[172:173], v203 offset:0
  ds_read_b64_tr_b16 a[174:175], v203 offset:2048
  ds_read_b64_tr_b16 a[176:177], v200 offset:16384
  s_add_u32 m0, s42, 98304
  s_add_u32 s38, s41, 1605632
  v_mfma_f32_32x32x16_bf16 v[112:127], a[204:207], v[56:59], v[112:127]
  buffer_load_dwordx4 v208, s[12:15], s38 offen lds
  ds_read_b64_tr_b16 a[178:179], v200 offset:18432
  v_mfma_f32_32x32x16_bf16 v[128:143], a[208:211], v[56:59], v[128:143]
  ds_read_b64_tr_b16 a[180:181], v201 offset:16384
  ds_read_b64_tr_b16 a[182:183], v201 offset:18432
  s_add_u32 m0, s42, 114688
  s_add_u32 s38, s41, 1605632
  v_mfma_f32_32x32x16_bf16 v[144:159], a[212:215], v[56:59], v[144:159]
  buffer_load_dwordx4 v208, s[16:19], s38 offen lds
  ds_read_b64_tr_b16 a[184:185], v202 offset:16384
  v_mfma_f32_32x32x16_bf16 v[160:175], a[216:219], v[56:59], v[160:175]
  ds_read_b64_tr_b16 a[186:187], v202 offset:18432
  ds_read_b64_tr_b16 a[188:189], v203 offset:16384
  s_add_u32 m0, s42, 102400
  s_add_u32 s38, s41, 1662976
  v_mfma_f32_32x32x16_bf16 v[176:191], a[220:223], v[56:59], v[176:191]
  buffer_load_dwordx4 v208, s[12:15], s38 offen lds
  ds_read_b64_tr_b16 a[190:191], v203 offset:18432
  v_mfma_f32_32x32x16_bf16 v[64:79], a[128:131], v[60:63], v[64:79]
  ds_read_b64_tr_b16 a[192:193], v200 offset:4096
  ds_read_b64_tr_b16 a[194:195], v200 offset:6144
  ds_read_b64_tr_b16 a[196:197], v201 offset:4096
  v_mfma_f32_32x32x16_bf16 v[80:95], a[132:135], v[60:63], v[80:95]
  ds_read_b64_tr_b16 a[198:199], v201 offset:6144
  ds_read_b64_tr_b16 a[200:201], v202 offset:4096
  ds_read_b64_tr_b16 a[202:203], v202 offset:6144
  v_mfma_f32_32x32x16_bf16 v[96:111], a[136:139], v[60:63], v[96:111]
  ds_read_b64_tr_b16 a[204:205], v203 offset:4096
  ds_read_b64_tr_b16 a[206:207], v203 offset:6144
  ds_read_b64_tr_b16 a[208:209], v200 offset:20480
  s_add_u32 m0, s42, 118784
  s_add_u32 s38, s41, 1662976
  v_mfma_f32_32x32x16_bf16 v[112:127], a[140:143], v[60:63], v[112:127]
  buffer_load_dwordx4 v208, s[16:19], s38 offen lds
  ds_read_b64_tr_b16 a[210:211], v200 offset:22528
  v_mfma_f32_32x32x16_bf16 v[128:143], a[144:147], v[60:63], v[128:143]
  ds_read_b64_tr_b16 a[212:213], v201 offset:20480
  ds_read_b64_tr_b16 a[214:215], v201 offset:22528
  s_add_u32 m0, s42, 106496
  s_add_u32 s38, s41, 1720320
  v_mfma_f32_32x32x16_bf16 v[144:159], a[148:151], v[60:63], v[144:159]
  buffer_load_dwordx4 v208, s[12:15], s38 offen lds
  ds_read_b64_tr_b16 a[216:217], v202 offset:20480
  v_mfma_f32_32x32x16_bf16 v[160:175], a[152:155], v[60:63], v[160:175]
  ds_read_b64_tr_b16 a[218:219], v202 offset:22528
  ds_read_b64_tr_b16 a[220:221], v203 offset:20480
  s_add_u32 m0, s42, 122880
  s_add_u32 s38, s41, 1720320
  v_mfma_f32_32x32x16_bf16 v[176:191], a[156:159], v[60:63], v[176:191]
  buffer_load_dwordx4 v208, s[16:19], s38 offen lds
  ds_read_b64_tr_b16 a[222:223], v203 offset:22528
  s_waitcnt lgkmcnt(15)
  v_mfma_f32_32x32x16_bf16 v[64:79], a[160:163], v[0:3], v[64:79]
  ds_read_b64_tr_b16 a[128:129], v200 offset:8192
  ds_read_b64_tr_b16 a[130:131], v200 offset:10240
  ds_read_b64_tr_b16 a[132:133], v201 offset:8192
  v_mfma_f32_32x32x16_bf16 v[80:95], a[164:167], v[0:3], v[80:95]
  ds_read_b64_tr_b16 a[134:135], v201 offset:10240
  ds_read_b64_tr_b16 a[136:137], v202 offset:8192
  ds_read_b64_tr_b16 a[138:139], v202 offset:10240
  v_mfma_f32_32x32x16_bf16 v[96:111], a[168:171], v[0:3], v[96:111]
  ds_read_b64_tr_b16 a[140:141], v203 offset:8192
  ds_read_b64_tr_b16 a[142:143], v203 offset:10240
  ds_read_b64_tr_b16 a[144:145], v200 offset:24576
  s_add_u32 m0, s42, 110592
  s_add_u32 s38, s41, 1777664
  v_mfma_f32_32x32x16_bf16 v[112:127], a[172:175], v[0:3], v[112:127]
  buffer_load_dwordx4 v208, s[12:15], s38 offen lds
  ds_read_b64_tr_b16 a[146:147], v200 offset:26624
  v_mfma_f32_32x32x16_bf16 v[128:143], a[176:179], v[0:3], v[128:143]
  ds_read_b64_tr_b16 a[148:149], v201 offset:24576
  ds_read_b64_tr_b16 a[150:151], v201 offset:26624
  s_add_u32 m0, s42, 126976
  s_add_u32 s38, s41, 1777664
  v_mfma_f32_32x32x16_bf16 v[144:159], a[180:183], v[0:3], v[144:159]
  buffer_load_dwordx4 v208, s[16:19], s38 offen lds
  ds_read_b64_tr_b16 a[152:153], v202 offset:24576
  v_mfma_f32_32x32x16_bf16 v[160:175], a[184:187], v[0:3], v[160:175]
  ds_read_b64_tr_b16 a[154:155], v202 offset:26624
  ds_read_b64_tr_b16 a[156:157], v203 offset:24576
  v_mfma_f32_32x32x16_bf16 v[176:191], a[188:191], v[0:3], v[176:191]
  buffer_load_dwordx4 v[52:55], v209, s[20:23], s54 offen offset:1024 sc1
  ds_read_b64_tr_b16 a[158:159], v203 offset:26624
  s_waitcnt vmcnt(36) lgkmcnt(15)
  v_mfma_f32_32x32x16_bf16 v[64:79], a[192:195], v[4:7], v[64:79]
  ds_read_b64_tr_b16 a[160:161], v200 offset:12288
  ds_read_b64_tr_b16 a[162:163], v200 offset:14336
  ds_read_b64_tr_b16 a[164:165], v201 offset:12288
  v_mfma_f32_32x32x16_bf16 v[80:95], a[196:199], v[4:7], v[80:95]
  ds_read_b64_tr_b16 a[166:167], v201 offset:14336
  ds_read_b64_tr_b16 a[168:169], v202 offset:12288
  ds_read_b64_tr_b16 a[170:171], v202 offset:14336
  v_mfma_f32_32x32x16_bf16 v[96:111], a[200:203], v[4:7], v[96:111]
  ds_read_b64_tr_b16 a[172:173], v203 offset:12288
  ds_read_b64_tr_b16 a[174:175], v203 offset:14336
  v_mfma_f32_32x32x16_bf16 v[112:127], a[204:207], v[4:7], v[112:127]
  ds_read_b64_tr_b16 a[176:177], v200 offset:28672
  ds_read_b64_tr_b16 a[178:179], v200 offset:30720
  v_mfma_f32_32x32x16_bf16 v[128:143], a[208:211], v[4:7], v[128:143]
  ds_read_b64_tr_b16 a[180:181], v201 offset:28672
  ds_read_b64_tr_b16 a[182:183], v201 offset:30720
  v_mfma_f32_32x32x16_bf16 v[144:159], a[212:215], v[4:7], v[144:159]
  buffer_load_dwordx4 v[56:59], v209, s[20:23], s54 offen offset:2048 sc1
  ds_read_b64_tr_b16 a[184:185], v202 offset:28672
  v_mfma_f32_32x32x16_bf16 v[160:175], a[216:219], v[4:7], v[160:175]
  ds_read_b64_tr_b16 a[186:187], v202 offset:30720
  ds_read_b64_tr_b16 a[188:189], v203 offset:28672
  v_mfma_f32_32x32x16_bf16 v[176:191], a[220:223], v[4:7], v[176:191]
  buffer_load_dwordx4 v[60:63], v209, s[20:23], s54 offen offset:3072 sc1
  ds_read_b64_tr_b16 a[190:191], v203 offset:30720
  s_waitcnt vmcnt(27) lgkmcnt(0)
  s_barrier
  v_mfma_f32_32x32x16_bf16 v[64:79], a[128:131], v[8:11], v[64:79]
  ds_read_b64_tr_b16 a[192:193], v200 offset:32768
  ds_read_b64_tr_b16 a[194:195], v200 offset:34816
  v_mfma_f32_32x32x16_bf16 v[80:95], a[132:135], v[8:11], v[80:95]
  ds_read_b64_tr_b16 a[196:197], v201 offset:32768
  ds_read_b64_tr_b16 a[198:199], v201 offset:34816
  v_mfma_f32_32x32x16_bf16 v[96:111], a[136:139], v[8:11], v[96:111]
  ds_read_b64_tr_b16 a[200:201], v202 offset:32768
  ds_read_b64_tr_b16 a[202:203], v202 offset:34816
  v_mfma_f32_32x32x16_bf16 v[112:127], a[140:143], v[8:11], v[112:127]
  ds_read_b64_tr_b16 a[204:205], v203 offset:32768
  ds_read_b64_tr_b16 a[206:207], v203 offset:34816
  v_mfma_f32_32x32x16_bf16 v[128:143], a[144:147], v[8:11], v[128:143]
  ds_read_b64_tr_b16 a[208:209], v200 offset:49152
  ds_read_b64_tr_b16 a[210:211], v200 offset:51200
  v_mfma_f32_32x32x16_bf16 v[144:159], a[148:151], v[8:11], v[144:159]
  ds_read_b64_tr_b16 a[212:213], v201 offset:49152
  ds_read_b64_tr_b16 a[214:215], v201 offset:51200
  v_mfma_f32_32x32x16_bf16 v[160:175], a[152:155], v[8:11], v[160:175]
  ds_read_b64_tr_b16 a[216:217], v202 offset:49152
  ds_read_b64_tr_b16 a[218:219], v202 offset:51200
  v_mfma_f32_32x32x16_bf16 v[176:191], a[156:159], v[8:11], v[176:191]
  ds_read_b64_tr_b16 a[220:221], v203 offset:49152
  ds_read_b64_tr_b16 a[222:223], v203 offset:51200
  v_mfma_f32_32x32x16_bf16 v[64:79], a[160:163], v[12:15], v[64:79]
  ds_read_b64_tr_b16 a[128:129], v200 offset:36864
  ds_read_b64_tr_b16 a[130:131], v200 offset:38912
  v_mfma_f32_32x32x16_bf16 v[80:95], a[164:167], v[12:15], v[80:95]
  ds_read_b64_tr_b16 a[132:133], v201 offset:36864
  ds_read_b64_tr_b16 a[134:135], v201 offset:38912
  v_mfma_f32_32x32x16_bf16 v[96:111], a[168:171], v[12:15], v[96:111]
  ds_read_b64_tr_b16 a[136:137], v202 offset:36864
  ds_read_b64_tr_b16 a[138:139], v202 offset:38912
  v_mfma_f32_32x32x16_bf16 v[112:127], a[172:175], v[12:15], v[112:127]
  ds_read_b64_tr_b16 a[140:141], v203 offset:36864
  ds_read_b64_tr_b16 a[142:143], v203 offset:38912
  v_mfma_f32_32x32x16_bf16 v[128:143], a[176:179], v[12:15], v[128:143]
  ds_read_b64_tr_b16 a[144:145], v200 offset:53248
  ds_read_b64_tr_b16 a[146:147], v200 offset:55296
  v_mfma_f32_32x32x16_bf16 v[144:159], a[180:183], v[12:15], v[144:159]
  ds_read_b64_tr_b16 a[148:149], v201 offset:53248
  ds_read_b64_tr_b16 a[150:151], v201 offset:55296
  v_mfma_f32_32x32x16_bf16 v[160:175], a[184:187], v[12:15], v[160:175]
  ds_read_b64_tr_b16 a[152:153], v202 offset:53248
  ds_read_b64_tr_b16 a[154:155], v202 offset:55296
  v_mfma_f32_32x32x16_bf16 v[176:191], a[188:191], v[12:15], v[176:191]
  ds_read_b64_tr_b16 a[156:157], v203 offset:53248
  ds_read_b64_tr_b16 a[158:159], v203 offset:55296
  s_waitcnt lgkmcnt(15)
  v_mfma_f32_32x32x16_bf16 v[64:79], a[192:195], v[16:19], v[64:79]
  ds_read_b64_tr_b16 a[160:161], v200 offset:40960
  ds_read_b64_tr_b16 a[162:163], v200 offset:43008
  v_mfma_f32_32x32x16_bf16 v[80:95], a[196:199], v[16:19], v[80:95]
  ds_read_b64_tr_b16 a[164:165], v201 offset:40960
  ds_read_b64_tr_b16 a[166:167], v201 offset:43008
  v_mfma_f32_32x32x16_bf16 v[96:111], a[200:203], v[16:19], v[96:111]
  ds_read_b64_tr_b16 a[168:169], v202 offset:40960
  ds_read_b64_tr_b16 a[170:171], v202 offset:43008
  v_mfma_f32_32x32x16_bf16 v[112:127], a[204:207], v[16:19], v[112:127]
  ds_read_b64_tr_b16 a[172:173], v203 offset:40960
  ds_read_b64_tr_b16 a[174:175], v203 offset:43008
  v_mfma_f32_32x32x16_bf16 v[128:143], a[208:211], v[16:19], v[128:143]
  ds_read_b64_tr_b16 a[176:177], v200 offset:57344
  ds_read_b64_tr_b16 a[178:179], v200 offset:59392
  v_mfma_f32_32x32x16_bf16 v[144:159], a[212:215], v[16:19], v[144:159]
  ds_read_b64_tr_b16 a[180:181], v201 offset:57344
  ds_read_b64_tr_b16 a[182:183], v201 offset:59392
  v_mfma_f32_32x32x16_bf16 v[160:175], a[216:219], v[16:19], v[160:175]
  ds_read_b64_tr_b16 a[184:185], v202 offset:57344
  ds_read_b64_tr_b16 a[186:187], v202 offset:59392
  v_mfma_f32_32x32x16_bf16 v[176:191], a[220:223], v[16:19], v[176:191]
  ds_read_b64_tr_b16 a[188:189], v203 offset:57344
  ds_read_b64_tr_b16 a[190:191], v203 offset:59392
  s_waitcnt vmcnt(26) lgkmcnt(15)
  v_mfma_f32_32x32x16_bf16 v[64:79], a[128:131], v[20:23], v[64:79]
  ds_read_b64_tr_b16 a[192:193], v200 offset:45056
  ds_read_b64_tr_b16 a[194:195], v200 offset:47104
  v_mfma_f32_32x32x16_bf16 v[80:95], a[132:135], v[20:23], v[80:95]
  ds_read_b64_tr_b16 a[196:197], v201 offset:45056
  ds_read_b64_tr_b16 a[198:199], v201 offset:47104
  v_mfma_f32_32x32x16_bf16 v[96:111], a[136:139], v[20:23], v[96:111]
  ds_read_b64_tr_b16 a[200:201], v202 offset:45056
  ds_read_b64_tr_b16 a[202:203], v202 offset:47104
  v_mfma_f32_32x32x16_bf16 v[112:127], a[140:143], v[20:23], v[112:127]
  ds_read_b64_tr_b16 a[204:205], v203 offset:45056
  ds_read_b64_tr_b16 a[206:207], v203 offset:47104
  v_mfma_f32_32x32x16_bf16 v[128:143], a[144:147], v[20:23], v[128:143]
  ds_read_b64_tr_b16 a[208:209], v200 offset:61440
  ds_read_b64_tr_b16 a[210:211], v200 offset:63488
  v_mfma_f32_32x32x16_bf16 v[144:159], a[148:151], v[20:23], v[144:159]
  ds_read_b64_tr_b16 a[212:213], v201 offset:61440
  ds_read_b64_tr_b16 a[214:215], v201 offset:63488
  v_mfma_f32_32x32x16_bf16 v[160:175], a[152:155], v[20:23], v[160:175]
  ds_read_b64_tr_b16 a[216:217], v202 offset:61440
  ds_read_b64_tr_b16 a[218:219], v202 offset:63488
  v_mfma_f32_32x32x16_bf16 v[176:191], a[156:159], v[20:23], v[176:191]
  ds_read_b64_tr_b16 a[220:221], v203 offset:61440
  ds_read_b64_tr_b16 a[222:223], v203 offset:63488
  s_waitcnt vmcnt(15) lgkmcnt(0)
  s_barrier
  v_mfma_f32_32x32x16_bf16 v[64:79], a[160:163], v[24:27], v[64:79]
  ds_read_b64_tr_b16 a[128:129], v204 offset:0
  ds_read_b64_tr_b16 a[130:131], v204 offset:2048
  v_mfma_f32_32x32x16_bf16 v[80:95], a[164:167], v[24:27], v[80:95]
  ds_read_b64_tr_b16 a[132:133], v205 offset:0
  ds_read_b64_tr_b16 a[134:135], v205 offset:2048
  v_mfma_f32_32x32x16_bf16 v[96:111], a[168:171], v[24:27], v[96:111]
  ds_read_b64_tr_b16 a[136:137], v206 offset:0
  ds_read_b64_tr_b16 a[138:139], v206 offset:2048
  v_mfma_f32_32x32x16_bf16 v[112:127], a[172:175], v[24:27], v[112:127]
  ds_read_b64_tr_b16 a[140:141], v207 offset:0
  ds_read_b64_tr_b16 a[142:143], v207 offset:2048
  v_mfma_f32_32x32x16_bf16 v[128:143], a[176:179], v[24:27], v[128:143]
  ds_read_b64_tr_b16 a[144:145], v204 offset:16384
  ds_read_b64_tr_b16 a[146:147], v204 offset:18432
  v_mfma_f32_32x32x16_bf16 v[144:159], a[180:183], v[24:27], v[144:159]
  ds_read_b64_tr_b16 a[148:149], v205 offset:16384
  ds_read_b64_tr_b16 a[150:151], v205 offset:18432
  v_mfma_f32_32x32x16_bf16 v[160:175], a[184:187], v[24:27], v[160:175]
  ds_read_b64_tr_b16 a[152:153], v206 offset:16384
  ds_read_b64_tr_b16 a[154:155], v206 offset:18432
  v_mfma_f32_32x32x16_bf16 v[176:191], a[188:191], v[24:27], v[176:191]
  ds_read_b64_tr_b16 a[156:157], v207 offset:16384
  ds_read_b64_tr_b16 a[158:159], v207 offset:18432
  v_mfma_f32_32x32x16_bf16 v[64:79], a[192:195], v[28:31], v[64:79]
  ds_read_b64_tr_b16 a[160:161], v204 offset:4096
  ds_read_b64_tr_b16 a[162:163], v204 offset:6144
  v_mfma_f32_32x32x16_bf16 v[80:95], a[196:199], v[28:31], v[80:95]
  ds_read_b64_tr_b16 a[164:165], v205 offset:4096
  ds_read_b64_tr_b16 a[166:167], v205 offset:6144
  v_mfma_f32_32x32x16_bf16 v[96:111], a[200:203], v[28:31], v[96:111]
  ds_read_b64_tr_b16 a[168:169], v206 offset:4096
  ds_read_b64_tr_b16 a[170:171], v206 offset:6144
  v_mfma_f32_32x32x16_bf16 v[112:127], a[204:207], v[28:31], v[112:127]
  ds_read_b64_tr_b16 a[172:173], v207 offset:4096
  ds_read_b64_tr_b16 a[174:175], v207 offset:6144
  v_mfma_f32_32x32x16_bf16 v[128:143], a[208:211], v[28:31], v[128:143]
  ds_read_b64_tr_b16 a[176:177], v204 offset:20480
  ds_read_b64_tr_b16 a[178:179], v204 offset:22528
  v_mfma_f32_32x32x16_bf16 v[144:159], a[212:215], v[28:31], v[144:159]
  ds_read_b64_tr_b16 a[180:181], v205 offset:20480
  ds_read_b64_tr_b16 a[182:183], v205 offset:22528
  v_mfma_f32_32x32x16_bf16 v[160:175], a[216:219], v[28:31], v[160:175]
  ds_read_b64_tr_b16 a[184:185], v206 offset:20480
  ds_read_b64_tr_b16 a[186:187], v206 offset:22528
  v_mfma_f32_32x32x16_bf16 v[176:191], a[220:223], v[28:31], v[176:191]
  ds_read_b64_tr_b16 a[188:189], v207 offset:20480
  ds_read_b64_tr_b16 a[190:191], v207 offset:22528
  s_waitcnt lgkmcnt(15)
  v_mfma_f32_32x32x16_bf16 v[64:79], a[128:131], v[32:35], v[64:79]
  ds_read_b64_tr_b16 a[192:193], v204 offset:8192
  ds_read_b64_tr_b16 a[194:195], v204 offset:10240
  v_mfma_f32_32x32x16_bf16 v[80:95], a[132:135], v[32:35], v[80:95]
  ds_read_b64_tr_b16 a[196:197], v205 offset:8192
  ds_read_b64_tr_b16 a[198:199], v205 offset:10240
  v_mfma_f32_32x32x16_bf16 v[96:111], a[136:139], v[32:35], v[96:111]
  ds_read_b64_tr_b16 a[200:201], v206 offset:8192
  ds_read_b64_tr_b16 a[202:203], v206 offset:10240
  v_mfma_f32_32x32x16_bf16 v[112:127], a[140:143], v[32:35], v[112:127]
  ds_read_b64_tr_b16 a[204:205], v207 offset:8192
  ds_read_b64_tr_b16 a[206:207], v207 offset:10240
  v_mfma_f32_32x32x16_bf16 v[128:143], a[144:147], v[32:35], v[128:143]
  ds_read_b64_tr_b16 a[208:209], v204 offset:24576
  ds_read_b64_tr_b16 a[210:211], v204 offset:26624
  v_mfma_f32_32x32x16_bf16 v[144:159], a[148:151], v[32:35], v[144:159]
  ds_read_b64_tr_b16 a[212:213], v205 offset:24576
  ds_read_b64_tr_b16 a[214:215], v205 offset:26624
  v_mfma_f32_32x32x16_bf16 v[160:175], a[152:155], v[32:35], v[160:175]
  ds_read_b64_tr_b16 a[216:217], v206 offset:24576
  ds_read_b64_tr_b16 a[218:219], v206 offset:26624
  v_mfma_f32_32x32x16_bf16 v[176:191], a[156:159], v[32:35], v[176:191]
  ds_read_b64_tr_b16 a[220:221], v207 offset:24576
  ds_read_b64_tr_b16 a[222:223], v207 offset:26624
  s_waitcnt vmcnt(14) lgkmcnt(15)
  v_mfma_f32_32x32x16_bf16 v[64:79], a[160:163], v[36:39], v[64:79]
  ds_read_b64_tr_b16 a[128:129], v204 offset:12288
  ds_read_b64_tr_b16 a[130:131], v204 offset:14336
  v_mfma_f32_32x32x16_bf16 v[80:95], a[164:167], v[36:39], v[80:95]
  ds_read_b64_tr_b16 a[132:133], v205 offset:12288
  ds_read_b64_tr_b16 a[134:135], v205 offset:14336
  v_mfma_f32_32x32x16_bf16 v[96:111], a[168:171], v[36:39], v[96:111]
  ds_read_b64_tr_b16 a[136:137], v206 offset:12288
  ds_read_b64_tr_b16 a[138:139], v206 offset:14336
  v_mfma_f32_32x32x16_bf16 v[112:127], a[172:175], v[36:39], v[112:127]
  ds_read_b64_tr_b16 a[140:141], v207 offset:12288
  ds_read_b64_tr_b16 a[142:143], v207 offset:14336
  v_mfma_f32_32x32x16_bf16 v[128:143], a[176:179], v[36:39], v[128:143]
  ds_read_b64_tr_b16 a[144:145], v204 offset:28672
  ds_read_b64_tr_b16 a[146:147], v204 offset:30720
  v_mfma_f32_32x32x16_bf16 v[144:159], a[180:183], v[36:39], v[144:159]
  ds_read_b64_tr_b16 a[148:149], v205 offset:28672
  ds_read_b64_tr_b16 a[150:151], v205 offset:30720
  v_mfma_f32_32x32x16_bf16 v[160:175], a[184:187], v[36:39], v[160:175]
  ds_read_b64_tr_b16 a[152:153], v206 offset:28672
  ds_read_b64_tr_b16 a[154:155], v206 offset:30720
  v_mfma_f32_32x32x16_bf16 v[176:191], a[188:191], v[36:39], v[176:191]
  ds_read_b64_tr_b16 a[156:157], v207 offset:28672
  ds_read_b64_tr_b16 a[158:159], v207 offset:30720
  s_waitcnt vmcnt(3) lgkmcnt(0)
  s_barrier
  v_mfma_f32_32x32x16_bf16 v[64:79], a[192:195], v[40:43], v[64:79]
  ds_read_b64_tr_b16 a[160:161], v204 offset:32768
  ds_read_b64_tr_b16 a[162:163], v204 offset:34816
  v_mfma_f32_32x32x16_bf16 v[80:95], a[196:199], v[40:43], v[80:95]
  ds_read_b64_tr_b16 a[164:165], v205 offset:32768
  ds_read_b64_tr_b16 a[166:167], v205 offset:34816
  v_mfma_f32_32x32x16_bf16 v[96:111], a[200:203], v[40:43], v[96:111]
  ds_read_b64_tr_b16 a[168:169], v206 offset:32768
  ds_read_b64_tr_b16 a[170:171], v206 offset:34816
  v_mfma_f32_32x32x16_bf16 v[112:127], a[204:207], v[40:43], v[112:127]
  ds_read_b64_tr_b16 a[172:173], v207 offset:32768
  ds_read_b64_tr_b16 a[174:175], v207 offset:34816
  v_mfma_f32_32x32x16_bf16 v[128:143], a[208:211], v[40:43], v[128:143]
  ds_read_b64_tr_b16 a[176:177], v204 offset:49152
  ds_read_b64_tr_b16 a[178:179], v204 offset:51200
  v_mfma_f32_32x32x16_bf16 v[144:159], a[212:215], v[40:43], v[144:159]
  ds_read_b64_tr_b16 a[180:181], v205 offset:49152
  ds_read_b64_tr_b16 a[182:183], v205 offset:51200
  v_mfma_f32_32x32x16_bf16 v[160:175], a[216:219], v[40:43], v[160:175]
  ds_read_b64_tr_b16 a[184:185], v206 offset:49152
  ds_read_b64_tr_b16 a[186:187], v206 offset:51200
  v_mfma_f32_32x32x16_bf16 v[176:191], a[220:223], v[40:43], v[176:191]
  ds_read_b64_tr_b16 a[188:189], v207 offset:49152
  ds_read_b64_tr_b16 a[190:191], v207 offset:51200
  v_mfma_f32_32x32x16_bf16 v[64:79], a[128:131], v[44:47], v[64:79]
  ds_read_b64_tr_b16 a[192:193], v204 offset:36864
  ds_read_b64_tr_b16 a[194:195], v204 offset:38912
  v_mfma_f32_32x32x16_bf16 v[80:95], a[132:135], v[44:47], v[80:95]
  ds_read_b64_tr_b16 a[196:197], v205 offset:36864
  ds_read_b64_tr_b16 a[198:199], v205 offset:38912
  v_mfma_f32_32x32x16_bf16 v[96:111], a[136:139], v[44:47], v[96:111]
  ds_read_b64_tr_b16 a[200:201], v206 offset:36864
  ds_read_b64_tr_b16 a[202:203], v206 offset:38912
  v_mfma_f32_32x32x16_bf16 v[112:127], a[140:143], v[44:47], v[112:127]
  ds_read_b64_tr_b16 a[204:205], v207 offset:36864
  ds_read_b64_tr_b16 a[206:207], v207 offset:38912
  v_mfma_f32_32x32x16_bf16 v[128:143], a[144:147], v[44:47], v[128:143]
  ds_read_b64_tr_b16 a[208:209], v204 offset:53248
  ds_read_b64_tr_b16 a[210:211], v204 offset:55296
  v_mfma_f32_32x32x16_bf16 v[144:159], a[148:151], v[44:47], v[144:159]
  ds_read_b64_tr_b16 a[212:213], v205 offset:53248
  ds_read_b64_tr_b16 a[214:215], v205 offset:55296
  v_mfma_f32_32x32x16_bf16 v[160:175], a[152:155], v[44:47], v[160:175]
  ds_read_b64_tr_b16 a[216:217], v206 offset:53248
  ds_read_b64_tr_b16 a[218:219], v206 offset:55296
  v_mfma_f32_32x32x16_bf16 v[176:191], a[156:159], v[44:47], v[176:191]
  ds_read_b64_tr_b16 a[220:221], v207 offset:53248
  ds_read_b64_tr_b16 a[222:223], v207 offset:55296
  s_waitcnt lgkmcnt(15)
  v_mfma_f32_32x32x16_bf16 v[64:79], a[160:163], v[48:51], v[64:79]
  ds_read_b64_tr_b16 a[128:129], v204 offset:40960
  ds_read_b64_tr_b16 a[130:131], v204 offset:43008
  v_mfma_f32_32x32x16_bf16 v[80:95], a[164:167], v[48:51], v[80:95]
  ds_read_b64_tr_b16 a[132:133], v205 offset:40960
  ds_read_b64_tr_b16 a[134:135], v205 offset:43008
  v_mfma_f32_32x32x16_bf16 v[96:111], a[168:171], v[48:51], v[96:111]
  ds_read_b64_tr_b16 a[136:137], v206 offset:40960
  ds_read_b64_tr_b16 a[138:139], v206 offset:43008
  v_mfma_f32_32x32x16_bf16 v[112:127], a[172:175], v[48:51], v[112:127]
  ds_read_b64_tr_b16 a[140:141], v207 offset:40960
  ds_read_b64_tr_b16 a[142:143], v207 offset:43008
  v_mfma_f32_32x32x16_bf16 v[128:143], a[176:179], v[48:51], v[128:143]
  ds_read_b64_tr_b16 a[144:145], v204 offset:57344
  ds_read_b64_tr_b16 a[146:147], v204 offset:59392
  v_mfma_f32_32x32x16_bf16 v[144:159], a[180:183], v[48:51], v[144:159]
  ds_read_b64_tr_b16 a[148:149], v205 offset:57344
  ds_read_b64_tr_b16 a[150:151], v205 offset:59392
  v_mfma_f32_32x32x16_bf16 v[160:175], a[184:187], v[48:51], v[160:175]
  ds_read_b64_tr_b16 a[152:153], v206 offset:57344
  ds_read_b64_tr_b16 a[154:155], v206 offset:59392
  v_mfma_f32_32x32x16_bf16 v[176:191], a[188:191], v[48:51], v[176:191]
  ds_read_b64_tr_b16 a[156:157], v207 offset:57344
  ds_read_b64_tr_b16 a[158:159], v207 offset:59392
  s_waitcnt vmcnt(2) lgkmcnt(15)
  v_mfma_f32_32x32x16_bf16 v[64:79], a[192:195], v[52:55], v[64:79]
  ds_read_b64_tr_b16 a[160:161], v204 offset:45056
  ds_read_b64_tr_b16 a[162:163], v204 offset:47104
  v_mfma_f32_32x32x16_bf16 v[80:95], a[196:199], v[52:55], v[80:95]
  ds_read_b64_tr_b16 a[164:165], v205 offset:45056
  ds_read_b64_tr_b16 a[166:167], v205 offset:47104
  v_mfma_f32_32x32x16_bf16 v[96:111], a[200:203], v[52:55], v[96:111]
  ds_read_b64_tr_b16 a[168:169], v206 offset:45056
  ds_read_b64_tr_b16 a[170:171], v206 offset:47104
  v_mfma_f32_32x32x16_bf16 v[112:127], a[204:207], v[52:55], v[112:127]
  ds_read_b64_tr_b16 a[172:173], v207 offset:45056
  ds_read_b64_tr_b16 a[174:175], v207 offset:47104
  v_mfma_f32_32x32x16_bf16 v[128:143], a[208:211], v[52:55], v[128:143]
  ds_read_b64_tr_b16 a[176:177], v204 offset:61440
  ds_read_b64_tr_b16 a[178:179], v204 offset:63488
  v_mfma_f32_32x32x16_bf16 v[144:159], a[212:215], v[52:55], v[144:159]
  ds_read_b64_tr_b16 a[180:181], v205 offset:61440
  ds_read_b64_tr_b16 a[182:183], v205 offset:63488
  v_mfma_f32_32x32x16_bf16 v[160:175], a[216:219], v[52:55], v[160:175]
  ds_read_b64_tr_b16 a[184:185], v206 offset:61440
  ds_read_b64_tr_b16 a[186:187], v206 offset:63488
  v_mfma_f32_32x32x16_bf16 v[176:191], a[220:223], v[52:55], v[176:191]
  ds_read_b64_tr_b16 a[188:189], v207 offset:61440
  ds_read_b64_tr_b16 a[190:191], v207 offset:63488
  s_waitcnt vmcnt(1) lgkmcnt(15)
  v_mfma_f32_32x32x16_bf16 v[64:79], a[128:131], v[56:59], v[64:79]
  v_mfma_f32_32x32x16_bf16 v[80:95], a[132:135], v[56:59], v[80:95]
  v_mfma_f32_32x32x16_bf16 v[96:111], a[136:139], v[56:59], v[96:111]
  v_mfma_f32_32x32x16_bf16 v[112:127], a[140:143], v[56:59], v[112:127]
  v_mfma_f32_32x32x16_bf16 v[128:143], a[144:147], v[56:59], v[128:143]
  v_mfma_f32_32x32x16_bf16 v[144:159], a[148:151], v[56:59], v[144:159]
  v_mfma_f32_32x32x16_bf16 v[160:175], a[152:155], v[56:59], v[160:175]
  v_mfma_f32_32x32x16_bf16 v[176:191], a[156:159], v[56:59], v[176:191]
  s_waitcnt vmcnt(0) lgkmcnt(0)
  v_mfma_f32_32x32x16_bf16 v[64:79], a[160:163], v[60:63], v[64:79]
  v_mfma_f32_32x32x16_bf16 v[80:95], a[164:167], v[60:63], v[80:95]
  v_mfma_f32_32x32x16_bf16 v[96:111], a[168:171], v[60:63], v[96:111]
  v_mfma_f32_32x32x16_bf16 v[112:127], a[172:175], v[60:63], v[112:127]
  v_mfma_f32_32x32x16_bf16 v[128:143], a[176:179], v[60:63], v[128:143]
  v_mfma_f32_32x32x16_bf16 v[144:159], a[180:183], v[60:63], v[144:159]
  v_mfma_f32_32x32x16_bf16 v[160:175], a[184:187], v[60:63], v[160:175]
  v_mfma_f32_32x32x16_bf16 v[176:191], a[188:191], v[60:63], v[176:191]
  s_mul_i32 s45, s39, 114688
  s_lshl_b32 s38, s37, 13
  s_add_u32 s45, s45, s38
  v_mov_b32 v210, 3216550459
  v_mov_b32 v212, 1.0
  v_mov_b32 v213, 1.0
  s_nop 11
  v_pk_mul_f32 v[0:1], v[64:65], v[210:211] op_sel_hi:[1,0]
  v_pk_mul_f32 v[2:3], v[66:67], v[210:211] op_sel_hi:[1,0]
  v_pk_mul_f32 v[4:5], v[68:69], v[210:211] op_sel_hi:[1,0]
  v_pk_mul_f32 v[6:7], v[70:71], v[210:211] op_sel_hi:[1,0]
  v_exp_f32 v0, v0
  v_exp_f32 v1, v1
  v_exp_f32 v2, v2
  v_exp_f32 v3, v3
  v_exp_f32 v4, v4
  v_exp_f32 v5, v5
  v_exp_f32 v6, v6
  v_exp_f32 v7, v7
  v_pk_mul_f32 v[128:129], v[64:65], v[128:129]
  v_pk_mul_f32 v[130:131], v[66:67], v[130:131]
  v_pk_mul_f32 v[132:133], v[68:69], v[132:133]
  v_pk_mul_f32 v[134:135], v[70:71], v[134:135]
  v_pk_add_f32 v[0:1], v[0:1], v[212:213]
  v_pk_add_f32 v[2:3], v[2:3], v[212:213]
  v_pk_add_f32 v[4:5], v[4:5], v[212:213]
  v_pk_add_f32 v[6:7], v[6:7], v[212:213]
  v_rcp_f32 v0, v0
  v_rcp_f32 v1, v1
  v_rcp_f32 v2, v2
  v_rcp_f32 v3, v3
  v_rcp_f32 v4, v4
  v_rcp_f32 v5, v5
  v_rcp_f32 v6, v6
  v_rcp_f32 v7, v7
  s_nop 0
  v_pk_mul_f32 v[128:129], v[128:129], v[0:1]
  v_pk_mul_f32 v[130:131], v[130:131], v[2:3]
  v_pk_mul_f32 v[132:133], v[132:133], v[4:5]
  v_pk_mul_f32 v[134:135], v[134:135], v[6:7]
  v_cvt_pk_bf16_f32 v8, v128, v129
  v_cvt_pk_bf16_f32 v9, v130, v131
  v_cvt_pk_bf16_f32 v10, v132, v133
  v_cvt_pk_bf16_f32 v11, v134, v135
  s_add_u32 s38, s45, 0
  buffer_store_dwordx4 v[8:11], v209, s[28:31], s38 offen offset:0 sc1
  v_pk_mul_f32 v[16:17], v[72:73], v[210:211] op_sel_hi:[1,0]
  v_pk_mul_f32 v[18:19], v[74:75], v[210:211] op_sel_hi:[1,0]
  v_pk_mul_f32 v[20:21], v[76:77], v[210:211] op_sel_hi:[1,0]
  v_pk_mul_f32 v[22:23], v[78:79], v[210:211] op_sel_hi:[1,0]
  v_exp_f32 v16, v16
  v_exp_f32 v17, v17
  v_exp_f32 v18, v18
  v_exp_f32 v19, v19
  v_exp_f32 v20, v20
  v_exp_f32 v21, v21
  v_exp_f32 v22, v22
  v_exp_f32 v23, v23
  v_pk_mul_f32 v[136:137], v[72:73], v[136:137]
  v_pk_mul_f32 v[138:139], v[74:75], v[138:139]
  v_pk_mul_f32 v[140:141], v[76:77], v[140:141]
  v_pk_mul_f32 v[142:143], v[78:79], v[142:143]
  v_pk_add_f32 v[16:17], v[16:17], v[212:213]
  v_pk_add_f32 v[18:19], v[18:19], v[212:213]
  v_pk_add_f32 v[20:21], v[20:21], v[212:213]
  v_pk_add_f32 v[22:23], v[22:23], v[212:213]
  v_rcp_f32 v16, v16
  v_rcp_f32 v17, v17
  v_rcp_f32 v18, v18
  v_rcp_f32 v19, v19
  v_rcp_f32 v20, v20
  v_rcp_f32 v21, v21
  v_rcp_f32 v22, v22
  v_rcp_f32 v23, v23
  s_nop 0
  v_pk_mul_f32 v[136:137], v[136:137], v[16:17]
  v_pk_mul_f32 v[138:139], v[138:139], v[18:19]
  v_pk_mul_f32 v[140:141], v[140:141], v[20:21]
  v_pk_mul_f32 v[142:143], v[142:143], v[22:23]
  v_cvt_pk_bf16_f32 v24, v136, v137
  v_cvt_pk_bf16_f32 v25, v138, v139
  v_cvt_pk_bf16_f32 v26, v140, v141
  v_cvt_pk_bf16_f32 v27, v142, v143
  s_add_u32 s38, s45, 0
  buffer_store_dwordx4 v[24:27], v209, s[28:31], s38 offen offset:1024 sc1
  v_pk_mul_f32 v[0:1], v[80:81], v[210:211] op_sel_hi:[1,0]
  v_pk_mul_f32 v[2:3], v[82:83], v[210:211] op_sel_hi:[1,0]
  v_pk_mul_f32 v[4:5], v[84:85], v[210:211] op_sel_hi:[1,0]
  v_pk_mul_f32 v[6:7], v[86:87], v[210:211] op_sel_hi:[1,0]
  v_exp_f32 v0, v0
  v_exp_f32 v1, v1
  v_exp_f32 v2, v2
  v_exp_f32 v3, v3
  v_exp_f32 v4, v4
  v_exp_f32 v5, v5
  v_exp_f32 v6, v6
  v_exp_f32 v7, v7
  v_pk_mul_f32 v[144:145], v[80:81], v[144:145]
  v_pk_mul_f32 v[146:147], v[82:83], v[146:147]
  v_pk_mul_f32 v[148:149], v[84:85], v[148:149]
  v_pk_mul_f32 v[150:151], v[86:87], v[150:151]
  v_pk_add_f32 v[0:1], v[0:1], v[212:213]
  v_pk_add_f32 v[2:3], v[2:3], v[212:213]
  v_pk_add_f32 v[4:5], v[4:5], v[212:213]
  v_pk_add_f32 v[6:7], v[6:7], v[212:213]
  v_rcp_f32 v0, v0
  v_rcp_f32 v1, v1
  v_rcp_f32 v2, v2
  v_rcp_f32 v3, v3
  v_rcp_f32 v4, v4
  v_rcp_f32 v5, v5
  v_rcp_f32 v6, v6
  v_rcp_f32 v7, v7
  s_nop 0
  v_pk_mul_f32 v[144:145], v[144:145], v[0:1]
  v_pk_mul_f32 v[146:147], v[146:147], v[2:3]
  v_pk_mul_f32 v[148:149], v[148:149], v[4:5]
  v_pk_mul_f32 v[150:151], v[150:151], v[6:7]
  v_cvt_pk_bf16_f32 v8, v144, v145
  v_cvt_pk_bf16_f32 v9, v146, v147
  v_cvt_pk_bf16_f32 v10, v148, v149
  v_cvt_pk_bf16_f32 v11, v150, v151
  s_add_u32 s38, s45, 0
  buffer_store_dwordx4 v[8:11], v209, s[28:31], s38 offen offset:2048 sc1
  v_pk_mul_f32 v[16:17], v[88:89], v[210:211] op_sel_hi:[1,0]
  v_pk_mul_f32 v[18:19], v[90:91], v[210:211] op_sel_hi:[1,0]
  v_pk_mul_f32 v[20:21], v[92:93], v[210:211] op_sel_hi:[1,0]
  v_pk_mul_f32 v[22:23], v[94:95], v[210:211] op_sel_hi:[1,0]
  v_exp_f32 v16, v16
  v_exp_f32 v17, v17
  v_exp_f32 v18, v18
  v_exp_f32 v19, v19
  v_exp_f32 v20, v20
  v_exp_f32 v21, v21
  v_exp_f32 v22, v22
  v_exp_f32 v23, v23
  v_pk_mul_f32 v[152:153], v[88:89], v[152:153]
  v_pk_mul_f32 v[154:155], v[90:91], v[154:155]
  v_pk_mul_f32 v[156:157], v[92:93], v[156:157]
  v_pk_mul_f32 v[158:159], v[94:95], v[158:159]
  v_pk_add_f32 v[16:17], v[16:17], v[212:213]
  v_pk_add_f32 v[18:19], v[18:19], v[212:213]
  v_pk_add_f32 v[20:21], v[20:21], v[212:213]
  v_pk_add_f32 v[22:23], v[22:23], v[212:213]
  v_rcp_f32 v16, v16
  v_rcp_f32 v17, v17
  v_rcp_f32 v18, v18
  v_rcp_f32 v19, v19
  v_rcp_f32 v20, v20
  v_rcp_f32 v21, v21
  v_rcp_f32 v22, v22
  v_rcp_f32 v23, v23
  s_nop 0
  v_pk_mul_f32 v[152:153], v[152:153], v[16:17]
  v_pk_mul_f32 v[154:155], v[154:155], v[18:19]
  v_pk_mul_f32 v[156:157], v[156:157], v[20:21]
  v_pk_mul_f32 v[158:159], v[158:159], v[22:23]
  v_cvt_pk_bf16_f32 v24, v152, v153
  v_cvt_pk_bf16_f32 v25, v154, v155
  v_cvt_pk_bf16_f32 v26, v156, v157
  v_cvt_pk_bf16_f32 v27, v158, v159
  s_add_u32 s38, s45, 0
  buffer_store_dwordx4 v[24:27], v209, s[28:31], s38 offen offset:3072 sc1
  v_pk_mul_f32 v[0:1], v[96:97], v[210:211] op_sel_hi:[1,0]
  v_pk_mul_f32 v[2:3], v[98:99], v[210:211] op_sel_hi:[1,0]
  v_pk_mul_f32 v[4:5], v[100:101], v[210:211] op_sel_hi:[1,0]
  v_pk_mul_f32 v[6:7], v[102:103], v[210:211] op_sel_hi:[1,0]
  v_exp_f32 v0, v0
  v_exp_f32 v1, v1
  v_exp_f32 v2, v2
  v_exp_f32 v3, v3
  v_exp_f32 v4, v4
  v_exp_f32 v5, v5
  v_exp_f32 v6, v6
  v_exp_f32 v7, v7
  v_pk_mul_f32 v[160:161], v[96:97], v[160:161]
  v_pk_mul_f32 v[162:163], v[98:99], v[162:163]
  v_pk_mul_f32 v[164:165], v[100:101], v[164:165]
  v_pk_mul_f32 v[166:167], v[102:103], v[166:167]
  v_pk_add_f32 v[0:1], v[0:1], v[212:213]
  v_pk_add_f32 v[2:3], v[2:3], v[212:213]
  v_pk_add_f32 v[4:5], v[4:5], v[212:213]
  v_pk_add_f32 v[6:7], v[6:7], v[212:213]
  v_rcp_f32 v0, v0
  v_rcp_f32 v1, v1
  v_rcp_f32 v2, v2
  v_rcp_f32 v3, v3
  v_rcp_f32 v4, v4
  v_rcp_f32 v5, v5
  v_rcp_f32 v6, v6
  v_rcp_f32 v7, v7
  s_nop 0
  v_pk_mul_f32 v[160:161], v[160:161], v[0:1]
  v_pk_mul_f32 v[162:163], v[162:163], v[2:3]
  v_pk_mul_f32 v[164:165], v[164:165], v[4:5]
  v_pk_mul_f32 v[166:167], v[166:167], v[6:7]
  v_cvt_pk_bf16_f32 v8, v160, v161
  v_cvt_pk_bf16_f32 v9, v162, v163
  v_cvt_pk_bf16_f32 v10, v164, v165
  v_cvt_pk_bf16_f32 v11, v166, v167
  s_add_u32 s38, s45, 4096
  buffer_store_dwordx4 v[8:11], v209, s[28:31], s38 offen offset:0 sc1
  v_pk_mul_f32 v[16:17], v[104:105], v[210:211] op_sel_hi:[1,0]
  v_pk_mul_f32 v[18:19], v[106:107], v[210:211] op_sel_hi:[1,0]
  v_pk_mul_f32 v[20:21], v[108:109], v[210:211] op_sel_hi:[1,0]
  v_pk_mul_f32 v[22:23], v[110:111], v[210:211] op_sel_hi:[1,0]
  v_exp_f32 v16, v16
  v_exp_f32 v17, v17
  v_exp_f32 v18, v18
  v_exp_f32 v19, v19
  v_exp_f32 v20, v20
  v_exp_f32 v21, v21
  v_exp_f32 v22, v22
  v_exp_f32 v23, v23
  v_pk_mul_f32 v[168:169], v[104:105], v[168:169]
  v_pk_mul_f32 v[170:171], v[106:107], v[170:171]
  v_pk_mul_f32 v[172:173], v[108:109], v[172:173]
  v_pk_mul_f32 v[174:175], v[110:111], v[174:175]
  v_pk_add_f32 v[16:17], v[16:17], v[212:213]
  v_pk_add_f32 v[18:19], v[18:19], v[212:213]
  v_pk_add_f32 v[20:21], v[20:21], v[212:213]
  v_pk_add_f32 v[22:23], v[22:23], v[212:213]
  v_rcp_f32 v16, v16
  v_rcp_f32 v17, v17
  v_rcp_f32 v18, v18
  v_rcp_f32 v19, v19
  v_rcp_f32 v20, v20
  v_rcp_f32 v21, v21
  v_rcp_f32 v22, v22
  v_rcp_f32 v23, v23
  s_nop 0
  v_pk_mul_f32 v[168:169], v[168:169], v[16:17]
  v_pk_mul_f32 v[170:171], v[170:171], v[18:19]
  v_pk_mul_f32 v[172:173], v[172:173], v[20:21]
  v_pk_mul_f32 v[174:175], v[174:175], v[22:23]
  v_cvt_pk_bf16_f32 v24, v168, v169
  v_cvt_pk_bf16_f32 v25, v170, v171
  v_cvt_pk_bf16_f32 v26, v172, v173
  v_cvt_pk_bf16_f32 v27, v174, v175
  s_add_u32 s38, s45, 4096
  buffer_store_dwordx4 v[24:27], v209, s[28:31], s38 offen offset:1024 sc1
  v_pk_mul_f32 v[0:1], v[112:113], v[210:211] op_sel_hi:[1,0]
  v_pk_mul_f32 v[2:3], v[114:115], v[210:211] op_sel_hi:[1,0]
  v_pk_mul_f32 v[4:5], v[116:117], v[210:211] op_sel_hi:[1,0]
  v_pk_mul_f32 v[6:7], v[118:119], v[210:211] op_sel_hi:[1,0]
  v_exp_f32 v0, v0
  v_exp_f32 v1, v1
  v_exp_f32 v2, v2
  v_exp_f32 v3, v3
  v_exp_f32 v4, v4
  v_exp_f32 v5, v5
  v_exp_f32 v6, v6
  v_exp_f32 v7, v7
  v_pk_mul_f32 v[176:177], v[112:113], v[176:177]
  v_pk_mul_f32 v[178:179], v[114:115], v[178:179]
  v_pk_mul_f32 v[180:181], v[116:117], v[180:181]
  v_pk_mul_f32 v[182:183], v[118:119], v[182:183]
  v_pk_add_f32 v[0:1], v[0:1], v[212:213]
  v_pk_add_f32 v[2:3], v[2:3], v[212:213]
  v_pk_add_f32 v[4:5], v[4:5], v[212:213]
  v_pk_add_f32 v[6:7], v[6:7], v[212:213]
  v_rcp_f32 v0, v0
  v_rcp_f32 v1, v1
  v_rcp_f32 v2, v2
  v_rcp_f32 v3, v3
  v_rcp_f32 v4, v4
  v_rcp_f32 v5, v5
  v_rcp_f32 v6, v6
  v_rcp_f32 v7, v7
  s_nop 0
  v_pk_mul_f32 v[176:177], v[176:177], v[0:1]
  v_pk_mul_f32 v[178:179], v[178:179], v[2:3]
  v_pk_mul_f32 v[180:181], v[180:181], v[4:5]
  v_pk_mul_f32 v[182:183], v[182:183], v[6:7]
  v_cvt_pk_bf16_f32 v8, v176, v177
  v_cvt_pk_bf16_f32 v9, v178, v179
  v_cvt_pk_bf16_f32 v10, v180, v181
  v_cvt_pk_bf16_f32 v11, v182, v183
  s_add_u32 s38, s45, 4096
  buffer_store_dwordx4 v[8:11], v209, s[28:31], s38 offen offset:2048 sc1
  v_pk_mul_f32 v[16:17], v[120:121], v[210:211] op_sel_hi:[1,0]
  v_pk_mul_f32 v[18:19], v[122:123], v[210:211] op_sel_hi:[1,0]
  v_pk_mul_f32 v[20:21], v[124:125], v[210:211] op_sel_hi:[1,0]
  v_pk_mul_f32 v[22:23], v[126:127], v[210:211] op_sel_hi:[1,0]
  v_exp_f32 v16, v16
  v_exp_f32 v17, v17
  v_exp_f32 v18, v18
  v_exp_f32 v19, v19
  v_exp_f32 v20, v20
  v_exp_f32 v21, v21
  v_exp_f32 v22, v22
  v_exp_f32 v23, v23
  v_pk_mul_f32 v[184:185], v[120:121], v[184:185]
  v_pk_mul_f32 v[186:187], v[122:123], v[186:187]
  v_pk_mul_f32 v[188:189], v[124:125], v[188:189]
  v_pk_mul_f32 v[190:191], v[126:127], v[190:191]
  v_pk_add_f32 v[16:17], v[16:17], v[212:213]
  v_pk_add_f32 v[18:19], v[18:19], v[212:213]
  v_pk_add_f32 v[20:21], v[20:21], v[212:213]
  v_pk_add_f32 v[22:23], v[22:23], v[212:213]
  v_rcp_f32 v16, v16
  v_rcp_f32 v17, v17
  v_rcp_f32 v18, v18
  v_rcp_f32 v19, v19
  v_rcp_f32 v20, v20
  v_rcp_f32 v21, v21
  v_rcp_f32 v22, v22
  v_rcp_f32 v23, v23
  s_nop 0
  v_pk_mul_f32 v[184:185], v[184:185], v[16:17]
  v_pk_mul_f32 v[186:187], v[186:187], v[18:19]
  v_pk_mul_f32 v[188:189], v[188:189], v[20:21]
  v_pk_mul_f32 v[190:191], v[190:191], v[22:23]
  v_cvt_pk_bf16_f32 v24, v184, v185
  v_cvt_pk_bf16_f32 v25, v186, v187
  v_cvt_pk_bf16_f32 v26, v188, v189
  v_cvt_pk_bf16_f32 v27, v190, v191
  s_add_u32 s38, s45, 4096
  buffer_store_dwordx4 v[24:27], v209, s[28:31], s38 offen offset:3072 sc1
  s_add_u32 s74, s36, 80
  s_lshl_b32 s74, s74, 8
E_PRE:
  s_load_dwordx2 s[6:7], s[0:1], 64
  s_load_dwordx2 s[8:9], s[0:1], 88
  s_and_b32 s33, s2, 7
  s_lshr_b32 s34, s2, 3
  s_and_b32 s36, s34, 3
  s_lshl_b32 s33, s33, 2
  s_add_u32 s36, s36, s33
  s_lshr_b32 s37, s34, 2
  v_lshrrev_b32 v2, 3, v245
  v_lshlrev_b32 v2, 10, v2
  v_bfe_u32 v3, v245, 4, 1
  v_lshlrev_b32 v3, 2, v3
  v_and_b32 v4, 7, v245
  v_xor_b32 v3, v3, v4
  v_lshlrev_b32 v3, 4, v3
  v_add_u32 v210, v2, v3
  v_add_u32 v211, 7168, v210
  v_lshlrev_b32 v212, 4, v245
  v_lshrrev_b32 v2, 5, v245
  v_bfe_u32 v3, v245, 4, 1
  v_bfe_u32 v4, v245, 2, 2
  v_and_b32 v5, 3, v245
  v_lshlrev_b32 v6, 2, v2
  v_add_u32 v6, v6, v4
  v_lshlrev_b32 v6, 7, v6
  v_and_b32 v7, 1, v5
  v_lshlrev_b32 v7, 3, v7
  v_add_u32 v6, v6, v7
  v_lshrrev_b32 v7, 1, v5
  v_lshlrev_b32 v8, 1, v3
  v_add_u32 v7, v7, v8
  v_lshrrev_b32 v8, 1, v4
  s_lshl_b32 s42, s3, 15
  v_xor_b32 v9, 0, v8
  v_lshlrev_b32 v9, 2, v9
  v_add_u32 v9, v9, v7
  v_lshlrev_b32 v9, 4, v9
  v_add_u32 v208, v6, v9
  v_add_u32 v208, s42, v208
  v_xor_b32 v9, 1, v8
  v_lshlrev_b32 v9, 2, v9
  v_add_u32 v9, v9, v7
  v_lshlrev_b32 v9, 4, v9
  v_add_u32 v209, v6, v9
  v_add_u32 v209, s42, v209
  s_mul_i32 s39, s3, 57344
  s_mul_i32 s38, s37, 229376
  s_add_u32 s39, s39, s38
  s_mul_i32 s40, s36, 229376
  s_mul_i32 s38, s3, 28672
  s_add_u32 s40, s40, s38
  s_add_u32 s41, s40, 114688
  s_waitcnt lgkmcnt(0)
  s_add_u32 s12, s4, 41943040
  s_addc_u32 s13, s5, 0
  s_mov_b32 s14, 1835008
  s_mov_b32 s15, 0x00020000
  s_add_u32 s16, s4, 25165824
  s_addc_u32 s17, s5, 0
  s_mov_b32 s18, 7340032
  s_mov_b32 s19, 0x00020000
  s_add_u32 s20, s4, 2228224
  s_addc_u32 s21, s5, 0
  s_mov_b32 s22, 65536
  s_mov_b32 s23, 0x00020000
  s_add_u32 s24, s4, 20971520
  s_addc_u32 s25, s5, 0
  s_mov_b32 s26, 2097152
  s_mov_b32 s27, 0x00020000
  s_mov_b32 s28, s8
  s_mov_b32 s29, s9
  s_mov_b32 s30, 2097152
  s_mov_b32 s31, 0x00020000
  s_waitcnt lgkmcnt(0)
  s_barrier
  s_lshr_b32 s70, s36, 1
  s_add_u32 s70, s70, 80
  s_lshl_b32 s70, s70, 8
  s_mov_b32 s71, 26368
  s_cmp_ge_u32 s2, 224
  s_cselect_b32 s74, s71, s74
  s_waitcnt vmcnt(0)
  s_barrier
  s_cmp_lg_u32 s3, 0
  s_cbranch_scc1 HO_69
  s_mov_b64 exec, 1
  v_mov_b32 v251, 1
  v_mov_b32 v252, s74
  buffer_atomic_add v251, v252, s[60:63], 0 offen sc1
  s_mov_b64 exec, -1
  s_add_u32 m0, s42, 0
  s_add_u32 s38, s39, 0
  buffer_load_dwordx4 v212, s[12:15], s38 offen sc1 lds
  buffer_load_dwordx4 v212, s[12:15], s38 offen offset:1024 sc1 lds
  s_add_u32 m0, s42, 2048
  s_add_u32 s38, s39, 2048
  buffer_load_dwordx4 v212, s[12:15], s38 offen sc1 lds
  buffer_load_dwordx4 v212, s[12:15], s38 offen offset:1024 sc1 lds
  s_add_u32 m0, s42, 4096
  s_add_u32 s38, s39, 4096
  buffer_load_dwordx4 v212, s[12:15], s38 offen sc1 lds
  buffer_load_dwordx4 v212, s[12:15], s38 offen offset:1024 sc1 lds
  s_add_u32 m0, s42, 6144
  s_add_u32 s38, s39, 6144
  buffer_load_dwordx4 v212, s[12:15], s38 offen sc1 lds
  buffer_load_dwordx4 v212, s[12:15], s38 offen offset:1024 sc1 lds
  s_add_u32 m0, s42, 8192
  s_add_u32 s38, s39, 8192
  buffer_load_dwordx4 v212, s[12:15], s38 offen sc1 lds
  buffer_load_dwordx4 v212, s[12:15], s38 offen offset:1024 sc1 lds
  s_mov_b64 exec, 1
  v_mov_b32 v252, s70
  s_mov_b32 s68, 0
POLL_72:
  buffer_load_dword v251, v252, s[60:63], 0 offen sc1
  s_waitcnt vmcnt(0)
  v_cmp_le_u32 vcc, 14, v251
  s_add_u32 s68, s68, 1
  s_cmp_eq_u64 vcc, exec
  s_cbranch_scc1 POK_73
  s_cmp_gt_u32 s68, 200000
  s_cbranch_scc1 POK_73
  s_sleep 1
  s_branch POLL_72
POK_73:
  s_mov_b64 exec, -1
  s_branch HW_68
HO_69:
  s_add_u32 m0, s42, 0
  s_add_u32 s38, s39, 0
  buffer_load_dwordx4 v212, s[12:15], s38 offen sc1 lds
  buffer_load_dwordx4 v212, s[12:15], s38 offen offset:1024 sc1 lds
  s_add_u32 m0, s42, 2048
  s_add_u32 s38, s39, 2048
  buffer_load_dwordx4 v212, s[12:15], s38 offen sc1 lds
  buffer_load_dwordx4 v212, s[12:15], s38 offen offset:1024 sc1 lds
  s_add_u32 m0, s42, 4096
  s_add_u32 s38, s39, 4096
  buffer_load_dwordx4 v212, s[12:15], s38 offen sc1 lds
  buffer_load_dwordx4 v212, s[12:15], s38 offen offset:1024 sc1 lds
  s_add_u32 m0, s42, 6144
  s_add_u32 s38, s39, 6144
  buffer_load_dwordx4 v212, s[12:15], s38 offen sc1 lds
  buffer_load_dwordx4 v212, s[12:15], s38 offen offset:1024 sc1 lds
  s_add_u32 m0, s42, 8192
  s_add_u32 s38, s39, 8192
  buffer_load_dwordx4 v212, s[12:15], s38 offen sc1 lds
  buffer_load_dwordx4 v212, s[12:15], s38 offen offset:1024 sc1 lds
  s_add_u32 m0, s42, 10240
  s_add_u32 s38, s39, 10240
  buffer_load_dwordx4 v212, s[12:15], s38 offen sc1 lds
  buffer_load_dwordx4 v212, s[12:15], s38 offen offset:1024 sc1 lds
  s_add_u32 m0, s42, 12288
  s_add_u32 s38, s39, 12288
  buffer_load_dwordx4 v212, s[12:15], s38 offen sc1 lds
  buffer_load_dwordx4 v212, s[12:15], s38 offen offset:1024 sc1 lds
  s_add_u32 m0, s42, 14336
  s_add_u32 s38, s39, 14336
  buffer_load_dwordx4 v212, s[12:15], s38 offen sc1 lds
  buffer_load_dwordx4 v212, s[12:15], s38 offen offset:1024 sc1 lds
  s_add_u32 m0, s42, 16384
  s_add_u32 s38, s39, 16384
  buffer_load_dwordx4 v212, s[12:15], s38 offen sc1 lds
  buffer_load_dwordx4 v212, s[12:15], s38 offen offset:1024 sc1 lds
  s_add_u32 m0, s42, 18432
  s_add_u32 s38, s39, 18432
  buffer_load_dwordx4 v212, s[12:15], s38 offen sc1 lds
  buffer_load_dwordx4 v212, s[12:15], s38 offen offset:1024 sc1 lds
  s_add_u32 m0, s42, 20480
  s_add_u32 s38, s39, 20480
  buffer_load_dwordx4 v212, s[12:15], s38 offen sc1 lds
  buffer_load_dwordx4 v212, s[12:15], s38 offen offset:1024 sc1 lds
  s_add_u32 m0, s42, 22528
  s_add_u32 s38, s39, 22528
  buffer_load_dwordx4 v212, s[12:15], s38 offen sc1 lds
  buffer_load_dwordx4 v212, s[12:15], s38 offen offset:1024 sc1 lds
  s_add_u32 m0, s42, 24576
  s_add_u32 s38, s39, 24576
  buffer_load_dwordx4 v212, s[12:15], s38 offen sc1 lds
  buffer_load_dwordx4 v212, s[12:15], s38 offen offset:1024 sc1 lds
  s_add_u32 m0, s42, 26624
  s_add_u32 s38, s39, 26624
  buffer_load_dwordx4 v212, s[12:15], s38 offen sc1 lds
  buffer_load_dwordx4 v212, s[12:15], s38 offen offset:1024 sc1 lds
  s_add_u32 m0, s42, 28672
  s_add_u32 s38, s39, 28672
  buffer_load_dwordx4 v212, s[12:15], s38 offen sc1 lds
  buffer_load_dwordx4 v212, s[12:15], s38 offen offset:1024 sc1 lds
  s_add_u32 m0, s42, 30720
  s_add_u32 s38, s39, 30720
  buffer_load_dwordx4 v212, s[12:15], s38 offen sc1 lds
  buffer_load_dwordx4 v212, s[12:15], s38 offen offset:1024 sc1 lds
HW_68:
  s_barrier
  s_cmp_lg_u32 s3, 0
  s_cbranch_scc1 HL_74
  s_add_u32 m0, s42, 10240
  s_add_u32 s38, s39, 10240
  buffer_load_dwordx4 v212, s[12:15], s38 offen sc1 lds
  buffer_load_dwordx4 v212, s[12:15], s38 offen offset:1024 sc1 lds
  s_add_u32 m0, s42, 12288
  s_add_u32 s38, s39, 12288
  buffer_load_dwordx4 v212, s[12:15], s38 offen sc1 lds
  buffer_load_dwordx4 v212, s[12:15], s38 offen offset:1024 sc1 lds
  s_add_u32 m0, s42, 14336
  s_add_u32 s38, s39, 14336
  buffer_load_dwordx4 v212, s[12:15], s38 offen sc1 lds
  buffer_load_dwordx4 v212, s[12:15], s38 offen offset:1024 sc1 lds
  s_add_u32 m0, s42, 16384
  s_add_u32 s38, s39, 16384
  buffer_load_dwordx4 v212, s[12:15], s38 offen sc1 lds
  buffer_load_dwordx4 v212, s[12:15], s38 offen offset:1024 sc1 lds
  s_add_u32 m0, s42, 18432
  s_add_u32 s38, s39, 18432
  buffer_load_dwordx4 v212, s[12:15], s38 offen sc1 lds
  buffer_load_dwordx4 v212, s[12:15], s38 offen offset:1024 sc1 lds
  s_add_u32 m0, s42, 20480
  s_add_u32 s38, s39, 20480
  buffer_load_dwordx4 v212, s[12:15], s38 offen sc1 lds
  buffer_load_dwordx4 v212, s[12:15], s38 offen offset:1024 sc1 lds
  s_add_u32 m0, s42, 22528
  s_add_u32 s38, s39, 22528
  buffer_load_dwordx4 v212, s[12:15], s38 offen sc1 lds
  buffer_load_dwordx4 v212, s[12:15], s38 offen offset:1024 sc1 lds
  s_add_u32 m0, s42, 24576
  s_add_u32 s38, s39, 24576
  buffer_load_dwordx4 v212, s[12:15], s38 offen sc1 lds
  buffer_load_dwordx4 v212, s[12:15], s38 offen offset:1024 sc1 lds
  s_add_u32 m0, s42, 26624
  s_add_u32 s38, s39, 26624
  buffer_load_dwordx4 v212, s[12:15], s38 offen sc1 lds
  buffer_load_dwordx4 v212, s[12:15], s38 offen offset:1024 sc1 lds
  s_add_u32 m0, s42, 28672
  s_add_u32 s38, s39, 28672
  buffer_load_dwordx4 v212, s[12:15], s38 offen sc1 lds
  buffer_load_dwordx4 v212, s[12:15], s38 offen offset:1024 sc1 lds
  s_add_u32 m0, s42, 30720
  s_add_u32 s38, s39, 30720
  buffer_load_dwordx4 v212, s[12:15], s38 offen sc1 lds
  buffer_load_dwordx4 v212, s[12:15], s38 offen offset:1024 sc1 lds
HL_74:
  s_add_u32 s43, s40, 0
  buffer_load_dwordx4 v[0:3], v212, s[16:19], s43 offen offset:0 sc1
  s_add_u32 s43, s41, 0
  buffer_load_dwordx4 v[4:7], v212, s[16:19], s43 offen offset:0 sc1
  s_add_u32 s43, s40, 0
  buffer_load_dwordx4 v[8:11], v212, s[16:19], s43 offen offset:1024 sc1
  s_add_u32 s43, s41, 0
  buffer_load_dwordx4 v[12:15], v212, s[16:19], s43 offen offset:1024 sc1
  s_add_u32 s43, s40, 0
  buffer_load_dwordx4 v[16:19], v212, s[16:19], s43 offen offset:2048 sc1
  s_add_u32 s43, s41, 0
  buffer_load_dwordx4 v[20:23], v212, s[16:19], s43 offen offset:2048 sc1
  s_add_u32 s43, s40, 0
  buffer_load_dwordx4 v[24:27], v212, s[16:19], s43 offen offset:3072 sc1
  s_add_u32 s43, s41, 0
  buffer_load_dwordx4 v[28:31], v212, s[16:19], s43 offen offset:3072 sc1
  s_add_u32 s43, s40, 4096
  buffer_load_dwordx4 v[32:35], v212, s[16:19], s43 offen offset:0 sc1
  s_add_u32 s43, s41, 4096
  buffer_load_dwordx4 v[36:39], v212, s[16:19], s43 offen offset:0 sc1
  s_add_u32 s43, s40, 4096
  buffer_load_dwordx4 v[40:43], v212, s[16:19], s43 offen offset:1024 sc1
  s_add_u32 s43, s41, 4096
  buffer_load_dwordx4 v[44:47], v212, s[16:19], s43 offen offset:1024 sc1
  s_add_u32 s43, s40, 4096
  buffer_load_dwordx4 v[48:51], v212, s[16:19], s43 offen offset:2048 sc1
  s_add_u32 s43, s41, 4096
  buffer_load_dwordx4 v[52:55], v212, s[16:19], s43 offen offset:2048 sc1
  s_add_u32 s43, s40, 4096
  buffer_load_dwordx4 v[56:59], v212, s[16:19], s43 offen offset:3072 sc1
  s_add_u32 s43, s41, 4096
  buffer_load_dwordx4 v[60:63], v212, s[16:19], s43 offen offset:3072 sc1
  s_add_u32 s43, s40, 8192
  buffer_load_dwordx4 v[64:67], v212, s[16:19], s43 offen offset:0 sc1
  s_add_u32 s43, s41, 8192
  buffer_load_dwordx4 v[68:71], v212, s[16:19], s43 offen offset:0 sc1
  s_add_u32 s43, s40, 8192
  buffer_load_dwordx4 v[72:75], v212, s[16:19], s43 offen offset:1024 sc1
  s_add_u32 s43, s41, 8192
  buffer_load_dwordx4 v[76:79], v212, s[16:19], s43 offen offset:1024 sc1
  s_waitcnt vmcnt(50)
  ds_read_b64_tr_b16 v[192:193], v208 offset:0
  ds_read_b64_tr_b16 v[194:195], v208 offset:1024
  ds_read_b64_tr_b16 v[196:197], v209 offset:0
  ds_read_b64_tr_b16 v[198:199], v209 offset:1024
  s_waitcnt vmcnt(18)
  s_waitcnt vmcnt(16)
  s_waitcnt lgkmcnt(0)
  s_add_u32 s43, s40, 8192
  v_mfma_f32_32x32x16_bf16 v[128:143], v[192:195], v[0:3], 0
  buffer_load_dwordx4 v[80:83], v212, s[16:19], s43 offen offset:2048 sc1
  ds_read_b64_tr_b16 v[200:201], v208 offset:2048
  ds_read_b64_tr_b16 v[202:203], v208 offset:3072
  s_add_u32 s43, s41, 8192
  v_mfma_f32_32x32x16_bf16 v[144:159], v[192:195], v[4:7], 0
  buffer_load_dwordx4 v[84:87], v212, s[16:19], s43 offen offset:2048 sc1
  ds_read_b64_tr_b16 v[204:205], v209 offset:2048
  ds_read_b64_tr_b16 v[206:207], v209 offset:3072
  v_mfma_f32_32x32x16_bf16 v[160:175], v[196:199], v[0:3], 0
  v_mfma_f32_32x32x16_bf16 v[176:191], v[196:199], v[4:7], 0
  s_waitcnt vmcnt(16)
  s_waitcnt lgkmcnt(0)
  s_add_u32 s43, s40, 8192
  v_mfma_f32_32x32x16_bf16 v[128:143], v[200:203], v[8:11], v[128:143]
  buffer_load_dwordx4 v[88:91], v212, s[16:19], s43 offen offset:3072 sc1
  ds_read_b64_tr_b16 v[192:193], v208 offset:4096
  ds_read_b64_tr_b16 v[194:195], v208 offset:5120
  s_add_u32 s43, s41, 8192
  v_mfma_f32_32x32x16_bf16 v[144:159], v[200:203], v[12:15], v[144:159]
  buffer_load_dwordx4 v[92:95], v212, s[16:19], s43 offen offset:3072 sc1
  ds_read_b64_tr_b16 v[196:197], v209 offset:4096
  ds_read_b64_tr_b16 v[198:199], v209 offset:5120
  v_mfma_f32_32x32x16_bf16 v[160:175], v[204:207], v[8:11], v[160:175]
  v_mfma_f32_32x32x16_bf16 v[176:191], v[204:207], v[12:15], v[176:191]
  s_waitcnt vmcnt(16)
  s_waitcnt lgkmcnt(0)
  s_add_u32 m0, s42, 0
  s_add_u32 s38, s39, 32768
  v_mfma_f32_32x32x16_bf16 v[128:143], v[192:195], v[16:19], v[128:143]
  buffer_load_dwordx4 v212, s[12:15], s38 offen sc1 lds
  ds_read_b64_tr_b16 v[200:201], v208 offset:6144
  ds_read_b64_tr_b16 v[202:203], v208 offset:7168
  v_mfma_f32_32x32x16_bf16 v[144:159], v[192:195], v[20:23], v[144:159]
  buffer_load_dwordx4 v212, s[12:15], s38 offen offset:1024 sc1 lds
  ds_read_b64_tr_b16 v[204:205], v209 offset:6144
  ds_read_b64_tr_b16 v[206:207], v209 offset:7168
  s_add_u32 s43, s40, 12288
  v_mfma_f32_32x32x16_bf16 v[160:175], v[196:199], v[16:19], v[160:175]
  buffer_load_dwordx4 v[96:99], v212, s[16:19], s43 offen offset:0 sc1
  s_add_u32 s43, s41, 12288
  v_mfma_f32_32x32x16_bf16 v[176:191], v[196:199], v[20:23], v[176:191]
  buffer_load_dwordx4 v[100:103], v212, s[16:19], s43 offen offset:0 sc1
  s_waitcnt vmcnt(18)
  s_waitcnt lgkmcnt(0)
  s_add_u32 m0, s42, 2048
  s_add_u32 s38, s39, 34816
  v_mfma_f32_32x32x16_bf16 v[128:143], v[200:203], v[24:27], v[128:143]
  buffer_load_dwordx4 v212, s[12:15], s38 offen sc1 lds
  ds_read_b64_tr_b16 v[192:193], v208 offset:8192
  ds_read_b64_tr_b16 v[194:195], v208 offset:9216
  v_mfma_f32_32x32x16_bf16 v[144:159], v[200:203], v[28:31], v[144:159]
  buffer_load_dwordx4 v212, s[12:15], s38 offen offset:1024 sc1 lds
  ds_read_b64_tr_b16 v[196:197], v209 offset:8192
  ds_read_b64_tr_b16 v[198:199], v209 offset:9216
  s_add_u32 s43, s40, 12288
  v_mfma_f32_32x32x16_bf16 v[160:175], v[204:207], v[24:27], v[160:175]
  buffer_load_dwordx4 v[104:107], v212, s[16:19], s43 offen offset:1024 sc1
  s_add_u32 s43, s41, 12288
  v_mfma_f32_32x32x16_bf16 v[176:191], v[204:207], v[28:31], v[176:191]
  buffer_load_dwordx4 v[108:111], v212, s[16:19], s43 offen offset:1024 sc1
  s_waitcnt vmcnt(20)
  s_waitcnt lgkmcnt(0)
  s_add_u32 m0, s42, 4096
  s_add_u32 s38, s39, 36864
  v_mfma_f32_32x32x16_bf16 v[128:143], v[192:195], v[32:35], v[128:143]
  buffer_load_dwordx4 v212, s[12:15], s38 offen sc1 lds
  ds_read_b64_tr_b16 v[200:201], v208 offset:10240
  ds_read_b64_tr_b16 v[202:203], v208 offset:11264
  v_mfma_f32_32x32x16_bf16 v[144:159], v[192:195], v[36:39], v[144:159]
  buffer_load_dwordx4 v212, s[12:15], s38 offen offset:1024 sc1 lds
  ds_read_b64_tr_b16 v[204:205], v209 offset:10240
  ds_read_b64_tr_b16 v[206:207], v209 offset:11264
  s_add_u32 s43, s40, 12288
  v_mfma_f32_32x32x16_bf16 v[160:175], v[196:199], v[32:35], v[160:175]
  buffer_load_dwordx4 v[112:115], v212, s[16:19], s43 offen offset:2048 sc1
  s_add_u32 s43, s41, 12288
  v_mfma_f32_32x32x16_bf16 v[176:191], v[196:199], v[36:39], v[176:191]
  buffer_load_dwordx4 v[116:119], v212, s[16:19], s43 offen offset:2048 sc1
  s_waitcnt vmcnt(22)
  s_waitcnt lgkmcnt(0)
  s_add_u32 m0, s42, 6144
  s_add_u32 s38, s39, 38912
  v_mfma_f32_32x32x16_bf16 v[128:143], v[200:203], v[40:43], v[128:143]
  buffer_load_dwordx4 v212, s[12:15], s38 offen sc1 lds
  ds_read_b64_tr_b16 v[192:193], v208 offset:12288
  ds_read_b64_tr_b16 v[194:195], v208 offset:13312
  v_mfma_f32_32x32x16_bf16 v[144:159], v[200:203], v[44:47], v[144:159]
  buffer_load_dwordx4 v212, s[12:15], s38 offen offset:1024 sc1 lds
  ds_read_b64_tr_b16 v[196:197], v209 offset:12288
  ds_read_b64_tr_b16 v[198:199], v209 offset:13312
  s_add_u32 s43, s40, 12288
  v_mfma_f32_32x32x16_bf16 v[160:175], v[204:207], v[40:43], v[160:175]
  buffer_load_dwordx4 v[120:123], v212, s[16:19], s43 offen offset:3072 sc1
  s_add_u32 s43, s41, 12288
  v_mfma_f32_32x32x16_bf16 v[176:191], v[204:207], v[44:47], v[176:191]
  buffer_load_dwordx4 v[124:127], v212, s[16:19], s43 offen offset:3072 sc1
  s_waitcnt vmcnt(24)
  s_waitcnt lgkmcnt(0)
  s_add_u32 m0, s42, 8192
  s_add_u32 s38, s39, 40960
  v_mfma_f32_32x32x16_bf16 v[128:143], v[192:195], v[48:51], v[128:143]
  buffer_load_dwordx4 v212, s[12:15], s38 offen sc1 lds
  ds_read_b64_tr_b16 v[200:201], v208 offset:14336
  ds_read_b64_tr_b16 v[202:203], v208 offset:15360
  v_mfma_f32_32x32x16_bf16 v[144:159], v[192:195], v[52:55], v[144:159]
  buffer_load_dwordx4 v212, s[12:15], s38 offen offset:1024 sc1 lds
  ds_read_b64_tr_b16 v[204:205], v209 offset:14336
  ds_read_b64_tr_b16 v[206:207], v209 offset:15360
  s_add_u32 s43, s40, 16384
  v_mfma_f32_32x32x16_bf16 v[160:175], v[196:199], v[48:51], v[160:175]
  buffer_load_dwordx4 v[0:3], v212, s[16:19], s43 offen offset:0 sc1
  s_add_u32 s43, s41, 16384
  v_mfma_f32_32x32x16_bf16 v[176:191], v[196:199], v[52:55], v[176:191]
  buffer_load_dwordx4 v[4:7], v212, s[16:19], s43 offen offset:0 sc1
  s_waitcnt vmcnt(26)
  s_waitcnt lgkmcnt(0)
  s_add_u32 m0, s42, 10240
  s_add_u32 s38, s39, 43008
  v_mfma_f32_32x32x16_bf16 v[128:143], v[200:203], v[56:59], v[128:143]
  buffer_load_dwordx4 v212, s[12:15], s38 offen sc1 lds
  ds_read_b64_tr_b16 v[192:193], v208 offset:16384
  ds_read_b64_tr_b16 v[194:195], v208 offset:17408
  v_mfma_f32_32x32x16_bf16 v[144:159], v[200:203], v[60:63], v[144:159]
  buffer_load_dwordx4 v212, s[12:15], s38 offen offset:1024 sc1 lds
  ds_read_b64_tr_b16 v[196:197], v209 offset:16384
  ds_read_b64_tr_b16 v[198:199], v209 offset:17408
  s_add_u32 s43, s40, 16384
  v_mfma_f32_32x32x16_bf16 v[160:175], v[204:207], v[56:59], v[160:175]
  buffer_load_dwordx4 v[8:11], v212, s[16:19], s43 offen offset:1024 sc1
  s_add_u32 s43, s41, 16384
  v_mfma_f32_32x32x16_bf16 v[176:191], v[204:207], v[60:63], v[176:191]
  buffer_load_dwordx4 v[12:15], v212, s[16:19], s43 offen offset:1024 sc1
  s_waitcnt vmcnt(28)
  s_waitcnt lgkmcnt(0)
  s_add_u32 m0, s42, 12288
  s_add_u32 s38, s39, 45056
  v_mfma_f32_32x32x16_bf16 v[128:143], v[192:195], v[64:67], v[128:143]
  buffer_load_dwordx4 v212, s[12:15], s38 offen sc1 lds
  ds_read_b64_tr_b16 v[200:201], v208 offset:18432
  ds_read_b64_tr_b16 v[202:203], v208 offset:19456
  v_mfma_f32_32x32x16_bf16 v[144:159], v[192:195], v[68:71], v[144:159]
  buffer_load_dwordx4 v212, s[12:15], s38 offen offset:1024 sc1 lds
  ds_read_b64_tr_b16 v[204:205], v209 offset:18432
  ds_read_b64_tr_b16 v[206:207], v209 offset:19456
  s_add_u32 s43, s40, 16384
  v_mfma_f32_32x32x16_bf16 v[160:175], v[196:199], v[64:67], v[160:175]
  buffer_load_dwordx4 v[16:19], v212, s[16:19], s43 offen offset:2048 sc1
  s_add_u32 s43, s41, 16384
  v_mfma_f32_32x32x16_bf16 v[176:191], v[196:199], v[68:71], v[176:191]
  buffer_load_dwordx4 v[20:23], v212, s[16:19], s43 offen offset:2048 sc1
  s_waitcnt vmcnt(30)
  s_waitcnt lgkmcnt(0)
  s_add_u32 m0, s42, 14336
  s_add_u32 s38, s39, 47104
  v_mfma_f32_32x32x16_bf16 v[128:143], v[200:203], v[72:75], v[128:143]
  buffer_load_dwordx4 v212, s[12:15], s38 offen sc1 lds
  ds_read_b64_tr_b16 v[192:193], v208 offset:20480
  ds_read_b64_tr_b16 v[194:195], v208 offset:21504
  v_mfma_f32_32x32x16_bf16 v[144:159], v[200:203], v[76:79], v[144:159]
  buffer_load_dwordx4 v212, s[12:15], s38 offen offset:1024 sc1 lds
  ds_read_b64_tr_b16 v[196:197], v209 offset:20480
  ds_read_b64_tr_b16 v[198:199], v209 offset:21504
  s_add_u32 s43, s40, 16384
  v_mfma_f32_32x32x16_bf16 v[160:175], v[204:207], v[72:75], v[160:175]
  buffer_load_dwordx4 v[24:27], v212, s[16:19], s43 offen offset:3072 sc1
  s_add_u32 s43, s41, 16384
  v_mfma_f32_32x32x16_bf16 v[176:191], v[204:207], v[76:79], v[176:191]
  buffer_load_dwordx4 v[28:31], v212, s[16:19], s43 offen offset:3072 sc1
  s_waitcnt vmcnt(32)
  s_waitcnt lgkmcnt(0)
  s_add_u32 m0, s42, 16384
  s_add_u32 s38, s39, 49152
  v_mfma_f32_32x32x16_bf16 v[128:143], v[192:195], v[80:83], v[128:143]
  buffer_load_dwordx4 v212, s[12:15], s38 offen sc1 lds
  ds_read_b64_tr_b16 v[200:201], v208 offset:22528
  ds_read_b64_tr_b16 v[202:203], v208 offset:23552
  v_mfma_f32_32x32x16_bf16 v[144:159], v[192:195], v[84:87], v[144:159]
  buffer_load_dwordx4 v212, s[12:15], s38 offen offset:1024 sc1 lds
  ds_read_b64_tr_b16 v[204:205], v209 offset:22528
  ds_read_b64_tr_b16 v[206:207], v209 offset:23552
  s_add_u32 s43, s40, 20480
  v_mfma_f32_32x32x16_bf16 v[160:175], v[196:199], v[80:83], v[160:175]
  buffer_load_dwordx4 v[32:35], v212, s[16:19], s43 offen offset:0 sc1
  s_add_u32 s43, s41, 20480
  v_mfma_f32_32x32x16_bf16 v[176:191], v[196:199], v[84:87], v[176:191]
  buffer_load_dwordx4 v[36:39], v212, s[16:19], s43 offen offset:0 sc1
  s_waitcnt vmcnt(32)
  s_waitcnt lgkmcnt(0)
  s_add_u32 m0, s42, 18432
  s_add_u32 s38, s39, 51200
  v_mfma_f32_32x32x16_bf16 v[128:143], v[200:203], v[88:91], v[128:143]
  buffer_load_dwordx4 v212, s[12:15], s38 offen sc1 lds
  ds_read_b64_tr_b16 v[192:193], v208 offset:24576
  ds_read_b64_tr_b16 v[194:195], v208 offset:25600
  v_mfma_f32_32x32x16_bf16 v[144:159], v[200:203], v[92:95], v[144:159]
  buffer_load_dwordx4 v212, s[12:15], s38 offen offset:1024 sc1 lds
  ds_read_b64_tr_b16 v[196:197], v209 offset:24576
  ds_read_b64_tr_b16 v[198:199], v209 offset:25600
  s_add_u32 s43, s40, 20480
  v_mfma_f32_32x32x16_bf16 v[160:175], v[204:207], v[88:91], v[160:175]
  buffer_load_dwordx4 v[40:43], v212, s[16:19], s43 offen offset:1024 sc1
  s_add_u32 s43, s41, 20480
  v_mfma_f32_32x32x16_bf16 v[176:191], v[204:207], v[92:95], v[176:191]
  buffer_load_dwordx4 v[44:47], v212, s[16:19], s43 offen offset:1024 sc1
  s_waitcnt vmcnt(32)
  s_waitcnt lgkmcnt(0)
  s_add_u32 m0, s42, 20480
  s_add_u32 s38, s39, 53248
  v_mfma_f32_32x32x16_bf16 v[128:143], v[192:195], v[96:99], v[128:143]
  buffer_load_dwordx4 v212, s[12:15], s38 offen sc1 lds
  ds_read_b64_tr_b16 v[200:201], v208 offset:26624
  ds_read_b64_tr_b16 v[202:203], v208 offset:27648
  v_mfma_f32_32x32x16_bf16 v[144:159], v[192:195], v[100:103], v[144:159]
  buffer_load_dwordx4 v212, s[12:15], s38 offen offset:1024 sc1 lds
  ds_read_b64_tr_b16 v[204:205], v209 offset:26624
  ds_read_b64_tr_b16 v[206:207], v209 offset:27648
  s_add_u32 s43, s40, 20480
  v_mfma_f32_32x32x16_bf16 v[160:175], v[196:199], v[96:99], v[160:175]
  buffer_load_dwordx4 v[48:51], v212, s[16:19], s43 offen offset:2048 sc1
  s_add_u32 s43, s41, 20480
  v_mfma_f32_32x32x16_bf16 v[176:191], v[196:199], v[100:103], v[176:191]
  buffer_load_dwordx4 v[52:55], v212, s[16:19], s43 offen offset:2048 sc1
  s_waitcnt vmcnt(32)
  s_waitcnt lgkmcnt(0)
  s_add_u32 m0, s42, 22528
  s_add_u32 s38, s39, 55296
  v_mfma_f32_32x32x16_bf16 v[128:143], v[200:203], v[104:107], v[128:143]
  buffer_load_dwordx4 v212, s[12:15], s38 offen sc1 lds
  ds_read_b64_tr_b16 v[192:193], v208 offset:28672
  ds_read_b64_tr_b16 v[194:195], v208 offset:29696
  v_mfma_f32_32x32x16_bf16 v[144:159], v[200:203], v[108:111], v[144:159]
  buffer_load_dwordx4 v212, s[12:15], s38 offen offset:1024 sc1 lds
  ds_read_b64_tr_b16 v[196:197], v209 offset:28672
  ds_read_b64_tr_b16 v[198:199], v209 offset:29696
  s_add_u32 s43, s40, 20480
  v_mfma_f32_32x32x16_bf16 v[160:175], v[204:207], v[104:107], v[160:175]
  buffer_load_dwordx4 v[56:59], v212, s[16:19], s43 offen offset:3072 sc1
  s_add_u32 s43, s41, 20480
  v_mfma_f32_32x32x16_bf16 v[176:191], v[204:207], v[108:111], v[176:191]
  buffer_load_dwordx4 v[60:63], v212, s[16:19], s43 offen offset:3072 sc1
  s_waitcnt vmcnt(32)
  s_waitcnt lgkmcnt(0)
  s_add_u32 s43, s40, 24576
  v_mfma_f32_32x32x16_bf16 v[128:143], v[192:195], v[112:115], v[128:143]
  buffer_load_dwordx4 v[64:67], v212, s[16:19], s43 offen offset:0 sc1
  ds_read_b64_tr_b16 v[200:201], v208 offset:30720
  ds_read_b64_tr_b16 v[202:203], v208 offset:31744
  s_add_u32 s43, s41, 24576
  v_mfma_f32_32x32x16_bf16 v[144:159], v[192:195], v[116:119], v[144:159]
  buffer_load_dwordx4 v[68:71], v212, s[16:19], s43 offen offset:0 sc1
  ds_read_b64_tr_b16 v[204:205], v209 offset:30720
  ds_read_b64_tr_b16 v[206:207], v209 offset:31744
  v_mfma_f32_32x32x16_bf16 v[160:175], v[196:199], v[112:115], v[160:175]
  v_mfma_f32_32x32x16_bf16 v[176:191], v[196:199], v[116:119], v[176:191]
  s_waitcnt vmcnt(30)
  s_waitcnt lgkmcnt(0)
  s_add_u32 s43, s40, 24576
  v_mfma_f32_32x32x16_bf16 v[128:143], v[200:203], v[120:123], v[128:143]
  buffer_load_dwordx4 v[72:75], v212, s[16:19], s43 offen offset:1024 sc1
  ds_read_b64_tr_b16 v[192:193], v208 offset:0
  ds_read_b64_tr_b16 v[194:195], v208 offset:1024
  s_add_u32 s43, s41, 24576
  v_mfma_f32_32x32x16_bf16 v[144:159], v[200:203], v[124:127], v[144:159]
  buffer_load_dwordx4 v[76:79], v212, s[16:19], s43 offen offset:1024 sc1
  ds_read_b64_tr_b16 v[196:197], v209 offset:0
  ds_read_b64_tr_b16 v[198:199], v209 offset:1024
  v_mfma_f32_32x32x16_bf16 v[160:175], v[204:207], v[120:123], v[160:175]
  v_mfma_f32_32x32x16_bf16 v[176:191], v[204:207], v[124:127], v[176:191]
  s_waitcnt vmcnt(28)
  s_waitcnt lgkmcnt(0)
  s_add_u32 s43, s40, 24576
  v_mfma_f32_32x32x16_bf16 v[128:143], v[192:195], v[0:3], v[128:143]
  buffer_load_dwordx4 v[80:83], v212, s[16:19], s43 offen offset:2048 sc1
  ds_read_b64_tr_b16 v[200:201], v208 offset:2048
  ds_read_b64_tr_b16 v[202:203], v208 offset:3072
  s_add_u32 s43, s41, 24576
  v_mfma_f32_32x32x16_bf16 v[144:159], v[192:195], v[4:7], v[144:159]
  buffer_load_dwordx4 v[84:87], v212, s[16:19], s43 offen offset:2048 sc1
  ds_read_b64_tr_b16 v[204:205], v209 offset:2048
  ds_read_b64_tr_b16 v[206:207], v209 offset:3072
  v_mfma_f32_32x32x16_bf16 v[160:175], v[196:199], v[0:3], v[160:175]
  v_mfma_f32_32x32x16_bf16 v[176:191], v[196:199], v[4:7], v[176:191]
  s_waitcnt vmcnt(26)
  s_waitcnt lgkmcnt(0)
  s_add_u32 s43, s40, 24576
  v_mfma_f32_32x32x16_bf16 v[128:143], v[200:203], v[8:11], v[128:143]
  buffer_load_dwordx4 v[88:91], v212, s[16:19], s43 offen offset:3072 sc1
  ds_read_b64_tr_b16 v[192:193], v208 offset:4096
  ds_read_b64_tr_b16 v[194:195], v208 offset:5120
  s_add_u32 s43, s41, 24576
  v_mfma_f32_32x32x16_bf16 v[144:159], v[200:203], v[12:15], v[144:159]
  buffer_load_dwordx4 v[92:95], v212, s[16:19], s43 offen offset:3072 sc1
  ds_read_b64_tr_b16 v[196:197], v209 offset:4096
  ds_read_b64_tr_b16 v[198:199], v209 offset:5120
  v_mfma_f32_32x32x16_bf16 v[160:175], v[204:207], v[8:11], v[160:175]
  v_mfma_f32_32x32x16_bf16 v[176:191], v[204:207], v[12:15], v[176:191]
  s_waitcnt vmcnt(24)
  s_waitcnt lgkmcnt(0)
  v_mfma_f32_32x32x16_bf16 v[128:143], v[192:195], v[16:19], v[128:143]
  ds_read_b64_tr_b16 v[200:201], v208 offset:6144
  ds_read_b64_tr_b16 v[202:203], v208 offset:7168
  v_mfma_f32_32x32x16_bf16 v[144:159], v[192:195], v[20:23], v[144:159]
  ds_read_b64_tr_b16 v[204:205], v209 offset:6144
  ds_read_b64_tr_b16 v[206:207], v209 offset:7168
  v_mfma_f32_32x32x16_bf16 v[160:175], v[196:199], v[16:19], v[160:175]
  v_mfma_f32_32x32x16_bf16 v[176:191], v[196:199], v[20:23], v[176:191]
  s_waitcnt vmcnt(20)
  s_waitcnt lgkmcnt(0)
  v_mfma_f32_32x32x16_bf16 v[128:143], v[200:203], v[24:27], v[128:143]
  ds_read_b64_tr_b16 v[192:193], v208 offset:8192
  ds_read_b64_tr_b16 v[194:195], v208 offset:9216
  v_mfma_f32_32x32x16_bf16 v[144:159], v[200:203], v[28:31], v[144:159]
  ds_read_b64_tr_b16 v[196:197], v209 offset:8192
  ds_read_b64_tr_b16 v[198:199], v209 offset:9216
  v_mfma_f32_32x32x16_bf16 v[160:175], v[204:207], v[24:27], v[160:175]
  v_mfma_f32_32x32x16_bf16 v[176:191], v[204:207], v[28:31], v[176:191]
  s_waitcnt vmcnt(16)
  s_waitcnt lgkmcnt(0)
  v_mfma_f32_32x32x16_bf16 v[128:143], v[192:195], v[32:35], v[128:143]
  ds_read_b64_tr_b16 v[200:201], v208 offset:10240
  ds_read_b64_tr_b16 v[202:203], v208 offset:11264
  v_mfma_f32_32x32x16_bf16 v[144:159], v[192:195], v[36:39], v[144:159]
  ds_read_b64_tr_b16 v[204:205], v209 offset:10240
  ds_read_b64_tr_b16 v[206:207], v209 offset:11264
  v_mfma_f32_32x32x16_bf16 v[160:175], v[196:199], v[32:35], v[160:175]
  v_mfma_f32_32x32x16_bf16 v[176:191], v[196:199], v[36:39], v[176:191]
  s_waitcnt vmcnt(12)
  s_waitcnt lgkmcnt(0)
  v_mfma_f32_32x32x16_bf16 v[128:143], v[200:203], v[40:43], v[128:143]
  ds_read_b64_tr_b16 v[192:193], v208 offset:12288
  ds_read_b64_tr_b16 v[194:195], v208 offset:13312
  v_mfma_f32_32x32x16_bf16 v[144:159], v[200:203], v[44:47], v[144:159]
  ds_read_b64_tr_b16 v[196:197], v209 offset:12288
  ds_read_b64_tr_b16 v[198:199], v209 offset:13312
  v_mfma_f32_32x32x16_bf16 v[160:175], v[204:207], v[40:43], v[160:175]
  v_mfma_f32_32x32x16_bf16 v[176:191], v[204:207], v[44:47], v[176:191]
  s_waitcnt vmcnt(8)
  s_waitcnt lgkmcnt(0)
  v_mfma_f32_32x32x16_bf16 v[128:143], v[192:195], v[48:51], v[128:143]
  ds_read_b64_tr_b16 v[200:201], v208 offset:14336
  ds_read_b64_tr_b16 v[202:203], v208 offset:15360
  v_mfma_f32_32x32x16_bf16 v[144:159], v[192:195], v[52:55], v[144:159]
  ds_read_b64_tr_b16 v[204:205], v209 offset:14336
  ds_read_b64_tr_b16 v[206:207], v209 offset:15360
  v_mfma_f32_32x32x16_bf16 v[160:175], v[196:199], v[48:51], v[160:175]
  v_mfma_f32_32x32x16_bf16 v[176:191], v[196:199], v[52:55], v[176:191]
  s_waitcnt vmcnt(6)
  s_waitcnt lgkmcnt(0)
  v_mfma_f32_32x32x16_bf16 v[128:143], v[200:203], v[56:59], v[128:143]
  ds_read_b64_tr_b16 v[192:193], v208 offset:16384
  ds_read_b64_tr_b16 v[194:195], v208 offset:17408
  v_mfma_f32_32x32x16_bf16 v[144:159], v[200:203], v[60:63], v[144:159]
  ds_read_b64_tr_b16 v[196:197], v209 offset:16384
  ds_read_b64_tr_b16 v[198:199], v209 offset:17408
  v_mfma_f32_32x32x16_bf16 v[160:175], v[204:207], v[56:59], v[160:175]
  v_mfma_f32_32x32x16_bf16 v[176:191], v[204:207], v[60:63], v[176:191]
  s_waitcnt vmcnt(4)
  s_waitcnt lgkmcnt(0)
  v_mfma_f32_32x32x16_bf16 v[128:143], v[192:195], v[64:67], v[128:143]
  ds_read_b64_tr_b16 v[200:201], v208 offset:18432
  ds_read_b64_tr_b16 v[202:203], v208 offset:19456
  v_mfma_f32_32x32x16_bf16 v[144:159], v[192:195], v[68:71], v[144:159]
  ds_read_b64_tr_b16 v[204:205], v209 offset:18432
  ds_read_b64_tr_b16 v[206:207], v209 offset:19456
  v_mfma_f32_32x32x16_bf16 v[160:175], v[196:199], v[64:67], v[160:175]
  v_mfma_f32_32x32x16_bf16 v[176:191], v[196:199], v[68:71], v[176:191]
  s_waitcnt vmcnt(2)
  s_waitcnt lgkmcnt(0)
  v_mfma_f32_32x32x16_bf16 v[128:143], v[200:203], v[72:75], v[128:143]
  ds_read_b64_tr_b16 v[192:193], v208 offset:20480
  ds_read_b64_tr_b16 v[194:195], v208 offset:21504
  v_mfma_f32_32x32x16_bf16 v[144:159], v[200:203], v[76:79], v[144:159]
  ds_read_b64_tr_b16 v[196:197], v209 offset:20480
  ds_read_b64_tr_b16 v[198:199], v209 offset:21504
  v_mfma_f32_32x32x16_bf16 v[160:175], v[204:207], v[72:75], v[160:175]
  v_mfma_f32_32x32x16_bf16 v[176:191], v[204:207], v[76:79], v[176:191]
  s_waitcnt vmcnt(0)
  s_waitcnt lgkmcnt(0)
  v_mfma_f32_32x32x16_bf16 v[128:143], v[192:195], v[80:83], v[128:143]
  ds_read_b64_tr_b16 v[200:201], v208 offset:22528
  ds_read_b64_tr_b16 v[202:203], v208 offset:23552
  v_mfma_f32_32x32x16_bf16 v[144:159], v[192:195], v[84:87], v[144:159]
  ds_read_b64_tr_b16 v[204:205], v209 offset:22528
  ds_read_b64_tr_b16 v[206:207], v209 offset:23552
  v_mfma_f32_32x32x16_bf16 v[160:175], v[196:199], v[80:83], v[160:175]
  v_mfma_f32_32x32x16_bf16 v[176:191], v[196:199], v[84:87], v[176:191]
  s_waitcnt lgkmcnt(0)
  v_mfma_f32_32x32x16_bf16 v[128:143], v[200:203], v[88:91], v[128:143]
  v_mfma_f32_32x32x16_bf16 v[144:159], v[200:203], v[92:95], v[144:159]
  v_mfma_f32_32x32x16_bf16 v[160:175], v[204:207], v[88:91], v[160:175]
  v_mfma_f32_32x32x16_bf16 v[176:191], v[204:207], v[92:95], v[176:191]
  s_lshr_b32 s46, s3, 1
  s_and_b32 s47, s3, 1
  s_lshl_b32 s48, s36, 1
  s_add_u32 s48, s48, s47
  s_lshl_b32 s49, s37, 2
  s_lshl_b32 s50, s46, 1
  s_add_u32 s49, s49, s50
  s_lshl_b32 s50, s48, 5
  s_add_u32 s50, s50, s49
  s_lshl_b32 s50, s50, 10
  v_and_b32 v2, 31, v245
  v_lshlrev_b32 v2, 10, v2
  v_lshrrev_b32 v3, 5, v245
  v_lshlrev_b32 v4, 4, v3
  v_add_u32 v2, v2, v4
  s_lshl_b32 s51, s48, 15
  s_lshl_b32 s33, s49, 5
  s_add_u32 s51, s51, s33
  buffer_load_dwordx4 v[8:11], v212, s[24:27], s50 offen offset:0 sc1
  buffer_load_dwordx4 v[12:15], v212, s[24:27], s50 offen offset:1024 sc1
  s_nop 11
  s_waitcnt lgkmcnt(0)
  s_barrier
  s_lshl_b32 s33, s3, 14
  v_add_u32 v5, s33, v212
  ds_write_b128 v5, v[128:131] offset:0
  ds_write_b128 v5, v[132:135] offset:1024
  ds_write_b128 v5, v[136:139] offset:2048
  ds_write_b128 v5, v[140:143] offset:3072
  ds_write_b128 v5, v[144:147] offset:4096
  ds_write_b128 v5, v[148:151] offset:5120
  ds_write_b128 v5, v[152:155] offset:6144
  ds_write_b128 v5, v[156:159] offset:7168
  ds_write_b128 v5, v[160:163] offset:8192
  ds_write_b128 v5, v[164:167] offset:9216
  ds_write_b128 v5, v[168:171] offset:10240
  ds_write_b128 v5, v[172:175] offset:11264
  ds_write_b128 v5, v[176:179] offset:12288
  ds_write_b128 v5, v[180:183] offset:13312
  ds_write_b128 v5, v[184:187] offset:14336
  ds_write_b128 v5, v[188:191] offset:15360
  v_lshlrev_b32 v6, 4, v3
  s_lshl_b32 s33, s46, 7
  s_lshl_b32 s34, s37, 8
  s_add_u32 s33, s33, s34
  s_add_u32 s33, s33, 145408
  v_add_u32 v6, s33, v6
  ds_read_b128 v[16:19], v6 offset:0
  ds_read_b128 v[20:23], v6 offset:32
  ds_read_b128 v[24:27], v6 offset:64
  ds_read_b128 v[28:31], v6 offset:96
  s_lshl_b32 s33, s3, 12
  v_add_u32 v5, s33, v212
  s_waitcnt lgkmcnt(0)
  s_barrier
  ds_read_b128 v[32:35], v5 offset:0
  ds_read_b128 v[36:39], v5 offset:1024
  ds_read_b128 v[40:43], v5 offset:2048
  ds_read_b128 v[44:47], v5 offset:3072
  ds_read_b128 v[48:51], v5 offset:16384
  ds_read_b128 v[52:55], v5 offset:17408
  ds_read_b128 v[56:59], v5 offset:18432
  ds_read_b128 v[60:63], v5 offset:19456
  ds_read_b128 v[64:67], v5 offset:32768
  ds_read_b128 v[68:71], v5 offset:33792
  ds_read_b128 v[72:75], v5 offset:34816
  ds_read_b128 v[76:79], v5 offset:35840
  ds_read_b128 v[80:83], v5 offset:49152
  ds_read_b128 v[84:87], v5 offset:50176
  ds_read_b128 v[88:91], v5 offset:51200
  ds_read_b128 v[92:95], v5 offset:52224
  s_waitcnt vmcnt(0)
  v_lshlrev_b32 v112, 16, v8
  v_and_b32 v113, 0xffff0000, v8
  v_lshlrev_b32 v114, 16, v9
  v_and_b32 v115, 0xffff0000, v9
  v_lshlrev_b32 v116, 16, v10
  v_and_b32 v117, 0xffff0000, v10
  v_lshlrev_b32 v118, 16, v11
  v_and_b32 v119, 0xffff0000, v11
  v_lshlrev_b32 v120, 16, v12
  v_and_b32 v121, 0xffff0000, v12
  v_lshlrev_b32 v122, 16, v13
  v_and_b32 v123, 0xffff0000, v13
  v_lshlrev_b32 v124, 16, v14
  v_and_b32 v125, 0xffff0000, v14
  v_lshlrev_b32 v126, 16, v15
  v_and_b32 v127, 0xffff0000, v15
  s_waitcnt lgkmcnt(0)
  v_pk_add_f32 v[32:33], v[32:33], v[48:49]
  v_pk_add_f32 v[64:65], v[64:65], v[80:81]
  v_pk_add_f32 v[34:35], v[34:35], v[50:51]
  v_pk_add_f32 v[66:67], v[66:67], v[82:83]
  v_pk_add_f32 v[36:37], v[36:37], v[52:53]
  v_pk_add_f32 v[68:69], v[68:69], v[84:85]
  v_pk_add_f32 v[38:39], v[38:39], v[54:55]
  v_pk_add_f32 v[70:71], v[70:71], v[86:87]
  v_pk_add_f32 v[40:41], v[40:41], v[56:57]
  v_pk_add_f32 v[72:73], v[72:73], v[88:89]
  v_pk_add_f32 v[42:43], v[42:43], v[58:59]
  v_pk_add_f32 v[74:75], v[74:75], v[90:91]
  v_pk_add_f32 v[44:45], v[44:45], v[60:61]
  v_pk_add_f32 v[76:77], v[76:77], v[92:93]
  v_pk_add_f32 v[46:47], v[46:47], v[62:63]
  v_pk_add_f32 v[78:79], v[78:79], v[94:95]
  v_pk_add_f32 v[32:33], v[32:33], v[64:65]
  v_pk_add_f32 v[34:35], v[34:35], v[66:67]
  v_pk_add_f32 v[36:37], v[36:37], v[68:69]
  v_pk_add_f32 v[38:39], v[38:39], v[70:71]
  v_pk_add_f32 v[40:41], v[40:41], v[72:73]
  v_pk_add_f32 v[42:43], v[42:43], v[74:75]
  v_pk_add_f32 v[44:45], v[44:45], v[76:77]
  v_pk_add_f32 v[46:47], v[46:47], v[78:79]
  v_pk_fma_f32 v[32:33], v[32:33], v[16:17], v[112:113]
  v_pk_fma_f32 v[34:35], v[34:35], v[18:19], v[114:115]
  v_pk_fma_f32 v[36:37], v[36:37], v[20:21], v[116:117]
  v_pk_fma_f32 v[38:39], v[38:39], v[22:23], v[118:119]
  v_pk_fma_f32 v[40:41], v[40:41], v[24:25], v[120:121]
  v_pk_fma_f32 v[42:43], v[42:43], v[26:27], v[122:123]
  v_pk_fma_f32 v[44:45], v[44:45], v[28:29], v[124:125]
  v_pk_fma_f32 v[46:47], v[46:47], v[30:31], v[126:127]
  v_cvt_pk_bf16_f32 v104, v32, v33
  v_cvt_pk_bf16_f32 v105, v34, v35
  v_cvt_pk_bf16_f32 v106, v36, v37
  v_cvt_pk_bf16_f32 v107, v38, v39
  v_cvt_pk_bf16_f32 v108, v40, v41
  v_cvt_pk_bf16_f32 v109, v42, v43
  v_cvt_pk_bf16_f32 v110, v44, v45
  v_cvt_pk_bf16_f32 v111, v46, v47
  s_nop 1
  v_permlane32_swap_b32 v104, v106
  v_permlane32_swap_b32 v105, v107
  v_permlane32_swap_b32 v108, v110
  v_permlane32_swap_b32 v109, v111
  s_nop 1
  buffer_store_dwordx4 v[104:107], v2, s[28:31], s51 offen offset:0
  buffer_store_dwordx4 v[108:111], v2, s[28:31], s51 offen offset:32
  s_waitcnt vmcnt(0)
K_END:
  s_endpgm
RSTUB_8:
  s_call_b64 s[46:47], RARE_0
  s_branch RBACK_9
RSTUB_10:
  s_call_b64 s[46:47], RARE_1
  s_branch RBACK_11
RSTUB_12:
  s_call_b64 s[46:47], RARE_0
  s_branch RBACK_13
RSTUB_14:
  s_call_b64 s[46:47], RARE_1
  s_branch RBACK_15
RSTUB_16:
  s_call_b64 s[46:47], RARE_0
  s_branch RBACK_17
RSTUB_18:
  s_call_b64 s[46:47], RARE_1
  s_branch RBACK_19
RSTUB_20:
  s_call_b64 s[46:47], RARE_0
  s_branch RBACK_21
RSTUB_22:
  s_call_b64 s[46:47], RARE_1
  s_branch RBACK_23
RSTUB_24:
  s_call_b64 s[46:47], RARE_0
  s_branch RBACK_25
RSTUB_26:
  s_call_b64 s[46:47], RARE_1
  s_branch RBACK_27
RSTUB_28:
  s_call_b64 s[46:47], RARE_0
  s_branch RBACK_29
RSTUB_30:
  s_call_b64 s[46:47], RARE_1
  s_branch RBACK_31
RSTUB_32:
  s_call_b64 s[46:47], RARE_0
  s_branch RBACK_33
RSTUB_34:
  s_call_b64 s[46:47], RARE_1
  s_branch RBACK_35
RSTUB_36:
  s_call_b64 s[46:47], RARE_0
  s_branch RBACK_37
RSTUB_38:
  s_call_b64 s[46:47], RARE_1
  s_branch RBACK_39
RARE_0:
  s_nop 15
  s_nop 3
  v_max3_f32 v247, v0, v1, v2
  v_max3_f32 v247, v247, v3, v4
  v_max3_f32 v247, v247, v5, v6
  v_max3_f32 v247, v247, v7, v8
  v_max3_f32 v247, v247, v9, v10
  v_max3_f32 v247, v247, v11, v12
  v_max3_f32 v247, v247, v13, v14
  v_max_f32 v247, v247, v15
  v_mov_b32 v248, v247
  s_nop 1
  v_permlane32_swap_b32 v248, v247
  s_nop 1
  v_max_f32 v247, v247, v248
  v_add_f32 v249, 1119879168, v247
  v_max_f32 v249, 0, v249
  v_mul_f32 v250, -0.5, v249
  v_exp_f32 v250, v250
  s_nop 0
  v_accvgpr_read_b32 v251, a0
  v_mul_f32 v251, v251, v250
  v_mul_f32 v251, v251, v250
  v_accvgpr_write_b32 a0, v251
  v_accvgpr_read_b32 v251, a1
  v_mul_f32 v251, v251, v250
  v_mul_f32 v251, v251, v250
  v_accvgpr_write_b32 a1, v251
  v_accvgpr_read_b32 v251, a2
  v_mul_f32 v251, v251, v250
  v_mul_f32 v251, v251, v250
  v_accvgpr_write_b32 a2, v251
  v_accvgpr_read_b32 v251, a3
  v_mul_f32 v251, v251, v250
  v_mul_f32 v251, v251, v250
  v_accvgpr_write_b32 a3, v251
  v_accvgpr_read_b32 v251, a4
  v_mul_f32 v251, v251, v250
  v_mul_f32 v251, v251, v250
  v_accvgpr_write_b32 a4, v251
  v_accvgpr_read_b32 v251, a5
  v_mul_f32 v251, v251, v250
  v_mul_f32 v251, v251, v250
  v_accvgpr_write_b32 a5, v251
  v_accvgpr_read_b32 v251, a6
  v_mul_f32 v251, v251, v250
  v_mul_f32 v251, v251, v250
  v_accvgpr_write_b32 a6, v251
  v_accvgpr_read_b32 v251, a7
  v_mul_f32 v251, v251, v250
  v_mul_f32 v251, v251, v250
  v_accvgpr_write_b32 a7, v251
  v_accvgpr_read_b32 v251, a8
  v_mul_f32 v251, v251, v250
  v_mul_f32 v251, v251, v250
  v_accvgpr_write_b32 a8, v251
  v_accvgpr_read_b32 v251, a9
  v_mul_f32 v251, v251, v250
  v_mul_f32 v251, v251, v250
  v_accvgpr_write_b32 a9, v251
  v_accvgpr_read_b32 v251, a10
  v_mul_f32 v251, v251, v250
  v_mul_f32 v251, v251, v250
  v_accvgpr_write_b32 a10, v251
  v_accvgpr_read_b32 v251, a11
  v_mul_f32 v251, v251, v250
  v_mul_f32 v251, v251, v250
  v_accvgpr_write_b32 a11, v251
  v_accvgpr_read_b32 v251, a12
  v_mul_f32 v251, v251, v250
  v_mul_f32 v251, v251, v250
  v_accvgpr_write_b32 a12, v251
  v_accvgpr_read_b32 v251, a13
  v_mul_f32 v251, v251, v250
  v_mul_f32 v251, v251, v250
  v_accvgpr_write_b32 a13, v251
  v_accvgpr_read_b32 v251, a14
  v_mul_f32 v251, v251, v250
  v_mul_f32 v251, v251, v250
  v_accvgpr_write_b32 a14, v251
  v_accvgpr_read_b32 v251, a15
  v_mul_f32 v251, v251, v250
  v_mul_f32 v251, v251, v250
  v_accvgpr_write_b32 a15, v251
  v_accvgpr_read_b32 v251, a16
  v_mul_f32 v251, v251, v250
  v_mul_f32 v251, v251, v250
  v_accvgpr_write_b32 a16, v251
  v_accvgpr_read_b32 v251, a17
  v_mul_f32 v251, v251, v250
  v_mul_f32 v251, v251, v250
  v_accvgpr_write_b32 a17, v251
  v_accvgpr_read_b32 v251, a18
  v_mul_f32 v251, v251, v250
  v_mul_f32 v251, v251, v250
  v_accvgpr_write_b32 a18, v251
  v_accvgpr_read_b32 v251, a19
  v_mul_f32 v251, v251, v250
  v_mul_f32 v251, v251, v250
  v_accvgpr_write_b32 a19, v251
  v_accvgpr_read_b32 v251, a20
  v_mul_f32 v251, v251, v250
  v_mul_f32 v251, v251, v250
  v_accvgpr_write_b32 a20, v251
  v_accvgpr_read_b32 v251, a21
  v_mul_f32 v251, v251, v250
  v_mul_f32 v251, v251, v250
  v_accvgpr_write_b32 a21, v251
  v_accvgpr_read_b32 v251, a22
  v_mul_f32 v251, v251, v250
  v_mul_f32 v251, v251, v250
  v_accvgpr_write_b32 a22, v251
  v_accvgpr_read_b32 v251, a23
  v_mul_f32 v251, v251, v250
  v_mul_f32 v251, v251, v250
  v_accvgpr_write_b32 a23, v251
  v_accvgpr_read_b32 v251, a24
  v_mul_f32 v251, v251, v250
  v_mul_f32 v251, v251, v250
  v_accvgpr_write_b32 a24, v251
  v_accvgpr_read_b32 v251, a25
  v_mul_f32 v251, v251, v250
  v_mul_f32 v251, v251, v250
  v_accvgpr_write_b32 a25, v251
  v_accvgpr_read_b32 v251, a26
  v_mul_f32 v251, v251, v250
  v_mul_f32 v251, v251, v250
  v_accvgpr_write_b32 a26, v251
  v_accvgpr_read_b32 v251, a27
  v_mul_f32 v251, v251, v250
  v_mul_f32 v251, v251, v250
  v_accvgpr_write_b32 a27, v251
  v_accvgpr_read_b32 v251, a28
  v_mul_f32 v251, v251, v250
  v_mul_f32 v251, v251, v250
  v_accvgpr_write_b32 a28, v251
  v_accvgpr_read_b32 v251, a29
  v_mul_f32 v251, v251, v250
  v_mul_f32 v251, v251, v250
  v_accvgpr_write_b32 a29, v251
  v_accvgpr_read_b32 v251, a30
  v_mul_f32 v251, v251, v250
  v_mul_f32 v251, v251, v250
  v_accvgpr_write_b32 a30, v251
  v_accvgpr_read_b32 v251, a31
  v_mul_f32 v251, v251, v250
  v_mul_f32 v251, v251, v250
  v_accvgpr_write_b32 a31, v251
  v_accvgpr_read_b32 v251, a32
  v_mul_f32 v251, v251, v250
  v_mul_f32 v251, v251, v250
  v_accvgpr_write_b32 a32, v251
  v_accvgpr_read_b32 v251, a33
  v_mul_f32 v251, v251, v250
  v_mul_f32 v251, v251, v250
  v_accvgpr_write_b32 a33, v251
  v_accvgpr_read_b32 v251, a34
  v_mul_f32 v251, v251, v250
  v_mul_f32 v251, v251, v250
  v_accvgpr_write_b32 a34, v251
  v_accvgpr_read_b32 v251, a35
  v_mul_f32 v251, v251, v250
  v_mul_f32 v251, v251, v250
  v_accvgpr_write_b32 a35, v251
  v_accvgpr_read_b32 v251, a36
  v_mul_f32 v251, v251, v250
  v_mul_f32 v251, v251, v250
  v_accvgpr_write_b32 a36, v251
  v_accvgpr_read_b32 v251, a37
  v_mul_f32 v251, v251, v250
  v_mul_f32 v251, v251, v250
  v_accvgpr_write_b32 a37, v251
  v_accvgpr_read_b32 v251, a38
  v_mul_f32 v251, v251, v250
  v_mul_f32 v251, v251, v250
  v_accvgpr_write_b32 a38, v251
  v_accvgpr_read_b32 v251, a39
  v_mul_f32 v251, v251, v250
  v_mul_f32 v251, v251, v250
  v_accvgpr_write_b32 a39, v251
  v_accvgpr_read_b32 v251, a40
  v_mul_f32 v251, v251, v250
  v_mul_f32 v251, v251, v250
  v_accvgpr_write_b32 a40, v251
  v_accvgpr_read_b32 v251, a41
  v_mul_f32 v251, v251, v250
  v_mul_f32 v251, v251, v250
  v_accvgpr_write_b32 a41, v251
  v_accvgpr_read_b32 v251, a42
  v_mul_f32 v251, v251, v250
  v_mul_f32 v251, v251, v250
  v_accvgpr_write_b32 a42, v251
  v_accvgpr_read_b32 v251, a43
  v_mul_f32 v251, v251, v250
  v_mul_f32 v251, v251, v250
  v_accvgpr_write_b32 a43, v251
  v_accvgpr_read_b32 v251, a44
  v_mul_f32 v251, v251, v250
  v_mul_f32 v251, v251, v250
  v_accvgpr_write_b32 a44, v251
  v_accvgpr_read_b32 v251, a45
  v_mul_f32 v251, v251, v250
  v_mul_f32 v251, v251, v250
  v_accvgpr_write_b32 a45, v251
  v_accvgpr_read_b32 v251, a46
  v_mul_f32 v251, v251, v250
  v_mul_f32 v251, v251, v250
  v_accvgpr_write_b32 a46, v251
  v_accvgpr_read_b32 v251, a47
  v_mul_f32 v251, v251, v250
  v_mul_f32 v251, v251, v250
  v_accvgpr_write_b32 a47, v251
  v_accvgpr_read_b32 v251, a48
  v_mul_f32 v251, v251, v250
  v_mul_f32 v251, v251, v250
  v_accvgpr_write_b32 a48, v251
  v_accvgpr_read_b32 v251, a49
  v_mul_f32 v251, v251, v250
  v_mul_f32 v251, v251, v250
  v_accvgpr_write_b32 a49, v251
  v_accvgpr_read_b32 v251, a50
  v_mul_f32 v251, v251, v250
  v_mul_f32 v251, v251, v250
  v_accvgpr_write_b32 a50, v251
  v_accvgpr_read_b32 v251, a51
  v_mul_f32 v251, v251, v250
  v_mul_f32 v251, v251, v250
  v_accvgpr_write_b32 a51, v251
  v_accvgpr_read_b32 v251, a52
  v_mul_f32 v251, v251, v250
  v_mul_f32 v251, v251, v250
  v_accvgpr_write_b32 a52, v251
  v_accvgpr_read_b32 v251, a53
  v_mul_f32 v251, v251, v250
  v_mul_f32 v251, v251, v250
  v_accvgpr_write_b32 a53, v251
  v_accvgpr_read_b32 v251, a54
  v_mul_f32 v251, v251, v250
  v_mul_f32 v251, v251, v250
  v_accvgpr_write_b32 a54, v251
  v_accvgpr_read_b32 v251, a55
  v_mul_f32 v251, v251, v250
  v_mul_f32 v251, v251, v250
  v_accvgpr_write_b32 a55, v251
  v_accvgpr_read_b32 v251, a56
  v_mul_f32 v251, v251, v250
  v_mul_f32 v251, v251, v250
  v_accvgpr_write_b32 a56, v251
  v_accvgpr_read_b32 v251, a57
  v_mul_f32 v251, v251, v250
  v_mul_f32 v251, v251, v250
  v_accvgpr_write_b32 a57, v251
  v_accvgpr_read_b32 v251, a58
  v_mul_f32 v251, v251, v250
  v_mul_f32 v251, v251, v250
  v_accvgpr_write_b32 a58, v251
  v_accvgpr_read_b32 v251, a59
  v_mul_f32 v251, v251, v250
  v_mul_f32 v251, v251, v250
  v_accvgpr_write_b32 a59, v251
  v_accvgpr_read_b32 v251, a60
  v_mul_f32 v251, v251, v250
  v_mul_f32 v251, v251, v250
  v_accvgpr_write_b32 a60, v251
  v_accvgpr_read_b32 v251, a61
  v_mul_f32 v251, v251, v250
  v_mul_f32 v251, v251, v250
  v_accvgpr_write_b32 a61, v251
  v_accvgpr_read_b32 v251, a62
  v_mul_f32 v251, v251, v250
  v_mul_f32 v251, v251, v250
  v_accvgpr_write_b32 a62, v251
  v_accvgpr_read_b32 v251, a63
  v_mul_f32 v251, v251, v250
  v_mul_f32 v251, v251, v250
  v_accvgpr_write_b32 a63, v251
  v_mul_f32 v243, v243, v250
  v_mul_f32 v243, v243, v250
  v_sub_f32 v64, v64, v249
  v_sub_f32 v32, v32, v249
  v_sub_f32 v0, v0, v249
  v_sub_f32 v65, v65, v249
  v_sub_f32 v33, v33, v249
  v_sub_f32 v1, v1, v249
  v_sub_f32 v66, v66, v249
  v_sub_f32 v34, v34, v249
  v_sub_f32 v2, v2, v249
  v_sub_f32 v67, v67, v249
  v_sub_f32 v35, v35, v249
  v_sub_f32 v3, v3, v249
  v_sub_f32 v68, v68, v249
  v_sub_f32 v36, v36, v249
  v_sub_f32 v4, v4, v249
  v_sub_f32 v69, v69, v249
  v_sub_f32 v37, v37, v249
  v_sub_f32 v5, v5, v249
  v_sub_f32 v70, v70, v249
  v_sub_f32 v38, v38, v249
  v_sub_f32 v6, v6, v249
  v_sub_f32 v71, v71, v249
  v_sub_f32 v39, v39, v249
  v_sub_f32 v7, v7, v249
  v_sub_f32 v72, v72, v249
  v_sub_f32 v40, v40, v249
  v_sub_f32 v8, v8, v249
  v_sub_f32 v73, v73, v249
  v_sub_f32 v41, v41, v249
  v_sub_f32 v9, v9, v249
  v_sub_f32 v74, v74, v249
  v_sub_f32 v42, v42, v249
  v_sub_f32 v10, v10, v249
  v_sub_f32 v75, v75, v249
  v_sub_f32 v43, v43, v249
  v_sub_f32 v11, v11, v249
  v_sub_f32 v76, v76, v249
  v_sub_f32 v44, v44, v249
  v_sub_f32 v12, v12, v249
  v_sub_f32 v77, v77, v249
  v_sub_f32 v45, v45, v249
  v_sub_f32 v13, v13, v249
  v_sub_f32 v78, v78, v249
  v_sub_f32 v46, v46, v249
  v_sub_f32 v14, v14, v249
  v_sub_f32 v79, v79, v249
  v_sub_f32 v47, v47, v249
  v_sub_f32 v15, v15, v249
  v_exp_f32 v128, v0
  v_exp_f32 v129, v1
  s_nop 0
  v_add_f32 v241, v128, v129
  v_cvt_pk_bf16_f32 v96, v128, v129
  v_exp_f32 v128, v2
  v_exp_f32 v129, v3
  s_nop 0
  v_add_f32 v241, v241, v128
  v_add_f32 v241, v241, v129
  v_cvt_pk_bf16_f32 v97, v128, v129
  v_exp_f32 v128, v4
  v_exp_f32 v129, v5
  s_nop 0
  v_add_f32 v241, v241, v128
  v_add_f32 v241, v241, v129
  v_cvt_pk_bf16_f32 v98, v128, v129
  v_exp_f32 v128, v6
  v_exp_f32 v129, v7
  s_nop 0
  v_add_f32 v241, v241, v128
  v_add_f32 v241, v241, v129
  v_cvt_pk_bf16_f32 v99, v128, v129
  v_exp_f32 v128, v8
  v_exp_f32 v129, v9
  s_nop 0
  v_add_f32 v241, v241, v128
  v_add_f32 v241, v241, v129
  v_cvt_pk_bf16_f32 v100, v128, v129
  v_exp_f32 v128, v10
  v_exp_f32 v129, v11
  s_nop 0
  v_add_f32 v241, v241, v128
  v_add_f32 v241, v241, v129
  v_cvt_pk_bf16_f32 v101, v128, v129
  v_exp_f32 v128, v12
  v_exp_f32 v129, v13
  s_nop 0
  v_add_f32 v241, v241, v128
  v_add_f32 v241, v241, v129
  v_cvt_pk_bf16_f32 v102, v128, v129
  v_exp_f32 v128, v14
  v_exp_f32 v129, v15
  s_nop 0
  v_add_f32 v241, v241, v128
  v_add_f32 v241, v241, v129
  v_cvt_pk_bf16_f32 v103, v128, v129
  v_max3_f32 v247, v16, v17, v18
  v_max3_f32 v247, v247, v19, v20
  v_max3_f32 v247, v247, v21, v22
  v_max3_f32 v247, v247, v23, v24
  v_max3_f32 v247, v247, v25, v26
  v_max3_f32 v247, v247, v27, v28
  v_max3_f32 v247, v247, v29, v30
  v_max_f32 v247, v247, v31
  v_mov_b32 v248, v247
  s_nop 1
  v_permlane32_swap_b32 v248, v247
  s_nop 1
  v_max_f32 v247, v247, v248
  v_add_f32 v249, 1119879168, v247
  v_max_f32 v249, 0, v249
  v_mul_f32 v250, -0.5, v249
  v_exp_f32 v250, v250
  s_nop 0
  v_accvgpr_read_b32 v251, a64
  v_mul_f32 v251, v251, v250
  v_mul_f32 v251, v251, v250
  v_accvgpr_write_b32 a64, v251
  v_accvgpr_read_b32 v251, a65
  v_mul_f32 v251, v251, v250
  v_mul_f32 v251, v251, v250
  v_accvgpr_write_b32 a65, v251
  v_accvgpr_read_b32 v251, a66
  v_mul_f32 v251, v251, v250
  v_mul_f32 v251, v251, v250
  v_accvgpr_write_b32 a66, v251
  v_accvgpr_read_b32 v251, a67
  v_mul_f32 v251, v251, v250
  v_mul_f32 v251, v251, v250
  v_accvgpr_write_b32 a67, v251
  v_accvgpr_read_b32 v251, a68
  v_mul_f32 v251, v251, v250
  v_mul_f32 v251, v251, v250
  v_accvgpr_write_b32 a68, v251
  v_accvgpr_read_b32 v251, a69
  v_mul_f32 v251, v251, v250
  v_mul_f32 v251, v251, v250
  v_accvgpr_write_b32 a69, v251
  v_accvgpr_read_b32 v251, a70
  v_mul_f32 v251, v251, v250
  v_mul_f32 v251, v251, v250
  v_accvgpr_write_b32 a70, v251
  v_accvgpr_read_b32 v251, a71
  v_mul_f32 v251, v251, v250
  v_mul_f32 v251, v251, v250
  v_accvgpr_write_b32 a71, v251
  v_accvgpr_read_b32 v251, a72
  v_mul_f32 v251, v251, v250
  v_mul_f32 v251, v251, v250
  v_accvgpr_write_b32 a72, v251
  v_accvgpr_read_b32 v251, a73
  v_mul_f32 v251, v251, v250
  v_mul_f32 v251, v251, v250
  v_accvgpr_write_b32 a73, v251
  v_accvgpr_read_b32 v251, a74
  v_mul_f32 v251, v251, v250
  v_mul_f32 v251, v251, v250
  v_accvgpr_write_b32 a74, v251
  v_accvgpr_read_b32 v251, a75
  v_mul_f32 v251, v251, v250
  v_mul_f32 v251, v251, v250
  v_accvgpr_write_b32 a75, v251
  v_accvgpr_read_b32 v251, a76
  v_mul_f32 v251, v251, v250
  v_mul_f32 v251, v251, v250
  v_accvgpr_write_b32 a76, v251
  v_accvgpr_read_b32 v251, a77
  v_mul_f32 v251, v251, v250
  v_mul_f32 v251, v251, v250
  v_accvgpr_write_b32 a77, v251
  v_accvgpr_read_b32 v251, a78
  v_mul_f32 v251, v251, v250
  v_mul_f32 v251, v251, v250
  v_accvgpr_write_b32 a78, v251
  v_accvgpr_read_b32 v251, a79
  v_mul_f32 v251, v251, v250
  v_mul_f32 v251, v251, v250
  v_accvgpr_write_b32 a79, v251
  v_accvgpr_read_b32 v251, a80
  v_mul_f32 v251, v251, v250
  v_mul_f32 v251, v251, v250
  v_accvgpr_write_b32 a80, v251
  v_accvgpr_read_b32 v251, a81
  v_mul_f32 v251, v251, v250
  v_mul_f32 v251, v251, v250
  v_accvgpr_write_b32 a81, v251
  v_accvgpr_read_b32 v251, a82
  v_mul_f32 v251, v251, v250
  v_mul_f32 v251, v251, v250
  v_accvgpr_write_b32 a82, v251
  v_accvgpr_read_b32 v251, a83
  v_mul_f32 v251, v251, v250
  v_mul_f32 v251, v251, v250
  v_accvgpr_write_b32 a83, v251
  v_accvgpr_read_b32 v251, a84
  v_mul_f32 v251, v251, v250
  v_mul_f32 v251, v251, v250
  v_accvgpr_write_b32 a84, v251
  v_accvgpr_read_b32 v251, a85
  v_mul_f32 v251, v251, v250
  v_mul_f32 v251, v251, v250
  v_accvgpr_write_b32 a85, v251
  v_accvgpr_read_b32 v251, a86
  v_mul_f32 v251, v251, v250
  v_mul_f32 v251, v251, v250
  v_accvgpr_write_b32 a86, v251
  v_accvgpr_read_b32 v251, a87
  v_mul_f32 v251, v251, v250
  v_mul_f32 v251, v251, v250
  v_accvgpr_write_b32 a87, v251
  v_accvgpr_read_b32 v251, a88
  v_mul_f32 v251, v251, v250
  v_mul_f32 v251, v251, v250
  v_accvgpr_write_b32 a88, v251
  v_accvgpr_read_b32 v251, a89
  v_mul_f32 v251, v251, v250
  v_mul_f32 v251, v251, v250
  v_accvgpr_write_b32 a89, v251
  v_accvgpr_read_b32 v251, a90
  v_mul_f32 v251, v251, v250
  v_mul_f32 v251, v251, v250
  v_accvgpr_write_b32 a90, v251
  v_accvgpr_read_b32 v251, a91
  v_mul_f32 v251, v251, v250
  v_mul_f32 v251, v251, v250
  v_accvgpr_write_b32 a91, v251
  v_accvgpr_read_b32 v251, a92
  v_mul_f32 v251, v251, v250
  v_mul_f32 v251, v251, v250
  v_accvgpr_write_b32 a92, v251
  v_accvgpr_read_b32 v251, a93
  v_mul_f32 v251, v251, v250
  v_mul_f32 v251, v251, v250
  v_accvgpr_write_b32 a93, v251
  v_accvgpr_read_b32 v251, a94
  v_mul_f32 v251, v251, v250
  v_mul_f32 v251, v251, v250
  v_accvgpr_write_b32 a94, v251
  v_accvgpr_read_b32 v251, a95
  v_mul_f32 v251, v251, v250
  v_mul_f32 v251, v251, v250
  v_accvgpr_write_b32 a95, v251
  v_accvgpr_read_b32 v251, a96
  v_mul_f32 v251, v251, v250
  v_mul_f32 v251, v251, v250
  v_accvgpr_write_b32 a96, v251
  v_accvgpr_read_b32 v251, a97
  v_mul_f32 v251, v251, v250
  v_mul_f32 v251, v251, v250
  v_accvgpr_write_b32 a97, v251
  v_accvgpr_read_b32 v251, a98
  v_mul_f32 v251, v251, v250
  v_mul_f32 v251, v251, v250
  v_accvgpr_write_b32 a98, v251
  v_accvgpr_read_b32 v251, a99
  v_mul_f32 v251, v251, v250
  v_mul_f32 v251, v251, v250
  v_accvgpr_write_b32 a99, v251
  v_accvgpr_read_b32 v251, a100
  v_mul_f32 v251, v251, v250
  v_mul_f32 v251, v251, v250
  v_accvgpr_write_b32 a100, v251
  v_accvgpr_read_b32 v251, a101
  v_mul_f32 v251, v251, v250
  v_mul_f32 v251, v251, v250
  v_accvgpr_write_b32 a101, v251
  v_accvgpr_read_b32 v251, a102
  v_mul_f32 v251, v251, v250
  v_mul_f32 v251, v251, v250
  v_accvgpr_write_b32 a102, v251
  v_accvgpr_read_b32 v251, a103
  v_mul_f32 v251, v251, v250
  v_mul_f32 v251, v251, v250
  v_accvgpr_write_b32 a103, v251
  v_accvgpr_read_b32 v251, a104
  v_mul_f32 v251, v251, v250
  v_mul_f32 v251, v251, v250
  v_accvgpr_write_b32 a104, v251
  v_accvgpr_read_b32 v251, a105
  v_mul_f32 v251, v251, v250
  v_mul_f32 v251, v251, v250
  v_accvgpr_write_b32 a105, v251
  v_accvgpr_read_b32 v251, a106
  v_mul_f32 v251, v251, v250
  v_mul_f32 v251, v251, v250
  v_accvgpr_write_b32 a106, v251
  v_accvgpr_read_b32 v251, a107
  v_mul_f32 v251, v251, v250
  v_mul_f32 v251, v251, v250
  v_accvgpr_write_b32 a107, v251
  v_accvgpr_read_b32 v251, a108
  v_mul_f32 v251, v251, v250
  v_mul_f32 v251, v251, v250
  v_accvgpr_write_b32 a108, v251
  v_accvgpr_read_b32 v251, a109
  v_mul_f32 v251, v251, v250
  v_mul_f32 v251, v251, v250
  v_accvgpr_write_b32 a109, v251
  v_accvgpr_read_b32 v251, a110
  v_mul_f32 v251, v251, v250
  v_mul_f32 v251, v251, v250
  v_accvgpr_write_b32 a110, v251
  v_accvgpr_read_b32 v251, a111
  v_mul_f32 v251, v251, v250
  v_mul_f32 v251, v251, v250
  v_accvgpr_write_b32 a111, v251
  v_accvgpr_read_b32 v251, a112
  v_mul_f32 v251, v251, v250
  v_mul_f32 v251, v251, v250
  v_accvgpr_write_b32 a112, v251
  v_accvgpr_read_b32 v251, a113
  v_mul_f32 v251, v251, v250
  v_mul_f32 v251, v251, v250
  v_accvgpr_write_b32 a113, v251
  v_accvgpr_read_b32 v251, a114
  v_mul_f32 v251, v251, v250
  v_mul_f32 v251, v251, v250
  v_accvgpr_write_b32 a114, v251
  v_accvgpr_read_b32 v251, a115
  v_mul_f32 v251, v251, v250
  v_mul_f32 v251, v251, v250
  v_accvgpr_write_b32 a115, v251
  v_accvgpr_read_b32 v251, a116
  v_mul_f32 v251, v251, v250
  v_mul_f32 v251, v251, v250
  v_accvgpr_write_b32 a116, v251
  v_accvgpr_read_b32 v251, a117
  v_mul_f32 v251, v251, v250
  v_mul_f32 v251, v251, v250
  v_accvgpr_write_b32 a117, v251
  v_accvgpr_read_b32 v251, a118
  v_mul_f32 v251, v251, v250
  v_mul_f32 v251, v251, v250
  v_accvgpr_write_b32 a118, v251
  v_accvgpr_read_b32 v251, a119
  v_mul_f32 v251, v251, v250
  v_mul_f32 v251, v251, v250
  v_accvgpr_write_b32 a119, v251
  v_accvgpr_read_b32 v251, a120
  v_mul_f32 v251, v251, v250
  v_mul_f32 v251, v251, v250
  v_accvgpr_write_b32 a120, v251
  v_accvgpr_read_b32 v251, a121
  v_mul_f32 v251, v251, v250
  v_mul_f32 v251, v251, v250
  v_accvgpr_write_b32 a121, v251
  v_accvgpr_read_b32 v251, a122
  v_mul_f32 v251, v251, v250
  v_mul_f32 v251, v251, v250
  v_accvgpr_write_b32 a122, v251
  v_accvgpr_read_b32 v251, a123
  v_mul_f32 v251, v251, v250
  v_mul_f32 v251, v251, v250
  v_accvgpr_write_b32 a123, v251
  v_accvgpr_read_b32 v251, a124
  v_mul_f32 v251, v251, v250
  v_mul_f32 v251, v251, v250
  v_accvgpr_write_b32 a124, v251
  v_accvgpr_read_b32 v251, a125
  v_mul_f32 v251, v251, v250
  v_mul_f32 v251, v251, v250
  v_accvgpr_write_b32 a125, v251
  v_accvgpr_read_b32 v251, a126
  v_mul_f32 v251, v251, v250
  v_mul_f32 v251, v251, v250
  v_accvgpr_write_b32 a126, v251
  v_accvgpr_read_b32 v251, a127
  v_mul_f32 v251, v251, v250
  v_mul_f32 v251, v251, v250
  v_accvgpr_write_b32 a127, v251
  v_mul_f32 v244, v244, v250
  v_mul_f32 v244, v244, v250
  v_sub_f32 v80, v80, v249
  v_sub_f32 v48, v48, v249
  v_sub_f32 v16, v16, v249
  v_sub_f32 v81, v81, v249
  v_sub_f32 v49, v49, v249
  v_sub_f32 v17, v17, v249
  v_sub_f32 v82, v82, v249
  v_sub_f32 v50, v50, v249
  v_sub_f32 v18, v18, v249
  v_sub_f32 v83, v83, v249
  v_sub_f32 v51, v51, v249
  v_sub_f32 v19, v19, v249
  v_sub_f32 v84, v84, v249
  v_sub_f32 v52, v52, v249
  v_sub_f32 v20, v20, v249
  v_sub_f32 v85, v85, v249
  v_sub_f32 v53, v53, v249
  v_sub_f32 v21, v21, v249
  v_sub_f32 v86, v86, v249
  v_sub_f32 v54, v54, v249
  v_sub_f32 v22, v22, v249
  v_sub_f32 v87, v87, v249
  v_sub_f32 v55, v55, v249
  v_sub_f32 v23, v23, v249
  v_sub_f32 v88, v88, v249
  v_sub_f32 v56, v56, v249
  v_sub_f32 v24, v24, v249
  v_sub_f32 v89, v89, v249
  v_sub_f32 v57, v57, v249
  v_sub_f32 v25, v25, v249
  v_sub_f32 v90, v90, v249
  v_sub_f32 v58, v58, v249
  v_sub_f32 v26, v26, v249
  v_sub_f32 v91, v91, v249
  v_sub_f32 v59, v59, v249
  v_sub_f32 v27, v27, v249
  v_sub_f32 v92, v92, v249
  v_sub_f32 v60, v60, v249
  v_sub_f32 v28, v28, v249
  v_sub_f32 v93, v93, v249
  v_sub_f32 v61, v61, v249
  v_sub_f32 v29, v29, v249
  v_sub_f32 v94, v94, v249
  v_sub_f32 v62, v62, v249
  v_sub_f32 v30, v30, v249
  v_sub_f32 v95, v95, v249
  v_sub_f32 v63, v63, v249
  v_sub_f32 v31, v31, v249
  v_exp_f32 v128, v16
  v_exp_f32 v129, v17
  s_nop 0
  v_add_f32 v242, v128, v129
  v_cvt_pk_bf16_f32 v104, v128, v129
  v_exp_f32 v128, v18
  v_exp_f32 v129, v19
  s_nop 0
  v_add_f32 v242, v242, v128
  v_add_f32 v242, v242, v129
  v_cvt_pk_bf16_f32 v105, v128, v129
  v_exp_f32 v128, v20
  v_exp_f32 v129, v21
  s_nop 0
  v_add_f32 v242, v242, v128
  v_add_f32 v242, v242, v129
  v_cvt_pk_bf16_f32 v106, v128, v129
  v_exp_f32 v128, v22
  v_exp_f32 v129, v23
  s_nop 0
  v_add_f32 v242, v242, v128
  v_add_f32 v242, v242, v129
  v_cvt_pk_bf16_f32 v107, v128, v129
  v_exp_f32 v128, v24
  v_exp_f32 v129, v25
  s_nop 0
  v_add_f32 v242, v242, v128
  v_add_f32 v242, v242, v129
  v_cvt_pk_bf16_f32 v108, v128, v129
  v_exp_f32 v128, v26
  v_exp_f32 v129, v27
  s_nop 0
  v_add_f32 v242, v242, v128
  v_add_f32 v242, v242, v129
  v_cvt_pk_bf16_f32 v109, v128, v129
  v_exp_f32 v128, v28
  v_exp_f32 v129, v29
  s_nop 0
  v_add_f32 v242, v242, v128
  v_add_f32 v242, v242, v129
  v_cvt_pk_bf16_f32 v110, v128, v129
  v_exp_f32 v128, v30
  v_exp_f32 v129, v31
  s_nop 0
  v_add_f32 v242, v242, v128
  v_add_f32 v242, v242, v129
  v_cvt_pk_bf16_f32 v111, v128, v129
  s_nop 1
  s_setpc_b64 s[46:47]
RARE_1:
  s_nop 15
  s_nop 3
  v_max3_f32 v247, v32, v33, v34
  v_max3_f32 v247, v247, v35, v36
  v_max3_f32 v247, v247, v37, v38
  v_max3_f32 v247, v247, v39, v40
  v_max3_f32 v247, v247, v41, v42
  v_max3_f32 v247, v247, v43, v44
  v_max3_f32 v247, v247, v45, v46
  v_max_f32 v247, v247, v47
  v_mov_b32 v248, v247
  s_nop 1
  v_permlane32_swap_b32 v248, v247
  s_nop 1
  v_max_f32 v247, v247, v248
  v_add_f32 v249, 1119879168, v247
  v_max_f32 v249, 0, v249
  v_mul_f32 v250, -0.5, v249
  v_exp_f32 v250, v250
  s_nop 0
  v_accvgpr_read_b32 v251, a0
  v_mul_f32 v251, v251, v250
  v_mul_f32 v251, v251, v250
  v_accvgpr_write_b32 a0, v251
  v_accvgpr_read_b32 v251, a1
  v_mul_f32 v251, v251, v250
  v_mul_f32 v251, v251, v250
  v_accvgpr_write_b32 a1, v251
  v_accvgpr_read_b32 v251, a2
  v_mul_f32 v251, v251, v250
  v_mul_f32 v251, v251, v250
  v_accvgpr_write_b32 a2, v251
  v_accvgpr_read_b32 v251, a3
  v_mul_f32 v251, v251, v250
  v_mul_f32 v251, v251, v250
  v_accvgpr_write_b32 a3, v251
  v_accvgpr_read_b32 v251, a4
  v_mul_f32 v251, v251, v250
  v_mul_f32 v251, v251, v250
  v_accvgpr_write_b32 a4, v251
  v_accvgpr_read_b32 v251, a5
  v_mul_f32 v251, v251, v250
  v_mul_f32 v251, v251, v250
  v_accvgpr_write_b32 a5, v251
  v_accvgpr_read_b32 v251, a6
  v_mul_f32 v251, v251, v250
  v_mul_f32 v251, v251, v250
  v_accvgpr_write_b32 a6, v251
  v_accvgpr_read_b32 v251, a7
  v_mul_f32 v251, v251, v250
  v_mul_f32 v251, v251, v250
  v_accvgpr_write_b32 a7, v251
  v_accvgpr_read_b32 v251, a8
  v_mul_f32 v251, v251, v250
  v_mul_f32 v251, v251, v250
  v_accvgpr_write_b32 a8, v251
  v_accvgpr_read_b32 v251, a9
  v_mul_f32 v251, v251, v250
  v_mul_f32 v251, v251, v250
  v_accvgpr_write_b32 a9, v251
  v_accvgpr_read_b32 v251, a10
  v_mul_f32 v251, v251, v250
  v_mul_f32 v251, v251, v250
  v_accvgpr_write_b32 a10, v251
  v_accvgpr_read_b32 v251, a11
  v_mul_f32 v251, v251, v250
  v_mul_f32 v251, v251, v250
  v_accvgpr_write_b32 a11, v251
  v_accvgpr_read_b32 v251, a12
  v_mul_f32 v251, v251, v250
  v_mul_f32 v251, v251, v250
  v_accvgpr_write_b32 a12, v251
  v_accvgpr_read_b32 v251, a13
  v_mul_f32 v251, v251, v250
  v_mul_f32 v251, v251, v250
  v_accvgpr_write_b32 a13, v251
  v_accvgpr_read_b32 v251, a14
  v_mul_f32 v251, v251, v250
  v_mul_f32 v251, v251, v250
  v_accvgpr_write_b32 a14, v251
  v_accvgpr_read_b32 v251, a15
  v_mul_f32 v251, v251, v250
  v_mul_f32 v251, v251, v250
  v_accvgpr_write_b32 a15, v251
  v_accvgpr_read_b32 v251, a16
  v_mul_f32 v251, v251, v250
  v_mul_f32 v251, v251, v250
  v_accvgpr_write_b32 a16, v251
  v_accvgpr_read_b32 v251, a17
  v_mul_f32 v251, v251, v250
  v_mul_f32 v251, v251, v250
  v_accvgpr_write_b32 a17, v251
  v_accvgpr_read_b32 v251, a18
  v_mul_f32 v251, v251, v250
  v_mul_f32 v251, v251, v250
  v_accvgpr_write_b32 a18, v251
  v_accvgpr_read_b32 v251, a19
  v_mul_f32 v251, v251, v250
  v_mul_f32 v251, v251, v250
  v_accvgpr_write_b32 a19, v251
  v_accvgpr_read_b32 v251, a20
  v_mul_f32 v251, v251, v250
  v_mul_f32 v251, v251, v250
  v_accvgpr_write_b32 a20, v251
  v_accvgpr_read_b32 v251, a21
  v_mul_f32 v251, v251, v250
  v_mul_f32 v251, v251, v250
  v_accvgpr_write_b32 a21, v251
  v_accvgpr_read_b32 v251, a22
  v_mul_f32 v251, v251, v250
  v_mul_f32 v251, v251, v250
  v_accvgpr_write_b32 a22, v251
  v_accvgpr_read_b32 v251, a23
  v_mul_f32 v251, v251, v250
  v_mul_f32 v251, v251, v250
  v_accvgpr_write_b32 a23, v251
  v_accvgpr_read_b32 v251, a24
  v_mul_f32 v251, v251, v250
  v_mul_f32 v251, v251, v250
  v_accvgpr_write_b32 a24, v251
  v_accvgpr_read_b32 v251, a25
  v_mul_f32 v251, v251, v250
  v_mul_f32 v251, v251, v250
  v_accvgpr_write_b32 a25, v251
  v_accvgpr_read_b32 v251, a26
  v_mul_f32 v251, v251, v250
  v_mul_f32 v251, v251, v250
  v_accvgpr_write_b32 a26, v251
  v_accvgpr_read_b32 v251, a27
  v_mul_f32 v251, v251, v250
  v_mul_f32 v251, v251, v250
  v_accvgpr_write_b32 a27, v251
  v_accvgpr_read_b32 v251, a28
  v_mul_f32 v251, v251, v250
  v_mul_f32 v251, v251, v250
  v_accvgpr_write_b32 a28, v251
  v_accvgpr_read_b32 v251, a29
  v_mul_f32 v251, v251, v250
  v_mul_f32 v251, v251, v250
  v_accvgpr_write_b32 a29, v251
  v_accvgpr_read_b32 v251, a30
  v_mul_f32 v251, v251, v250
  v_mul_f32 v251, v251, v250
  v_accvgpr_write_b32 a30, v251
  v_accvgpr_read_b32 v251, a31
  v_mul_f32 v251, v251, v250
  v_mul_f32 v251, v251, v250
  v_accvgpr_write_b32 a31, v251
  v_accvgpr_read_b32 v251, a32
  v_mul_f32 v251, v251, v250
  v_mul_f32 v251, v251, v250
  v_accvgpr_write_b32 a32, v251
  v_accvgpr_read_b32 v251, a33
  v_mul_f32 v251, v251, v250
  v_mul_f32 v251, v251, v250
  v_accvgpr_write_b32 a33, v251
  v_accvgpr_read_b32 v251, a34
  v_mul_f32 v251, v251, v250
  v_mul_f32 v251, v251, v250
  v_accvgpr_write_b32 a34, v251
  v_accvgpr_read_b32 v251, a35
  v_mul_f32 v251, v251, v250
  v_mul_f32 v251, v251, v250
  v_accvgpr_write_b32 a35, v251
  v_accvgpr_read_b32 v251, a36
  v_mul_f32 v251, v251, v250
  v_mul_f32 v251, v251, v250
  v_accvgpr_write_b32 a36, v251
  v_accvgpr_read_b32 v251, a37
  v_mul_f32 v251, v251, v250
  v_mul_f32 v251, v251, v250
  v_accvgpr_write_b32 a37, v251
  v_accvgpr_read_b32 v251, a38
  v_mul_f32 v251, v251, v250
  v_mul_f32 v251, v251, v250
  v_accvgpr_write_b32 a38, v251
  v_accvgpr_read_b32 v251, a39
  v_mul_f32 v251, v251, v250
  v_mul_f32 v251, v251, v250
  v_accvgpr_write_b32 a39, v251
  v_accvgpr_read_b32 v251, a40
  v_mul_f32 v251, v251, v250
  v_mul_f32 v251, v251, v250
  v_accvgpr_write_b32 a40, v251
  v_accvgpr_read_b32 v251, a41
  v_mul_f32 v251, v251, v250
  v_mul_f32 v251, v251, v250
  v_accvgpr_write_b32 a41, v251
  v_accvgpr_read_b32 v251, a42
  v_mul_f32 v251, v251, v250
  v_mul_f32 v251, v251, v250
  v_accvgpr_write_b32 a42, v251
  v_accvgpr_read_b32 v251, a43
  v_mul_f32 v251, v251, v250
  v_mul_f32 v251, v251, v250
  v_accvgpr_write_b32 a43, v251
  v_accvgpr_read_b32 v251, a44
  v_mul_f32 v251, v251, v250
  v_mul_f32 v251, v251, v250
  v_accvgpr_write_b32 a44, v251
  v_accvgpr_read_b32 v251, a45
  v_mul_f32 v251, v251, v250
  v_mul_f32 v251, v251, v250
  v_accvgpr_write_b32 a45, v251
  v_accvgpr_read_b32 v251, a46
  v_mul_f32 v251, v251, v250
  v_mul_f32 v251, v251, v250
  v_accvgpr_write_b32 a46, v251
  v_accvgpr_read_b32 v251, a47
  v_mul_f32 v251, v251, v250
  v_mul_f32 v251, v251, v250
  v_accvgpr_write_b32 a47, v251
  v_accvgpr_read_b32 v251, a48
  v_mul_f32 v251, v251, v250
  v_mul_f32 v251, v251, v250
  v_accvgpr_write_b32 a48, v251
  v_accvgpr_read_b32 v251, a49
  v_mul_f32 v251, v251, v250
  v_mul_f32 v251, v251, v250
  v_accvgpr_write_b32 a49, v251
  v_accvgpr_read_b32 v251, a50
  v_mul_f32 v251, v251, v250
  v_mul_f32 v251, v251, v250
  v_accvgpr_write_b32 a50, v251
  v_accvgpr_read_b32 v251, a51
  v_mul_f32 v251, v251, v250
  v_mul_f32 v251, v251, v250
  v_accvgpr_write_b32 a51, v251
  v_accvgpr_read_b32 v251, a52
  v_mul_f32 v251, v251, v250
  v_mul_f32 v251, v251, v250
  v_accvgpr_write_b32 a52, v251
  v_accvgpr_read_b32 v251, a53
  v_mul_f32 v251, v251, v250
  v_mul_f32 v251, v251, v250
  v_accvgpr_write_b32 a53, v251
  v_accvgpr_read_b32 v251, a54
  v_mul_f32 v251, v251, v250
  v_mul_f32 v251, v251, v250
  v_accvgpr_write_b32 a54, v251
  v_accvgpr_read_b32 v251, a55
  v_mul_f32 v251, v251, v250
  v_mul_f32 v251, v251, v250
  v_accvgpr_write_b32 a55, v251
  v_accvgpr_read_b32 v251, a56
  v_mul_f32 v251, v251, v250
  v_mul_f32 v251, v251, v250
  v_accvgpr_write_b32 a56, v251
  v_accvgpr_read_b32 v251, a57
  v_mul_f32 v251, v251, v250
  v_mul_f32 v251, v251, v250
  v_accvgpr_write_b32 a57, v251
  v_accvgpr_read_b32 v251, a58
  v_mul_f32 v251, v251, v250
  v_mul_f32 v251, v251, v250
  v_accvgpr_write_b32 a58, v251
  v_accvgpr_read_b32 v251, a59
  v_mul_f32 v251, v251, v250
  v_mul_f32 v251, v251, v250
  v_accvgpr_write_b32 a59, v251
  v_accvgpr_read_b32 v251, a60
  v_mul_f32 v251, v251, v250
  v_mul_f32 v251, v251, v250
  v_accvgpr_write_b32 a60, v251
  v_accvgpr_read_b32 v251, a61
  v_mul_f32 v251, v251, v250
  v_mul_f32 v251, v251, v250
  v_accvgpr_write_b32 a61, v251
  v_accvgpr_read_b32 v251, a62
  v_mul_f32 v251, v251, v250
  v_mul_f32 v251, v251, v250
  v_accvgpr_write_b32 a62, v251
  v_accvgpr_read_b32 v251, a63
  v_mul_f32 v251, v251, v250
  v_mul_f32 v251, v251, v250
  v_accvgpr_write_b32 a63, v251
  v_mul_f32 v243, v243, v250
  v_mul_f32 v243, v243, v250
  v_sub_f32 v64, v64, v249
  v_sub_f32 v0, v0, v249
  v_sub_f32 v32, v32, v249
  v_sub_f32 v65, v65, v249
  v_sub_f32 v1, v1, v249
  v_sub_f32 v33, v33, v249
  v_sub_f32 v66, v66, v249
  v_sub_f32 v2, v2, v249
  v_sub_f32 v34, v34, v249
  v_sub_f32 v67, v67, v249
  v_sub_f32 v3, v3, v249
  v_sub_f32 v35, v35, v249
  v_sub_f32 v68, v68, v249
  v_sub_f32 v4, v4, v249
  v_sub_f32 v36, v36, v249
  v_sub_f32 v69, v69, v249
  v_sub_f32 v5, v5, v249
  v_sub_f32 v37, v37, v249
  v_sub_f32 v70, v70, v249
  v_sub_f32 v6, v6, v249
  v_sub_f32 v38, v38, v249
  v_sub_f32 v71, v71, v249
  v_sub_f32 v7, v7, v249
  v_sub_f32 v39, v39, v249
  v_sub_f32 v72, v72, v249
  v_sub_f32 v8, v8, v249
  v_sub_f32 v40, v40, v249
  v_sub_f32 v73, v73, v249
  v_sub_f32 v9, v9, v249
  v_sub_f32 v41, v41, v249
  v_sub_f32 v74, v74, v249
  v_sub_f32 v10, v10, v249
  v_sub_f32 v42, v42, v249
  v_sub_f32 v75, v75, v249
  v_sub_f32 v11, v11, v249
  v_sub_f32 v43, v43, v249
  v_sub_f32 v76, v76, v249
  v_sub_f32 v12, v12, v249
  v_sub_f32 v44, v44, v249
  v_sub_f32 v77, v77, v249
  v_sub_f32 v13, v13, v249
  v_sub_f32 v45, v45, v249
  v_sub_f32 v78, v78, v249
  v_sub_f32 v14, v14, v249
  v_sub_f32 v46, v46, v249
  v_sub_f32 v79, v79, v249
  v_sub_f32 v15, v15, v249
  v_sub_f32 v47, v47, v249
  v_exp_f32 v128, v32
  v_exp_f32 v129, v33
  s_nop 0
  v_add_f32 v241, v128, v129
  v_cvt_pk_bf16_f32 v112, v128, v129
  v_exp_f32 v128, v34
  v_exp_f32 v129, v35
  s_nop 0
  v_add_f32 v241, v241, v128
  v_add_f32 v241, v241, v129
  v_cvt_pk_bf16_f32 v113, v128, v129
  v_exp_f32 v128, v36
  v_exp_f32 v129, v37
  s_nop 0
  v_add_f32 v241, v241, v128
  v_add_f32 v241, v241, v129
  v_cvt_pk_bf16_f32 v114, v128, v129
  v_exp_f32 v128, v38
  v_exp_f32 v129, v39
  s_nop 0
  v_add_f32 v241, v241, v128
  v_add_f32 v241, v241, v129
  v_cvt_pk_bf16_f32 v115, v128, v129
  v_exp_f32 v128, v40
  v_exp_f32 v129, v41
  s_nop 0
  v_add_f32 v241, v241, v128
  v_add_f32 v241, v241, v129
  v_cvt_pk_bf16_f32 v116, v128, v129
  v_exp_f32 v128, v42
  v_exp_f32 v129, v43
  s_nop 0
  v_add_f32 v241, v241, v128
  v_add_f32 v241, v241, v129
  v_cvt_pk_bf16_f32 v117, v128, v129
  v_exp_f32 v128, v44
  v_exp_f32 v129, v45
  s_nop 0
  v_add_f32 v241, v241, v128
  v_add_f32 v241, v241, v129
  v_cvt_pk_bf16_f32 v118, v128, v129
  v_exp_f32 v128, v46
  v_exp_f32 v129, v47
  s_nop 0
  v_add_f32 v241, v241, v128
  v_add_f32 v241, v241, v129
  v_cvt_pk_bf16_f32 v119, v128, v129
  v_max3_f32 v247, v48, v49, v50
  v_max3_f32 v247, v247, v51, v52
  v_max3_f32 v247, v247, v53, v54
  v_max3_f32 v247, v247, v55, v56
  v_max3_f32 v247, v247, v57, v58
  v_max3_f32 v247, v247, v59, v60
  v_max3_f32 v247, v247, v61, v62
  v_max_f32 v247, v247, v63
  v_mov_b32 v248, v247
  s_nop 1
  v_permlane32_swap_b32 v248, v247
  s_nop 1
  v_max_f32 v247, v247, v248
  v_add_f32 v249, 1119879168, v247
  v_max_f32 v249, 0, v249
  v_mul_f32 v250, -0.5, v249
  v_exp_f32 v250, v250
  s_nop 0
  v_accvgpr_read_b32 v251, a64
  v_mul_f32 v251, v251, v250
  v_mul_f32 v251, v251, v250
  v_accvgpr_write_b32 a64, v251
  v_accvgpr_read_b32 v251, a65
  v_mul_f32 v251, v251, v250
  v_mul_f32 v251, v251, v250
  v_accvgpr_write_b32 a65, v251
  v_accvgpr_read_b32 v251, a66
  v_mul_f32 v251, v251, v250
  v_mul_f32 v251, v251, v250
  v_accvgpr_write_b32 a66, v251
  v_accvgpr_read_b32 v251, a67
  v_mul_f32 v251, v251, v250
  v_mul_f32 v251, v251, v250
  v_accvgpr_write_b32 a67, v251
  v_accvgpr_read_b32 v251, a68
  v_mul_f32 v251, v251, v250
  v_mul_f32 v251, v251, v250
  v_accvgpr_write_b32 a68, v251
  v_accvgpr_read_b32 v251, a69
  v_mul_f32 v251, v251, v250
  v_mul_f32 v251, v251, v250
  v_accvgpr_write_b32 a69, v251
  v_accvgpr_read_b32 v251, a70
  v_mul_f32 v251, v251, v250
  v_mul_f32 v251, v251, v250
  v_accvgpr_write_b32 a70, v251
  v_accvgpr_read_b32 v251, a71
  v_mul_f32 v251, v251, v250
  v_mul_f32 v251, v251, v250
  v_accvgpr_write_b32 a71, v251
  v_accvgpr_read_b32 v251, a72
  v_mul_f32 v251, v251, v250
  v_mul_f32 v251, v251, v250
  v_accvgpr_write_b32 a72, v251
  v_accvgpr_read_b32 v251, a73
  v_mul_f32 v251, v251, v250
  v_mul_f32 v251, v251, v250
  v_accvgpr_write_b32 a73, v251
  v_accvgpr_read_b32 v251, a74
  v_mul_f32 v251, v251, v250
  v_mul_f32 v251, v251, v250
  v_accvgpr_write_b32 a74, v251
  v_accvgpr_read_b32 v251, a75
  v_mul_f32 v251, v251, v250
  v_mul_f32 v251, v251, v250
  v_accvgpr_write_b32 a75, v251
  v_accvgpr_read_b32 v251, a76
  v_mul_f32 v251, v251, v250
  v_mul_f32 v251, v251, v250
  v_accvgpr_write_b32 a76, v251
  v_accvgpr_read_b32 v251, a77
  v_mul_f32 v251, v251, v250
  v_mul_f32 v251, v251, v250
  v_accvgpr_write_b32 a77, v251
  v_accvgpr_read_b32 v251, a78
  v_mul_f32 v251, v251, v250
  v_mul_f32 v251, v251, v250
  v_accvgpr_write_b32 a78, v251
  v_accvgpr_read_b32 v251, a79
  v_mul_f32 v251, v251, v250
  v_mul_f32 v251, v251, v250
  v_accvgpr_write_b32 a79, v251
  v_accvgpr_read_b32 v251, a80
  v_mul_f32 v251, v251, v250
  v_mul_f32 v251, v251, v250
  v_accvgpr_write_b32 a80, v251
  v_accvgpr_read_b32 v251, a81
  v_mul_f32 v251, v251, v250
  v_mul_f32 v251, v251, v250
  v_accvgpr_write_b32 a81, v251
  v_accvgpr_read_b32 v251, a82
  v_mul_f32 v251, v251, v250
  v_mul_f32 v251, v251, v250
  v_accvgpr_write_b32 a82, v251
  v_accvgpr_read_b32 v251, a83
  v_mul_f32 v251, v251, v250
  v_mul_f32 v251, v251, v250
  v_accvgpr_write_b32 a83, v251
  v_accvgpr_read_b32 v251, a84
  v_mul_f32 v251, v251, v250
  v_mul_f32 v251, v251, v250
  v_accvgpr_write_b32 a84, v251
  v_accvgpr_read_b32 v251, a85
  v_mul_f32 v251, v251, v250
  v_mul_f32 v251, v251, v250
  v_accvgpr_write_b32 a85, v251
  v_accvgpr_read_b32 v251, a86
  v_mul_f32 v251, v251, v250
  v_mul_f32 v251, v251, v250
  v_accvgpr_write_b32 a86, v251
  v_accvgpr_read_b32 v251, a87
  v_mul_f32 v251, v251, v250
  v_mul_f32 v251, v251, v250
  v_accvgpr_write_b32 a87, v251
  v_accvgpr_read_b32 v251, a88
  v_mul_f32 v251, v251, v250
  v_mul_f32 v251, v251, v250
  v_accvgpr_write_b32 a88, v251
  v_accvgpr_read_b32 v251, a89
  v_mul_f32 v251, v251, v250
  v_mul_f32 v251, v251, v250
  v_accvgpr_write_b32 a89, v251
  v_accvgpr_read_b32 v251, a90
  v_mul_f32 v251, v251, v250
  v_mul_f32 v251, v251, v250
  v_accvgpr_write_b32 a90, v251
  v_accvgpr_read_b32 v251, a91
  v_mul_f32 v251, v251, v250
  v_mul_f32 v251, v251, v250
  v_accvgpr_write_b32 a91, v251
  v_accvgpr_read_b32 v251, a92
  v_mul_f32 v251, v251, v250
  v_mul_f32 v251, v251, v250
  v_accvgpr_write_b32 a92, v251
  v_accvgpr_read_b32 v251, a93
  v_mul_f32 v251, v251, v250
  v_mul_f32 v251, v251, v250
  v_accvgpr_write_b32 a93, v251
  v_accvgpr_read_b32 v251, a94
  v_mul_f32 v251, v251, v250
  v_mul_f32 v251, v251, v250
  v_accvgpr_write_b32 a94, v251
  v_accvgpr_read_b32 v251, a95
  v_mul_f32 v251, v251, v250
  v_mul_f32 v251, v251, v250
  v_accvgpr_write_b32 a95, v251
  v_accvgpr_read_b32 v251, a96
  v_mul_f32 v251, v251, v250
  v_mul_f32 v251, v251, v250
  v_accvgpr_write_b32 a96, v251
  v_accvgpr_read_b32 v251, a97
  v_mul_f32 v251, v251, v250
  v_mul_f32 v251, v251, v250
  v_accvgpr_write_b32 a97, v251
  v_accvgpr_read_b32 v251, a98
  v_mul_f32 v251, v251, v250
  v_mul_f32 v251, v251, v250
  v_accvgpr_write_b32 a98, v251
  v_accvgpr_read_b32 v251, a99
  v_mul_f32 v251, v251, v250
  v_mul_f32 v251, v251, v250
  v_accvgpr_write_b32 a99, v251
  v_accvgpr_read_b32 v251, a100
  v_mul_f32 v251, v251, v250
  v_mul_f32 v251, v251, v250
  v_accvgpr_write_b32 a100, v251
  v_accvgpr_read_b32 v251, a101
  v_mul_f32 v251, v251, v250
  v_mul_f32 v251, v251, v250
  v_accvgpr_write_b32 a101, v251
  v_accvgpr_read_b32 v251, a102
  v_mul_f32 v251, v251, v250
  v_mul_f32 v251, v251, v250
  v_accvgpr_write_b32 a102, v251
  v_accvgpr_read_b32 v251, a103
  v_mul_f32 v251, v251, v250
  v_mul_f32 v251, v251, v250
  v_accvgpr_write_b32 a103, v251
  v_accvgpr_read_b32 v251, a104
  v_mul_f32 v251, v251, v250
  v_mul_f32 v251, v251, v250
  v_accvgpr_write_b32 a104, v251
  v_accvgpr_read_b32 v251, a105
  v_mul_f32 v251, v251, v250
  v_mul_f32 v251, v251, v250
  v_accvgpr_write_b32 a105, v251
  v_accvgpr_read_b32 v251, a106
  v_mul_f32 v251, v251, v250
  v_mul_f32 v251, v251, v250
  v_accvgpr_write_b32 a106, v251
  v_accvgpr_read_b32 v251, a107
  v_mul_f32 v251, v251, v250
  v_mul_f32 v251, v251, v250
  v_accvgpr_write_b32 a107, v251
  v_accvgpr_read_b32 v251, a108
  v_mul_f32 v251, v251, v250
  v_mul_f32 v251, v251, v250
  v_accvgpr_write_b32 a108, v251
  v_accvgpr_read_b32 v251, a109
  v_mul_f32 v251, v251, v250
  v_mul_f32 v251, v251, v250
  v_accvgpr_write_b32 a109, v251
  v_accvgpr_read_b32 v251, a110
  v_mul_f32 v251, v251, v250
  v_mul_f32 v251, v251, v250
  v_accvgpr_write_b32 a110, v251
  v_accvgpr_read_b32 v251, a111
  v_mul_f32 v251, v251, v250
  v_mul_f32 v251, v251, v250
  v_accvgpr_write_b32 a111, v251
  v_accvgpr_read_b32 v251, a112
  v_mul_f32 v251, v251, v250
  v_mul_f32 v251, v251, v250
  v_accvgpr_write_b32 a112, v251
  v_accvgpr_read_b32 v251, a113
  v_mul_f32 v251, v251, v250
  v_mul_f32 v251, v251, v250
  v_accvgpr_write_b32 a113, v251
  v_accvgpr_read_b32 v251, a114
  v_mul_f32 v251, v251, v250
  v_mul_f32 v251, v251, v250
  v_accvgpr_write_b32 a114, v251
  v_accvgpr_read_b32 v251, a115
  v_mul_f32 v251, v251, v250
  v_mul_f32 v251, v251, v250
  v_accvgpr_write_b32 a115, v251
  v_accvgpr_read_b32 v251, a116
  v_mul_f32 v251, v251, v250
  v_mul_f32 v251, v251, v250
  v_accvgpr_write_b32 a116, v251
  v_accvgpr_read_b32 v251, a117
  v_mul_f32 v251, v251, v250
  v_mul_f32 v251, v251, v250
  v_accvgpr_write_b32 a117, v251
  v_accvgpr_read_b32 v251, a118
  v_mul_f32 v251, v251, v250
  v_mul_f32 v251, v251, v250
  v_accvgpr_write_b32 a118, v251
  v_accvgpr_read_b32 v251, a119
  v_mul_f32 v251, v251, v250
  v_mul_f32 v251, v251, v250
  v_accvgpr_write_b32 a119, v251
  v_accvgpr_read_b32 v251, a120
  v_mul_f32 v251, v251, v250
  v_mul_f32 v251, v251, v250
  v_accvgpr_write_b32 a120, v251
  v_accvgpr_read_b32 v251, a121
  v_mul_f32 v251, v251, v250
  v_mul_f32 v251, v251, v250
  v_accvgpr_write_b32 a121, v251
  v_accvgpr_read_b32 v251, a122
  v_mul_f32 v251, v251, v250
  v_mul_f32 v251, v251, v250
  v_accvgpr_write_b32 a122, v251
  v_accvgpr_read_b32 v251, a123
  v_mul_f32 v251, v251, v250
  v_mul_f32 v251, v251, v250
  v_accvgpr_write_b32 a123, v251
  v_accvgpr_read_b32 v251, a124
  v_mul_f32 v251, v251, v250
  v_mul_f32 v251, v251, v250
  v_accvgpr_write_b32 a124, v251
  v_accvgpr_read_b32 v251, a125
  v_mul_f32 v251, v251, v250
  v_mul_f32 v251, v251, v250
  v_accvgpr_write_b32 a125, v251
  v_accvgpr_read_b32 v251, a126
  v_mul_f32 v251, v251, v250
  v_mul_f32 v251, v251, v250
  v_accvgpr_write_b32 a126, v251
  v_accvgpr_read_b32 v251, a127
  v_mul_f32 v251, v251, v250
  v_mul_f32 v251, v251, v250
  v_accvgpr_write_b32 a127, v251
  v_mul_f32 v244, v244, v250
  v_mul_f32 v244, v244, v250
  v_sub_f32 v80, v80, v249
  v_sub_f32 v16, v16, v249
  v_sub_f32 v48, v48, v249
  v_sub_f32 v81, v81, v249
  v_sub_f32 v17, v17, v249
  v_sub_f32 v49, v49, v249
  v_sub_f32 v82, v82, v249
  v_sub_f32 v18, v18, v249
  v_sub_f32 v50, v50, v249
  v_sub_f32 v83, v83, v249
  v_sub_f32 v19, v19, v249
  v_sub_f32 v51, v51, v249
  v_sub_f32 v84, v84, v249
  v_sub_f32 v20, v20, v249
  v_sub_f32 v52, v52, v249
  v_sub_f32 v85, v85, v249
  v_sub_f32 v21, v21, v249
  v_sub_f32 v53, v53, v249
  v_sub_f32 v86, v86, v249
  v_sub_f32 v22, v22, v249
  v_sub_f32 v54, v54, v249
  v_sub_f32 v87, v87, v249
  v_sub_f32 v23, v23, v249
  v_sub_f32 v55, v55, v249
  v_sub_f32 v88, v88, v249
  v_sub_f32 v24, v24, v249
  v_sub_f32 v56, v56, v249
  v_sub_f32 v89, v89, v249
  v_sub_f32 v25, v25, v249
  v_sub_f32 v57, v57, v249
  v_sub_f32 v90, v90, v249
  v_sub_f32 v26, v26, v249
  v_sub_f32 v58, v58, v249
  v_sub_f32 v91, v91, v249
  v_sub_f32 v27, v27, v249
  v_sub_f32 v59, v59, v249
  v_sub_f32 v92, v92, v249
  v_sub_f32 v28, v28, v249
  v_sub_f32 v60, v60, v249
  v_sub_f32 v93, v93, v249
  v_sub_f32 v29, v29, v249
  v_sub_f32 v61, v61, v249
  v_sub_f32 v94, v94, v249
  v_sub_f32 v30, v30, v249
  v_sub_f32 v62, v62, v249
  v_sub_f32 v95, v95, v249
  v_sub_f32 v31, v31, v249
  v_sub_f32 v63, v63, v249
  v_exp_f32 v128, v48
  v_exp_f32 v129, v49
  s_nop 0
  v_add_f32 v242, v128, v129
  v_cvt_pk_bf16_f32 v120, v128, v129
  v_exp_f32 v128, v50
  v_exp_f32 v129, v51
  s_nop 0
  v_add_f32 v242, v242, v128
  v_add_f32 v242, v242, v129
  v_cvt_pk_bf16_f32 v121, v128, v129
  v_exp_f32 v128, v52
  v_exp_f32 v129, v53
  s_nop 0
  v_add_f32 v242, v242, v128
  v_add_f32 v242, v242, v129
  v_cvt_pk_bf16_f32 v122, v128, v129
  v_exp_f32 v128, v54
  v_exp_f32 v129, v55
  s_nop 0
  v_add_f32 v242, v242, v128
  v_add_f32 v242, v242, v129
  v_cvt_pk_bf16_f32 v123, v128, v129
  v_exp_f32 v128, v56
  v_exp_f32 v129, v57
  s_nop 0
  v_add_f32 v242, v242, v128
  v_add_f32 v242, v242, v129
  v_cvt_pk_bf16_f32 v124, v128, v129
  v_exp_f32 v128, v58
  v_exp_f32 v129, v59
  s_nop 0
  v_add_f32 v242, v242, v128
  v_add_f32 v242, v242, v129
  v_cvt_pk_bf16_f32 v125, v128, v129
  v_exp_f32 v128, v60
  v_exp_f32 v129, v61
  s_nop 0
  v_add_f32 v242, v242, v128
  v_add_f32 v242, v242, v129
  v_cvt_pk_bf16_f32 v126, v128, v129
  v_exp_f32 v128, v62
  v_exp_f32 v129, v63
  s_nop 0
  v_add_f32 v242, v242, v128
  v_add_f32 v242, v242, v129
  v_cvt_pk_bf16_f32 v127, v128, v129
  s_nop 1
  s_setpc_b64 s[46:47]
CODE_END:
  s_endpgm
.section .rodata,"a"
.p2align 6
.amdhsa_kernel adaLN_cond__mha_block_cached__swiglu_ffn__prompt_kernel
  .amdhsa_next_free_vgpr 512
  .amdhsa_next_free_sgpr 102
  .amdhsa_accum_offset 256
  .amdhsa_group_segment_fixed_size 0
  .amdhsa_kernarg_size 112
  .amdhsa_user_sgpr_count 2
  .amdhsa_user_sgpr_kernarg_segment_ptr 1
  .amdhsa_system_sgpr_workgroup_id_x 1
.end_amdhsa_kernel
```
